```python
import torch

def _softmax(x, axis=-1):
    return torch.softmax(x, dim=axis)
def _gelu(x):
    return torch.nn.functional.gelu(x, approximate="tanh")
def _silu(x):
    return torch.nn.functional.silu(x)
def _sigmoid(x):
    return torch.sigmoid(x)
def _layernorm(x, axis=-1, eps=1e-5):
    m = x.mean(dim=axis, keepdim=True)
    v = x.var(dim=axis, keepdim=True, unbiased=False)
    return (x - m) / torch.sqrt(v + eps)
def _scatter_add(tgt, idx, src, axis=0):
    return tgt.clone().index_add_(axis, idx, src)
def _segment_sum(src, seg, n):
    out = torch.zeros((n,) + src.shape[1:], dtype=src.dtype)
    return out.index_add_(0, seg, src)
def _pad(x, pw):
    flat = tuple(v for pair in reversed(pw) for v in pair)
    return torch.nn.functional.pad(x, flat)

kernel_name = 'gated_mix__ssm_conv_h3__glu_gated_swiglu__prompt'

def setup_inputs():

    _w = (lambda a: (lambda t: t.to(torch.bfloat16) if t.is_floating_point() else t)(torch.as_tensor(a)))
    def _A_setup():
        B, S, D = 1, 2048, 576
        ks = 4
        return {
            "q": _w((lambda *s: torch.randn(*s, dtype=torch.bfloat16) * 0.05)(B, S, D)),
            "k": _w((lambda *s: torch.randn(*s, dtype=torch.bfloat16) * 0.05)(B, S, D)),
            "v": _w((lambda *s: torch.randn(*s, dtype=torch.bfloat16) * 0.05)(B, S, D)),
            "shift_k": _w((lambda *s: torch.randn(*s, dtype=torch.bfloat16) * 0.05)(D, ks) * 0.5),
            "ssm_k": _w((lambda *s: torch.randn(*s, dtype=torch.bfloat16) * 0.05)(D, S) * (1.0 / S ** 0.5)),
            "ssm_D": _w((lambda *s: torch.randn(*s, dtype=torch.bfloat16) * 0.05)(D)),
        }
    _A_in = _A_setup()

    def _B_setup():
        B, S, D, F = 1, 2048, 576, 4608
        return {
            "x": _w((lambda *s: torch.randn(*s, dtype=torch.bfloat16) * 0.05)(B, S, D)),
            "w1": _w((lambda *s: torch.randn(*s, dtype=torch.bfloat16) * 0.05)(D, F) * (2.0 / D) ** 0.5),
            "w3": _w((lambda *s: torch.randn(*s, dtype=torch.bfloat16) * 0.05)(D, F) * (2.0 / D) ** 0.5),
            "w2": _w((lambda *s: torch.randn(*s, dtype=torch.bfloat16) * 0.05)(F, D) * (2.0 / F) ** 0.5),
        }
    _B_in = _B_setup()

    return {
        "A_q": _A_in["q"],
        "A_k": _A_in["k"],
        "A_v": _A_in["v"],
        "A_shift_k": _A_in["shift_k"],
        "A_ssm_k": _A_in["ssm_k"],
        "A_ssm_D": _A_in["ssm_D"],
        "B_x": _B_in["x"],
        "B_w1": _B_in["w1"],
        "B_w3": _B_in["w3"],
        "B_w2": _B_in["w2"],
        "gate_w": _w((lambda *s: torch.randn(*s, dtype=torch.bfloat16) * 0.05)(576) * 16.0),
    }

def reference(A_q, A_k, A_v, A_shift_k, A_ssm_k, A_ssm_D, B_x, B_w1, B_w3, B_w2, gate_w):
    def _A_ref(q, k, v, shift_k, ssm_k, ssm_D):
        B, S, D = q.shape
        ks = shift_k.shape[-1]
        k_pad = _pad(k, ((0, 0), (ks - 1, 0), (0, 0)))
        k_shift = torch.zeros_like(k)
        for t in range(ks):
            k_shift = k_shift + k_pad[:, t:t + S, :] * shift_k[:, ks - 1 - t][None, None, :]
        kv = k_shift * v
        L = 2 * S
        kv_pad = _pad(kv, ((0, 0), (0, S), (0, 0)))
        kf_pad = _pad(ssm_k, ((0, 0), (0, S)))
        kv_f = (lambda x, axes=(-2,-1): torch.fft.rfft2(x.float(), dim=axes))(kv_pad[:, None, :, :], axes=(1, 2))
        kf_f = (lambda x, axes=(-2,-1): torch.fft.rfft2(x.float(), dim=axes))(kf_pad[:, None, :], axes=(1, 2))
        kf_f = (lambda x, *d: x.permute(*d))(kf_f, 1, 2, 0)
        y_f = kv_f * kf_f[None, :, :, :]
        y = (lambda x, s, axes=(-2,-1): torch.fft.irfft2(x, s=s, dim=axes).to(torch.bfloat16))(y_f, (1, L), axes=(1, 2))[:, 0, :S, :]
        y = y + kv * ssm_D[None, None, :]
        return q * y

    def _B_ref(x, w1, w3, w2):
        gate = torch.einsum("bsd,df->bsf", x, w1)
        up = torch.einsum("bsd,df->bsf", x, w3)
        h = _silu(gate) * up
        out = torch.einsum("bsf,fd->bsd", h, w2)
        return out

    x = A_q
    g = _sigmoid((x * gate_w).sum(-1, keepdims=True))
    a = _A_ref(x, A_k, A_v, A_shift_k, A_ssm_k, A_ssm_D)
    b = _B_ref(x, B_w1, B_w3, B_w2)
    return g * a + (1 - g) * b
```

```asm
; @launch kernel=fused_kernel grid=(256,1,1) block=(512,1,1) lds=163840
.amdgcn_target "amdgcn-amd-amdhsa--gfx950"
.text
.globl fused_kernel
.p2align 8
.type fused_kernel,@function
fused_kernel:
    s_cmp_ge_u32 s2, 256
    s_cbranch_scc0 fused_kernel_go
    s_endpgm
fused_kernel_go:
    s_mov_b32 s96, s2
    s_and_b32 s23, s96, 7
    s_lshr_b32 s29, s96, 3
    s_lshr_b32 s49, s23, 1
    s_and_b32 s32, s23, 1
    s_lshl_b32 s28, s32, 5
    s_add_u32 s28, s28, s29
    s_cmp_eq_u32 s28, 63
    s_cbranch_scc1 fused_kernel_gate
    s_load_dwordx2 s[8:9], s[0:1], 0
    s_load_dwordx4 s[24:27], s[0:1], 56
    s_load_dwordx2 s[6:7], s[0:1], 104
    s_load_dwordx2 s[92:93], s[0:1], 96
    s_load_dwordx2 s[12:13], s[0:1], 72
    s_load_dwordx2 s[88:89], s[0:1], 32
    s_mul_i32 s30, s49, 63
    s_add_u32 s28, s28, s30
    v_lshrrev_b32 v10, 6, v0
    v_and_b32 v11, 63, v0
    v_readfirstlane_b32 s22, v10
    s_mul_i32 s29, s28, 9363
    s_lshr_b32 s30, s29, 16
    s_mul_i32 s29, s30, 7
    s_sub_u32 s31, s28, s29
    s_mul_i32 s52, s31, 18
    s_cmp_eq_u32 s31, 6
    s_cselect_b32 s29, 2, 0
    s_add_u32 s52, s52, s29
    s_add_u32 s34, s49, s30
    s_and_b32 s34, s34, 1
    s_lshl_b32 s34, s34, 2
    s_xor_b32 s35, s34, 4
    s_mul_i32 s29, s32, 10
    s_add_u32 s50, s52, s29
    s_add_u32 s47, s50, s34
    s_add_u32 s50, s50, s35
    s_sub_u32 s29, 10, s29
    s_add_u32 s90, s52, s29
    s_add_u32 s51, s90, s34
    s_add_u32 s90, s90, s35
    s_add_u32 s52, s52, 8
    s_add_u32 s53, s31, 103
    s_add_u32 s34, s47, s22
    s_add_u32 s35, s52, s22
    s_sub_u32 s35, s35, 4
    s_cmp_lt_u32 s22, 4
    s_cselect_b32 s34, s34, s35
    s_cmp_lt_u32 s31, 5
    s_cselect_b32 s35, s50, s53
    s_cmp_lt_u32 s22, 6
    s_cselect_b32 s34, s34, s35
    s_mul_i32 s39, s34, 18432
    s_add_u32 s34, s30, s31
    s_mul_i32 s35, s34, 21846
    s_lshr_b32 s35, s35, 16
    s_mul_i32 s35, s35, 3
    s_sub_u32 s34, s34, s35
    s_mul_i32 s49, s34, 3
    s_mul_i32 s36, s34, 1769472
    s_mul_i32 s4, s34, 384
    s_add_u32 s34, s34, 1
    s_cmp_eq_u32 s34, 3
    s_cselect_b32 s34, 0, s34
    s_mul_i32 s37, s34, 1769472
    s_mul_i32 s5, s34, 384
    s_add_u32 s34, s34, 1
    s_cmp_eq_u32 s34, 3
    s_cselect_b32 s34, 0, s34
    s_mul_i32 s38, s34, 1769472
    s_mul_i32 s48, s34, 384
    v_lshrrev_b32 v12, 4, v11
    v_and_b32 v13, 15, v11
    s_and_b32 s33, s22, 3
    s_lshl_b32 s33, s33, 4
    v_add_u32 v14, s33, v12
    v_mul_u32_u24 v14, 9216, v14
    s_lshl_b32 s33, s30, 8
    v_add_u32 v14, s33, v14
    v_lshlrev_b32 v15, 1, v12
    v_xor_b32 v15, v15, v13
    v_lshl_add_u32 v1, v15, 4, v14
    v_xor_b32 v15, 8, v15
    v_lshl_add_u32 v14, v15, 4, v14
    v_add_u32 v2, 71680, v14
    v_lshrrev_b32 v14, 3, v11
    v_and_b32 v15, 7, v11
    v_xor_b32 v15, v15, v12
    v_mul_u32_u24 v14, 1152, v14
    v_lshl_add_u32 v3, v15, 4, v14
    v_xor_b32 v15, 4, v15
    v_lshl_add_u32 v14, v15, 4, v14
    v_add_u32 v4, 8192, v14
    s_lshr_b32 s33, s22, 2
    s_lshl_b32 s97, s22, 12
    s_lshl_b32 s42, s22, 11
    s_cmp_eq_u32 s22, 7
    s_cselect_b64 s[64:65], 0, -1
    s_mov_b32 s10, 2359296
    s_mov_b32 s11, 0x00020000
    s_cmp_eq_u32 s33, 0
    s_waitcnt lgkmcnt(0)
    s_cselect_b32 s24, s24, s26
    s_cselect_b32 s25, s25, s27
    s_and_b32 s25, s25, 0xffff
    s_mov_b32 s26, 5308416
    s_mov_b32 s27, 0x00020000
    s_and_b32 s9, s9, 0xffff
    s_add_u32 m0, s97, 0
    s_add_u32 s21, s36, 35840
    s_add_u32 s20, s36, 0
    buffer_load_dwordx4 v1, s[24:27], s20 offen lds
    buffer_load_dwordx4 v1, s[24:27], s21 offen offset:1024 lds
    buffer_load_dwordx4 v2, s[24:27], s20 offen offset:2048 lds
    buffer_load_dwordx4 v2, s[24:27], s21 offen offset:3072 lds
    s_add_u32 m0, s42, 98304
    s_add_u32 s45, s39, s4
    s_add_u32 s45, s45, 0
    s_mov_b64 exec, s[64:65]
    buffer_load_dwordx4 v3, s[8:11], s45 offen lds
    s_mov_b64 exec, -1
    s_mov_b64 exec, s[64:65]
    buffer_load_dwordx4 v4, s[8:11], s45 offen offset:1024 lds
    s_mov_b64 exec, -1
    v_bfe_u32 v14, v11, 3, 1
    s_lshl_b32 s34, s22, 1
    v_add_u32 v14, s34, v14
    v_mul_u32_u24 v14, 1152, v14
    v_and_b32 v15, 7, v11
    v_xor_b32 v15, s22, v15
    v_lshl_add_u32 v5, v15, 4, v14
    s_add_u32 s34, s49, s22
    s_sub_u32 s35, s34, 9
    s_cmp_ge_u32 s34, 9
    s_cselect_b32 s34, s35, s34
    s_lshl_b32 s63, s34, 7
    s_add_u32 s49, s48, 256
    v_lshrrev_b32 v14, 2, v13
    v_and_b32 v15, 1, v12
    v_lshl_add_u32 v15, v15, 2, v14
    v_xor_b32 v15, s22, v15
    v_lshl_add_u32 v14, v12, 3, v14
    v_lshlrev_b32 v14, 8, v14
    v_lshl_add_u32 v14, v15, 5, v14
    v_and_b32 v15, 3, v11
    v_lshl_add_u32 v6, v15, 3, v14
    v_add_u32 v22, 0x10000, v6
    v_lshrrev_b32 v14, 1, v13
    v_xor_b32 v14, v14, v12
    v_lshlrev_b32 v15, 7, v13
    v_lshl_add_u32 v14, v14, 4, v15
    v_add_u32 v7, 98304, v14
    v_xor_b32 v8, 64, v7
    s_lshl_b32 s34, s30, 3
    s_add_u32 s34, s34, s22
    s_lshr_b32 s35, s34, 2
    s_lshl_b32 s35, s35, 18
    s_and_b32 s34, s34, 3
    s_lshl_b32 s34, s34, 9
    s_add_u32 s34, s34, s35
    v_lshlrev_b32 v14, 5, v13
    v_lshrrev_b32 v15, 1, v12
    v_lshl_add_u32 v14, v15, 4, v14
    v_and_b32 v15, 1, v12
    v_lshl_add_u32 v14, v15, 11, v14
    v_add_u32 v23, s34, v14
    s_lshl_b32 s43, s22, 8
    s_add_u32 s43, s43, 16384
    s_mov_b32 s46, 0xbfb8aa3b
    s_lshl_b32 s47, s47, 11
    s_lshl_b32 s52, s52, 11
    s_lshl_b32 s53, s53, 11
    s_lshl_b32 s50, s50, 11
    s_lshl_b32 s51, s51, 11
    s_lshl_b32 s90, s90, 11
    s_mov_b32 s16, s6
    s_and_b32 s17, s7, 0xffff
    s_mov_b32 s18, 18874368
    s_mov_b32 s19, 0x00020000
    s_and_b32 s93, s93, 0xffff
    s_movk_i32 s94, 256
    s_mov_b32 s95, 0x00020000
    s_lshl_b32 s2, s28, 7
    s_cmp_eq_u32 s22, 0
    s_cselect_b32 s100, -1, 0
    s_mov_b32 s101, 0
    s_lshr_b32 s34, s96, 3
    s_bitcmp1_b32 s96, 0
    s_mov_b32 s35, 50727960
    s_cselect_b32 s35, 2418041025, s35
    s_lshr_b32 s76, s35, s34
    s_and_b32 s76, s76, 1
    s_bfm_b32 s78, s34, 0
    s_and_b32 s78, s78, s35
    s_bcnt1_i32_b32 s78, s78
    s_sub_u32 s34, s34, s78
    s_and_b32 s35, s96, 7
    s_mul_i32 s77, s35, 24
    s_add_u32 s77, s77, s34
    s_lshl_b32 s35, s35, 3
    s_add_u32 s78, s78, s35
    s_add_u32 s35, s78, 192
    s_cmp_eq_u32 s76, 1
    s_cselect_b32 s78, s78, s34
    s_cselect_b32 s77, s35, s77
    s_lshl_b32 s99, s77, 7
    s_add_u32 s99, s99, 32768
    s_mul_i32 s69, s77, 40960
    s_mul_i32 s34, s22, 5120
    s_add_u32 s69, s69, s34
    s_add_u32 s56, s6, 20971520
    s_addc_u32 s57, s7, 0
    s_and_b32 s57, s57, 0xffff
    s_mov_b32 s58, 10493952
    s_mov_b32 s59, 0x00020000
    v_mov_b32 v12, -1
    v_mov_b32 v13, -1
    v_mov_b32 v14, -1
    v_mov_b32 v15, -1
    v_lshlrev_b32 v16, 4, v11
    s_mov_b32 s98, s31
    s_cmp_lt_u32 s31, 4
    s_cselect_b64 s[66:67], -1, 0
    s_lshr_b32 s34, s96, 3
    s_lshl_b32 s34, s34, 3
    s_add_u32 s34, s34, s22
    s_lshr_b32 s35, s23, 1
    s_mul_i32 s35, s35, 162
    s_add_u32 s91, s35, s34
    s_lshl_b32 s35, s23, 5
    s_add_u32 s35, s35, s34
    s_sub_u32 s35, s35, 162
    s_lshl_b32 s29, s23, 2
    s_add_u32 s29, s29, s34
    s_add_u32 s29, s29, 62
    s_cmp_lt_u32 s34, 194
    s_cselect_b32 s35, s35, s29
    s_mov_b32 s30, 2359296
    s_cmp_lt_u32 s34, 162
    s_cselect_b32 s91, s91, s35
    s_cselect_b32 s28, s12, s88
    s_cselect_b32 s29, s13, s89
    s_cselect_b32 s30, 5308416, s30
    s_and_b32 s29, s29, 0xffff
    s_lshl_b32 s91, s91, 13
    s_cmp_lt_u32 s34, 198
    s_cselect_b32 s30, s30, 0
    s_mov_b32 s31, 0x00020000
    s_add_u32 m0, s97, 32768
    s_add_u32 s21, s36, 625664
    s_add_u32 s20, s36, 589824
    buffer_load_dwordx4 v1, s[24:27], s20 offen lds
    buffer_load_dwordx4 v1, s[24:27], s21 offen offset:1024 lds
    buffer_load_dwordx4 v2, s[24:27], s20 offen offset:2048 lds
    buffer_load_dwordx4 v2, s[24:27], s21 offen offset:3072 lds
    s_add_u32 m0, s42, 112640
    s_add_u32 s45, s39, s4
    s_add_u32 s45, s45, 128
    s_mov_b64 exec, s[64:65]
    buffer_load_dwordx4 v3, s[8:11], s45 offen lds
    s_mov_b64 exec, -1
    s_mov_b64 exec, s[64:65]
    buffer_load_dwordx4 v4, s[8:11], s45 offen offset:1024 lds
    s_mov_b64 exec, -1
    s_cmp_eq_u32 s76, 1
    s_cbranch_scc1 fused_kernel_rsc
    s_and_b32 s32, s96, 1
    s_bfe_u32 s79, s96, 0x20001
    s_mul_i32 s85, s78, 43
    s_lshr_b32 s85, s85, 7
    s_and_b32 s85, s85, 7
    s_mul_i32 s34, s85, 3
    s_sub_u32 s86, s78, s34
    s_min_u32 s86, s86, 2
    s_and_b32 s84, s22, 3
    s_and_b32 s34, s85, 3
    s_lshl_b32 s34, s34, 1
    s_lshr_b32 s35, s84, 1
    s_add_u32 s87, s34, s35
    s_lshr_b32 s34, s85, 2
    s_lshl_b32 s34, s34, 1
    s_and_b32 s35, s84, 1
    s_add_u32 s34, s34, s35
    s_lshl_b32 s35, s32, 2
    s_add_u32 s35, s35, s34
    s_add_u32 s34, s35, s32
    s_cmp_eq_u32 s87, 7
    s_cselect_b32 s89, 1, 0
    s_cselect_b32 s87, s35, s87
    s_cselect_b32 s34, 4, s34
    s_mul_i32 s3, s87, 9
    s_add_u32 s3, s3, s34
    s_cmp_eq_u32 s87, 6
    s_addc_u32 s3, s3, 0
    s_mov_b32 s88, s87
    s_cmp_eq_u32 s87, 7
    s_cselect_b32 s3, 54, s3
    s_cselect_b32 s87, 5, s87
    s_cselect_b32 s88, 6, s88
    s_lshl_b32 s3, s3, 12
    s_mul_i32 s34, s79, 4718592
    s_add_u32 s3, s3, s34
    s_and_b32 s34, s79, 1
    s_lshl_b32 s34, s34, 11
    s_add_u32 s60, s3, s34
    s_sub_u32 s61, s3, s34
    s_lshr_b32 s34, s84, 1
    s_lshl_b32 s34, s34, 2
    s_and_b32 s35, s84, 1
    s_add_u32 s35, s35, s34
    s_mul_i32 s62, s79, 1327104
    s_mul_i32 s34, s35, 9216
    s_add_u32 s62, s62, s34
    s_mul_i32 s34, s86, 384
    s_add_u32 s62, s62, s34
    s_mul_i32 s41, s35, 3072
    s_add_u32 s41, s41, 16384
    s_lshr_b32 s34, s79, 1
    s_xor_b32 s34, s34, s84
    s_lshl_b32 s40, s34, 12
    s_sub_u32 s12, s12, 2048
    s_subb_u32 s13, s13, 0
    s_and_b32 s13, s13, 0xffff
    s_mov_b32 s14, 5310464
    s_mov_b32 s15, 0x00020000
    s_cmp_lt_u32 s85, 4
    s_mov_b32 s34, 1685397553
    s_cselect_b32 s34, 1482961184, s34
    s_mov_b32 s35, 605251671
    s_cselect_b32 s35, 807688040, s35
    s_cmp_eq_u32 s32, 0
    s_cselect_b32 s54, s34, s35
    s_cmp_lt_u32 s85, 4
    s_mov_b32 s34, 8
    s_cselect_b32 s34, 7, s34
    s_mov_b32 s35, 0
    s_cselect_b32 s35, 1, s35
    s_cmp_eq_u32 s32, 0
    s_cselect_b32 s55, s34, s35
    v_and_b32 v24, 63, v0
    v_add_u32 v24, 0, v24
    v_mul_u32_u24 v25, 2731, v24
    v_lshrrev_b32 v25, 16, v25
    v_mul_u32_u24 v26, 24, v25
    v_sub_u32 v24, v24, v26
    v_and_b32 v26, 2, v25
    v_xor_b32 v24, v24, v26
    v_bfe_u32 v26, v0, 6, 1
    v_lshlrev_b32 v26, 2, v26
    v_xor_b32 v24, v24, v26
    v_mul_u32_u24 v25, 1152, v25
    v_add_u32 v25, 2048, v25
    v_lshl_add_u32 v104, v24, 4, v25
    v_and_b32 v28, 63, v0
    v_add_u32 v28, 64, v28
    v_mul_u32_u24 v29, 2731, v28
    v_lshrrev_b32 v29, 16, v29
    v_mul_u32_u24 v30, 24, v29
    v_sub_u32 v28, v28, v30
    v_and_b32 v30, 2, v29
    v_xor_b32 v28, v28, v30
    v_bfe_u32 v30, v0, 6, 1
    v_lshlrev_b32 v30, 2, v30
    v_xor_b32 v28, v28, v30
    v_mul_u32_u24 v29, 1152, v29
    v_add_u32 v29, 1024, v29
    v_lshl_add_u32 v105, v28, 4, v29
    v_and_b32 v32, 63, v0
    v_add_u32 v32, 128, v32
    v_mul_u32_u24 v33, 2731, v32
    v_lshrrev_b32 v33, 16, v33
    v_mul_u32_u24 v34, 24, v33
    v_sub_u32 v32, v32, v34
    v_and_b32 v34, 2, v33
    v_xor_b32 v32, v32, v34
    v_bfe_u32 v34, v0, 6, 1
    v_lshlrev_b32 v34, 2, v34
    v_xor_b32 v32, v32, v34
    v_mul_u32_u24 v33, 1152, v33
    v_add_u32 v33, 0, v33
    v_lshl_add_u32 v106, v32, 4, v33
    v_and_b32 v36, 15, v0
    v_lshlrev_b32 v36, 2, v36
    v_lshrrev_b64 v[38:39], v36, s[54:55]
    v_and_b32 v36, 15, v38
    v_mov_b32 v37, s87
    v_mov_b32 v38, s88
    v_and_b32 v39, 16, v0
    v_cmp_eq_u32 vcc, 0, v39
    s_nop 1
    v_cndmask_b32 v37, v38, v37, vcc
    v_mad_u32_u24 v37, v36, 7, v37
    v_lshrrev_b32 v39, 5, v37
    s_mul_i32 s34, s79, 8064
    v_lshl_add_u32 v37, v37, 7, s34
    s_lshr_b32 s34, s85, 2
    v_xor_b32 v36, s34, v36
    v_and_b32 v36, 1, v36
    v_xor_b32 v39, s32, v39
    v_mad_u32_u24 v36, v39, 3, v36
    s_cmp_eq_u32 s89, 1
    s_cselect_b64 vcc, -1, 0
    v_cndmask_b32 v36, v36, 2, vcc
    v_lshl_add_u32 v107, v36, 2, v37
    s_cmp_eq_u32 s87, s88
    s_cselect_b32 s76, 0xffff0000, 0
    v_and_b32 v24, 31, v0
    v_bfe_i32 v110, s76, v24, 1
    s_waitcnt vmcnt(6) lgkmcnt(0)
    s_barrier
    s_cmp_ge_u32 s98, 5
    s_cbranch_scc1 fused_kernel_g19
fused_kernel_g18:
    ds_read_b64_tr_b16 v[112:113], v6 offset:0
    ds_read_b64_tr_b16 v[114:115], v6 offset:1024
    ds_read_b128 v[24:27], v7 offset:0
    ds_read_b64_tr_b16 v[184:185], v6 offset:16384
    ds_read_b64_tr_b16 v[186:187], v6 offset:17408
    ds_read_b128 v[28:31], v7 offset:2048
    ds_read_b128 v[32:35], v7 offset:4096
    ds_read_b128 v[36:39], v7 offset:6144
    ds_read_b128 v[40:43], v7 offset:8192
    ds_read_b128 v[44:47], v7 offset:10240
    ds_read_b64_tr_b16 v[116:117], v6 offset:8192
    ds_read_b64_tr_b16 v[118:119], v6 offset:9216
    ds_read_b64_tr_b16 v[188:189], v6 offset:24576
    ds_read_b64_tr_b16 v[190:191], v6 offset:25600
    s_cmp_eq_u32 s33, 0
    s_cbranch_scc1 fused_kernel_skipYg18
    s_add_u32 m0, s97, 65536
    s_add_u32 s21, s36, 1215488
    s_add_u32 s20, s36, 1179648
    buffer_load_dwordx4 v1, s[24:27], s20 offen lds
    buffer_load_dwordx4 v1, s[24:27], s21 offen offset:1024 lds
    buffer_load_dwordx4 v2, s[24:27], s20 offen offset:2048 lds
    buffer_load_dwordx4 v2, s[24:27], s21 offen offset:3072 lds
    s_add_u32 m0, s42, 126976
    s_add_u32 s45, s39, s4
    s_add_u32 s45, s45, 256
    s_mov_b64 exec, s[64:65]
    buffer_load_dwordx4 v3, s[8:11], s45 offen lds
    s_mov_b64 exec, -1
    s_mov_b64 exec, s[64:65]
    buffer_load_dwordx4 v4, s[8:11], s45 offen offset:1024 lds
    s_mov_b64 exec, -1
    s_waitcnt vmcnt(6) lgkmcnt(0)
    s_barrier
fused_kernel_skipYg18:
    s_setprio 1
    s_waitcnt lgkmcnt(11)
    v_mfma_f32_16x16x32_bf16 v[48:51], v[112:115], v[24:27], 0
    s_waitcnt lgkmcnt(9)
    v_mfma_f32_16x16x32_bf16 v[52:55], v[184:187], v[24:27], 0
    ds_read_b128 v[24:27], v7 offset:12288
    s_waitcnt lgkmcnt(9)
    v_mfma_f32_16x16x32_bf16 v[56:59], v[112:115], v[28:31], 0
    v_mfma_f32_16x16x32_bf16 v[60:63], v[184:187], v[28:31], 0
    ds_read_b128 v[28:31], v8 offset:0
    s_waitcnt lgkmcnt(9)
    v_mfma_f32_16x16x32_bf16 v[64:67], v[112:115], v[32:35], 0
    v_mfma_f32_16x16x32_bf16 v[68:71], v[184:187], v[32:35], 0
    ds_read_b128 v[32:35], v8 offset:2048
    s_waitcnt lgkmcnt(9)
    v_mfma_f32_16x16x32_bf16 v[72:75], v[112:115], v[36:39], 0
    v_mfma_f32_16x16x32_bf16 v[76:79], v[184:187], v[36:39], 0
    ds_read_b128 v[36:39], v8 offset:4096
    s_waitcnt lgkmcnt(9)
    v_mfma_f32_16x16x32_bf16 v[80:83], v[112:115], v[40:43], 0
    v_mfma_f32_16x16x32_bf16 v[84:87], v[184:187], v[40:43], 0
    ds_read_b128 v[40:43], v8 offset:6144
    s_waitcnt lgkmcnt(9)
    v_mfma_f32_16x16x32_bf16 v[88:91], v[112:115], v[44:47], 0
    v_mfma_f32_16x16x32_bf16 v[92:95], v[184:187], v[44:47], 0
    ds_read_b128 v[44:47], v8 offset:8192
    s_waitcnt lgkmcnt(5)
    v_mfma_f32_16x16x32_bf16 v[96:99], v[112:115], v[24:27], 0
    v_mfma_f32_16x16x32_bf16 v[100:103], v[184:187], v[24:27], 0
    ds_read_b128 v[24:27], v8 offset:10240
    s_waitcnt lgkmcnt(5)
    v_mfma_f32_16x16x32_bf16 v[48:51], v[116:119], v[28:31], v[48:51]
    v_mfma_f32_16x16x32_bf16 v[52:55], v[188:191], v[28:31], v[52:55]
    ds_read_b128 v[28:31], v8 offset:12288
    s_waitcnt lgkmcnt(5)
    v_mfma_f32_16x16x32_bf16 v[56:59], v[116:119], v[32:35], v[56:59]
    v_mfma_f32_16x16x32_bf16 v[60:63], v[188:191], v[32:35], v[60:63]
    s_waitcnt lgkmcnt(4)
    v_mfma_f32_16x16x32_bf16 v[64:67], v[116:119], v[36:39], v[64:67]
    v_mfma_f32_16x16x32_bf16 v[68:71], v[188:191], v[36:39], v[68:71]
    s_waitcnt lgkmcnt(3)
    v_mfma_f32_16x16x32_bf16 v[72:75], v[116:119], v[40:43], v[72:75]
    v_mfma_f32_16x16x32_bf16 v[76:79], v[188:191], v[40:43], v[76:79]
    s_waitcnt lgkmcnt(2)
    v_mfma_f32_16x16x32_bf16 v[80:83], v[116:119], v[44:47], v[80:83]
    v_mfma_f32_16x16x32_bf16 v[84:87], v[188:191], v[44:47], v[84:87]
    s_waitcnt lgkmcnt(1)
    v_mfma_f32_16x16x32_bf16 v[88:91], v[116:119], v[24:27], v[88:91]
    v_mfma_f32_16x16x32_bf16 v[92:95], v[188:191], v[24:27], v[92:95]
    s_waitcnt lgkmcnt(0)
    s_setprio 3
    s_cmp_eq_u32 s33, 0
    s_cbranch_scc1 fused_kernel_skip0g18
    s_barrier
fused_kernel_skip0g18:
    v_mfma_f32_16x16x32_bf16 v[96:99], v[116:119], v[28:31], v[96:99]
    v_mfma_f32_16x16x32_bf16 v[100:103], v[188:191], v[28:31], v[100:103]
    s_setprio 0
    s_cmp_eq_u32 s33, 0
    s_cbranch_scc0 fused_kernel_skip1g18
    s_add_u32 m0, s97, 65536
    s_add_u32 s21, s36, 1215488
    s_add_u32 s20, s36, 1179648
    buffer_load_dwordx4 v1, s[24:27], s20 offen lds
    buffer_load_dwordx4 v1, s[24:27], s21 offen offset:1024 lds
    buffer_load_dwordx4 v2, s[24:27], s20 offen offset:2048 lds
    buffer_load_dwordx4 v2, s[24:27], s21 offen offset:3072 lds
    s_add_u32 m0, s42, 126976
    s_add_u32 s45, s39, s4
    s_add_u32 s45, s45, 256
    s_mov_b64 exec, s[64:65]
    buffer_load_dwordx4 v3, s[8:11], s45 offen lds
    s_mov_b64 exec, -1
    s_mov_b64 exec, s[64:65]
    buffer_load_dwordx4 v4, s[8:11], s45 offen offset:1024 lds
    s_mov_b64 exec, -1
    s_waitcnt vmcnt(6)
    s_barrier
fused_kernel_skip1g18:
    s_add_u32 m0, s97, 0
    s_add_u32 s21, s37, 35840
    s_add_u32 s20, s37, 0
    buffer_load_dwordx4 v1, s[24:27], s20 offen lds
    buffer_load_dwordx4 v1, s[24:27], s21 offen offset:1024 lds
    ds_read_b64_tr_b16 v[120:121], v6 offset:32768
    ds_read_b64_tr_b16 v[122:123], v6 offset:33792
    ds_read_b128 v[32:35], v7 offset:14336
    buffer_load_dwordx4 v2, s[24:27], s20 offen offset:2048 lds
    ds_read_b64_tr_b16 v[192:193], v6 offset:49152
    ds_read_b64_tr_b16 v[194:195], v6 offset:50176
    ds_read_b128 v[36:39], v7 offset:16384
    buffer_load_dwordx4 v2, s[24:27], s21 offen offset:3072 lds
    ds_read_b128 v[40:43], v7 offset:18432
    ds_read_b128 v[44:47], v7 offset:20480
    s_add_u32 m0, s42, 141312
    s_add_u32 s45, s39, s5
    s_add_u32 s45, s45, 0
    s_mov_b64 exec, s[64:65]
    buffer_load_dwordx4 v3, s[8:11], s45 offen lds
    s_mov_b64 exec, -1
    ds_read_b128 v[24:27], v7 offset:22528
    ds_read_b128 v[28:31], v7 offset:24576
    s_mov_b64 exec, s[64:65]
    buffer_load_dwordx4 v4, s[8:11], s45 offen offset:1024 lds
    s_mov_b64 exec, -1
    ds_read_b64_tr_b16 v[124:125], v6 offset:40960
    ds_read_b64_tr_b16 v[126:127], v6 offset:41984
    ds_read_b64_tr_b16 v[196:197], v6 offset:57344
    ds_read_b64_tr_b16 v[198:199], v6 offset:58368
    s_cmp_eq_u32 s33, 0
    s_cbranch_scc1 fused_kernel_xwg180
    s_waitcnt vmcnt(6)
fused_kernel_xwg180:
    s_waitcnt lgkmcnt(0)
    s_barrier
    s_setprio 1
    v_mfma_f32_16x16x32_bf16 v[48:51], v[120:123], v[32:35], v[48:51]
    v_mfma_f32_16x16x32_bf16 v[52:55], v[192:195], v[32:35], v[52:55]
    ds_read_b128 v[32:35], v7 offset:26624
    v_mfma_f32_16x16x32_bf16 v[56:59], v[120:123], v[36:39], v[56:59]
    v_mfma_f32_16x16x32_bf16 v[60:63], v[192:195], v[36:39], v[60:63]
    ds_read_b128 v[36:39], v8 offset:14336
    v_mfma_f32_16x16x32_bf16 v[64:67], v[120:123], v[40:43], v[64:67]
    v_mfma_f32_16x16x32_bf16 v[68:71], v[192:195], v[40:43], v[68:71]
    ds_read_b128 v[40:43], v8 offset:16384
    v_mfma_f32_16x16x32_bf16 v[72:75], v[120:123], v[44:47], v[72:75]
    v_mfma_f32_16x16x32_bf16 v[76:79], v[192:195], v[44:47], v[76:79]
    ds_read_b128 v[44:47], v8 offset:18432
    v_mfma_f32_16x16x32_bf16 v[80:83], v[120:123], v[24:27], v[80:83]
    v_mfma_f32_16x16x32_bf16 v[84:87], v[192:195], v[24:27], v[84:87]
    ds_read_b128 v[24:27], v8 offset:20480
    v_mfma_f32_16x16x32_bf16 v[88:91], v[120:123], v[28:31], v[88:91]
    v_mfma_f32_16x16x32_bf16 v[92:95], v[192:195], v[28:31], v[92:95]
    ds_read_b128 v[28:31], v8 offset:22528
    s_waitcnt lgkmcnt(5)
    v_mfma_f32_16x16x32_bf16 v[96:99], v[120:123], v[32:35], v[96:99]
    v_mfma_f32_16x16x32_bf16 v[100:103], v[192:195], v[32:35], v[100:103]
    ds_read_b128 v[32:35], v8 offset:24576
    s_waitcnt lgkmcnt(5)
    v_mfma_f32_16x16x32_bf16 v[48:51], v[124:127], v[36:39], v[48:51]
    v_mfma_f32_16x16x32_bf16 v[52:55], v[196:199], v[36:39], v[52:55]
    ds_read_b128 v[36:39], v8 offset:26624
    s_waitcnt lgkmcnt(5)
    v_mfma_f32_16x16x32_bf16 v[56:59], v[124:127], v[40:43], v[56:59]
    v_mfma_f32_16x16x32_bf16 v[60:63], v[196:199], v[40:43], v[60:63]
    s_waitcnt lgkmcnt(4)
    v_mfma_f32_16x16x32_bf16 v[64:67], v[124:127], v[44:47], v[64:67]
    s_add_u32 m0, s42, 98304
    s_add_u32 s45, s39, s5
    v_mfma_f32_16x16x32_bf16 v[68:71], v[196:199], v[44:47], v[68:71]
    s_add_u32 s45, s45, 128
    s_waitcnt lgkmcnt(3)
    v_mfma_f32_16x16x32_bf16 v[72:75], v[124:127], v[24:27], v[72:75]
    s_mov_b64 exec, s[64:65]
    buffer_load_dwordx4 v3, s[8:11], s45 offen lds
    s_mov_b64 exec, -1
    v_mfma_f32_16x16x32_bf16 v[76:79], v[196:199], v[24:27], v[76:79]
    s_waitcnt lgkmcnt(2)
    v_mfma_f32_16x16x32_bf16 v[80:83], v[124:127], v[28:31], v[80:83]
    v_mfma_f32_16x16x32_bf16 v[84:87], v[196:199], v[28:31], v[84:87]
    s_waitcnt lgkmcnt(1)
    v_mfma_f32_16x16x32_bf16 v[88:91], v[124:127], v[32:35], v[88:91]
    s_mov_b64 exec, s[64:65]
    buffer_load_dwordx4 v4, s[8:11], s45 offen offset:1024 lds
    s_mov_b64 exec, -1
    v_mfma_f32_16x16x32_bf16 v[92:95], v[196:199], v[32:35], v[92:95]
    s_waitcnt vmcnt(8) lgkmcnt(0)
    s_setprio 3
    s_barrier
    v_mfma_f32_16x16x32_bf16 v[96:99], v[124:127], v[36:39], v[96:99]
    v_mfma_f32_16x16x32_bf16 v[100:103], v[196:199], v[36:39], v[100:103]
    s_setprio 0
    s_add_u32 m0, s97, 32768
    s_add_u32 s21, s37, 625664
    s_add_u32 s20, s37, 589824
    buffer_load_dwordx4 v1, s[24:27], s20 offen lds
    buffer_load_dwordx4 v1, s[24:27], s21 offen offset:1024 lds
    ds_read_b64_tr_b16 v[128:129], v22 offset:0
    ds_read_b64_tr_b16 v[130:131], v22 offset:1024
    ds_read_b128 v[40:43], v7 offset:28672
    buffer_load_dwordx4 v2, s[24:27], s20 offen offset:2048 lds
    ds_read_b64_tr_b16 v[200:201], v22 offset:16384
    ds_read_b64_tr_b16 v[202:203], v22 offset:17408
    ds_read_b128 v[44:47], v7 offset:30720
    buffer_load_dwordx4 v2, s[24:27], s21 offen offset:3072 lds
    ds_read_b128 v[24:27], v7 offset:32768
    ds_read_b128 v[28:31], v7 offset:34816
    ds_read_b128 v[32:35], v7 offset:36864
    ds_read_b128 v[36:39], v7 offset:38912
    ds_read_b64_tr_b16 v[132:133], v22 offset:8192
    ds_read_b64_tr_b16 v[134:135], v22 offset:9216
    ds_read_b64_tr_b16 v[204:205], v22 offset:24576
    ds_read_b64_tr_b16 v[206:207], v22 offset:25600
    s_waitcnt vmcnt(6) lgkmcnt(0)
    s_barrier
    s_setprio 1
    v_mfma_f32_16x16x32_bf16 v[48:51], v[128:131], v[40:43], v[48:51]
    v_mfma_f32_16x16x32_bf16 v[52:55], v[200:203], v[40:43], v[52:55]
    ds_read_b128 v[40:43], v7 offset:40960
    v_mfma_f32_16x16x32_bf16 v[56:59], v[128:131], v[44:47], v[56:59]
    v_mfma_f32_16x16x32_bf16 v[60:63], v[200:203], v[44:47], v[60:63]
    ds_read_b128 v[44:47], v8 offset:28672
    v_mfma_f32_16x16x32_bf16 v[64:67], v[128:131], v[24:27], v[64:67]
    v_mfma_f32_16x16x32_bf16 v[68:71], v[200:203], v[24:27], v[68:71]
    ds_read_b128 v[24:27], v8 offset:30720
    v_mfma_f32_16x16x32_bf16 v[72:75], v[128:131], v[28:31], v[72:75]
    v_mfma_f32_16x16x32_bf16 v[76:79], v[200:203], v[28:31], v[76:79]
    ds_read_b128 v[28:31], v8 offset:32768
    v_mfma_f32_16x16x32_bf16 v[80:83], v[128:131], v[32:35], v[80:83]
    v_mfma_f32_16x16x32_bf16 v[84:87], v[200:203], v[32:35], v[84:87]
    ds_read_b128 v[32:35], v8 offset:34816
    v_mfma_f32_16x16x32_bf16 v[88:91], v[128:131], v[36:39], v[88:91]
    v_mfma_f32_16x16x32_bf16 v[92:95], v[200:203], v[36:39], v[92:95]
    ds_read_b128 v[36:39], v8 offset:36864
    s_waitcnt lgkmcnt(5)
    v_mfma_f32_16x16x32_bf16 v[96:99], v[128:131], v[40:43], v[96:99]
    v_mfma_f32_16x16x32_bf16 v[100:103], v[200:203], v[40:43], v[100:103]
    ds_read_b128 v[40:43], v8 offset:38912
    s_waitcnt lgkmcnt(5)
    v_mfma_f32_16x16x32_bf16 v[48:51], v[132:135], v[44:47], v[48:51]
    v_mfma_f32_16x16x32_bf16 v[52:55], v[204:207], v[44:47], v[52:55]
    ds_read_b128 v[44:47], v8 offset:40960
    s_waitcnt lgkmcnt(5)
    v_mfma_f32_16x16x32_bf16 v[56:59], v[132:135], v[24:27], v[56:59]
    v_mfma_f32_16x16x32_bf16 v[60:63], v[204:207], v[24:27], v[60:63]
    s_waitcnt lgkmcnt(4)
    v_mfma_f32_16x16x32_bf16 v[64:67], v[132:135], v[28:31], v[64:67]
    s_add_u32 m0, s42, 112640
    s_add_u32 s45, s39, s5
    v_mfma_f32_16x16x32_bf16 v[68:71], v[204:207], v[28:31], v[68:71]
    s_add_u32 s45, s45, 256
    s_waitcnt lgkmcnt(3)
    v_mfma_f32_16x16x32_bf16 v[72:75], v[132:135], v[32:35], v[72:75]
    s_mov_b64 exec, s[64:65]
    buffer_load_dwordx4 v3, s[8:11], s45 offen lds
    s_mov_b64 exec, -1
    v_mfma_f32_16x16x32_bf16 v[76:79], v[204:207], v[32:35], v[76:79]
    s_waitcnt lgkmcnt(2)
    v_mfma_f32_16x16x32_bf16 v[80:83], v[132:135], v[36:39], v[80:83]
    v_mfma_f32_16x16x32_bf16 v[84:87], v[204:207], v[36:39], v[84:87]
    s_waitcnt lgkmcnt(1)
    v_mfma_f32_16x16x32_bf16 v[88:91], v[132:135], v[40:43], v[88:91]
    s_mov_b64 exec, s[64:65]
    buffer_load_dwordx4 v4, s[8:11], s45 offen offset:1024 lds
    s_mov_b64 exec, -1
    v_mfma_f32_16x16x32_bf16 v[92:95], v[204:207], v[40:43], v[92:95]
    s_waitcnt lgkmcnt(0)
    s_setprio 3
    s_barrier
    v_mfma_f32_16x16x32_bf16 v[96:99], v[132:135], v[44:47], v[96:99]
    v_mfma_f32_16x16x32_bf16 v[100:103], v[204:207], v[44:47], v[100:103]
    s_setprio 0
    s_add_u32 m0, s97, 65536
    s_add_u32 s21, s37, 1215488
    s_add_u32 s20, s37, 1179648
    buffer_load_dwordx4 v1, s[24:27], s20 offen lds
    buffer_load_dwordx4 v1, s[24:27], s21 offen offset:1024 lds
    ds_read_b64_tr_b16 v[136:137], v6 offset:0
    ds_read_b64_tr_b16 v[138:139], v6 offset:1024
    ds_read_b128 v[24:27], v7 offset:43008
    buffer_load_dwordx4 v2, s[24:27], s20 offen offset:2048 lds
    ds_read_b64_tr_b16 v[208:209], v6 offset:16384
    ds_read_b64_tr_b16 v[210:211], v6 offset:17408
    ds_read_b128 v[28:31], v7 offset:45056
    buffer_load_dwordx4 v2, s[24:27], s21 offen offset:3072 lds
    ds_read_b128 v[32:35], v7 offset:47104
    ds_read_b128 v[36:39], v7 offset:49152
    buffer_store_dwordx4 v[12:15], v16, s[56:59], s69 offen sc0 sc1
    s_add_u32 s69, s69, 1024
    ds_read_b128 v[40:43], v7 offset:51200
    ds_read_b128 v[44:47], v7 offset:53248
    ds_read_b64_tr_b16 v[140:141], v6 offset:8192
    ds_read_b64_tr_b16 v[142:143], v6 offset:9216
    ds_read_b64_tr_b16 v[212:213], v6 offset:24576
    ds_read_b64_tr_b16 v[214:215], v6 offset:25600
    s_waitcnt vmcnt(7) lgkmcnt(0)
    s_barrier
    s_setprio 1
    v_mfma_f32_16x16x32_bf16 v[48:51], v[136:139], v[24:27], v[48:51]
    v_mfma_f32_16x16x32_bf16 v[52:55], v[208:211], v[24:27], v[52:55]
    ds_read_b128 v[24:27], v7 offset:55296
    v_mfma_f32_16x16x32_bf16 v[56:59], v[136:139], v[28:31], v[56:59]
    v_mfma_f32_16x16x32_bf16 v[60:63], v[208:211], v[28:31], v[60:63]
    ds_read_b128 v[28:31], v8 offset:43008
    v_mfma_f32_16x16x32_bf16 v[64:67], v[136:139], v[32:35], v[64:67]
    v_mfma_f32_16x16x32_bf16 v[68:71], v[208:211], v[32:35], v[68:71]
    ds_read_b128 v[32:35], v8 offset:45056
    v_mfma_f32_16x16x32_bf16 v[72:75], v[136:139], v[36:39], v[72:75]
    v_mfma_f32_16x16x32_bf16 v[76:79], v[208:211], v[36:39], v[76:79]
    ds_read_b128 v[36:39], v8 offset:47104
    v_mfma_f32_16x16x32_bf16 v[80:83], v[136:139], v[40:43], v[80:83]
    v_mfma_f32_16x16x32_bf16 v[84:87], v[208:211], v[40:43], v[84:87]
    ds_read_b128 v[40:43], v8 offset:49152
    v_mfma_f32_16x16x32_bf16 v[88:91], v[136:139], v[44:47], v[88:91]
    v_mfma_f32_16x16x32_bf16 v[92:95], v[208:211], v[44:47], v[92:95]
    ds_read_b128 v[44:47], v8 offset:51200
    s_waitcnt lgkmcnt(5)
    v_mfma_f32_16x16x32_bf16 v[96:99], v[136:139], v[24:27], v[96:99]
    v_mfma_f32_16x16x32_bf16 v[100:103], v[208:211], v[24:27], v[100:103]
    ds_read_b128 v[24:27], v8 offset:53248
    s_waitcnt lgkmcnt(5)
    v_mfma_f32_16x16x32_bf16 v[48:51], v[140:143], v[28:31], v[48:51]
    v_mfma_f32_16x16x32_bf16 v[52:55], v[212:215], v[28:31], v[52:55]
    ds_read_b128 v[28:31], v8 offset:55296
    s_waitcnt lgkmcnt(5)
    v_mfma_f32_16x16x32_bf16 v[56:59], v[140:143], v[32:35], v[56:59]
    v_mfma_f32_16x16x32_bf16 v[60:63], v[212:215], v[32:35], v[60:63]
    s_waitcnt lgkmcnt(4)
    v_mfma_f32_16x16x32_bf16 v[64:67], v[140:143], v[36:39], v[64:67]
    s_add_u32 m0, s42, 126976
    s_add_u32 s45, s39, s48
    v_mfma_f32_16x16x32_bf16 v[68:71], v[212:215], v[36:39], v[68:71]
    s_add_u32 s45, s45, 0
    s_waitcnt lgkmcnt(3)
    v_mfma_f32_16x16x32_bf16 v[72:75], v[140:143], v[40:43], v[72:75]
    s_mov_b64 exec, s[64:65]
    buffer_load_dwordx4 v3, s[8:11], s45 offen lds
    s_mov_b64 exec, -1
    v_mfma_f32_16x16x32_bf16 v[76:79], v[212:215], v[40:43], v[76:79]
    s_waitcnt lgkmcnt(2)
    v_mfma_f32_16x16x32_bf16 v[80:83], v[140:143], v[44:47], v[80:83]
    v_mfma_f32_16x16x32_bf16 v[84:87], v[212:215], v[44:47], v[84:87]
    s_waitcnt lgkmcnt(1)
    v_mfma_f32_16x16x32_bf16 v[88:91], v[140:143], v[24:27], v[88:91]
    s_mov_b64 exec, s[64:65]
    buffer_load_dwordx4 v4, s[8:11], s45 offen offset:1024 lds
    s_mov_b64 exec, -1
    v_mfma_f32_16x16x32_bf16 v[92:95], v[212:215], v[24:27], v[92:95]
    s_waitcnt lgkmcnt(0)
    s_setprio 3
    s_barrier
    v_mfma_f32_16x16x32_bf16 v[96:99], v[140:143], v[28:31], v[96:99]
    v_mfma_f32_16x16x32_bf16 v[100:103], v[212:215], v[28:31], v[100:103]
    s_setprio 0
    s_add_u32 m0, s97, 0
    s_add_u32 s21, s38, 35840
    s_add_u32 s20, s38, 0
    buffer_load_dwordx4 v1, s[24:27], s20 offen lds
    buffer_load_dwordx4 v1, s[24:27], s21 offen offset:1024 lds
    ds_read_b64_tr_b16 v[144:145], v6 offset:32768
    ds_read_b64_tr_b16 v[146:147], v6 offset:33792
    ds_read_b128 v[32:35], v7 offset:0
    buffer_load_dwordx4 v2, s[24:27], s20 offen offset:2048 lds
    ds_read_b64_tr_b16 v[216:217], v6 offset:49152
    ds_read_b64_tr_b16 v[218:219], v6 offset:50176
    ds_read_b128 v[36:39], v7 offset:2048
    buffer_load_dwordx4 v2, s[24:27], s21 offen offset:3072 lds
    ds_read_b128 v[40:43], v7 offset:4096
    ds_read_b128 v[44:47], v7 offset:6144
    buffer_store_dwordx4 v[12:15], v16, s[56:59], s69 offen sc0 sc1
    s_add_u32 s69, s69, 1024
    ds_read_b128 v[24:27], v7 offset:8192
    ds_read_b128 v[28:31], v7 offset:10240
    ds_read_b64_tr_b16 v[148:149], v6 offset:40960
    ds_read_b64_tr_b16 v[150:151], v6 offset:41984
    ds_read_b64_tr_b16 v[220:221], v6 offset:57344
    ds_read_b64_tr_b16 v[222:223], v6 offset:58368
    s_waitcnt vmcnt(8) lgkmcnt(0)
    s_barrier
    s_setprio 1
    v_mfma_f32_16x16x32_bf16 v[48:51], v[144:147], v[32:35], v[48:51]
    v_mfma_f32_16x16x32_bf16 v[52:55], v[216:219], v[32:35], v[52:55]
    ds_read_b128 v[32:35], v7 offset:12288
    v_mfma_f32_16x16x32_bf16 v[56:59], v[144:147], v[36:39], v[56:59]
    v_mfma_f32_16x16x32_bf16 v[60:63], v[216:219], v[36:39], v[60:63]
    ds_read_b128 v[36:39], v8 offset:0
    v_mfma_f32_16x16x32_bf16 v[64:67], v[144:147], v[40:43], v[64:67]
    v_mfma_f32_16x16x32_bf16 v[68:71], v[216:219], v[40:43], v[68:71]
    ds_read_b128 v[40:43], v8 offset:2048
    v_mfma_f32_16x16x32_bf16 v[72:75], v[144:147], v[44:47], v[72:75]
    v_mfma_f32_16x16x32_bf16 v[76:79], v[216:219], v[44:47], v[76:79]
    ds_read_b128 v[44:47], v8 offset:4096
    v_mfma_f32_16x16x32_bf16 v[80:83], v[144:147], v[24:27], v[80:83]
    v_mfma_f32_16x16x32_bf16 v[84:87], v[216:219], v[24:27], v[84:87]
    ds_read_b128 v[24:27], v8 offset:6144
    v_mfma_f32_16x16x32_bf16 v[88:91], v[144:147], v[28:31], v[88:91]
    v_mfma_f32_16x16x32_bf16 v[92:95], v[216:219], v[28:31], v[92:95]
    ds_read_b128 v[28:31], v8 offset:8192
    s_waitcnt lgkmcnt(5)
    v_mfma_f32_16x16x32_bf16 v[96:99], v[144:147], v[32:35], v[96:99]
    v_mfma_f32_16x16x32_bf16 v[100:103], v[216:219], v[32:35], v[100:103]
    ds_read_b128 v[32:35], v8 offset:10240
    s_waitcnt lgkmcnt(5)
    v_mfma_f32_16x16x32_bf16 v[48:51], v[148:151], v[36:39], v[48:51]
    v_mfma_f32_16x16x32_bf16 v[52:55], v[220:223], v[36:39], v[52:55]
    ds_read_b128 v[36:39], v8 offset:12288
    s_waitcnt lgkmcnt(5)
    v_mfma_f32_16x16x32_bf16 v[56:59], v[148:151], v[40:43], v[56:59]
    v_mfma_f32_16x16x32_bf16 v[60:63], v[220:223], v[40:43], v[60:63]
    s_waitcnt lgkmcnt(4)
    v_mfma_f32_16x16x32_bf16 v[64:67], v[148:151], v[44:47], v[64:67]
    s_add_u32 m0, s42, 141312
    s_add_u32 s45, s39, s48
    v_mfma_f32_16x16x32_bf16 v[68:71], v[220:223], v[44:47], v[68:71]
    s_add_u32 s45, s45, 128
    s_waitcnt lgkmcnt(3)
    v_mfma_f32_16x16x32_bf16 v[72:75], v[148:151], v[24:27], v[72:75]
    s_mov_b64 exec, s[64:65]
    buffer_load_dwordx4 v3, s[8:11], s45 offen lds
    s_mov_b64 exec, -1
    v_mfma_f32_16x16x32_bf16 v[76:79], v[220:223], v[24:27], v[76:79]
    s_waitcnt lgkmcnt(2)
    v_mfma_f32_16x16x32_bf16 v[80:83], v[148:151], v[28:31], v[80:83]
    v_mfma_f32_16x16x32_bf16 v[84:87], v[220:223], v[28:31], v[84:87]
    s_waitcnt lgkmcnt(1)
    v_mfma_f32_16x16x32_bf16 v[88:91], v[148:151], v[32:35], v[88:91]
    s_mov_b64 exec, s[64:65]
    buffer_load_dwordx4 v4, s[8:11], s45 offen offset:1024 lds
    s_mov_b64 exec, -1
    v_mfma_f32_16x16x32_bf16 v[92:95], v[220:223], v[32:35], v[92:95]
    s_waitcnt lgkmcnt(0)
    s_setprio 3
    s_barrier
    v_mfma_f32_16x16x32_bf16 v[96:99], v[148:151], v[36:39], v[96:99]
    v_mfma_f32_16x16x32_bf16 v[100:103], v[220:223], v[36:39], v[100:103]
    s_setprio 0
    s_add_u32 m0, s97, 32768
    s_add_u32 s21, s38, 625664
    s_add_u32 s20, s38, 589824
    buffer_load_dwordx4 v1, s[24:27], s20 offen lds
    s_and_b64 exec, s[100:101], 1
    buffer_load_dword v9, off, s[92:95], 0 sc0 sc1
    s_mov_b64 exec, -1
    buffer_load_dwordx4 v1, s[24:27], s21 offen offset:1024 lds
    ds_read_b64_tr_b16 v[152:153], v22 offset:0
    ds_read_b64_tr_b16 v[154:155], v22 offset:1024
    ds_read_b128 v[40:43], v7 offset:14336
    buffer_load_dwordx4 v2, s[24:27], s20 offen offset:2048 lds
    ds_read_b64_tr_b16 v[224:225], v22 offset:16384
    ds_read_b64_tr_b16 v[226:227], v22 offset:17408
    ds_read_b128 v[44:47], v7 offset:16384
    buffer_load_dwordx4 v2, s[24:27], s21 offen offset:3072 lds
    ds_read_b128 v[24:27], v7 offset:18432
    ds_read_b128 v[28:31], v7 offset:20480
    buffer_store_dwordx4 v[12:15], v16, s[56:59], s69 offen sc0 sc1
    s_add_u32 s69, s69, 1024
    ds_read_b128 v[32:35], v7 offset:22528
    ds_read_b128 v[36:39], v7 offset:24576
    ds_read_b64_tr_b16 v[156:157], v22 offset:8192
    ds_read_b64_tr_b16 v[158:159], v22 offset:9216
    ds_read_b64_tr_b16 v[228:229], v22 offset:24576
    ds_read_b64_tr_b16 v[230:231], v22 offset:25600
    s_waitcnt vmcnt(9) lgkmcnt(0)
    s_barrier
    s_setprio 1
    v_mfma_f32_16x16x32_bf16 v[48:51], v[152:155], v[40:43], v[48:51]
    v_mfma_f32_16x16x32_bf16 v[52:55], v[224:227], v[40:43], v[52:55]
    ds_read_b128 v[40:43], v7 offset:26624
    v_mfma_f32_16x16x32_bf16 v[56:59], v[152:155], v[44:47], v[56:59]
    v_mfma_f32_16x16x32_bf16 v[60:63], v[224:227], v[44:47], v[60:63]
    ds_read_b128 v[44:47], v8 offset:14336
    v_mfma_f32_16x16x32_bf16 v[64:67], v[152:155], v[24:27], v[64:67]
    v_mfma_f32_16x16x32_bf16 v[68:71], v[224:227], v[24:27], v[68:71]
    ds_read_b128 v[24:27], v8 offset:16384
    v_mfma_f32_16x16x32_bf16 v[72:75], v[152:155], v[28:31], v[72:75]
    v_mfma_f32_16x16x32_bf16 v[76:79], v[224:227], v[28:31], v[76:79]
    ds_read_b128 v[28:31], v8 offset:18432
    v_mfma_f32_16x16x32_bf16 v[80:83], v[152:155], v[32:35], v[80:83]
    v_mfma_f32_16x16x32_bf16 v[84:87], v[224:227], v[32:35], v[84:87]
    ds_read_b128 v[32:35], v8 offset:20480
    v_mfma_f32_16x16x32_bf16 v[88:91], v[152:155], v[36:39], v[88:91]
    v_mfma_f32_16x16x32_bf16 v[92:95], v[224:227], v[36:39], v[92:95]
    ds_read_b128 v[36:39], v8 offset:22528
    s_waitcnt lgkmcnt(5)
    v_mfma_f32_16x16x32_bf16 v[96:99], v[152:155], v[40:43], v[96:99]
    v_mfma_f32_16x16x32_bf16 v[100:103], v[224:227], v[40:43], v[100:103]
    ds_read_b128 v[40:43], v8 offset:24576
    s_waitcnt lgkmcnt(5)
    v_mfma_f32_16x16x32_bf16 v[48:51], v[156:159], v[44:47], v[48:51]
    v_mfma_f32_16x16x32_bf16 v[52:55], v[228:231], v[44:47], v[52:55]
    ds_read_b128 v[44:47], v8 offset:26624
    s_waitcnt lgkmcnt(5)
    v_mfma_f32_16x16x32_bf16 v[56:59], v[156:159], v[24:27], v[56:59]
    v_mfma_f32_16x16x32_bf16 v[60:63], v[228:231], v[24:27], v[60:63]
    s_waitcnt lgkmcnt(4)
    v_mfma_f32_16x16x32_bf16 v[64:67], v[156:159], v[28:31], v[64:67]
    s_add_u32 m0, s42, 98304
    s_add_u32 s45, s39, s48
    v_mfma_f32_16x16x32_bf16 v[68:71], v[228:231], v[28:31], v[68:71]
    s_add_u32 s45, s45, 256
    s_waitcnt lgkmcnt(3)
    v_mfma_f32_16x16x32_bf16 v[72:75], v[156:159], v[32:35], v[72:75]
    s_mov_b64 exec, s[64:65]
    buffer_load_dwordx4 v3, s[8:11], s45 offen lds
    s_mov_b64 exec, -1
    v_mfma_f32_16x16x32_bf16 v[76:79], v[228:231], v[32:35], v[76:79]
    s_waitcnt lgkmcnt(2)
    v_mfma_f32_16x16x32_bf16 v[80:83], v[156:159], v[36:39], v[80:83]
    v_mfma_f32_16x16x32_bf16 v[84:87], v[228:231], v[36:39], v[84:87]
    s_waitcnt lgkmcnt(1)
    v_mfma_f32_16x16x32_bf16 v[88:91], v[156:159], v[40:43], v[88:91]
    s_mov_b64 exec, s[64:65]
    buffer_load_dwordx4 v4, s[8:11], s45 offen offset:1024 lds
    s_mov_b64 exec, -1
    v_mfma_f32_16x16x32_bf16 v[92:95], v[228:231], v[40:43], v[92:95]
    s_waitcnt lgkmcnt(0)
    s_setprio 3
    s_barrier
    v_mfma_f32_16x16x32_bf16 v[96:99], v[156:159], v[44:47], v[96:99]
    v_mfma_f32_16x16x32_bf16 v[100:103], v[228:231], v[44:47], v[100:103]
    s_setprio 0
    s_add_u32 m0, s97, 65536
    s_add_u32 s21, s38, 1215488
    s_add_u32 s20, s38, 1179648
    buffer_load_dwordx4 v1, s[24:27], s20 offen lds
    buffer_load_dwordx4 v1, s[24:27], s21 offen offset:1024 lds
    ds_read_b64_tr_b16 v[160:161], v6 offset:0
    ds_read_b64_tr_b16 v[162:163], v6 offset:1024
    ds_read_b128 v[24:27], v7 offset:28672
    buffer_load_dwordx4 v2, s[24:27], s20 offen offset:2048 lds
    ds_read_b64_tr_b16 v[232:233], v6 offset:16384
    ds_read_b64_tr_b16 v[234:235], v6 offset:17408
    ds_read_b128 v[28:31], v7 offset:30720
    buffer_load_dwordx4 v2, s[24:27], s21 offen offset:3072 lds
    ds_read_b128 v[32:35], v7 offset:32768
    ds_read_b128 v[36:39], v7 offset:34816
    buffer_store_dwordx4 v[12:15], v16, s[56:59], s69 offen sc0 sc1
    s_add_u32 s69, s69, 1024
    ds_read_b128 v[40:43], v7 offset:36864
    ds_read_b128 v[44:47], v7 offset:38912
    ds_read_b64_tr_b16 v[164:165], v6 offset:8192
    ds_read_b64_tr_b16 v[166:167], v6 offset:9216
    ds_read_b64_tr_b16 v[236:237], v6 offset:24576
    ds_read_b64_tr_b16 v[238:239], v6 offset:25600
    s_waitcnt vmcnt(8) lgkmcnt(0)
    s_barrier
    s_setprio 1
    v_mfma_f32_16x16x32_bf16 v[48:51], v[160:163], v[24:27], v[48:51]
    s_lshr_b32 s34, s2, 7
    v_mfma_f32_16x16x32_bf16 v[52:55], v[232:235], v[24:27], v[52:55]
    s_mul_i32 s35, s34, 9363
    ds_read_b128 v[24:27], v7 offset:40960
    v_mfma_f32_16x16x32_bf16 v[56:59], v[160:163], v[28:31], v[56:59]
    s_lshr_b32 s35, s35, 16
    v_mfma_f32_16x16x32_bf16 v[60:63], v[232:235], v[28:31], v[60:63]
    s_mul_i32 s35, s35, 3
    ds_read_b128 v[28:31], v8 offset:28672
    v_mfma_f32_16x16x32_bf16 v[64:67], v[160:163], v[32:35], v[64:67]
    s_sub_u32 s34, s34, s35
    v_mfma_f32_16x16x32_bf16 v[68:71], v[232:235], v[32:35], v[68:71]
    s_min_u32 s34, s34, 143
    ds_read_b128 v[32:35], v8 offset:30720
    v_mfma_f32_16x16x32_bf16 v[72:75], v[160:163], v[36:39], v[72:75]
    s_mul_i32 s35, s34, 7282
    v_mfma_f32_16x16x32_bf16 v[76:79], v[232:235], v[36:39], v[76:79]
    s_lshr_b32 s35, s35, 16
    ds_read_b128 v[36:39], v8 offset:32768
    v_mfma_f32_16x16x32_bf16 v[80:83], v[160:163], v[40:43], v[80:83]
    s_mul_i32 s4, s35, 9
    v_mfma_f32_16x16x32_bf16 v[84:87], v[232:235], v[40:43], v[84:87]
    s_sub_u32 s34, s34, s4
    ds_read_b128 v[40:43], v8 offset:34816
    v_mfma_f32_16x16x32_bf16 v[88:91], v[160:163], v[44:47], v[88:91]
    s_lshl_b32 s35, s35, 3
    v_mfma_f32_16x16x32_bf16 v[92:95], v[232:235], v[44:47], v[92:95]
    s_add_u32 s35, s35, s22
    ds_read_b128 v[44:47], v8 offset:36864
    s_waitcnt lgkmcnt(5)
    v_mfma_f32_16x16x32_bf16 v[96:99], v[160:163], v[24:27], v[96:99]
    s_mul_i32 s4, s35, 18432
    v_mfma_f32_16x16x32_bf16 v[100:103], v[232:235], v[24:27], v[100:103]
    s_lshl_b32 s5, s34, 7
    ds_read_b128 v[24:27], v8 offset:38912
    s_waitcnt lgkmcnt(5)
    v_mfma_f32_16x16x32_bf16 v[48:51], v[164:167], v[28:31], v[48:51]
    s_add_u32 s4, s4, s5
    v_mfma_f32_16x16x32_bf16 v[52:55], v[236:239], v[28:31], v[52:55]
    s_lshl_b32 s48, s34, 9
    ds_read_b128 v[28:31], v8 offset:40960
    s_waitcnt lgkmcnt(5)
    v_mfma_f32_16x16x32_bf16 v[56:59], v[164:167], v[32:35], v[56:59]
    s_sub_u32 s5, 127, s35
    v_mfma_f32_16x16x32_bf16 v[60:63], v[236:239], v[32:35], v[60:63]
    s_lshl_b32 s35, s5, 8
    s_waitcnt lgkmcnt(4)
    v_mfma_f32_16x16x32_bf16 v[64:67], v[164:167], v[36:39], v[64:67]
    s_lshl_b32 s34, s34, 18
    v_mfma_f32_16x16x32_bf16 v[68:71], v[236:239], v[36:39], v[68:71]
    s_add_u32 s34, s34, s35
    s_waitcnt lgkmcnt(3)
    v_mfma_f32_16x16x32_bf16 v[72:75], v[164:167], v[40:43], v[72:75]
    s_add_u32 s34, s34, 50331776
    v_mfma_f32_16x16x32_bf16 v[76:79], v[236:239], v[40:43], v[76:79]
    s_add_u32 s64, s6, s34
    s_waitcnt lgkmcnt(2)
    v_mfma_f32_16x16x32_bf16 v[80:83], v[164:167], v[44:47], v[80:83]
    s_addc_u32 s65, s7, 0
    v_mfma_f32_16x16x32_bf16 v[84:87], v[236:239], v[44:47], v[84:87]
    s_and_b32 s34, s22, 3
    s_waitcnt lgkmcnt(1)
    v_mfma_f32_16x16x32_bf16 v[88:91], v[164:167], v[24:27], v[88:91]
    s_lshl_b32 s35, s33, 15
    v_mfma_f32_16x16x32_bf16 v[92:95], v[236:239], v[24:27], v[92:95]
    s_lshl_b32 s3, s34, 11
    s_waitcnt lgkmcnt(0)
    s_setprio 3
    s_barrier
    v_mfma_f32_16x16x32_bf16 v[96:99], v[164:167], v[28:31], v[96:99]
    s_add_u32 s3, s3, s35
    v_mfma_f32_16x16x32_bf16 v[100:103], v[236:239], v[28:31], v[100:103]
    s_add_u32 s36, s3, 18944
    s_setprio 0
    s_mul_i32 s44, s50, 9
    s_add_u32 s68, s44, s49
    s_add_u32 s44, s44, s63
    s_add_u32 m0, s42, 0
    s_add_u32 s45, s44, 18432
    buffer_load_dwordx4 v3, s[8:11], s45 offen lds
    s_load_dwordx4 s[84:87], s[0:1], 8
    s_load_dwordx2 s[88:89], s[0:1], 24
    s_cmp_eq_u32 s100, 0
    s_cbranch_scc1 fused_kernel_dcg18_ok
    s_movk_i32 s98, 0x4000
fused_kernel_dcg18_l:
    v_readfirstlane_b32 s34, v9
    s_cmp_lg_u32 s34, 0
    s_cbranch_scc1 fused_kernel_dcg18_ok
    s_sleep 2
    s_mov_b64 exec, 1
    buffer_load_dword v9, off, s[92:95], 0 sc0 sc1
    s_mov_b64 exec, -1
    s_waitcnt vmcnt(0)
    s_sub_u32 s98, s98, 1
    s_cbranch_scc0 fused_kernel_dcg18_l
fused_kernel_dcg18_ok:
    s_add_u32 s92, s6, 31465472
    s_addc_u32 s93, s7, 0
    s_and_b32 s93, s93, 0xffff
    s_mov_b32 s94, 65536
    s_mov_b32 s95, 0x00020000
    buffer_load_dwordx4 v4, s[8:11], s45 offen offset:1024 lds
    ds_read_b64_tr_b16 v[168:169], v6 offset:32768
    ds_read_b64_tr_b16 v[170:171], v6 offset:33792
    ds_read_b128 v[32:35], v7 offset:43008
    s_add_u32 m0, s43, 0
    s_add_u32 s45, s68, 18432
    s_mov_b64 exec, 0xffff
    buffer_load_dwordx4 v5, s[8:11], s45 offen lds
    s_mov_b64 exec, -1
    ds_read_b64_tr_b16 v[240:241], v6 offset:49152
    ds_read_b64_tr_b16 v[242:243], v6 offset:50176
    ds_read_b128 v[36:39], v7 offset:45056
    buffer_store_dwordx4 v[12:15], v16, s[56:59], s69 offen sc0 sc1
    s_add_u32 s69, s69, 1024
    ds_read_b128 v[40:43], v7 offset:47104
    ds_read_b128 v[44:47], v7 offset:49152
    ds_read_b128 v[24:27], v7 offset:51200
    ds_read_b128 v[28:31], v7 offset:53248
    ds_read_b64_tr_b16 v[172:173], v6 offset:40960
    ds_read_b64_tr_b16 v[174:175], v6 offset:41984
    ds_read_b64_tr_b16 v[244:245], v6 offset:57344
    ds_read_b64_tr_b16 v[246:247], v6 offset:58368
    s_waitcnt vmcnt(5) lgkmcnt(0)
    s_barrier
    s_setprio 1
    v_mfma_f32_16x16x32_bf16 v[48:51], v[168:171], v[32:35], v[48:51]
    v_bfe_u32 v10, v0, 3, 3
    v_mfma_f32_16x16x32_bf16 v[52:55], v[240:243], v[32:35], v[52:55]
    v_mul_u32_u24 v10, 1152, v10
    ds_read_b128 v[32:35], v7 offset:55296
    v_mfma_f32_16x16x32_bf16 v[56:59], v[168:171], v[36:39], v[56:59]
    v_and_b32 v11, 7, v0
    v_mfma_f32_16x16x32_bf16 v[60:63], v[240:243], v[36:39], v[60:63]
    v_lshl_add_u32 v10, v11, 4, v10
    ds_read_b128 v[36:39], v8 offset:43008
    v_mfma_f32_16x16x32_bf16 v[64:67], v[168:171], v[40:43], v[64:67]
    v_add_u32 v10, s4, v10
    v_mfma_f32_16x16x32_bf16 v[68:71], v[240:243], v[40:43], v[68:71]
    v_add_u32 v11, 9216, v10
    ds_read_b128 v[40:43], v8 offset:45056
    v_mfma_f32_16x16x32_bf16 v[72:75], v[168:171], v[44:47], v[72:75]
    v_subrev_u32 v12, 4608, v10
    v_mfma_f32_16x16x32_bf16 v[76:79], v[240:243], v[44:47], v[76:79]
    v_max_i32 v12, 0, v12
    ds_read_b128 v[44:47], v8 offset:47104
    v_mfma_f32_16x16x32_bf16 v[80:83], v[168:171], v[24:27], v[80:83]
    v_mov_b32 v14, 0
    v_mfma_f32_16x16x32_bf16 v[84:87], v[240:243], v[24:27], v[84:87]
    v_mov_b32 v15, 0
    ds_read_b128 v[24:27], v8 offset:49152
    v_mfma_f32_16x16x32_bf16 v[88:91], v[168:171], v[28:31], v[88:91]
    v_and_b32 v13, 63, v0
    v_mfma_f32_16x16x32_bf16 v[92:95], v[240:243], v[28:31], v[92:95]
    v_lshlrev_b32 v13, 3, v13
    ds_read_b128 v[28:31], v8 offset:51200
    s_waitcnt lgkmcnt(5)
    v_mfma_f32_16x16x32_bf16 v[96:99], v[168:171], v[32:35], v[96:99]
    v_lshl_add_u32 v16, v13, 1, s48
    v_mfma_f32_16x16x32_bf16 v[100:103], v[240:243], v[32:35], v[100:103]
    s_and_b32 s34, s22, 3
    ds_read_b128 v[32:35], v8 offset:53248
    s_waitcnt lgkmcnt(5)
    v_mfma_f32_16x16x32_bf16 v[48:51], v[172:175], v[36:39], v[48:51]
    s_lshl_b32 s35, s33, 15
    v_mfma_f32_16x16x32_bf16 v[52:55], v[244:247], v[36:39], v[52:55]
    s_lshl_b32 s3, s34, 10
    ds_read_b128 v[36:39], v8 offset:55296
    s_waitcnt lgkmcnt(5)
    v_mfma_f32_16x16x32_bf16 v[56:59], v[172:175], v[40:43], v[56:59]
    s_add_u32 s3, s3, s35
    v_mfma_f32_16x16x32_bf16 v[60:63], v[244:247], v[40:43], v[60:63]
    s_add_u32 s37, s3, 27136
    s_waitcnt lgkmcnt(4)
    v_mfma_f32_16x16x32_bf16 v[64:67], v[172:175], v[44:47], v[64:67]
    s_add_u32 s38, s35, 18432
    v_mfma_f32_16x16x32_bf16 v[68:71], v[244:247], v[44:47], v[68:71]
    s_cmp_lt_u32 s4, 1152
    s_waitcnt lgkmcnt(3)
    v_mfma_f32_16x16x32_bf16 v[72:75], v[172:175], v[24:27], v[72:75]
    s_cselect_b64 s[20:21], -1, 0
    v_mfma_f32_16x16x32_bf16 v[76:79], v[244:247], v[24:27], v[76:79]
    s_cselect_b32 s34, 1, s34
    s_waitcnt lgkmcnt(2)
    v_mfma_f32_16x16x32_bf16 v[80:83], v[172:175], v[28:31], v[80:83]
    s_cmp_eq_u32 s34, 0
    v_mfma_f32_16x16x32_bf16 v[84:87], v[244:247], v[28:31], v[84:87]
    s_cselect_b32 s39, s66, 0
    s_waitcnt lgkmcnt(1)
    v_mfma_f32_16x16x32_bf16 v[88:91], v[172:175], v[32:35], v[88:91]
    v_mfma_f32_16x16x32_bf16 v[92:95], v[244:247], v[32:35], v[92:95]
    s_waitcnt lgkmcnt(0)
    s_setprio 3
    s_barrier
    v_mfma_f32_16x16x32_bf16 v[96:99], v[172:175], v[36:39], v[96:99]
    v_mfma_f32_16x16x32_bf16 v[100:103], v[244:247], v[36:39], v[100:103]
    s_setprio 0
    s_add_u32 m0, s42, 32768
    s_add_u32 s45, s44, 36864
    buffer_load_dwordx4 v3, s[8:11], s45 offen lds
    buffer_load_dwordx4 v4, s[8:11], s45 offen offset:1024 lds
    s_add_u32 m0, s43, 32768
    s_add_u32 s45, s68, 36864
    s_mov_b64 exec, 0xffff
    buffer_load_dwordx4 v5, s[8:11], s45 offen lds
    s_mov_b64 exec, -1
    s_mov_b32 m0, s36
    s_mov_b64 exec, s[66:67]
    global_load_lds_dwordx4 v10, s[84:85]
    s_add_u32 m0, m0, 1024
    s_nop 0
    global_load_lds_dwordx4 v11, s[84:85]
    s_mov_b32 m0, s37
    s_nop 0
    global_load_lds_dwordx4 v10, s[86:87]
    s_mov_b32 m0, s38
    s_mov_b64 exec, s[20:21]
    ds_write_b64 v13, v[14:15] offset:18432
    s_mov_b32 exec_lo, s39
    s_mov_b32 exec_hi, 0
    global_load_lds_dwordx4 v12, s[84:85]
    s_mov_b32 m0, 65024
    s_and_b64 exec, s[66:67], s[100:101]
    global_load_lds_dwordx4 v16, s[88:89]
    s_mov_b64 exec, -1
    ds_read_b64_tr_b16 v[176:177], v22 offset:0
    ds_read_b64_tr_b16 v[178:179], v22 offset:1024
    ds_read_b128 v[40:43], v7 offset:0
    ds_read_b64_tr_b16 v[248:249], v22 offset:16384
    ds_read_b64_tr_b16 v[250:251], v22 offset:17408
    ds_read_b128 v[44:47], v7 offset:2048
    ds_read_b128 v[24:27], v7 offset:4096
    ds_read_b128 v[28:31], v7 offset:6144
    ds_read_b128 v[32:35], v7 offset:8192
    ds_read_b128 v[36:39], v7 offset:10240
    ds_read_b64_tr_b16 v[180:181], v22 offset:8192
    ds_read_b64_tr_b16 v[182:183], v22 offset:9216
    ds_read_b64_tr_b16 v[252:253], v22 offset:24576
    ds_read_b64_tr_b16 v[254:255], v22 offset:25600
    s_waitcnt vmcnt(9) lgkmcnt(0)
    s_barrier
    s_setprio 1
    v_mfma_f32_16x16x32_bf16 v[48:51], v[176:179], v[40:43], v[48:51]
    v_mov_b32 v1, v104
    v_mfma_f32_16x16x32_bf16 v[52:55], v[248:251], v[40:43], v[52:55]
    v_mov_b32 v2, v105
    ds_read_b128 v[40:43], v7 offset:12288
    v_mfma_f32_16x16x32_bf16 v[56:59], v[176:179], v[44:47], v[56:59]
    v_mov_b32 v6, v106
    v_mfma_f32_16x16x32_bf16 v[60:63], v[248:251], v[44:47], v[60:63]
    v_mov_b32 v22, v107
    ds_read_b128 v[44:47], v8 offset:0
    v_mfma_f32_16x16x32_bf16 v[64:67], v[176:179], v[24:27], v[64:67]
    v_mov_b32 v9, v110
    v_mfma_f32_16x16x32_bf16 v[68:71], v[248:251], v[24:27], v[68:71]
    s_lshl_b32 s39, s33, 15
    ds_read_b128 v[24:27], v8 offset:2048
    v_mfma_f32_16x16x32_bf16 v[72:75], v[176:179], v[28:31], v[72:75]
    s_add_u32 s39, s39, 31232
    v_mfma_f32_16x16x32_bf16 v[76:79], v[248:251], v[28:31], v[76:79]
    s_sub_u32 s34, s22, s33
    ds_read_b128 v[28:31], v8 offset:4096
    v_mfma_f32_16x16x32_bf16 v[80:83], v[176:179], v[32:35], v[80:83]
    s_lshl_b32 s34, s34, 10
    v_mfma_f32_16x16x32_bf16 v[84:87], v[248:251], v[32:35], v[84:87]
    s_add_u32 s34, s34, 83968
    ds_read_b128 v[32:35], v8 offset:6144
    v_mfma_f32_16x16x32_bf16 v[88:91], v[176:179], v[36:39], v[88:91]
    s_and_b32 s3, s22, 3
    v_mfma_f32_16x16x32_bf16 v[92:95], v[248:251], v[36:39], v[92:95]
    s_cmp_eq_u32 s3, 3
    ds_read_b128 v[36:39], v8 offset:8192
    s_waitcnt lgkmcnt(5)
    v_mfma_f32_16x16x32_bf16 v[96:99], v[176:179], v[40:43], v[96:99]
    s_cselect_b32 s39, s39, s34
    v_mfma_f32_16x16x32_bf16 v[100:103], v[248:251], v[40:43], v[100:103]
    ds_read_b128 v[40:43], v8 offset:10240
    s_waitcnt lgkmcnt(5)
    v_mfma_f32_16x16x32_bf16 v[48:51], v[180:183], v[44:47], v[48:51]
    v_mfma_f32_16x16x32_bf16 v[52:55], v[252:255], v[44:47], v[52:55]
    ds_read_b128 v[44:47], v8 offset:12288
    s_waitcnt lgkmcnt(5)
    v_mfma_f32_16x16x32_bf16 v[56:59], v[180:183], v[24:27], v[56:59]
    v_mfma_f32_16x16x32_bf16 v[60:63], v[252:255], v[24:27], v[60:63]
    s_waitcnt lgkmcnt(4)
    v_mfma_f32_16x16x32_bf16 v[64:67], v[180:183], v[28:31], v[64:67]
    v_mfma_f32_16x16x32_bf16 v[68:71], v[252:255], v[28:31], v[68:71]
    s_waitcnt lgkmcnt(3)
    v_mfma_f32_16x16x32_bf16 v[72:75], v[180:183], v[32:35], v[72:75]
    v_mfma_f32_16x16x32_bf16 v[76:79], v[252:255], v[32:35], v[76:79]
    s_waitcnt lgkmcnt(2)
    v_mfma_f32_16x16x32_bf16 v[80:83], v[180:183], v[36:39], v[80:83]
    v_mfma_f32_16x16x32_bf16 v[84:87], v[252:255], v[36:39], v[84:87]
    s_waitcnt lgkmcnt(1)
    v_mfma_f32_16x16x32_bf16 v[88:91], v[180:183], v[40:43], v[88:91]
    v_mfma_f32_16x16x32_bf16 v[92:95], v[252:255], v[40:43], v[92:95]
    s_waitcnt lgkmcnt(0)
    s_setprio 3
    s_barrier
    v_mfma_f32_16x16x32_bf16 v[96:99], v[180:183], v[44:47], v[96:99]
    v_mfma_f32_16x16x32_bf16 v[100:103], v[252:255], v[44:47], v[100:103]
    s_setprio 0
    s_add_u32 m0, s42, 65536
    s_add_u32 s45, s44, 55296
    buffer_load_dwordx4 v3, s[8:11], s45 offen lds
    buffer_load_dwordx4 v4, s[8:11], s45 offen offset:1024 lds
    s_add_u32 m0, s43, 65536
    s_add_u32 s45, s68, 55296
    s_mov_b64 exec, 0xffff
    buffer_load_dwordx4 v5, s[8:11], s45 offen lds
    s_mov_b64 exec, -1
    s_mov_b32 m0, s39
    s_mov_b64 exec, s[66:67]
    global_load_lds_dwordx4 v11, s[86:87]
    s_mov_b64 exec, -1
    v_mul_f32 v10, s46, v48
    v_mul_f32 v11, s46, v49
    v_add_u32 v7, 4294868992, v7
    v_add_u32 v8, 4294868992, v8
    ds_read_b128 v[24:27], v7 offset:0
    v_mul_f32 v12, s46, v50
    v_mul_f32 v13, s46, v51
    ds_read_b128 v[28:31], v8 offset:0
    v_exp_f32 v10, v10
    ds_read_b128 v[32:35], v7 offset:2048
    v_exp_f32 v11, v11
    ds_read_b128 v[36:39], v8 offset:2048
    v_exp_f32 v12, v12
    ds_read_b128 v[40:43], v7 offset:4096
    v_exp_f32 v13, v13
    ds_read_b128 v[44:47], v8 offset:4096
    v_mul_f32 v14, v48, v52
    v_mul_f32 v15, v49, v53
    v_mul_f32 v16, v50, v54
    v_mul_f32 v17, v51, v55
    v_add_f32 v10, 1.0, v10
    v_add_f32 v11, 1.0, v11
    v_add_f32 v12, 1.0, v12
    v_add_f32 v13, 1.0, v13
    v_rcp_f32 v10, v10
    v_rcp_f32 v11, v11
    v_rcp_f32 v12, v12
    s_waitcnt vmcnt(9) lgkmcnt(0)
    s_barrier
    s_setprio 1
    v_mfma_f32_16x16x32_bf16 v[104:107], v[112:115], v[24:27], 0
    s_and_b32 s32, s96, 1
    v_rcp_f32 v13, v13
    v_mfma_f32_16x16x32_bf16 v[108:111], v[184:187], v[24:27], 0
    s_bfe_u32 s79, s96, 0x20001
    ds_read_b128 v[24:27], v7 offset:6144
    v_mfma_f32_16x16x32_bf16 v[104:107], v[116:119], v[28:31], v[104:107]
    s_mul_i32 s85, s78, 43
    v_mul_f32 v14, v14, v10
    v_mul_f32 v15, v15, v11
    v_mfma_f32_16x16x32_bf16 v[108:111], v[188:191], v[28:31], v[108:111]
    s_lshr_b32 s85, s85, 7
    ds_read_b128 v[28:31], v8 offset:6144
    v_mfma_f32_16x16x32_bf16 v[104:107], v[120:123], v[32:35], v[104:107]
    s_and_b32 s85, s85, 7
    v_mul_f32 v16, v16, v12
    v_mul_f32 v17, v17, v13
    v_mfma_f32_16x16x32_bf16 v[108:111], v[192:195], v[32:35], v[108:111]
    s_mul_i32 s34, s85, 3
    ds_read_b128 v[32:35], v7 offset:8192
    v_mfma_f32_16x16x32_bf16 v[104:107], v[124:127], v[36:39], v[104:107]
    s_sub_u32 s86, s78, s34
    v_cvt_pk_bf16_f32 v18, v14, v15
    v_cvt_pk_bf16_f32 v19, v16, v17
    v_mfma_f32_16x16x32_bf16 v[108:111], v[196:199], v[36:39], v[108:111]
    s_min_u32 s86, s86, 2
    ds_read_b128 v[36:39], v8 offset:8192
    v_mfma_f32_16x16x32_bf16 v[104:107], v[128:131], v[40:43], v[104:107]
    s_and_b32 s84, s22, 3
    v_mul_f32 v10, s46, v56
    v_mul_f32 v11, s46, v57
    v_mfma_f32_16x16x32_bf16 v[108:111], v[200:203], v[40:43], v[108:111]
    ds_read_b128 v[40:43], v7 offset:10240
    v_mfma_f32_16x16x32_bf16 v[104:107], v[132:135], v[44:47], v[104:107]
    v_mul_f32 v12, s46, v58
    v_mul_f32 v13, s46, v59
    v_mfma_f32_16x16x32_bf16 v[108:111], v[204:207], v[44:47], v[108:111]
    ds_read_b128 v[44:47], v8 offset:10240
    s_waitcnt lgkmcnt(5)
    v_mfma_f32_16x16x32_bf16 v[104:107], v[136:139], v[24:27], v[104:107]
    v_exp_f32 v10, v10
    v_mfma_f32_16x16x32_bf16 v[108:111], v[208:211], v[24:27], v[108:111]
    ds_read_b128 v[24:27], v7 offset:12288
    s_waitcnt lgkmcnt(5)
    v_mfma_f32_16x16x32_bf16 v[104:107], v[140:143], v[28:31], v[104:107]
    v_exp_f32 v11, v11
    v_mfma_f32_16x16x32_bf16 v[108:111], v[212:215], v[28:31], v[108:111]
    ds_read_b128 v[28:31], v8 offset:12288
    s_waitcnt lgkmcnt(5)
    v_mfma_f32_16x16x32_bf16 v[104:107], v[144:147], v[32:35], v[104:107]
    v_exp_f32 v12, v12
    v_mfma_f32_16x16x32_bf16 v[108:111], v[216:219], v[32:35], v[108:111]
    ds_read_b128 v[32:35], v7 offset:14336
    s_waitcnt lgkmcnt(5)
    v_mfma_f32_16x16x32_bf16 v[104:107], v[148:151], v[36:39], v[104:107]
    v_exp_f32 v13, v13
    v_mfma_f32_16x16x32_bf16 v[108:111], v[220:223], v[36:39], v[108:111]
    ds_read_b128 v[36:39], v8 offset:14336
    s_waitcnt lgkmcnt(5)
    v_mfma_f32_16x16x32_bf16 v[104:107], v[152:155], v[40:43], v[104:107]
    v_mul_f32 v14, v56, v60
    v_mul_f32 v15, v57, v61
    v_mfma_f32_16x16x32_bf16 v[108:111], v[224:227], v[40:43], v[108:111]
    ds_read_b128 v[40:43], v7 offset:16384
    s_waitcnt lgkmcnt(5)
    v_mfma_f32_16x16x32_bf16 v[104:107], v[156:159], v[44:47], v[104:107]
    v_mul_f32 v16, v58, v62
    v_mul_f32 v17, v59, v63
    v_mfma_f32_16x16x32_bf16 v[108:111], v[228:231], v[44:47], v[108:111]
    ds_read_b128 v[44:47], v8 offset:16384
    s_waitcnt lgkmcnt(5)
    v_mfma_f32_16x16x32_bf16 v[104:107], v[160:163], v[24:27], v[104:107]
    v_add_f32 v10, 1.0, v10
    v_add_f32 v11, 1.0, v11
    v_mfma_f32_16x16x32_bf16 v[108:111], v[232:235], v[24:27], v[108:111]
    s_waitcnt lgkmcnt(4)
    v_mfma_f32_16x16x32_bf16 v[104:107], v[164:167], v[28:31], v[104:107]
    v_add_f32 v12, 1.0, v12
    v_add_f32 v13, 1.0, v13
    v_mfma_f32_16x16x32_bf16 v[108:111], v[236:239], v[28:31], v[108:111]
    s_waitcnt lgkmcnt(3)
    v_mfma_f32_16x16x32_bf16 v[104:107], v[168:171], v[32:35], v[104:107]
    v_rcp_f32 v10, v10
    v_mfma_f32_16x16x32_bf16 v[108:111], v[240:243], v[32:35], v[108:111]
    s_waitcnt lgkmcnt(2)
    v_mfma_f32_16x16x32_bf16 v[104:107], v[172:175], v[36:39], v[104:107]
    v_rcp_f32 v11, v11
    v_mfma_f32_16x16x32_bf16 v[108:111], v[244:247], v[36:39], v[108:111]
    s_waitcnt lgkmcnt(1)
    v_mfma_f32_16x16x32_bf16 v[104:107], v[176:179], v[40:43], v[104:107]
    v_rcp_f32 v12, v12
    v_mfma_f32_16x16x32_bf16 v[108:111], v[248:251], v[40:43], v[108:111]
    s_waitcnt lgkmcnt(0)
    s_setprio 3
    s_barrier
    v_mfma_f32_16x16x32_bf16 v[104:107], v[180:183], v[44:47], v[104:107]
    v_rcp_f32 v13, v13
    v_mfma_f32_16x16x32_bf16 v[108:111], v[252:255], v[44:47], v[108:111]
    s_setprio 0
    s_mul_i32 s44, s51, 9
    s_add_u32 s68, s44, s49
    s_add_u32 s44, s44, s63
    s_add_u32 m0, s42, 90112
    s_add_u32 s45, s44, 0
    buffer_load_dwordx4 v3, s[8:11], s45 offen lds
    v_mov_b32 v24, 1
    v_lshlrev_b32 v25, 2, v0
    v_and_b32 v25, 127, v25
    s_mov_b64 exec, s[100:101]
    buffer_store_dword v24, v25, s[92:95], s99 offen sc0 sc1
    s_mov_b64 exec, -1
    buffer_load_dwordx4 v4, s[8:11], s45 offen offset:1024 lds
    s_add_u32 m0, s43, 90112
    s_add_u32 s45, s68, 0
    s_mov_b64 exec, 0xffff
    buffer_load_dwordx4 v5, s[8:11], s45 offen lds
    s_mov_b64 exec, -1
    v_and_b32 v28, 63, v0
    v_lshlrev_b32 v28, 7, v28
    s_mov_b32 m0, 32256
    s_and_b32 s34, s22, 3
    s_cmp_eq_u32 s34, 0
    s_cselect_b64 exec, -1, 0
    buffer_load_dword v28, s[28:31], s91 offen lds
    s_mov_b64 exec, -1
    v_mul_f32 v14, v14, v10
    v_mul_f32 v15, v15, v11
    ds_read_b128 v[24:27], v7 offset:32768
    v_mul_f32 v16, v16, v12
    v_mul_f32 v17, v17, v13
    ds_read_b128 v[28:31], v8 offset:32768
    v_cvt_pk_bf16_f32 v20, v14, v15
    v_cvt_pk_bf16_f32 v21, v16, v17
    ds_read_b128 v[32:35], v7 offset:34816
    s_nop 0
    v_permlane16_swap_b32 v18, v20
    v_permlane16_swap_b32 v19, v21
    ds_read_b128 v[36:39], v8 offset:34816
    s_nop 0
    buffer_store_dwordx4 v[18:21], v23, s[16:19], s47 offen sc0 sc1
    s_add_u32 s47, s47, 4096
    v_mul_f32 v10, s46, v64
    v_mul_f32 v11, s46, v65
    ds_read_b128 v[40:43], v7 offset:36864
    v_mul_f32 v12, s46, v66
    v_mul_f32 v13, s46, v67
    ds_read_b128 v[44:47], v8 offset:36864
    v_exp_f32 v10, v10
    v_exp_f32 v11, v11
    v_exp_f32 v12, v12
    v_exp_f32 v13, v13
    v_mul_f32 v14, v64, v68
    v_mul_f32 v15, v65, v69
    v_mul_f32 v16, v66, v70
    v_mul_f32 v17, v67, v71
    v_add_f32 v10, 1.0, v10
    s_waitcnt vmcnt(7) lgkmcnt(0)
    s_barrier
    s_setprio 1
    v_mfma_f32_16x16x32_bf16 v[48:51], v[112:115], v[24:27], 0
    v_add_f32 v11, 1.0, v11
    v_add_f32 v12, 1.0, v12
    v_mfma_f32_16x16x32_bf16 v[52:55], v[184:187], v[24:27], 0
    ds_read_b128 v[24:27], v7 offset:38912
    v_mfma_f32_16x16x32_bf16 v[48:51], v[116:119], v[28:31], v[48:51]
    v_add_f32 v13, 1.0, v13
    v_mfma_f32_16x16x32_bf16 v[52:55], v[188:191], v[28:31], v[52:55]
    ds_read_b128 v[28:31], v8 offset:38912
    v_mfma_f32_16x16x32_bf16 v[48:51], v[120:123], v[32:35], v[48:51]
    v_rcp_f32 v10, v10
    v_mfma_f32_16x16x32_bf16 v[52:55], v[192:195], v[32:35], v[52:55]
    ds_read_b128 v[32:35], v7 offset:40960
    v_mfma_f32_16x16x32_bf16 v[48:51], v[124:127], v[36:39], v[48:51]
    v_rcp_f32 v11, v11
    v_mfma_f32_16x16x32_bf16 v[52:55], v[196:199], v[36:39], v[52:55]
    ds_read_b128 v[36:39], v8 offset:40960
    v_mfma_f32_16x16x32_bf16 v[48:51], v[128:131], v[40:43], v[48:51]
    v_rcp_f32 v12, v12
    v_mfma_f32_16x16x32_bf16 v[52:55], v[200:203], v[40:43], v[52:55]
    ds_read_b128 v[40:43], v7 offset:43008
    v_mfma_f32_16x16x32_bf16 v[48:51], v[132:135], v[44:47], v[48:51]
    v_rcp_f32 v13, v13
    v_mfma_f32_16x16x32_bf16 v[52:55], v[204:207], v[44:47], v[52:55]
    ds_read_b128 v[44:47], v8 offset:43008
    s_waitcnt lgkmcnt(5)
    v_mfma_f32_16x16x32_bf16 v[48:51], v[136:139], v[24:27], v[48:51]
    v_mul_f32 v14, v14, v10
    v_mul_f32 v15, v15, v11
    v_mfma_f32_16x16x32_bf16 v[52:55], v[208:211], v[24:27], v[52:55]
    ds_read_b128 v[24:27], v7 offset:45056
    s_waitcnt lgkmcnt(5)
    v_mfma_f32_16x16x32_bf16 v[48:51], v[140:143], v[28:31], v[48:51]
    v_mul_f32 v16, v16, v12
    v_mul_f32 v17, v17, v13
    v_mfma_f32_16x16x32_bf16 v[52:55], v[212:215], v[28:31], v[52:55]
    ds_read_b128 v[28:31], v8 offset:45056
    s_waitcnt lgkmcnt(5)
    v_mfma_f32_16x16x32_bf16 v[48:51], v[144:147], v[32:35], v[48:51]
    v_cvt_pk_bf16_f32 v18, v14, v15
    v_cvt_pk_bf16_f32 v19, v16, v17
    v_mfma_f32_16x16x32_bf16 v[52:55], v[216:219], v[32:35], v[52:55]
    ds_read_b128 v[32:35], v7 offset:47104
    s_waitcnt lgkmcnt(5)
    v_mfma_f32_16x16x32_bf16 v[48:51], v[148:151], v[36:39], v[48:51]
    v_mul_f32 v10, s46, v72
    v_mul_f32 v11, s46, v73
    v_mfma_f32_16x16x32_bf16 v[52:55], v[220:223], v[36:39], v[52:55]
    ds_read_b128 v[36:39], v8 offset:47104
    s_waitcnt lgkmcnt(5)
    v_mfma_f32_16x16x32_bf16 v[48:51], v[152:155], v[40:43], v[48:51]
    v_mul_f32 v12, s46, v74
    v_mul_f32 v13, s46, v75
    v_mfma_f32_16x16x32_bf16 v[52:55], v[224:227], v[40:43], v[52:55]
    ds_read_b128 v[40:43], v7 offset:49152
    s_waitcnt lgkmcnt(5)
    v_mfma_f32_16x16x32_bf16 v[48:51], v[156:159], v[44:47], v[48:51]
    v_exp_f32 v10, v10
    v_mfma_f32_16x16x32_bf16 v[52:55], v[228:231], v[44:47], v[52:55]
    ds_read_b128 v[44:47], v8 offset:49152
    s_waitcnt lgkmcnt(5)
    v_mfma_f32_16x16x32_bf16 v[48:51], v[160:163], v[24:27], v[48:51]
    v_exp_f32 v11, v11
    v_mfma_f32_16x16x32_bf16 v[52:55], v[232:235], v[24:27], v[52:55]
    s_waitcnt lgkmcnt(4)
    v_mfma_f32_16x16x32_bf16 v[48:51], v[164:167], v[28:31], v[48:51]
    v_exp_f32 v12, v12
    v_mfma_f32_16x16x32_bf16 v[52:55], v[236:239], v[28:31], v[52:55]
    s_waitcnt lgkmcnt(3)
    v_mfma_f32_16x16x32_bf16 v[48:51], v[168:171], v[32:35], v[48:51]
    v_exp_f32 v13, v13
    v_mfma_f32_16x16x32_bf16 v[52:55], v[240:243], v[32:35], v[52:55]
    s_waitcnt lgkmcnt(2)
    v_mfma_f32_16x16x32_bf16 v[48:51], v[172:175], v[36:39], v[48:51]
    v_mul_f32 v14, v72, v76
    v_mul_f32 v15, v73, v77
    v_mfma_f32_16x16x32_bf16 v[52:55], v[244:247], v[36:39], v[52:55]
    s_waitcnt lgkmcnt(1)
    v_mfma_f32_16x16x32_bf16 v[48:51], v[176:179], v[40:43], v[48:51]
    v_mul_f32 v16, v74, v78
    v_mul_f32 v17, v75, v79
    v_mfma_f32_16x16x32_bf16 v[52:55], v[248:251], v[40:43], v[52:55]
    s_waitcnt lgkmcnt(0)
    s_setprio 3
    s_barrier
    v_mfma_f32_16x16x32_bf16 v[48:51], v[180:183], v[44:47], v[48:51]
    v_add_f32 v10, 1.0, v10
    v_add_f32 v11, 1.0, v11
    v_mfma_f32_16x16x32_bf16 v[52:55], v[252:255], v[44:47], v[52:55]
    s_setprio 0
    v_and_b32 v29, 63, v0
    v_lshlrev_b32 v29, 3, v29
    ds_read_b64 v[24:25], v29 offset:65024
    v_bfe_u32 v26, v0, 2, 2
    v_xor_b32 v26, 3, v26
    v_bfe_u32 v27, v0, 4, 2
    v_lshlrev_b32 v27, 5, v27
    v_lshl_add_u32 v26, v26, 7, v27
    v_and_b32 v27, 3, v0
    v_lshl_add_u32 v26, v27, 3, v26
    s_and_b32 s34, s22, 3
    s_lshl_b32 s35, s33, 15
    s_lshl_b32 s3, s34, 11
    s_add_u32 s3, s3, s35
    v_add_u32 v29, s3, v26
    ds_read_b64_tr_b16 v[30:31], v29 offset:18432
    ds_read_b64_tr_b16 v[32:33], v29 offset:18944
    ds_read_b64_tr_b16 v[34:35], v29 offset:19456
    s_lshl_b32 s34, s34, 10
    s_add_u32 s35, s35, s34
    s_add_u32 s35, s35, 27136
    v_add_u32 v27, s35, v26
    ds_read_b64_tr_b16 v[38:39], v27 offset:0
    ds_read_b64_tr_b16 v[36:37], v27 offset:512
    s_add_u32 m0, s42, 108544
    s_add_u32 s45, s44, 18432
    buffer_load_dwordx4 v3, s[8:11], s45 offen lds
    buffer_load_dwordx4 v4, s[8:11], s45 offen offset:1024 lds
    s_add_u32 m0, s43, 108544
    s_add_u32 s45, s68, 18432
    s_mov_b64 exec, 0xffff
    buffer_load_dwordx4 v5, s[8:11], s45 offen lds
    s_mov_b64 exec, -1
    s_waitcnt lgkmcnt(0)
    v_lshlrev_b32 v26, 16, v24
    v_alignbit_b32 v27, v25, v24, 16
    v_lshrrev_b32 v28, 16, v25
    v_xor_b32 v29, s5, v0
    v_and_b32 v29, 7, v29
    v_dot2_f32_bf16 v46, v33, v24, 0
    v_dot2_f32_bf16 v44, v32, v24, 0
    v_dot2_f32_bf16 v42, v35, v24, 0
    v_dot2_f32_bf16 v40, v34, v24, 0
    v_dot2_f32_bf16 v47, v33, v26, 0
    v_dot2_f32_bf16 v45, v32, v26, 0
    v_dot2_f32_bf16 v43, v35, v26, 0
    v_dot2_f32_bf16 v41, v34, v26, 0
    v_dot2_f32_bf16 v46, v30, v25, v46
    v_dot2_f32_bf16 v44, v33, v25, v44
    v_dot2_f32_bf16 v42, v32, v25, v42
    v_dot2_f32_bf16 v40, v35, v25, v40
    v_dot2_f32_bf16 v47, v30, v27, v47
    v_dot2_f32_bf16 v45, v33, v27, v45
    v_dot2_f32_bf16 v43, v32, v27, v43
    v_dot2_f32_bf16 v41, v35, v27, v41
    v_dot2_f32_bf16 v47, v31, v28, v47
    v_dot2_f32_bf16 v45, v30, v28, v45
    v_dot2_f32_bf16 v43, v33, v28, v43
    v_dot2_f32_bf16 v41, v32, v28, v41
    v_bfe_u32 v28, v0, 3, 3
    v_lshlrev_b32 v28, 15, v28
    v_lshl_add_u32 v29, v29, 4, v28
    v_lshlrev_b32 v24, 16, v36
    v_and_b32 v25, 0xffff0000, v36
    v_lshlrev_b32 v26, 16, v37
    v_and_b32 v27, 0xffff0000, v37
    v_lshlrev_b32 v30, 16, v38
    v_and_b32 v31, 0xffff0000, v38
    v_lshlrev_b32 v32, 16, v39
    v_and_b32 v33, 0xffff0000, v39
    v_mul_f32 v40, v40, v24
    v_mul_f32 v41, v41, v25
    v_mul_f32 v42, v42, v26
    v_mul_f32 v43, v43, v27
    v_mul_f32 v44, v44, v30
    v_mul_f32 v45, v45, v31
    v_mul_f32 v46, v46, v32
    v_mul_f32 v47, v47, v33
    v_cvt_pk_bf16_f32 v36, v40, v41
    v_cvt_pk_bf16_f32 v37, v42, v43
    v_cvt_pk_bf16_f32 v38, v44, v45
    v_cvt_pk_bf16_f32 v39, v46, v47
    s_mov_b64 exec, s[66:67]
    global_store_dwordx4 v29, v[36:39], s[64:65] offset:0 sc0 sc1
    s_mov_b64 exec, -1
    v_and_b32 v28, 63, v0
    v_lshlrev_b32 v28, 7, v28
    s_mov_b32 m0, 32256
    s_and_b32 s34, s22, 3
    s_cmp_eq_u32 s34, 1
    s_cselect_b64 exec, -1, 0
    buffer_load_dword v28, s[28:31], s91 offen lds
    s_mov_b64 exec, -1
    v_add_u32 v7, 65536, v7
    v_add_u32 v8, 65536, v8
    ds_read_b128 v[24:27], v7 offset:0
    ds_read_b128 v[28:31], v8 offset:0
    ds_read_b128 v[32:35], v7 offset:2048
    ds_read_b128 v[36:39], v8 offset:2048
    ds_read_b128 v[40:43], v7 offset:4096
    ds_read_b128 v[44:47], v8 offset:4096
    s_waitcnt vmcnt(7) lgkmcnt(0)
    s_barrier
    s_setprio 1
    v_mfma_f32_16x16x32_bf16 v[56:59], v[112:115], v[24:27], 0
    v_add_f32 v12, 1.0, v12
    v_add_f32 v13, 1.0, v13
    v_mfma_f32_16x16x32_bf16 v[60:63], v[184:187], v[24:27], 0
    ds_read_b128 v[24:27], v7 offset:6144
    v_mfma_f32_16x16x32_bf16 v[56:59], v[116:119], v[28:31], v[56:59]
    v_rcp_f32 v10, v10
    v_mfma_f32_16x16x32_bf16 v[60:63], v[188:191], v[28:31], v[60:63]
    ds_read_b128 v[28:31], v8 offset:6144
    v_mfma_f32_16x16x32_bf16 v[56:59], v[120:123], v[32:35], v[56:59]
    v_rcp_f32 v11, v11
    v_mfma_f32_16x16x32_bf16 v[60:63], v[192:195], v[32:35], v[60:63]
    ds_read_b128 v[32:35], v7 offset:8192
    v_mfma_f32_16x16x32_bf16 v[56:59], v[124:127], v[36:39], v[56:59]
    v_rcp_f32 v12, v12
    v_mfma_f32_16x16x32_bf16 v[60:63], v[196:199], v[36:39], v[60:63]
    ds_read_b128 v[36:39], v8 offset:8192
    v_mfma_f32_16x16x32_bf16 v[56:59], v[128:131], v[40:43], v[56:59]
    v_rcp_f32 v13, v13
    v_mfma_f32_16x16x32_bf16 v[60:63], v[200:203], v[40:43], v[60:63]
    ds_read_b128 v[40:43], v7 offset:10240
    v_mfma_f32_16x16x32_bf16 v[56:59], v[132:135], v[44:47], v[56:59]
    v_mul_f32 v14, v14, v10
    v_mul_f32 v15, v15, v11
    v_mfma_f32_16x16x32_bf16 v[60:63], v[204:207], v[44:47], v[60:63]
    ds_read_b128 v[44:47], v8 offset:10240
    s_waitcnt lgkmcnt(5)
    v_mfma_f32_16x16x32_bf16 v[56:59], v[136:139], v[24:27], v[56:59]
    v_mul_f32 v16, v16, v12
    v_mul_f32 v17, v17, v13
    v_mfma_f32_16x16x32_bf16 v[60:63], v[208:211], v[24:27], v[60:63]
    ds_read_b128 v[24:27], v7 offset:12288
    s_waitcnt lgkmcnt(5)
    v_mfma_f32_16x16x32_bf16 v[56:59], v[140:143], v[28:31], v[56:59]
    v_cvt_pk_bf16_f32 v20, v14, v15
    v_cvt_pk_bf16_f32 v21, v16, v17
    v_mfma_f32_16x16x32_bf16 v[60:63], v[212:215], v[28:31], v[60:63]
    ds_read_b128 v[28:31], v8 offset:12288
    s_waitcnt lgkmcnt(5)
    v_mfma_f32_16x16x32_bf16 v[56:59], v[144:147], v[32:35], v[56:59]
    s_nop 0
    v_permlane16_swap_b32 v18, v20
    v_permlane16_swap_b32 v19, v21
    s_nop 0
    buffer_store_dwordx4 v[18:21], v23, s[16:19], s47 offen sc0 sc1
    s_add_u32 s47, s47, 4096
    v_mfma_f32_16x16x32_bf16 v[60:63], v[216:219], v[32:35], v[60:63]
    ds_read_b128 v[32:35], v7 offset:14336
    s_waitcnt lgkmcnt(5)
    v_mfma_f32_16x16x32_bf16 v[56:59], v[148:151], v[36:39], v[56:59]
    v_mul_f32 v10, s46, v80
    v_mul_f32 v11, s46, v81
    v_mfma_f32_16x16x32_bf16 v[60:63], v[220:223], v[36:39], v[60:63]
    ds_read_b128 v[36:39], v8 offset:14336
    s_waitcnt lgkmcnt(5)
    v_mfma_f32_16x16x32_bf16 v[56:59], v[152:155], v[40:43], v[56:59]
    v_mul_f32 v12, s46, v82
    v_mul_f32 v13, s46, v83
    v_mfma_f32_16x16x32_bf16 v[60:63], v[224:227], v[40:43], v[60:63]
    ds_read_b128 v[40:43], v7 offset:16384
    s_waitcnt lgkmcnt(5)
    v_mfma_f32_16x16x32_bf16 v[56:59], v[156:159], v[44:47], v[56:59]
    v_exp_f32 v10, v10
    v_mfma_f32_16x16x32_bf16 v[60:63], v[228:231], v[44:47], v[60:63]
    ds_read_b128 v[44:47], v8 offset:16384
    s_waitcnt lgkmcnt(5)
    v_mfma_f32_16x16x32_bf16 v[56:59], v[160:163], v[24:27], v[56:59]
    v_exp_f32 v11, v11
    v_mfma_f32_16x16x32_bf16 v[60:63], v[232:235], v[24:27], v[60:63]
    s_waitcnt lgkmcnt(4)
    v_mfma_f32_16x16x32_bf16 v[56:59], v[164:167], v[28:31], v[56:59]
    v_exp_f32 v12, v12
    v_mfma_f32_16x16x32_bf16 v[60:63], v[236:239], v[28:31], v[60:63]
    s_waitcnt lgkmcnt(3)
    v_mfma_f32_16x16x32_bf16 v[56:59], v[168:171], v[32:35], v[56:59]
    v_exp_f32 v13, v13
    v_mfma_f32_16x16x32_bf16 v[60:63], v[240:243], v[32:35], v[60:63]
    s_waitcnt lgkmcnt(2)
    v_mfma_f32_16x16x32_bf16 v[56:59], v[172:175], v[36:39], v[56:59]
    v_mul_f32 v14, v80, v84
    v_mul_f32 v15, v81, v85
    v_mfma_f32_16x16x32_bf16 v[60:63], v[244:247], v[36:39], v[60:63]
    s_waitcnt lgkmcnt(1)
    v_mfma_f32_16x16x32_bf16 v[56:59], v[176:179], v[40:43], v[56:59]
    v_mul_f32 v16, v82, v86
    v_mul_f32 v17, v83, v87
    v_mfma_f32_16x16x32_bf16 v[60:63], v[248:251], v[40:43], v[60:63]
    s_waitcnt lgkmcnt(0)
    s_setprio 3
    s_barrier
    v_mfma_f32_16x16x32_bf16 v[56:59], v[180:183], v[44:47], v[56:59]
    v_add_f32 v10, 1.0, v10
    v_add_f32 v11, 1.0, v11
    v_mfma_f32_16x16x32_bf16 v[60:63], v[252:255], v[44:47], v[60:63]
    s_setprio 0
    v_and_b32 v29, 63, v0
    v_lshlrev_b32 v29, 3, v29
    ds_read_b64 v[24:25], v29 offset:65024
    v_bfe_u32 v26, v0, 2, 2
    v_xor_b32 v26, 3, v26
    v_bfe_u32 v27, v0, 4, 2
    v_lshlrev_b32 v27, 5, v27
    v_lshl_add_u32 v26, v26, 7, v27
    v_and_b32 v27, 3, v0
    v_lshl_add_u32 v26, v27, 3, v26
    s_and_b32 s34, s22, 3
    s_lshl_b32 s35, s33, 15
    s_lshl_b32 s3, s34, 11
    s_add_u32 s3, s3, s35
    v_add_u32 v29, s3, v26
    ds_read_b64_tr_b16 v[30:31], v29 offset:19456
    ds_read_b64_tr_b16 v[32:33], v29 offset:19968
    ds_read_b64_tr_b16 v[34:35], v29 offset:20480
    s_lshl_b32 s35, s33, 15
    s_add_u32 s35, s35, 31232
    s_sub_u32 s34, s22, s33
    s_lshl_b32 s34, s34, 10
    s_add_u32 s34, s34, 83968
    s_and_b32 s3, s22, 3
    s_cmp_eq_u32 s3, 3
    s_cselect_b32 s35, s35, s34
    v_add_u32 v27, s35, v26
    ds_read_b64_tr_b16 v[38:39], v27 offset:0
    ds_read_b64_tr_b16 v[36:37], v27 offset:512
    s_add_u32 m0, s42, 126976
    s_add_u32 s45, s44, 36864
    buffer_load_dwordx4 v3, s[8:11], s45 offen lds
    buffer_load_dwordx4 v4, s[8:11], s45 offen offset:1024 lds
    s_add_u32 m0, s43, 126976
    s_add_u32 s45, s68, 36864
    s_mov_b64 exec, 0xffff
    buffer_load_dwordx4 v5, s[8:11], s45 offen lds
    s_mov_b64 exec, -1
    s_waitcnt lgkmcnt(0)
    v_lshlrev_b32 v26, 16, v24
    v_alignbit_b32 v27, v25, v24, 16
    v_lshrrev_b32 v28, 16, v25
    v_xor_b32 v29, s5, v0
    v_and_b32 v29, 7, v29
    v_dot2_f32_bf16 v46, v33, v24, 0
    v_dot2_f32_bf16 v44, v32, v24, 0
    v_dot2_f32_bf16 v42, v35, v24, 0
    v_dot2_f32_bf16 v40, v34, v24, 0
    v_dot2_f32_bf16 v47, v33, v26, 0
    v_dot2_f32_bf16 v45, v32, v26, 0
    v_dot2_f32_bf16 v43, v35, v26, 0
    v_dot2_f32_bf16 v41, v34, v26, 0
    v_dot2_f32_bf16 v46, v30, v25, v46
    v_dot2_f32_bf16 v44, v33, v25, v44
    v_dot2_f32_bf16 v42, v32, v25, v42
    v_dot2_f32_bf16 v40, v35, v25, v40
    v_dot2_f32_bf16 v47, v30, v27, v47
    v_dot2_f32_bf16 v45, v33, v27, v45
    v_dot2_f32_bf16 v43, v32, v27, v43
    v_dot2_f32_bf16 v41, v35, v27, v41
    v_dot2_f32_bf16 v47, v31, v28, v47
    v_dot2_f32_bf16 v45, v30, v28, v45
    v_dot2_f32_bf16 v43, v33, v28, v43
    v_dot2_f32_bf16 v41, v32, v28, v41
    v_bfe_u32 v28, v0, 3, 3
    v_lshlrev_b32 v28, 15, v28
    v_lshl_add_u32 v29, v29, 4, v28
    v_lshlrev_b32 v24, 16, v36
    v_and_b32 v25, 0xffff0000, v36
    v_lshlrev_b32 v26, 16, v37
    v_and_b32 v27, 0xffff0000, v37
    v_lshlrev_b32 v30, 16, v38
    v_and_b32 v31, 0xffff0000, v38
    v_lshlrev_b32 v32, 16, v39
    v_and_b32 v33, 0xffff0000, v39
    v_mul_f32 v40, v40, v24
    v_mul_f32 v41, v41, v25
    v_mul_f32 v42, v42, v26
    v_mul_f32 v43, v43, v27
    v_mul_f32 v44, v44, v30
    v_mul_f32 v45, v45, v31
    v_mul_f32 v46, v46, v32
    v_mul_f32 v47, v47, v33
    v_cvt_pk_bf16_f32 v36, v40, v41
    v_cvt_pk_bf16_f32 v37, v42, v43
    v_cvt_pk_bf16_f32 v38, v44, v45
    v_cvt_pk_bf16_f32 v39, v46, v47
    s_mov_b64 exec, s[66:67]
    global_store_dwordx4 v29, v[36:39], s[64:65] offset:-128 sc0 sc1
    s_mov_b64 exec, -1
    v_and_b32 v28, 63, v0
    v_lshlrev_b32 v28, 7, v28
    s_mov_b32 m0, 32256
    s_and_b32 s34, s22, 3
    s_cmp_eq_u32 s34, 2
    s_cselect_b64 exec, -1, 0
    buffer_load_dword v28, s[28:31], s91 offen lds
    s_mov_b64 exec, -1
    ds_read_b128 v[24:27], v7 offset:24576
    ds_read_b128 v[28:31], v8 offset:24576
    ds_read_b128 v[32:35], v7 offset:26624
    ds_read_b128 v[36:39], v8 offset:26624
    ds_read_b128 v[40:43], v7 offset:28672
    ds_read_b128 v[44:47], v8 offset:28672
    s_waitcnt vmcnt(8) lgkmcnt(0)
    s_barrier
    s_setprio 1
    v_mfma_f32_16x16x32_bf16 v[64:67], v[112:115], v[24:27], 0
    v_add_f32 v12, 1.0, v12
    v_add_f32 v13, 1.0, v13
    v_mfma_f32_16x16x32_bf16 v[68:71], v[184:187], v[24:27], 0
    ds_read_b128 v[24:27], v7 offset:30720
    v_mfma_f32_16x16x32_bf16 v[64:67], v[116:119], v[28:31], v[64:67]
    v_rcp_f32 v10, v10
    v_mfma_f32_16x16x32_bf16 v[68:71], v[188:191], v[28:31], v[68:71]
    ds_read_b128 v[28:31], v8 offset:30720
    v_mfma_f32_16x16x32_bf16 v[64:67], v[120:123], v[32:35], v[64:67]
    v_rcp_f32 v11, v11
    v_mfma_f32_16x16x32_bf16 v[68:71], v[192:195], v[32:35], v[68:71]
    ds_read_b128 v[32:35], v7 offset:32768
    v_mfma_f32_16x16x32_bf16 v[64:67], v[124:127], v[36:39], v[64:67]
    v_rcp_f32 v12, v12
    v_mfma_f32_16x16x32_bf16 v[68:71], v[196:199], v[36:39], v[68:71]
    ds_read_b128 v[36:39], v8 offset:32768
    v_mfma_f32_16x16x32_bf16 v[64:67], v[128:131], v[40:43], v[64:67]
    v_rcp_f32 v13, v13
    v_mfma_f32_16x16x32_bf16 v[68:71], v[200:203], v[40:43], v[68:71]
    ds_read_b128 v[40:43], v7 offset:34816
    v_mfma_f32_16x16x32_bf16 v[64:67], v[132:135], v[44:47], v[64:67]
    v_mul_f32 v14, v14, v10
    v_mul_f32 v15, v15, v11
    v_mfma_f32_16x16x32_bf16 v[68:71], v[204:207], v[44:47], v[68:71]
    ds_read_b128 v[44:47], v8 offset:34816
    s_waitcnt lgkmcnt(5)
    v_mfma_f32_16x16x32_bf16 v[64:67], v[136:139], v[24:27], v[64:67]
    v_mul_f32 v16, v16, v12
    v_mul_f32 v17, v17, v13
    v_mfma_f32_16x16x32_bf16 v[68:71], v[208:211], v[24:27], v[68:71]
    ds_read_b128 v[24:27], v7 offset:36864
    s_waitcnt lgkmcnt(5)
    v_mfma_f32_16x16x32_bf16 v[64:67], v[140:143], v[28:31], v[64:67]
    v_cvt_pk_bf16_f32 v18, v14, v15
    v_cvt_pk_bf16_f32 v19, v16, v17
    v_mfma_f32_16x16x32_bf16 v[68:71], v[212:215], v[28:31], v[68:71]
    ds_read_b128 v[28:31], v8 offset:36864
    s_waitcnt lgkmcnt(5)
    v_mfma_f32_16x16x32_bf16 v[64:67], v[144:147], v[32:35], v[64:67]
    v_mul_f32 v10, s46, v88
    v_mul_f32 v11, s46, v89
    v_mfma_f32_16x16x32_bf16 v[68:71], v[216:219], v[32:35], v[68:71]
    ds_read_b128 v[32:35], v7 offset:38912
    s_waitcnt lgkmcnt(5)
    v_mfma_f32_16x16x32_bf16 v[64:67], v[148:151], v[36:39], v[64:67]
    v_mul_f32 v12, s46, v90
    v_mul_f32 v13, s46, v91
    v_mfma_f32_16x16x32_bf16 v[68:71], v[220:223], v[36:39], v[68:71]
    ds_read_b128 v[36:39], v8 offset:38912
    s_waitcnt lgkmcnt(5)
    v_mfma_f32_16x16x32_bf16 v[64:67], v[152:155], v[40:43], v[64:67]
    v_exp_f32 v10, v10
    v_mfma_f32_16x16x32_bf16 v[68:71], v[224:227], v[40:43], v[68:71]
    ds_read_b128 v[40:43], v7 offset:40960
    s_waitcnt lgkmcnt(5)
    v_mfma_f32_16x16x32_bf16 v[64:67], v[156:159], v[44:47], v[64:67]
    v_exp_f32 v11, v11
    v_mfma_f32_16x16x32_bf16 v[68:71], v[228:231], v[44:47], v[68:71]
    ds_read_b128 v[44:47], v8 offset:40960
    s_waitcnt lgkmcnt(5)
    v_mfma_f32_16x16x32_bf16 v[64:67], v[160:163], v[24:27], v[64:67]
    v_exp_f32 v12, v12
    v_mfma_f32_16x16x32_bf16 v[68:71], v[232:235], v[24:27], v[68:71]
    s_waitcnt lgkmcnt(4)
    v_mfma_f32_16x16x32_bf16 v[64:67], v[164:167], v[28:31], v[64:67]
    v_exp_f32 v13, v13
    v_mfma_f32_16x16x32_bf16 v[68:71], v[236:239], v[28:31], v[68:71]
    s_waitcnt lgkmcnt(3)
    v_mfma_f32_16x16x32_bf16 v[64:67], v[168:171], v[32:35], v[64:67]
    v_mul_f32 v14, v88, v92
    v_mul_f32 v15, v89, v93
    v_mfma_f32_16x16x32_bf16 v[68:71], v[240:243], v[32:35], v[68:71]
    s_waitcnt lgkmcnt(2)
    v_mfma_f32_16x16x32_bf16 v[64:67], v[172:175], v[36:39], v[64:67]
    v_mul_f32 v16, v90, v94
    v_mul_f32 v17, v91, v95
    v_mfma_f32_16x16x32_bf16 v[68:71], v[244:247], v[36:39], v[68:71]
    s_waitcnt lgkmcnt(1)
    v_mfma_f32_16x16x32_bf16 v[64:67], v[176:179], v[40:43], v[64:67]
    v_add_f32 v10, 1.0, v10
    v_add_f32 v11, 1.0, v11
    v_mfma_f32_16x16x32_bf16 v[68:71], v[248:251], v[40:43], v[68:71]
    s_waitcnt lgkmcnt(0)
    s_setprio 3
    s_barrier
    v_mfma_f32_16x16x32_bf16 v[64:67], v[180:183], v[44:47], v[64:67]
    v_add_f32 v12, 1.0, v12
    v_add_f32 v13, 1.0, v13
    v_mfma_f32_16x16x32_bf16 v[68:71], v[252:255], v[44:47], v[68:71]
    s_setprio 0
    s_add_u32 m0, s42, 145408
    s_add_u32 s45, s44, 55296
    buffer_load_dwordx4 v3, s[8:11], s45 offen lds
    buffer_load_dwordx4 v4, s[8:11], s45 offen offset:1024 lds
    s_add_u32 m0, s43, 145408
    s_add_u32 s45, s68, 55296
    s_mov_b64 exec, 0xffff
    buffer_load_dwordx4 v5, s[8:11], s45 offen lds
    s_mov_b64 exec, -1
    v_and_b32 v28, 63, v0
    v_lshlrev_b32 v28, 7, v28
    s_mov_b32 m0, 32256
    s_and_b32 s34, s22, 3
    s_cmp_eq_u32 s34, 3
    s_cselect_b64 exec, -1, 0
    buffer_load_dword v28, s[28:31], s91 offen lds
    s_mov_b64 exec, -1
    v_rcp_f32 v10, v10
    ds_read_b128 v[24:27], v7 offset:43008
    v_rcp_f32 v11, v11
    ds_read_b128 v[28:31], v8 offset:43008
    v_rcp_f32 v12, v12
    ds_read_b128 v[32:35], v7 offset:45056
    v_rcp_f32 v13, v13
    ds_read_b128 v[36:39], v8 offset:45056
    v_mul_f32 v14, v14, v10
    v_mul_f32 v15, v15, v11
    ds_read_b128 v[40:43], v7 offset:47104
    v_mul_f32 v16, v16, v12
    v_mul_f32 v17, v17, v13
    ds_read_b128 v[44:47], v8 offset:47104
    v_cvt_pk_bf16_f32 v20, v14, v15
    v_cvt_pk_bf16_f32 v21, v16, v17
    s_nop 0
    v_permlane16_swap_b32 v18, v20
    v_permlane16_swap_b32 v19, v21
    s_mov_b32 s47, s52
    s_nop 0
    buffer_store_dwordx4 v[18:21], v23, s[16:19], s47 offen sc0 sc1
    s_add_u32 s47, s47, 4096
    v_mul_f32 v10, s46, v96
    v_mul_f32 v11, s46, v97
    v_mul_f32 v12, s46, v98
    v_mul_f32 v13, s46, v99
    v_exp_f32 v10, v10
    v_exp_f32 v11, v11
    v_exp_f32 v12, v12
    v_exp_f32 v13, v13
    v_mul_f32 v14, v96, v100
    v_mul_f32 v15, v97, v101
    v_mul_f32 v16, v98, v102
    v_mul_f32 v17, v99, v103
    v_add_f32 v10, 1.0, v10
    v_add_f32 v11, 1.0, v11
    s_waitcnt vmcnt(6) lgkmcnt(0)
    s_barrier
    s_setprio 1
    v_mfma_f32_16x16x32_bf16 v[72:75], v[112:115], v[24:27], 0
    v_add_f32 v12, 1.0, v12
    v_add_f32 v13, 1.0, v13
    v_mfma_f32_16x16x32_bf16 v[76:79], v[184:187], v[24:27], 0
    ds_read_b128 v[24:27], v7 offset:49152
    v_mfma_f32_16x16x32_bf16 v[72:75], v[116:119], v[28:31], v[72:75]
    v_rcp_f32 v10, v10
    v_mfma_f32_16x16x32_bf16 v[76:79], v[188:191], v[28:31], v[76:79]
    ds_read_b128 v[28:31], v8 offset:49152
    v_mfma_f32_16x16x32_bf16 v[72:75], v[120:123], v[32:35], v[72:75]
    v_rcp_f32 v11, v11
    v_mfma_f32_16x16x32_bf16 v[76:79], v[192:195], v[32:35], v[76:79]
    ds_read_b128 v[32:35], v7 offset:51200
    v_mfma_f32_16x16x32_bf16 v[72:75], v[124:127], v[36:39], v[72:75]
    v_rcp_f32 v12, v12
    v_mfma_f32_16x16x32_bf16 v[76:79], v[196:199], v[36:39], v[76:79]
    ds_read_b128 v[36:39], v8 offset:51200
    v_mfma_f32_16x16x32_bf16 v[72:75], v[128:131], v[40:43], v[72:75]
    v_rcp_f32 v13, v13
    v_mfma_f32_16x16x32_bf16 v[76:79], v[200:203], v[40:43], v[76:79]
    ds_read_b128 v[40:43], v7 offset:53248
    v_mfma_f32_16x16x32_bf16 v[72:75], v[132:135], v[44:47], v[72:75]
    v_mul_f32 v14, v14, v10
    v_mul_f32 v15, v15, v11
    v_mfma_f32_16x16x32_bf16 v[76:79], v[204:207], v[44:47], v[76:79]
    ds_read_b128 v[44:47], v8 offset:53248
    s_waitcnt lgkmcnt(5)
    v_mfma_f32_16x16x32_bf16 v[72:75], v[136:139], v[24:27], v[72:75]
    v_mul_f32 v16, v16, v12
    v_mul_f32 v17, v17, v13
    v_mfma_f32_16x16x32_bf16 v[76:79], v[208:211], v[24:27], v[76:79]
    ds_read_b128 v[24:27], v7 offset:55296
    s_waitcnt lgkmcnt(5)
    v_mfma_f32_16x16x32_bf16 v[72:75], v[140:143], v[28:31], v[72:75]
    v_cvt_pk_bf16_f32 v18, v14, v15
    v_cvt_pk_bf16_f32 v19, v16, v17
    v_mfma_f32_16x16x32_bf16 v[76:79], v[212:215], v[28:31], v[76:79]
    ds_read_b128 v[28:31], v8 offset:55296
    s_waitcnt lgkmcnt(5)
    v_mfma_f32_16x16x32_bf16 v[72:75], v[144:147], v[32:35], v[72:75]
    v_mul_f32 v10, s46, v104
    v_mul_f32 v11, s46, v105
    v_mfma_f32_16x16x32_bf16 v[76:79], v[216:219], v[32:35], v[76:79]
    ds_read_b128 v[32:35], v7 offset:57344
    s_waitcnt lgkmcnt(5)
    v_mfma_f32_16x16x32_bf16 v[72:75], v[148:151], v[36:39], v[72:75]
    v_mul_f32 v12, s46, v106
    v_mul_f32 v13, s46, v107
    v_mfma_f32_16x16x32_bf16 v[76:79], v[220:223], v[36:39], v[76:79]
    ds_read_b128 v[36:39], v8 offset:57344
    s_waitcnt lgkmcnt(5)
    v_mfma_f32_16x16x32_bf16 v[72:75], v[152:155], v[40:43], v[72:75]
    v_exp_f32 v10, v10
    v_mfma_f32_16x16x32_bf16 v[76:79], v[224:227], v[40:43], v[76:79]
    ds_read_b128 v[40:43], v7 offset:59392
    s_waitcnt lgkmcnt(5)
    v_mfma_f32_16x16x32_bf16 v[72:75], v[156:159], v[44:47], v[72:75]
    v_exp_f32 v11, v11
    v_mfma_f32_16x16x32_bf16 v[76:79], v[228:231], v[44:47], v[76:79]
    ds_read_b128 v[44:47], v8 offset:59392
    s_waitcnt lgkmcnt(5)
    v_mfma_f32_16x16x32_bf16 v[72:75], v[160:163], v[24:27], v[72:75]
    v_exp_f32 v12, v12
    v_mfma_f32_16x16x32_bf16 v[76:79], v[232:235], v[24:27], v[76:79]
    s_waitcnt lgkmcnt(4)
    v_mfma_f32_16x16x32_bf16 v[72:75], v[164:167], v[28:31], v[72:75]
    v_exp_f32 v13, v13
    v_mfma_f32_16x16x32_bf16 v[76:79], v[236:239], v[28:31], v[76:79]
    s_waitcnt lgkmcnt(3)
    v_mfma_f32_16x16x32_bf16 v[72:75], v[168:171], v[32:35], v[72:75]
    v_mul_f32 v14, v104, v108
    v_mul_f32 v15, v105, v109
    v_mfma_f32_16x16x32_bf16 v[76:79], v[240:243], v[32:35], v[76:79]
    s_waitcnt lgkmcnt(2)
    v_mfma_f32_16x16x32_bf16 v[72:75], v[172:175], v[36:39], v[72:75]
    v_mul_f32 v16, v106, v110
    v_mul_f32 v17, v107, v111
    v_mfma_f32_16x16x32_bf16 v[76:79], v[244:247], v[36:39], v[76:79]
    s_waitcnt lgkmcnt(1)
    v_mfma_f32_16x16x32_bf16 v[72:75], v[176:179], v[40:43], v[72:75]
    v_add_f32 v10, 1.0, v10
    v_add_f32 v11, 1.0, v11
    v_mfma_f32_16x16x32_bf16 v[76:79], v[248:251], v[40:43], v[76:79]
    s_waitcnt lgkmcnt(0)
    s_setprio 3
    s_barrier
    v_mfma_f32_16x16x32_bf16 v[72:75], v[180:183], v[44:47], v[72:75]
    v_add_f32 v12, 1.0, v12
    v_add_f32 v13, 1.0, v13
    v_mfma_f32_16x16x32_bf16 v[76:79], v[252:255], v[44:47], v[76:79]
    s_setprio 0
    s_mul_i32 s44, s90, 9
    s_add_u32 s68, s44, s49
    s_add_u32 s44, s44, s63
    s_add_u32 m0, s42, 90112
    s_add_u32 s45, s44, 0
    buffer_load_dwordx4 v3, s[8:11], s45 offen lds
    v_mov_b32 v26, 33
    v_lshlrev_b32 v27, 2, v0
    v_and_b32 v27, 127, v27
    s_mov_b64 exec, s[100:101]
    buffer_store_dword v26, v27, s[92:95], s2 offen sc0 sc1
    s_mov_b64 exec, -1
    buffer_load_dwordx4 v4, s[8:11], s45 offen offset:1024 lds
    v_rcp_f32 v10, v10
    v_add_u32 v7, 61440, v7
    v_add_u32 v8, 61440, v8
    ds_read_b128 v[24:27], v7 offset:0
    v_rcp_f32 v11, v11
    ds_read_b128 v[28:31], v8 offset:0
    v_rcp_f32 v12, v12
    ds_read_b128 v[32:35], v7 offset:2048
    v_rcp_f32 v13, v13
    ds_read_b128 v[36:39], v8 offset:2048
    v_mul_f32 v14, v14, v10
    v_mul_f32 v15, v15, v11
    ds_read_b128 v[40:43], v7 offset:4096
    v_mul_f32 v16, v16, v12
    v_mul_f32 v17, v17, v13
    ds_read_b128 v[44:47], v8 offset:4096
    v_cvt_pk_bf16_f32 v20, v14, v15
    s_add_u32 m0, s43, 90112
    s_add_u32 s45, s68, 0
    s_mov_b64 exec, 0xffff
    buffer_load_dwordx4 v5, s[8:11], s45 offen lds
    s_mov_b64 exec, -1
    v_cvt_pk_bf16_f32 v21, v16, v17
    s_nop 0
    v_permlane16_swap_b32 v18, v20
    v_permlane16_swap_b32 v19, v21
    s_mov_b32 s47, s50
    s_nop 0
    buffer_store_dwordx4 v[18:21], v23, s[16:19], s47 offen sc0 sc1
    s_add_u32 s47, s47, 4096
    v_mul_f32 v10, s46, v48
    v_mul_f32 v11, s46, v49
    v_mul_f32 v12, s46, v50
    v_mul_f32 v13, s46, v51
    v_exp_f32 v10, v10
    v_exp_f32 v11, v11
    v_exp_f32 v12, v12
    v_exp_f32 v13, v13
    v_mul_f32 v14, v48, v52
    v_mul_f32 v15, v49, v53
    v_mul_f32 v16, v50, v54
    v_mul_f32 v17, v51, v55
    s_waitcnt vmcnt(7) lgkmcnt(0)
    s_barrier
    s_setprio 1
    v_mfma_f32_16x16x32_bf16 v[80:83], v[112:115], v[24:27], 0
    v_add_f32 v10, 1.0, v10
    v_add_f32 v11, 1.0, v11
    v_mfma_f32_16x16x32_bf16 v[84:87], v[184:187], v[24:27], 0
    ds_read_b128 v[24:27], v7 offset:6144
    v_mfma_f32_16x16x32_bf16 v[80:83], v[116:119], v[28:31], v[80:83]
    v_add_f32 v12, 1.0, v12
    v_add_f32 v13, 1.0, v13
    v_mfma_f32_16x16x32_bf16 v[84:87], v[188:191], v[28:31], v[84:87]
    ds_read_b128 v[28:31], v8 offset:6144
    v_mfma_f32_16x16x32_bf16 v[80:83], v[120:123], v[32:35], v[80:83]
    v_rcp_f32 v10, v10
    v_mfma_f32_16x16x32_bf16 v[84:87], v[192:195], v[32:35], v[84:87]
    ds_read_b128 v[32:35], v7 offset:8192
    v_mfma_f32_16x16x32_bf16 v[80:83], v[124:127], v[36:39], v[80:83]
    v_rcp_f32 v11, v11
    v_mfma_f32_16x16x32_bf16 v[84:87], v[196:199], v[36:39], v[84:87]
    ds_read_b128 v[36:39], v8 offset:8192
    v_mfma_f32_16x16x32_bf16 v[80:83], v[128:131], v[40:43], v[80:83]
    v_rcp_f32 v12, v12
    v_mfma_f32_16x16x32_bf16 v[84:87], v[200:203], v[40:43], v[84:87]
    ds_read_b128 v[40:43], v7 offset:10240
    v_mfma_f32_16x16x32_bf16 v[80:83], v[132:135], v[44:47], v[80:83]
    v_rcp_f32 v13, v13
    v_mfma_f32_16x16x32_bf16 v[84:87], v[204:207], v[44:47], v[84:87]
    ds_read_b128 v[44:47], v8 offset:10240
    s_waitcnt lgkmcnt(5)
    v_mfma_f32_16x16x32_bf16 v[80:83], v[136:139], v[24:27], v[80:83]
    v_mul_f32 v14, v14, v10
    v_mul_f32 v15, v15, v11
    v_mfma_f32_16x16x32_bf16 v[84:87], v[208:211], v[24:27], v[84:87]
    ds_read_b128 v[24:27], v7 offset:12288
    s_waitcnt lgkmcnt(5)
    v_mfma_f32_16x16x32_bf16 v[80:83], v[140:143], v[28:31], v[80:83]
    v_mul_f32 v16, v16, v12
    v_mul_f32 v17, v17, v13
    v_mfma_f32_16x16x32_bf16 v[84:87], v[212:215], v[28:31], v[84:87]
    ds_read_b128 v[28:31], v8 offset:12288
    s_waitcnt lgkmcnt(5)
    v_mfma_f32_16x16x32_bf16 v[80:83], v[144:147], v[32:35], v[80:83]
    v_cvt_pk_bf16_f32 v18, v14, v15
    v_cvt_pk_bf16_f32 v19, v16, v17
    v_mfma_f32_16x16x32_bf16 v[84:87], v[216:219], v[32:35], v[84:87]
    ds_read_b128 v[32:35], v7 offset:14336
    s_waitcnt lgkmcnt(5)
    v_mfma_f32_16x16x32_bf16 v[80:83], v[148:151], v[36:39], v[80:83]
    v_mul_f32 v10, s46, v56
    v_mul_f32 v11, s46, v57
    v_mfma_f32_16x16x32_bf16 v[84:87], v[220:223], v[36:39], v[84:87]
    ds_read_b128 v[36:39], v8 offset:14336
    s_waitcnt lgkmcnt(5)
    v_mfma_f32_16x16x32_bf16 v[80:83], v[152:155], v[40:43], v[80:83]
    v_mul_f32 v12, s46, v58
    v_mul_f32 v13, s46, v59
    v_mfma_f32_16x16x32_bf16 v[84:87], v[224:227], v[40:43], v[84:87]
    ds_read_b128 v[40:43], v7 offset:16384
    s_waitcnt lgkmcnt(5)
    v_mfma_f32_16x16x32_bf16 v[80:83], v[156:159], v[44:47], v[80:83]
    v_exp_f32 v10, v10
    v_mfma_f32_16x16x32_bf16 v[84:87], v[228:231], v[44:47], v[84:87]
    ds_read_b128 v[44:47], v8 offset:16384
    s_waitcnt lgkmcnt(5)
    v_mfma_f32_16x16x32_bf16 v[80:83], v[160:163], v[24:27], v[80:83]
    v_exp_f32 v11, v11
    v_mfma_f32_16x16x32_bf16 v[84:87], v[232:235], v[24:27], v[84:87]
    s_waitcnt lgkmcnt(4)
    v_mfma_f32_16x16x32_bf16 v[80:83], v[164:167], v[28:31], v[80:83]
    v_exp_f32 v12, v12
    v_mfma_f32_16x16x32_bf16 v[84:87], v[236:239], v[28:31], v[84:87]
    s_waitcnt lgkmcnt(3)
    v_mfma_f32_16x16x32_bf16 v[80:83], v[168:171], v[32:35], v[80:83]
    v_exp_f32 v13, v13
    v_mfma_f32_16x16x32_bf16 v[84:87], v[240:243], v[32:35], v[84:87]
    s_waitcnt lgkmcnt(2)
    v_mfma_f32_16x16x32_bf16 v[80:83], v[172:175], v[36:39], v[80:83]
    v_mul_f32 v14, v56, v60
    v_mul_f32 v15, v57, v61
    v_mfma_f32_16x16x32_bf16 v[84:87], v[244:247], v[36:39], v[84:87]
    s_waitcnt lgkmcnt(1)
    v_mfma_f32_16x16x32_bf16 v[80:83], v[176:179], v[40:43], v[80:83]
    v_mul_f32 v16, v58, v62
    v_mul_f32 v17, v59, v63
    v_mfma_f32_16x16x32_bf16 v[84:87], v[248:251], v[40:43], v[84:87]
    s_waitcnt lgkmcnt(0)
    s_setprio 3
    s_barrier
    v_mfma_f32_16x16x32_bf16 v[80:83], v[180:183], v[44:47], v[80:83]
    v_add_f32 v10, 1.0, v10
    v_add_f32 v11, 1.0, v11
    v_mfma_f32_16x16x32_bf16 v[84:87], v[252:255], v[44:47], v[84:87]
    s_setprio 0
    s_add_u32 m0, s42, 108544
    s_add_u32 s45, s44, 18432
    buffer_load_dwordx4 v3, s[8:11], s45 offen lds
    buffer_load_dwordx4 v4, s[8:11], s45 offen offset:1024 lds
    v_add_f32 v12, 1.0, v12
    v_add_f32 v13, 1.0, v13
    ds_read_b128 v[24:27], v7 offset:18432
    v_rcp_f32 v10, v10
    ds_read_b128 v[28:31], v8 offset:18432
    v_rcp_f32 v11, v11
    ds_read_b128 v[32:35], v7 offset:20480
    v_rcp_f32 v12, v12
    ds_read_b128 v[36:39], v8 offset:20480
    v_rcp_f32 v13, v13
    ds_read_b128 v[40:43], v7 offset:22528
    v_mul_f32 v14, v14, v10
    v_mul_f32 v15, v15, v11
    ds_read_b128 v[44:47], v8 offset:22528
    v_mul_f32 v16, v16, v12
    s_add_u32 m0, s43, 108544
    s_add_u32 s45, s68, 18432
    s_mov_b64 exec, 0xffff
    buffer_load_dwordx4 v5, s[8:11], s45 offen lds
    s_mov_b64 exec, -1
    v_mul_f32 v17, v17, v13
    v_cvt_pk_bf16_f32 v20, v14, v15
    v_cvt_pk_bf16_f32 v21, v16, v17
    s_nop 0
    v_permlane16_swap_b32 v18, v20
    v_permlane16_swap_b32 v19, v21
    s_nop 0
    buffer_store_dwordx4 v[18:21], v23, s[16:19], s47 offen sc0 sc1
    s_add_u32 s47, s47, 4096
    v_mul_f32 v10, s46, v64
    v_mul_f32 v11, s46, v65
    v_mul_f32 v12, s46, v66
    v_mul_f32 v13, s46, v67
    v_exp_f32 v10, v10
    v_exp_f32 v11, v11
    v_exp_f32 v12, v12
    v_exp_f32 v13, v13
    v_mul_f32 v14, v64, v68
    s_waitcnt vmcnt(5) lgkmcnt(0)
    s_barrier
    s_setprio 1
    v_mfma_f32_16x16x32_bf16 v[88:91], v[112:115], v[24:27], 0
    v_mul_f32 v15, v65, v69
    v_mul_f32 v16, v66, v70
    v_mfma_f32_16x16x32_bf16 v[92:95], v[184:187], v[24:27], 0
    ds_read_b128 v[24:27], v7 offset:24576
    v_mfma_f32_16x16x32_bf16 v[88:91], v[116:119], v[28:31], v[88:91]
    v_mul_f32 v17, v67, v71
    v_add_f32 v10, 1.0, v10
    v_mfma_f32_16x16x32_bf16 v[92:95], v[188:191], v[28:31], v[92:95]
    ds_read_b128 v[28:31], v8 offset:24576
    v_mfma_f32_16x16x32_bf16 v[88:91], v[120:123], v[32:35], v[88:91]
    v_add_f32 v11, 1.0, v11
    v_add_f32 v12, 1.0, v12
    v_mfma_f32_16x16x32_bf16 v[92:95], v[192:195], v[32:35], v[92:95]
    ds_read_b128 v[32:35], v7 offset:26624
    v_mfma_f32_16x16x32_bf16 v[88:91], v[124:127], v[36:39], v[88:91]
    v_add_f32 v13, 1.0, v13
    v_mfma_f32_16x16x32_bf16 v[92:95], v[196:199], v[36:39], v[92:95]
    ds_read_b128 v[36:39], v8 offset:26624
    v_mfma_f32_16x16x32_bf16 v[88:91], v[128:131], v[40:43], v[88:91]
    v_rcp_f32 v10, v10
    v_mfma_f32_16x16x32_bf16 v[92:95], v[200:203], v[40:43], v[92:95]
    ds_read_b128 v[40:43], v7 offset:28672
    v_mfma_f32_16x16x32_bf16 v[88:91], v[132:135], v[44:47], v[88:91]
    v_rcp_f32 v11, v11
    v_mfma_f32_16x16x32_bf16 v[92:95], v[204:207], v[44:47], v[92:95]
    ds_read_b128 v[44:47], v8 offset:28672
    s_waitcnt lgkmcnt(5)
    v_mfma_f32_16x16x32_bf16 v[88:91], v[136:139], v[24:27], v[88:91]
    v_rcp_f32 v12, v12
    v_mfma_f32_16x16x32_bf16 v[92:95], v[208:211], v[24:27], v[92:95]
    ds_read_b128 v[24:27], v7 offset:30720
    s_waitcnt lgkmcnt(5)
    v_mfma_f32_16x16x32_bf16 v[88:91], v[140:143], v[28:31], v[88:91]
    v_rcp_f32 v13, v13
    v_mfma_f32_16x16x32_bf16 v[92:95], v[212:215], v[28:31], v[92:95]
    ds_read_b128 v[28:31], v8 offset:30720
    s_waitcnt lgkmcnt(5)
    v_mfma_f32_16x16x32_bf16 v[88:91], v[144:147], v[32:35], v[88:91]
    v_mul_f32 v14, v14, v10
    v_mul_f32 v15, v15, v11
    v_mfma_f32_16x16x32_bf16 v[92:95], v[216:219], v[32:35], v[92:95]
    ds_read_b128 v[32:35], v7 offset:32768
    s_waitcnt lgkmcnt(5)
    v_mfma_f32_16x16x32_bf16 v[88:91], v[148:151], v[36:39], v[88:91]
    v_mul_f32 v16, v16, v12
    v_mul_f32 v17, v17, v13
    v_mfma_f32_16x16x32_bf16 v[92:95], v[220:223], v[36:39], v[92:95]
    ds_read_b128 v[36:39], v8 offset:32768
    s_waitcnt lgkmcnt(5)
    v_mfma_f32_16x16x32_bf16 v[88:91], v[152:155], v[40:43], v[88:91]
    v_cvt_pk_bf16_f32 v18, v14, v15
    v_cvt_pk_bf16_f32 v19, v16, v17
    v_mfma_f32_16x16x32_bf16 v[92:95], v[224:227], v[40:43], v[92:95]
    ds_read_b128 v[40:43], v7 offset:34816
    s_waitcnt lgkmcnt(5)
    v_mfma_f32_16x16x32_bf16 v[88:91], v[156:159], v[44:47], v[88:91]
    v_mul_f32 v10, s46, v72
    v_mul_f32 v11, s46, v73
    v_mfma_f32_16x16x32_bf16 v[92:95], v[228:231], v[44:47], v[92:95]
    ds_read_b128 v[44:47], v8 offset:34816
    s_waitcnt lgkmcnt(5)
    v_mfma_f32_16x16x32_bf16 v[88:91], v[160:163], v[24:27], v[88:91]
    v_mul_f32 v12, s46, v74
    v_mul_f32 v13, s46, v75
    v_mfma_f32_16x16x32_bf16 v[92:95], v[232:235], v[24:27], v[92:95]
    s_waitcnt lgkmcnt(4)
    v_mfma_f32_16x16x32_bf16 v[88:91], v[164:167], v[28:31], v[88:91]
    v_exp_f32 v10, v10
    v_mfma_f32_16x16x32_bf16 v[92:95], v[236:239], v[28:31], v[92:95]
    s_waitcnt lgkmcnt(3)
    v_mfma_f32_16x16x32_bf16 v[88:91], v[168:171], v[32:35], v[88:91]
    v_exp_f32 v11, v11
    v_mfma_f32_16x16x32_bf16 v[92:95], v[240:243], v[32:35], v[92:95]
    s_waitcnt lgkmcnt(2)
    v_mfma_f32_16x16x32_bf16 v[88:91], v[172:175], v[36:39], v[88:91]
    v_exp_f32 v12, v12
    v_mfma_f32_16x16x32_bf16 v[92:95], v[244:247], v[36:39], v[92:95]
    s_waitcnt lgkmcnt(1)
    v_mfma_f32_16x16x32_bf16 v[88:91], v[176:179], v[40:43], v[88:91]
    v_exp_f32 v13, v13
    v_mfma_f32_16x16x32_bf16 v[92:95], v[248:251], v[40:43], v[92:95]
    s_waitcnt lgkmcnt(0)
    s_setprio 3
    s_barrier
    v_mfma_f32_16x16x32_bf16 v[88:91], v[180:183], v[44:47], v[88:91]
    v_mul_f32 v14, v72, v76
    v_mul_f32 v15, v73, v77
    v_mfma_f32_16x16x32_bf16 v[92:95], v[252:255], v[44:47], v[92:95]
    s_setprio 0
    s_add_u32 m0, s42, 126976
    s_add_u32 s45, s44, 36864
    buffer_load_dwordx4 v3, s[8:11], s45 offen lds
    v_mov_b32 v26, 37
    v_lshlrev_b32 v27, 2, v0
    v_and_b32 v27, 127, v27
    s_mov_b64 exec, s[100:101]
    buffer_store_dword v26, v27, s[92:95], s2 offen sc0 sc1
    s_mov_b64 exec, -1
    buffer_load_dwordx4 v4, s[8:11], s45 offen offset:1024 lds
    v_mul_f32 v16, v74, v78
    v_mul_f32 v17, v75, v79
    v_add_u32 v7, 4294930432, v7
    v_add_u32 v8, 4294930432, v8
    ds_read_b128 v[24:27], v7 offset:0
    v_add_f32 v10, 1.0, v10
    v_add_f32 v11, 1.0, v11
    ds_read_b128 v[28:31], v8 offset:0
    v_add_f32 v12, 1.0, v12
    v_add_f32 v13, 1.0, v13
    s_add_u32 m0, s43, 126976
    s_add_u32 s45, s68, 36864
    s_mov_b64 exec, 0xffff
    buffer_load_dwordx4 v5, s[8:11], s45 offen lds
    s_mov_b64 exec, -1
    v_rcp_f32 v10, v10
    ds_read_b128 v[32:35], v7 offset:2048
    v_rcp_f32 v11, v11
    ds_read_b128 v[36:39], v8 offset:2048
    v_rcp_f32 v12, v12
    s_and_b32 s3, s54, 15
    s_lshl_b32 s3, s3, 1
    s_add_u32 s3, s3, s33
    s_mul_i32 s3, s3, 73728
    s_add_u32 s3, s3, s62
    s_mul_i32 s21, s33, 40960
    s_add_u32 s21, s21, s41
    s_add_u32 m0, s21, 0
    s_nop 0
    buffer_load_dwordx4 v1, s[12:15], s3 offen offset:0 lds
    v_rcp_f32 v13, v13
    ds_read_b128 v[40:43], v7 offset:4096
    v_mul_f32 v14, v14, v10
    v_mul_f32 v15, v15, v11
    ds_read_b128 v[44:47], v8 offset:4096
    v_mul_f32 v16, v16, v12
    buffer_load_dwordx4 v2, s[12:15], s3 offen offset:1024 lds
    v_mul_f32 v17, v17, v13
    v_cvt_pk_bf16_f32 v20, v14, v15
    v_cvt_pk_bf16_f32 v21, v16, v17
    s_nop 0
    v_permlane16_swap_b32 v18, v20
    v_permlane16_swap_b32 v19, v21
    buffer_load_dwordx4 v6, s[12:15], s3 offen offset:2048 lds
    s_mov_b32 s47, s51
    s_nop 0
    buffer_store_dwordx4 v[18:21], v23, s[16:19], s47 offen sc0 sc1
    s_add_u32 s47, s47, 4096
    v_mul_f32 v10, s46, v80
    v_mul_f32 v11, s46, v81
    v_mul_f32 v12, s46, v82
    v_mul_f32 v13, s46, v83
    v_exp_f32 v10, v10
    v_exp_f32 v11, v11
    s_waitcnt vmcnt(9) lgkmcnt(0)
    s_barrier
    s_setprio 1
    v_mfma_f32_16x16x32_bf16 v[96:99], v[112:115], v[24:27], 0
    v_exp_f32 v12, v12
    v_mfma_f32_16x16x32_bf16 v[100:103], v[184:187], v[24:27], 0
    ds_read_b128 v[24:27], v7 offset:6144
    v_mfma_f32_16x16x32_bf16 v[96:99], v[116:119], v[28:31], v[96:99]
    v_exp_f32 v13, v13
    v_mfma_f32_16x16x32_bf16 v[100:103], v[188:191], v[28:31], v[100:103]
    ds_read_b128 v[28:31], v8 offset:6144
    v_mfma_f32_16x16x32_bf16 v[96:99], v[120:123], v[32:35], v[96:99]
    v_mul_f32 v14, v80, v84
    v_mul_f32 v15, v81, v85
    v_mfma_f32_16x16x32_bf16 v[100:103], v[192:195], v[32:35], v[100:103]
    ds_read_b128 v[32:35], v7 offset:8192
    v_mfma_f32_16x16x32_bf16 v[96:99], v[124:127], v[36:39], v[96:99]
    v_mul_f32 v16, v82, v86
    v_mul_f32 v17, v83, v87
    v_mfma_f32_16x16x32_bf16 v[100:103], v[196:199], v[36:39], v[100:103]
    ds_read_b128 v[36:39], v8 offset:8192
    v_mfma_f32_16x16x32_bf16 v[96:99], v[128:131], v[40:43], v[96:99]
    v_add_f32 v10, 1.0, v10
    v_add_f32 v11, 1.0, v11
    v_mfma_f32_16x16x32_bf16 v[100:103], v[200:203], v[40:43], v[100:103]
    ds_read_b128 v[40:43], v7 offset:10240
    v_mfma_f32_16x16x32_bf16 v[96:99], v[132:135], v[44:47], v[96:99]
    v_add_f32 v12, 1.0, v12
    v_add_f32 v13, 1.0, v13
    v_mfma_f32_16x16x32_bf16 v[100:103], v[204:207], v[44:47], v[100:103]
    ds_read_b128 v[44:47], v8 offset:10240
    s_waitcnt lgkmcnt(5)
    v_mfma_f32_16x16x32_bf16 v[96:99], v[136:139], v[24:27], v[96:99]
    v_rcp_f32 v10, v10
    v_mfma_f32_16x16x32_bf16 v[100:103], v[208:211], v[24:27], v[100:103]
    ds_read_b128 v[24:27], v7 offset:12288
    s_waitcnt lgkmcnt(5)
    v_mfma_f32_16x16x32_bf16 v[96:99], v[140:143], v[28:31], v[96:99]
    v_rcp_f32 v11, v11
    v_mfma_f32_16x16x32_bf16 v[100:103], v[212:215], v[28:31], v[100:103]
    ds_read_b128 v[28:31], v8 offset:12288
    s_waitcnt lgkmcnt(5)
    v_mfma_f32_16x16x32_bf16 v[96:99], v[144:147], v[32:35], v[96:99]
    v_rcp_f32 v12, v12
    v_mfma_f32_16x16x32_bf16 v[100:103], v[216:219], v[32:35], v[100:103]
    ds_read_b128 v[32:35], v7 offset:14336
    s_waitcnt lgkmcnt(5)
    v_mfma_f32_16x16x32_bf16 v[96:99], v[148:151], v[36:39], v[96:99]
    v_rcp_f32 v13, v13
    v_mfma_f32_16x16x32_bf16 v[100:103], v[220:223], v[36:39], v[100:103]
    ds_read_b128 v[36:39], v8 offset:14336
    s_waitcnt lgkmcnt(5)
    v_mfma_f32_16x16x32_bf16 v[96:99], v[152:155], v[40:43], v[96:99]
    v_mul_f32 v14, v14, v10
    v_mul_f32 v15, v15, v11
    v_mfma_f32_16x16x32_bf16 v[100:103], v[224:227], v[40:43], v[100:103]
    ds_read_b128 v[40:43], v7 offset:16384
    s_waitcnt lgkmcnt(5)
    v_mfma_f32_16x16x32_bf16 v[96:99], v[156:159], v[44:47], v[96:99]
    v_mul_f32 v16, v16, v12
    v_mul_f32 v17, v17, v13
    v_mfma_f32_16x16x32_bf16 v[100:103], v[228:231], v[44:47], v[100:103]
    ds_read_b128 v[44:47], v8 offset:16384
    s_waitcnt lgkmcnt(5)
    v_mfma_f32_16x16x32_bf16 v[96:99], v[160:163], v[24:27], v[96:99]
    v_cvt_pk_bf16_f32 v18, v14, v15
    v_cvt_pk_bf16_f32 v19, v16, v17
    v_mfma_f32_16x16x32_bf16 v[100:103], v[232:235], v[24:27], v[100:103]
    s_waitcnt lgkmcnt(4)
    v_mfma_f32_16x16x32_bf16 v[96:99], v[164:167], v[28:31], v[96:99]
    v_mul_f32 v10, s46, v88
    v_mul_f32 v11, s46, v89
    v_mfma_f32_16x16x32_bf16 v[100:103], v[236:239], v[28:31], v[100:103]
    s_waitcnt lgkmcnt(3)
    v_mfma_f32_16x16x32_bf16 v[96:99], v[168:171], v[32:35], v[96:99]
    v_mul_f32 v12, s46, v90
    v_mul_f32 v13, s46, v91
    v_mfma_f32_16x16x32_bf16 v[100:103], v[240:243], v[32:35], v[100:103]
    s_waitcnt lgkmcnt(2)
    v_mfma_f32_16x16x32_bf16 v[96:99], v[172:175], v[36:39], v[96:99]
    v_exp_f32 v10, v10
    v_mfma_f32_16x16x32_bf16 v[100:103], v[244:247], v[36:39], v[100:103]
    s_waitcnt lgkmcnt(1)
    v_mfma_f32_16x16x32_bf16 v[96:99], v[176:179], v[40:43], v[96:99]
    v_exp_f32 v11, v11
    v_mfma_f32_16x16x32_bf16 v[100:103], v[248:251], v[40:43], v[100:103]
    s_waitcnt lgkmcnt(0)
    s_setprio 3
    s_barrier
    v_mfma_f32_16x16x32_bf16 v[96:99], v[180:183], v[44:47], v[96:99]
    v_exp_f32 v12, v12
    v_mfma_f32_16x16x32_bf16 v[100:103], v[252:255], v[44:47], v[100:103]
    s_setprio 0
    s_add_u32 m0, s42, 145408
    s_add_u32 s45, s44, 55296
    buffer_load_dwordx4 v3, s[8:11], s45 offen lds
    s_mov_b32 s67, 0
    s_andn2_b32 exec_lo, 0x70007, s76
    s_mov_b32 exec_hi, 0
    buffer_load_dword v9, v22, s[92:95], 0 offen sc0 sc1
    s_mov_b64 exec, -1
    buffer_load_dwordx4 v4, s[8:11], s45 offen offset:1024 lds
    v_exp_f32 v13, v13
    ds_read_b128 v[24:27], v7 offset:18432
    v_mul_f32 v14, v88, v92
    v_mul_f32 v15, v89, v93
    ds_read_b128 v[28:31], v8 offset:18432
    v_mul_f32 v16, v90, v94
    s_add_u32 m0, s43, 145408
    s_add_u32 s45, s68, 55296
    s_mov_b64 exec, 0xffff
    buffer_load_dwordx4 v5, s[8:11], s45 offen lds
    s_mov_b64 exec, -1
    v_mul_f32 v17, v91, v95
    ds_read_b128 v[32:35], v7 offset:20480
    v_add_f32 v10, 1.0, v10
    v_add_f32 v11, 1.0, v11
    ds_read_b128 v[36:39], v8 offset:20480
    v_add_f32 v12, 1.0, v12
    v_add_f32 v13, 1.0, v13
    s_and_b32 s3, s54, 15
    s_lshl_b32 s3, s3, 1
    s_add_u32 s3, s3, s33
    s_mul_i32 s3, s3, 73728
    s_add_u32 s3, s3, s62
    s_mul_i32 s21, s33, 40960
    s_add_u32 s21, s21, s41
    s_add_u32 s3, s3, 18432
    s_add_u32 m0, s21, 6144
    s_nop 0
    buffer_load_dwordx4 v1, s[12:15], s3 offen offset:0 lds
    v_rcp_f32 v10, v10
    ds_read_b128 v[40:43], v7 offset:22528
    v_rcp_f32 v11, v11
    ds_read_b128 v[44:47], v8 offset:22528
    v_rcp_f32 v12, v12
    buffer_load_dwordx4 v2, s[12:15], s3 offen offset:1024 lds
    v_rcp_f32 v13, v13
    v_mul_f32 v14, v14, v10
    buffer_load_dwordx4 v6, s[12:15], s3 offen offset:2048 lds
    v_mul_f32 v15, v15, v11
    v_mul_f32 v16, v16, v12
    v_mul_f32 v17, v17, v13
    v_cvt_pk_bf16_f32 v20, v14, v15
    v_cvt_pk_bf16_f32 v21, v16, v17
    s_nop 0
    v_permlane16_swap_b32 v18, v20
    v_permlane16_swap_b32 v19, v21
    s_nop 0
    buffer_store_dwordx4 v[18:21], v23, s[16:19], s47 offen sc0 sc1
    s_add_u32 s47, s47, 4096
    s_waitcnt vmcnt(12) lgkmcnt(0)
    s_barrier
    s_setprio 1
    v_mfma_f32_16x16x32_bf16 v[104:107], v[112:115], v[24:27], 0
    v_mul_f32 v10, s46, v96
    v_mul_f32 v11, s46, v97
    v_mfma_f32_16x16x32_bf16 v[108:111], v[184:187], v[24:27], 0
    ds_read_b128 v[24:27], v7 offset:24576
    v_mfma_f32_16x16x32_bf16 v[104:107], v[116:119], v[28:31], v[104:107]
    v_mul_f32 v12, s46, v98
    v_mul_f32 v13, s46, v99
    v_mfma_f32_16x16x32_bf16 v[108:111], v[188:191], v[28:31], v[108:111]
    ds_read_b128 v[28:31], v8 offset:24576
    v_mfma_f32_16x16x32_bf16 v[104:107], v[120:123], v[32:35], v[104:107]
    v_exp_f32 v10, v10
    v_mfma_f32_16x16x32_bf16 v[108:111], v[192:195], v[32:35], v[108:111]
    ds_read_b128 v[32:35], v7 offset:26624
    v_mfma_f32_16x16x32_bf16 v[104:107], v[124:127], v[36:39], v[104:107]
    v_exp_f32 v11, v11
    v_mfma_f32_16x16x32_bf16 v[108:111], v[196:199], v[36:39], v[108:111]
    ds_read_b128 v[36:39], v8 offset:26624
    v_mfma_f32_16x16x32_bf16 v[104:107], v[128:131], v[40:43], v[104:107]
    v_exp_f32 v12, v12
    v_mfma_f32_16x16x32_bf16 v[108:111], v[200:203], v[40:43], v[108:111]
    ds_read_b128 v[40:43], v7 offset:28672
    v_mfma_f32_16x16x32_bf16 v[104:107], v[132:135], v[44:47], v[104:107]
    v_exp_f32 v13, v13
    v_mfma_f32_16x16x32_bf16 v[108:111], v[204:207], v[44:47], v[108:111]
    ds_read_b128 v[44:47], v8 offset:28672
    s_waitcnt lgkmcnt(5)
    v_mfma_f32_16x16x32_bf16 v[104:107], v[136:139], v[24:27], v[104:107]
    v_mul_f32 v14, v96, v100
    v_mul_f32 v15, v97, v101
    v_mfma_f32_16x16x32_bf16 v[108:111], v[208:211], v[24:27], v[108:111]
    ds_read_b128 v[24:27], v7 offset:30720
    s_waitcnt lgkmcnt(5)
    v_mfma_f32_16x16x32_bf16 v[104:107], v[140:143], v[28:31], v[104:107]
    v_mul_f32 v16, v98, v102
    v_mul_f32 v17, v99, v103
    v_mfma_f32_16x16x32_bf16 v[108:111], v[212:215], v[28:31], v[108:111]
    ds_read_b128 v[28:31], v8 offset:30720
    s_waitcnt lgkmcnt(5)
    v_mfma_f32_16x16x32_bf16 v[104:107], v[144:147], v[32:35], v[104:107]
    v_add_f32 v10, 1.0, v10
    v_add_f32 v11, 1.0, v11
    v_mfma_f32_16x16x32_bf16 v[108:111], v[216:219], v[32:35], v[108:111]
    ds_read_b128 v[32:35], v7 offset:32768
    s_waitcnt lgkmcnt(5)
    v_mfma_f32_16x16x32_bf16 v[104:107], v[148:151], v[36:39], v[104:107]
    v_add_f32 v12, 1.0, v12
    v_add_f32 v13, 1.0, v13
    v_mfma_f32_16x16x32_bf16 v[108:111], v[220:223], v[36:39], v[108:111]
    ds_read_b128 v[36:39], v8 offset:32768
    s_waitcnt lgkmcnt(5)
    v_mfma_f32_16x16x32_bf16 v[104:107], v[152:155], v[40:43], v[104:107]
    v_rcp_f32 v10, v10
    v_mfma_f32_16x16x32_bf16 v[108:111], v[224:227], v[40:43], v[108:111]
    ds_read_b128 v[40:43], v7 offset:34816
    s_waitcnt lgkmcnt(5)
    v_mfma_f32_16x16x32_bf16 v[104:107], v[156:159], v[44:47], v[104:107]
    v_rcp_f32 v11, v11
    v_mfma_f32_16x16x32_bf16 v[108:111], v[228:231], v[44:47], v[108:111]
    ds_read_b128 v[44:47], v8 offset:34816
    s_waitcnt lgkmcnt(5)
    v_mfma_f32_16x16x32_bf16 v[104:107], v[160:163], v[24:27], v[104:107]
    v_rcp_f32 v12, v12
    v_mfma_f32_16x16x32_bf16 v[108:111], v[232:235], v[24:27], v[108:111]
    s_waitcnt lgkmcnt(4)
    v_mfma_f32_16x16x32_bf16 v[104:107], v[164:167], v[28:31], v[104:107]
    v_rcp_f32 v13, v13
    v_mfma_f32_16x16x32_bf16 v[108:111], v[236:239], v[28:31], v[108:111]
    s_waitcnt lgkmcnt(3)
    v_mfma_f32_16x16x32_bf16 v[104:107], v[168:171], v[32:35], v[104:107]
    v_mul_f32 v14, v14, v10
    v_mul_f32 v15, v15, v11
    v_mfma_f32_16x16x32_bf16 v[108:111], v[240:243], v[32:35], v[108:111]
    s_waitcnt lgkmcnt(2)
    v_mfma_f32_16x16x32_bf16 v[104:107], v[172:175], v[36:39], v[104:107]
    v_mul_f32 v16, v16, v12
    v_mul_f32 v17, v17, v13
    v_mfma_f32_16x16x32_bf16 v[108:111], v[244:247], v[36:39], v[108:111]
    s_waitcnt lgkmcnt(1)
    v_mfma_f32_16x16x32_bf16 v[104:107], v[176:179], v[40:43], v[104:107]
    v_cvt_pk_bf16_f32 v18, v14, v15
    v_cvt_pk_bf16_f32 v19, v16, v17
    v_mfma_f32_16x16x32_bf16 v[108:111], v[248:251], v[40:43], v[108:111]
    s_waitcnt lgkmcnt(0)
    s_setprio 3
    s_barrier
    v_mfma_f32_16x16x32_bf16 v[104:107], v[180:183], v[44:47], v[104:107]
    v_mfma_f32_16x16x32_bf16 v[108:111], v[252:255], v[44:47], v[108:111]
    s_setprio 0
    v_mov_b32 v26, 39
    v_lshlrev_b32 v27, 2, v0
    v_and_b32 v27, 127, v27
    s_mov_b64 exec, s[100:101]
    buffer_store_dword v26, v27, s[92:95], s2 offen sc0 sc1
    s_mov_b64 exec, -1
    s_waitcnt vmcnt(7)
    v_bfe_u32 v24, v22, 2, 3
    v_bfe_u32 v24, v9, v24, 1
    v_cmp_ne_u32 vcc, 0, v24
    s_nop 1
    s_mov_b32 s76, vcc_lo
    s_lshr_b32 s66, vcc_lo, 16
    s_and_b32 s66, s66, vcc_lo
    s_and_b32 s34, s66, 1
    s_or_b32 s67, s67, s34
    s_andn2_b32 exec_lo, 0x70007, s76
    s_mov_b32 exec_hi, 0
    buffer_load_dword v9, v22, s[92:95], 0 offen sc0 sc1
    s_mov_b64 exec, -1
    v_and_b32 v3, 63, v0
    v_lshlrev_b32 v3, 4, v3
    s_and_b32 s3, s54, 15
    s_lshl_b32 s3, s3, 1
    s_add_u32 s3, s3, s33
    s_lshl_b32 s21, s3, 18
    s_add_u32 s20, s21, s60
    s_add_u32 s21, s21, s61
    s_mul_i32 s34, s33, 40960
    s_add_u32 m0, s40, s34
    s_nop 0
    buffer_load_dwordx4 v3, s[16:19], s20 offen sc0 sc1 lds
    v_mul_f32 v10, s46, v104
    v_mul_f32 v11, s46, v105
    ds_read_b128 v[24:27], v7 offset:36864
    v_mul_f32 v12, s46, v106
    buffer_load_dwordx4 v3, s[16:19], s20 offen offset:1024 sc0 sc1 lds
    ds_read_b128 v[28:31], v8 offset:36864
    ds_read_b128 v[32:35], v7 offset:38912
    buffer_load_dwordx4 v3, s[16:19], s21 offen offset:2048 sc0 sc1 lds
    ds_read_b128 v[36:39], v8 offset:38912
    ds_read_b128 v[40:43], v7 offset:40960
    buffer_load_dwordx4 v3, s[16:19], s21 offen offset:3072 sc0 sc1 lds
    ds_read_b128 v[44:47], v8 offset:40960
    s_waitcnt vmcnt(6) lgkmcnt(0)
    s_barrier
    s_setprio 1
    v_mfma_f32_16x16x32_bf16 v[48:51], v[112:115], v[24:27], 0
    v_mul_f32 v13, s46, v107
    v_mfma_f32_16x16x32_bf16 v[52:55], v[184:187], v[24:27], 0
    ds_read_b128 v[24:27], v7 offset:43008
    v_mfma_f32_16x16x32_bf16 v[48:51], v[116:119], v[28:31], v[48:51]
    v_exp_f32 v10, v10
    v_mfma_f32_16x16x32_bf16 v[52:55], v[188:191], v[28:31], v[52:55]
    ds_read_b128 v[28:31], v8 offset:43008
    v_mfma_f32_16x16x32_bf16 v[48:51], v[120:123], v[32:35], v[48:51]
    v_exp_f32 v11, v11
    v_mfma_f32_16x16x32_bf16 v[52:55], v[192:195], v[32:35], v[52:55]
    ds_read_b128 v[32:35], v7 offset:45056
    v_mfma_f32_16x16x32_bf16 v[48:51], v[124:127], v[36:39], v[48:51]
    v_exp_f32 v12, v12
    v_mfma_f32_16x16x32_bf16 v[52:55], v[196:199], v[36:39], v[52:55]
    ds_read_b128 v[36:39], v8 offset:45056
    v_mfma_f32_16x16x32_bf16 v[48:51], v[128:131], v[40:43], v[48:51]
    v_exp_f32 v13, v13
    v_mfma_f32_16x16x32_bf16 v[52:55], v[200:203], v[40:43], v[52:55]
    ds_read_b128 v[40:43], v7 offset:47104
    v_mfma_f32_16x16x32_bf16 v[48:51], v[132:135], v[44:47], v[48:51]
    v_mul_f32 v14, v104, v108
    v_mul_f32 v15, v105, v109
    v_mfma_f32_16x16x32_bf16 v[52:55], v[204:207], v[44:47], v[52:55]
    ds_read_b128 v[44:47], v8 offset:47104
    s_waitcnt lgkmcnt(5)
    v_mfma_f32_16x16x32_bf16 v[48:51], v[136:139], v[24:27], v[48:51]
    v_mul_f32 v16, v106, v110
    v_mul_f32 v17, v107, v111
    v_mfma_f32_16x16x32_bf16 v[52:55], v[208:211], v[24:27], v[52:55]
    ds_read_b128 v[24:27], v7 offset:49152
    s_waitcnt lgkmcnt(5)
    v_mfma_f32_16x16x32_bf16 v[48:51], v[140:143], v[28:31], v[48:51]
    v_add_f32 v10, 1.0, v10
    v_add_f32 v11, 1.0, v11
    v_mfma_f32_16x16x32_bf16 v[52:55], v[212:215], v[28:31], v[52:55]
    ds_read_b128 v[28:31], v8 offset:49152
    s_waitcnt lgkmcnt(5)
    v_mfma_f32_16x16x32_bf16 v[48:51], v[144:147], v[32:35], v[48:51]
    v_add_f32 v12, 1.0, v12
    v_add_f32 v13, 1.0, v13
    v_mfma_f32_16x16x32_bf16 v[52:55], v[216:219], v[32:35], v[52:55]
    ds_read_b128 v[32:35], v7 offset:51200
    s_waitcnt lgkmcnt(5)
    v_mfma_f32_16x16x32_bf16 v[48:51], v[148:151], v[36:39], v[48:51]
    v_rcp_f32 v10, v10
    v_mfma_f32_16x16x32_bf16 v[52:55], v[220:223], v[36:39], v[52:55]
    ds_read_b128 v[36:39], v8 offset:51200
    s_waitcnt lgkmcnt(5)
    v_mfma_f32_16x16x32_bf16 v[48:51], v[152:155], v[40:43], v[48:51]
    v_rcp_f32 v11, v11
    v_mfma_f32_16x16x32_bf16 v[52:55], v[224:227], v[40:43], v[52:55]
    ds_read_b128 v[40:43], v7 offset:53248
    s_waitcnt lgkmcnt(5)
    v_mfma_f32_16x16x32_bf16 v[48:51], v[156:159], v[44:47], v[48:51]
    v_rcp_f32 v12, v12
    v_mfma_f32_16x16x32_bf16 v[52:55], v[228:231], v[44:47], v[52:55]
    ds_read_b128 v[44:47], v8 offset:53248
    s_waitcnt lgkmcnt(5)
    v_mfma_f32_16x16x32_bf16 v[48:51], v[160:163], v[24:27], v[48:51]
    v_rcp_f32 v13, v13
    v_mfma_f32_16x16x32_bf16 v[52:55], v[232:235], v[24:27], v[52:55]
    s_waitcnt lgkmcnt(4)
    v_mfma_f32_16x16x32_bf16 v[48:51], v[164:167], v[28:31], v[48:51]
    v_mul_f32 v14, v14, v10
    v_mul_f32 v15, v15, v11
    v_mfma_f32_16x16x32_bf16 v[52:55], v[236:239], v[28:31], v[52:55]
    s_waitcnt lgkmcnt(3)
    v_mfma_f32_16x16x32_bf16 v[48:51], v[168:171], v[32:35], v[48:51]
    v_mul_f32 v16, v16, v12
    v_mul_f32 v17, v17, v13
    v_mfma_f32_16x16x32_bf16 v[52:55], v[240:243], v[32:35], v[52:55]
    s_waitcnt lgkmcnt(2)
    v_mfma_f32_16x16x32_bf16 v[48:51], v[172:175], v[36:39], v[48:51]
    v_cvt_pk_bf16_f32 v20, v14, v15
    v_cvt_pk_bf16_f32 v21, v16, v17
    v_mfma_f32_16x16x32_bf16 v[52:55], v[244:247], v[36:39], v[52:55]
    s_waitcnt lgkmcnt(1)
    v_mfma_f32_16x16x32_bf16 v[48:51], v[176:179], v[40:43], v[48:51]
    s_nop 0
    v_permlane16_swap_b32 v18, v20
    v_permlane16_swap_b32 v19, v21
    s_mov_b32 s47, s90
    s_nop 0
    buffer_store_dwordx4 v[18:21], v23, s[16:19], s47 offen sc0 sc1
    s_add_u32 s47, s47, 4096
    v_mfma_f32_16x16x32_bf16 v[52:55], v[248:251], v[40:43], v[52:55]
    s_waitcnt lgkmcnt(0)
    s_setprio 3
    s_barrier
    v_mfma_f32_16x16x32_bf16 v[48:51], v[180:183], v[44:47], v[48:51]
    v_mfma_f32_16x16x32_bf16 v[52:55], v[252:255], v[44:47], v[52:55]
    s_setprio 0
    v_mov_b32 v26, 47
    v_lshlrev_b32 v27, 2, v0
    v_and_b32 v27, 127, v27
    s_mov_b64 exec, s[100:101]
    buffer_store_dword v26, v27, s[92:95], s2 offen sc0 sc1
    s_mov_b64 exec, -1
    s_waitcnt vmcnt(6)
    v_bfe_u32 v24, v22, 2, 3
    v_bfe_u32 v24, v9, v24, 1
    v_cmp_ne_u32 vcc, 0, v24
    s_nop 1
    s_mov_b32 s76, vcc_lo
    s_lshr_b32 s66, vcc_lo, 16
    s_and_b32 s66, s66, vcc_lo
    s_bitcmp1_b32 s67, 0
    s_cbranch_scc1 fused_kernel_a0g18
    s_bitcmp1_b32 s66, 0
    s_cbranch_scc1 fused_kernel_a0sg18_ok
    s_movk_i32 s98, 0x4000
fused_kernel_a0sg18_l:
    s_andn2_b32 exec_lo, 0x10001, s76
    s_mov_b32 exec_hi, 0
    buffer_load_dword v9, v22, s[92:95], 0 offen sc0 sc1
    s_mov_b64 exec, -1
    s_waitcnt vmcnt(0)
    v_bfe_u32 v24, v22, 2, 3
    v_bfe_u32 v24, v9, v24, 1
    v_cmp_ne_u32 vcc, 0, v24
    s_nop 1
    s_mov_b32 s76, vcc_lo
    s_lshr_b32 s66, vcc_lo, 16
    s_and_b32 s66, s66, vcc_lo
    s_bitcmp1_b32 s66, 0
    s_cbranch_scc1 fused_kernel_a0sg18_ok
    s_sleep 2
    s_sub_u32 s98, s98, 1
    s_cbranch_scc0 fused_kernel_a0sg18_l
fused_kernel_a0sg18_ok:
    s_and_b32 s3, s54, 15
    s_lshl_b32 s3, s3, 1
    s_add_u32 s3, s3, s33
    s_lshl_b32 s21, s3, 18
    s_add_u32 s20, s21, s60
    s_add_u32 s21, s21, s61
    s_mul_i32 s34, s33, 40960
    s_add_u32 m0, s40, s34
    s_nop 0
    buffer_load_dwordx4 v3, s[16:19], s20 offen sc0 sc1 lds
    buffer_load_dwordx4 v3, s[16:19], s20 offen offset:1024 sc0 sc1 lds
    buffer_load_dwordx4 v3, s[16:19], s21 offen offset:2048 sc0 sc1 lds
    buffer_load_dwordx4 v3, s[16:19], s21 offen offset:3072 sc0 sc1 lds
    s_waitcnt vmcnt(0)
fused_kernel_a0g18:
    s_and_b32 s34, s66, 2
    s_or_b32 s67, s67, s34
    s_andn2_b32 exec_lo, 0x70007, s76
    s_mov_b32 exec_hi, 0
    buffer_load_dword v9, v22, s[92:95], 0 offen sc0 sc1
    s_mov_b64 exec, -1
    s_bfe_u32 s3, s54, 0x40004
    s_lshl_b32 s3, s3, 1
    s_lshl_b32 s21, s3, 18
    s_add_u32 s20, s21, s60
    s_add_u32 s21, s21, s61
    s_mul_i32 s3, s3, 73728
    s_add_u32 s3, s3, s62
    s_add_u32 s21, s21, 2048
    s_cmp_eq_u32 s33, 0
    s_cselect_b32 s20, s20, s21
    s_lshl_b32 s21, s33, 11
    s_add_u32 s21, s21, s40
    s_add_u32 m0, s21, 81920
    s_nop 0
    buffer_load_dwordx4 v3, s[16:19], s20 offen sc0 sc1 lds
    v_mul_f32 v10, s46, v48
    v_mul_f32 v11, s46, v49
    buffer_load_dwordx4 v3, s[16:19], s20 offen offset:1024 sc0 sc1 lds
    v_add_u32 v7, 55296, v7
    v_add_u32 v8, 55296, v8
    ds_read_b128 v[24:27], v7 offset:0
    ds_read_b128 v[28:31], v8 offset:0
    s_mul_i32 s21, s33, 18432
    s_add_u32 s3, s3, s21
    s_mul_i32 s21, s33, 6144
    s_add_u32 s21, s21, s41
    s_add_u32 m0, s21, 81920
    s_nop 0
    buffer_load_dwordx4 v1, s[12:15], s3 offen lds
    ds_read_b128 v[32:35], v7 offset:2048
    ds_read_b128 v[36:39], v8 offset:2048
    buffer_load_dwordx4 v2, s[12:15], s3 offen offset:1024 lds
    ds_read_b128 v[40:43], v7 offset:4096
    ds_read_b128 v[44:47], v8 offset:4096
    buffer_load_dwordx4 v6, s[12:15], s3 offen offset:2048 lds
    s_waitcnt lgkmcnt(0)
    s_barrier
    s_setprio 1
    v_mfma_f32_16x16x32_bf16 v[64:67], v[112:115], v[24:27], 0
    v_mul_f32 v12, s46, v50
    v_mul_f32 v13, s46, v51
    v_mfma_f32_16x16x32_bf16 v[68:71], v[184:187], v[24:27], 0
    ds_read_b128 v[24:27], v7 offset:6144
    v_mfma_f32_16x16x32_bf16 v[64:67], v[116:119], v[28:31], v[64:67]
    v_exp_f32 v10, v10
    v_mfma_f32_16x16x32_bf16 v[68:71], v[188:191], v[28:31], v[68:71]
    ds_read_b128 v[28:31], v8 offset:6144
    v_mfma_f32_16x16x32_bf16 v[64:67], v[120:123], v[32:35], v[64:67]
    v_exp_f32 v11, v11
    v_mfma_f32_16x16x32_bf16 v[68:71], v[192:195], v[32:35], v[68:71]
    ds_read_b128 v[32:35], v7 offset:8192
    v_mfma_f32_16x16x32_bf16 v[64:67], v[124:127], v[36:39], v[64:67]
    v_exp_f32 v12, v12
    v_mfma_f32_16x16x32_bf16 v[68:71], v[196:199], v[36:39], v[68:71]
    ds_read_b128 v[36:39], v8 offset:8192
    v_mfma_f32_16x16x32_bf16 v[64:67], v[128:131], v[40:43], v[64:67]
    v_exp_f32 v13, v13
    v_mfma_f32_16x16x32_bf16 v[68:71], v[200:203], v[40:43], v[68:71]
    ds_read_b128 v[40:43], v7 offset:10240
    v_mfma_f32_16x16x32_bf16 v[64:67], v[132:135], v[44:47], v[64:67]
    v_mul_f32 v14, v48, v52
    v_mul_f32 v15, v49, v53
    v_mfma_f32_16x16x32_bf16 v[68:71], v[204:207], v[44:47], v[68:71]
    ds_read_b128 v[44:47], v8 offset:10240
    s_waitcnt lgkmcnt(5)
    v_mfma_f32_16x16x32_bf16 v[64:67], v[136:139], v[24:27], v[64:67]
    v_mul_f32 v16, v50, v54
    v_mul_f32 v17, v51, v55
    v_mfma_f32_16x16x32_bf16 v[68:71], v[208:211], v[24:27], v[68:71]
    ds_read_b128 v[24:27], v7 offset:12288
    s_waitcnt lgkmcnt(5)
    v_mfma_f32_16x16x32_bf16 v[64:67], v[140:143], v[28:31], v[64:67]
    v_add_f32 v10, 1.0, v10
    v_add_f32 v11, 1.0, v11
    v_mfma_f32_16x16x32_bf16 v[68:71], v[212:215], v[28:31], v[68:71]
    ds_read_b128 v[28:31], v8 offset:12288
    s_waitcnt lgkmcnt(5)
    v_mfma_f32_16x16x32_bf16 v[64:67], v[144:147], v[32:35], v[64:67]
    v_add_f32 v12, 1.0, v12
    v_add_f32 v13, 1.0, v13
    v_mfma_f32_16x16x32_bf16 v[68:71], v[216:219], v[32:35], v[68:71]
    ds_read_b128 v[32:35], v7 offset:14336
    s_waitcnt lgkmcnt(5)
    v_mfma_f32_16x16x32_bf16 v[64:67], v[148:151], v[36:39], v[64:67]
    v_rcp_f32 v10, v10
    v_mfma_f32_16x16x32_bf16 v[68:71], v[220:223], v[36:39], v[68:71]
    ds_read_b128 v[36:39], v8 offset:14336
    s_waitcnt lgkmcnt(5)
    v_mfma_f32_16x16x32_bf16 v[64:67], v[152:155], v[40:43], v[64:67]
    v_rcp_f32 v11, v11
    v_mfma_f32_16x16x32_bf16 v[68:71], v[224:227], v[40:43], v[68:71]
    ds_read_b128 v[40:43], v7 offset:16384
    s_waitcnt lgkmcnt(5)
    v_mfma_f32_16x16x32_bf16 v[64:67], v[156:159], v[44:47], v[64:67]
    v_rcp_f32 v12, v12
    v_mfma_f32_16x16x32_bf16 v[68:71], v[228:231], v[44:47], v[68:71]
    ds_read_b128 v[44:47], v8 offset:16384
    s_waitcnt lgkmcnt(5)
    v_mfma_f32_16x16x32_bf16 v[64:67], v[160:163], v[24:27], v[64:67]
    v_rcp_f32 v13, v13
    v_mfma_f32_16x16x32_bf16 v[68:71], v[232:235], v[24:27], v[68:71]
    s_waitcnt lgkmcnt(4)
    v_mfma_f32_16x16x32_bf16 v[64:67], v[164:167], v[28:31], v[64:67]
    v_mul_f32 v14, v14, v10
    v_mul_f32 v15, v15, v11
    v_mfma_f32_16x16x32_bf16 v[68:71], v[236:239], v[28:31], v[68:71]
    s_waitcnt lgkmcnt(3)
    v_mfma_f32_16x16x32_bf16 v[64:67], v[168:171], v[32:35], v[64:67]
    v_mul_f32 v16, v16, v12
    v_mul_f32 v17, v17, v13
    v_mfma_f32_16x16x32_bf16 v[68:71], v[240:243], v[32:35], v[68:71]
    s_waitcnt lgkmcnt(2)
    v_mfma_f32_16x16x32_bf16 v[64:67], v[172:175], v[36:39], v[64:67]
    v_cvt_pk_bf16_f32 v18, v14, v15
    v_cvt_pk_bf16_f32 v19, v16, v17
    v_mfma_f32_16x16x32_bf16 v[68:71], v[244:247], v[36:39], v[68:71]
    s_waitcnt vmcnt(8) lgkmcnt(0)
    s_setprio 3
    s_cmp_eq_u32 s33, 0
    s_cbranch_scc1 fused_kernel_skipBg18
    s_barrier
fused_kernel_skipBg18:
    v_mfma_f32_16x16x32_bf16 v[64:67], v[176:179], v[40:43], v[64:67]
    v_mfma_f32_16x16x32_bf16 v[68:71], v[248:251], v[40:43], v[68:71]
    s_waitcnt lgkmcnt(0)
    s_setprio 3
    s_cmp_eq_u32 s33, 0
    s_cbranch_scc0 fused_kernel_skipAg18
    s_barrier
fused_kernel_skipAg18:
    v_mfma_f32_16x16x32_bf16 v[64:67], v[180:183], v[44:47], v[64:67]
    v_mfma_f32_16x16x32_bf16 v[68:71], v[252:255], v[44:47], v[68:71]
    s_setprio 0
    s_nop 7
    s_cmp_eq_u32 s33, 0
    s_cbranch_scc0 fused_kernel_tYg18
    s_nop 1
    s_bitcmp1_b32 s67, 1
    s_cbranch_scc0 fused_kernel_xlate
    s_branch fused_kernel_cons
fused_kernel_tYg18:
    s_nop 1
    s_bitcmp1_b32 s67, 1
    s_cbranch_scc0 fused_kernel_ylate
    s_branch fused_kernel_prod
fused_kernel_rsc:
    s_add_u32 s12, s6, 50331648
    s_addc_u32 s13, s7, 0
    s_and_b32 s13, s13, 0xffff
    s_mov_b32 s14, 2359296
    s_mov_b32 s15, 0x00020000
    s_lshl_b32 s79, s78, 3
    s_add_u32 s79, s79, s22
    s_lshl_b32 s79, s79, 12
    s_lshr_b32 s34, s78, 3
    s_add_u32 s34, s34, 64
    s_lshl_b32 s34, s34, 3
    s_add_u32 s34, s34, s22
    s_lshl_b32 s40, s34, 12
    v_and_b32 v24, 63, v0
    v_lshlrev_b32 v104, 4, v24
    v_lshrrev_b32 v25, 1, v24
    v_xor_b32 v25, s78, v25
    v_and_b32 v25, 7, v25
    v_lshlrev_b32 v24, 7, v24
    v_lshl_add_u32 v105, v25, 4, v24
    s_lshr_b32 s34, s78, 3
    v_mov_b32 v24, s34
    v_and_b32 v25, 16, v0
    v_cmp_eq_u32 vcc, 0, v25
    s_nop 1
    v_cndmask_b32 v24, 8, v24, vcc
    v_and_b32 v25, 15, v0
    v_mad_u32_u24 v24, v25, 9, v24
    v_lshrrev_b32 v25, 2, v24
    v_and_b32 v24, 3, v24
    v_mul_u32_u24 v26, 57, v25
    v_lshrrev_b32 v26, 9, v26
    v_mul_u32_u24 v27, 9, v26
    v_sub_u32 v27, v25, v27
    s_movk_i32 s34, 0
    v_bfe_u32 v27, s34, v27, 1
    v_add_u32 v27, v27, v24
    v_cmp_eq_u32 vcc, 4, v27
    v_add_u32 v26, 252, v26
    v_mad_u32_u24 v24, v25, 7, v24
    v_cndmask_b32 v24, v24, v26, vcc
    v_lshlrev_b32 v107, 7, v24
    s_waitcnt vmcnt(6) lgkmcnt(0)
    s_barrier
    s_cmp_ge_u32 s98, 5
fused_kernel_c18:
    ds_read_b64_tr_b16 v[112:113], v6 offset:0
    ds_read_b64_tr_b16 v[114:115], v6 offset:1024
    ds_read_b128 v[24:27], v7 offset:0
    ds_read_b64_tr_b16 v[184:185], v6 offset:16384
    ds_read_b64_tr_b16 v[186:187], v6 offset:17408
    ds_read_b128 v[28:31], v7 offset:2048
    ds_read_b128 v[32:35], v7 offset:4096
    ds_read_b128 v[36:39], v7 offset:6144
    ds_read_b128 v[40:43], v7 offset:8192
    ds_read_b128 v[44:47], v7 offset:10240
    ds_read_b64_tr_b16 v[116:117], v6 offset:8192
    ds_read_b64_tr_b16 v[118:119], v6 offset:9216
    ds_read_b64_tr_b16 v[188:189], v6 offset:24576
    ds_read_b64_tr_b16 v[190:191], v6 offset:25600
    s_cmp_eq_u32 s33, 0
    s_cbranch_scc1 fused_kernel_skipYc18
    s_add_u32 m0, s97, 65536
    s_add_u32 s21, s36, 1215488
    s_add_u32 s20, s36, 1179648
    buffer_load_dwordx4 v1, s[24:27], s20 offen lds
    buffer_load_dwordx4 v1, s[24:27], s21 offen offset:1024 lds
    buffer_load_dwordx4 v2, s[24:27], s20 offen offset:2048 lds
    buffer_load_dwordx4 v2, s[24:27], s21 offen offset:3072 lds
    s_add_u32 m0, s42, 126976
    s_add_u32 s45, s39, s4
    s_add_u32 s45, s45, 256
    s_mov_b64 exec, s[64:65]
    buffer_load_dwordx4 v3, s[8:11], s45 offen lds
    s_mov_b64 exec, -1
    s_mov_b64 exec, s[64:65]
    buffer_load_dwordx4 v4, s[8:11], s45 offen offset:1024 lds
    s_mov_b64 exec, -1
    s_waitcnt vmcnt(6) lgkmcnt(0)
    s_barrier
fused_kernel_skipYc18:
    s_setprio 1
    s_waitcnt lgkmcnt(11)
    v_mfma_f32_16x16x32_bf16 v[48:51], v[112:115], v[24:27], 0
    s_waitcnt lgkmcnt(9)
    v_mfma_f32_16x16x32_bf16 v[52:55], v[184:187], v[24:27], 0
    ds_read_b128 v[24:27], v7 offset:12288
    s_waitcnt lgkmcnt(9)
    v_mfma_f32_16x16x32_bf16 v[56:59], v[112:115], v[28:31], 0
    v_mfma_f32_16x16x32_bf16 v[60:63], v[184:187], v[28:31], 0
    ds_read_b128 v[28:31], v8 offset:0
    s_waitcnt lgkmcnt(9)
    v_mfma_f32_16x16x32_bf16 v[64:67], v[112:115], v[32:35], 0
    v_mfma_f32_16x16x32_bf16 v[68:71], v[184:187], v[32:35], 0
    ds_read_b128 v[32:35], v8 offset:2048
    s_waitcnt lgkmcnt(9)
    v_mfma_f32_16x16x32_bf16 v[72:75], v[112:115], v[36:39], 0
    v_mfma_f32_16x16x32_bf16 v[76:79], v[184:187], v[36:39], 0
    ds_read_b128 v[36:39], v8 offset:4096
    s_waitcnt lgkmcnt(9)
    v_mfma_f32_16x16x32_bf16 v[80:83], v[112:115], v[40:43], 0
    v_mfma_f32_16x16x32_bf16 v[84:87], v[184:187], v[40:43], 0
    ds_read_b128 v[40:43], v8 offset:6144
    s_waitcnt lgkmcnt(9)
    v_mfma_f32_16x16x32_bf16 v[88:91], v[112:115], v[44:47], 0
    v_mfma_f32_16x16x32_bf16 v[92:95], v[184:187], v[44:47], 0
    ds_read_b128 v[44:47], v8 offset:8192
    s_waitcnt lgkmcnt(5)
    v_mfma_f32_16x16x32_bf16 v[96:99], v[112:115], v[24:27], 0
    v_mfma_f32_16x16x32_bf16 v[100:103], v[184:187], v[24:27], 0
    ds_read_b128 v[24:27], v8 offset:10240
    s_waitcnt lgkmcnt(5)
    v_mfma_f32_16x16x32_bf16 v[48:51], v[116:119], v[28:31], v[48:51]
    v_mfma_f32_16x16x32_bf16 v[52:55], v[188:191], v[28:31], v[52:55]
    ds_read_b128 v[28:31], v8 offset:12288
    s_waitcnt lgkmcnt(5)
    v_mfma_f32_16x16x32_bf16 v[56:59], v[116:119], v[32:35], v[56:59]
    v_mfma_f32_16x16x32_bf16 v[60:63], v[188:191], v[32:35], v[60:63]
    s_waitcnt lgkmcnt(4)
    v_mfma_f32_16x16x32_bf16 v[64:67], v[116:119], v[36:39], v[64:67]
    v_mfma_f32_16x16x32_bf16 v[68:71], v[188:191], v[36:39], v[68:71]
    s_waitcnt lgkmcnt(3)
    v_mfma_f32_16x16x32_bf16 v[72:75], v[116:119], v[40:43], v[72:75]
    v_mfma_f32_16x16x32_bf16 v[76:79], v[188:191], v[40:43], v[76:79]
    s_waitcnt lgkmcnt(2)
    v_mfma_f32_16x16x32_bf16 v[80:83], v[116:119], v[44:47], v[80:83]
    v_mfma_f32_16x16x32_bf16 v[84:87], v[188:191], v[44:47], v[84:87]
    s_waitcnt lgkmcnt(1)
    v_mfma_f32_16x16x32_bf16 v[88:91], v[116:119], v[24:27], v[88:91]
    v_mfma_f32_16x16x32_bf16 v[92:95], v[188:191], v[24:27], v[92:95]
    s_waitcnt lgkmcnt(0)
    s_setprio 3
    s_cmp_eq_u32 s33, 0
    s_cbranch_scc1 fused_kernel_skip0c18
    s_barrier
fused_kernel_skip0c18:
    v_mfma_f32_16x16x32_bf16 v[96:99], v[116:119], v[28:31], v[96:99]
    v_mfma_f32_16x16x32_bf16 v[100:103], v[188:191], v[28:31], v[100:103]
    s_setprio 0
    s_cmp_eq_u32 s33, 0
    s_cbranch_scc0 fused_kernel_skip1c18
    s_add_u32 m0, s97, 65536
    s_add_u32 s21, s36, 1215488
    s_add_u32 s20, s36, 1179648
    buffer_load_dwordx4 v1, s[24:27], s20 offen lds
    buffer_load_dwordx4 v1, s[24:27], s21 offen offset:1024 lds
    buffer_load_dwordx4 v2, s[24:27], s20 offen offset:2048 lds
    buffer_load_dwordx4 v2, s[24:27], s21 offen offset:3072 lds
    s_add_u32 m0, s42, 126976
    s_add_u32 s45, s39, s4
    s_add_u32 s45, s45, 256
    s_mov_b64 exec, s[64:65]
    buffer_load_dwordx4 v3, s[8:11], s45 offen lds
    s_mov_b64 exec, -1
    s_mov_b64 exec, s[64:65]
    buffer_load_dwordx4 v4, s[8:11], s45 offen offset:1024 lds
    s_mov_b64 exec, -1
    s_waitcnt vmcnt(6)
    s_barrier
fused_kernel_skip1c18:
    s_add_u32 m0, s97, 0
    s_add_u32 s21, s37, 35840
    s_add_u32 s20, s37, 0
    buffer_load_dwordx4 v1, s[24:27], s20 offen lds
    buffer_load_dwordx4 v1, s[24:27], s21 offen offset:1024 lds
    ds_read_b64_tr_b16 v[120:121], v6 offset:32768
    ds_read_b64_tr_b16 v[122:123], v6 offset:33792
    ds_read_b128 v[32:35], v7 offset:14336
    buffer_load_dwordx4 v2, s[24:27], s20 offen offset:2048 lds
    ds_read_b64_tr_b16 v[192:193], v6 offset:49152
    ds_read_b64_tr_b16 v[194:195], v6 offset:50176
    ds_read_b128 v[36:39], v7 offset:16384
    buffer_load_dwordx4 v2, s[24:27], s21 offen offset:3072 lds
    ds_read_b128 v[40:43], v7 offset:18432
    ds_read_b128 v[44:47], v7 offset:20480
    s_add_u32 m0, s42, 141312
    s_add_u32 s45, s39, s5
    s_add_u32 s45, s45, 0
    s_mov_b64 exec, s[64:65]
    buffer_load_dwordx4 v3, s[8:11], s45 offen lds
    s_mov_b64 exec, -1
    ds_read_b128 v[24:27], v7 offset:22528
    ds_read_b128 v[28:31], v7 offset:24576
    s_mov_b64 exec, s[64:65]
    buffer_load_dwordx4 v4, s[8:11], s45 offen offset:1024 lds
    s_mov_b64 exec, -1
    ds_read_b64_tr_b16 v[124:125], v6 offset:40960
    ds_read_b64_tr_b16 v[126:127], v6 offset:41984
    ds_read_b64_tr_b16 v[196:197], v6 offset:57344
    ds_read_b64_tr_b16 v[198:199], v6 offset:58368
    s_cmp_eq_u32 s33, 0
    s_cbranch_scc1 fused_kernel_xwc180
    s_waitcnt vmcnt(6)
fused_kernel_xwc180:
    s_waitcnt lgkmcnt(0)
    s_barrier
    s_setprio 1
    v_mfma_f32_16x16x32_bf16 v[48:51], v[120:123], v[32:35], v[48:51]
    v_mfma_f32_16x16x32_bf16 v[52:55], v[192:195], v[32:35], v[52:55]
    ds_read_b128 v[32:35], v7 offset:26624
    v_mfma_f32_16x16x32_bf16 v[56:59], v[120:123], v[36:39], v[56:59]
    v_mfma_f32_16x16x32_bf16 v[60:63], v[192:195], v[36:39], v[60:63]
    ds_read_b128 v[36:39], v8 offset:14336
    v_mfma_f32_16x16x32_bf16 v[64:67], v[120:123], v[40:43], v[64:67]
    v_mfma_f32_16x16x32_bf16 v[68:71], v[192:195], v[40:43], v[68:71]
    ds_read_b128 v[40:43], v8 offset:16384
    v_mfma_f32_16x16x32_bf16 v[72:75], v[120:123], v[44:47], v[72:75]
    v_mfma_f32_16x16x32_bf16 v[76:79], v[192:195], v[44:47], v[76:79]
    ds_read_b128 v[44:47], v8 offset:18432
    v_mfma_f32_16x16x32_bf16 v[80:83], v[120:123], v[24:27], v[80:83]
    v_mfma_f32_16x16x32_bf16 v[84:87], v[192:195], v[24:27], v[84:87]
    ds_read_b128 v[24:27], v8 offset:20480
    v_mfma_f32_16x16x32_bf16 v[88:91], v[120:123], v[28:31], v[88:91]
    v_mfma_f32_16x16x32_bf16 v[92:95], v[192:195], v[28:31], v[92:95]
    ds_read_b128 v[28:31], v8 offset:22528
    s_waitcnt lgkmcnt(5)
    v_mfma_f32_16x16x32_bf16 v[96:99], v[120:123], v[32:35], v[96:99]
    v_mfma_f32_16x16x32_bf16 v[100:103], v[192:195], v[32:35], v[100:103]
    ds_read_b128 v[32:35], v8 offset:24576
    s_waitcnt lgkmcnt(5)
    v_mfma_f32_16x16x32_bf16 v[48:51], v[124:127], v[36:39], v[48:51]
    v_mfma_f32_16x16x32_bf16 v[52:55], v[196:199], v[36:39], v[52:55]
    ds_read_b128 v[36:39], v8 offset:26624
    s_waitcnt lgkmcnt(5)
    v_mfma_f32_16x16x32_bf16 v[56:59], v[124:127], v[40:43], v[56:59]
    v_mfma_f32_16x16x32_bf16 v[60:63], v[196:199], v[40:43], v[60:63]
    s_waitcnt lgkmcnt(4)
    v_mfma_f32_16x16x32_bf16 v[64:67], v[124:127], v[44:47], v[64:67]
    s_add_u32 m0, s42, 98304
    s_add_u32 s45, s39, s5
    v_mfma_f32_16x16x32_bf16 v[68:71], v[196:199], v[44:47], v[68:71]
    s_add_u32 s45, s45, 128
    s_waitcnt lgkmcnt(3)
    v_mfma_f32_16x16x32_bf16 v[72:75], v[124:127], v[24:27], v[72:75]
    s_mov_b64 exec, s[64:65]
    buffer_load_dwordx4 v3, s[8:11], s45 offen lds
    s_mov_b64 exec, -1
    v_mfma_f32_16x16x32_bf16 v[76:79], v[196:199], v[24:27], v[76:79]
    s_waitcnt lgkmcnt(2)
    v_mfma_f32_16x16x32_bf16 v[80:83], v[124:127], v[28:31], v[80:83]
    v_mfma_f32_16x16x32_bf16 v[84:87], v[196:199], v[28:31], v[84:87]
    s_waitcnt lgkmcnt(1)
    v_mfma_f32_16x16x32_bf16 v[88:91], v[124:127], v[32:35], v[88:91]
    s_mov_b64 exec, s[64:65]
    buffer_load_dwordx4 v4, s[8:11], s45 offen offset:1024 lds
    s_mov_b64 exec, -1
    v_mfma_f32_16x16x32_bf16 v[92:95], v[196:199], v[32:35], v[92:95]
    s_waitcnt vmcnt(8) lgkmcnt(0)
    s_setprio 3
    s_barrier
    v_mfma_f32_16x16x32_bf16 v[96:99], v[124:127], v[36:39], v[96:99]
    v_mfma_f32_16x16x32_bf16 v[100:103], v[196:199], v[36:39], v[100:103]
    s_setprio 0
    s_add_u32 m0, s97, 32768
    s_add_u32 s21, s37, 625664
    s_add_u32 s20, s37, 589824
    buffer_load_dwordx4 v1, s[24:27], s20 offen lds
    buffer_load_dwordx4 v1, s[24:27], s21 offen offset:1024 lds
    ds_read_b64_tr_b16 v[128:129], v22 offset:0
    ds_read_b64_tr_b16 v[130:131], v22 offset:1024
    ds_read_b128 v[40:43], v7 offset:28672
    buffer_load_dwordx4 v2, s[24:27], s20 offen offset:2048 lds
    ds_read_b64_tr_b16 v[200:201], v22 offset:16384
    ds_read_b64_tr_b16 v[202:203], v22 offset:17408
    ds_read_b128 v[44:47], v7 offset:30720
    buffer_load_dwordx4 v2, s[24:27], s21 offen offset:3072 lds
    ds_read_b128 v[24:27], v7 offset:32768
    ds_read_b128 v[28:31], v7 offset:34816
    ds_read_b128 v[32:35], v7 offset:36864
    ds_read_b128 v[36:39], v7 offset:38912
    ds_read_b64_tr_b16 v[132:133], v22 offset:8192
    ds_read_b64_tr_b16 v[134:135], v22 offset:9216
    ds_read_b64_tr_b16 v[204:205], v22 offset:24576
    ds_read_b64_tr_b16 v[206:207], v22 offset:25600
    s_waitcnt vmcnt(6) lgkmcnt(0)
    s_barrier
    s_setprio 1
    v_mfma_f32_16x16x32_bf16 v[48:51], v[128:131], v[40:43], v[48:51]
    v_mfma_f32_16x16x32_bf16 v[52:55], v[200:203], v[40:43], v[52:55]
    ds_read_b128 v[40:43], v7 offset:40960
    v_mfma_f32_16x16x32_bf16 v[56:59], v[128:131], v[44:47], v[56:59]
    v_mfma_f32_16x16x32_bf16 v[60:63], v[200:203], v[44:47], v[60:63]
    ds_read_b128 v[44:47], v8 offset:28672
    v_mfma_f32_16x16x32_bf16 v[64:67], v[128:131], v[24:27], v[64:67]
    v_mfma_f32_16x16x32_bf16 v[68:71], v[200:203], v[24:27], v[68:71]
    ds_read_b128 v[24:27], v8 offset:30720
    v_mfma_f32_16x16x32_bf16 v[72:75], v[128:131], v[28:31], v[72:75]
    v_mfma_f32_16x16x32_bf16 v[76:79], v[200:203], v[28:31], v[76:79]
    ds_read_b128 v[28:31], v8 offset:32768
    v_mfma_f32_16x16x32_bf16 v[80:83], v[128:131], v[32:35], v[80:83]
    v_mfma_f32_16x16x32_bf16 v[84:87], v[200:203], v[32:35], v[84:87]
    ds_read_b128 v[32:35], v8 offset:34816
    v_mfma_f32_16x16x32_bf16 v[88:91], v[128:131], v[36:39], v[88:91]
    v_mfma_f32_16x16x32_bf16 v[92:95], v[200:203], v[36:39], v[92:95]
    ds_read_b128 v[36:39], v8 offset:36864
    s_waitcnt lgkmcnt(5)
    v_mfma_f32_16x16x32_bf16 v[96:99], v[128:131], v[40:43], v[96:99]
    v_mfma_f32_16x16x32_bf16 v[100:103], v[200:203], v[40:43], v[100:103]
    ds_read_b128 v[40:43], v8 offset:38912
    s_waitcnt lgkmcnt(5)
    v_mfma_f32_16x16x32_bf16 v[48:51], v[132:135], v[44:47], v[48:51]
    v_mfma_f32_16x16x32_bf16 v[52:55], v[204:207], v[44:47], v[52:55]
    ds_read_b128 v[44:47], v8 offset:40960
    s_waitcnt lgkmcnt(5)
    v_mfma_f32_16x16x32_bf16 v[56:59], v[132:135], v[24:27], v[56:59]
    v_mfma_f32_16x16x32_bf16 v[60:63], v[204:207], v[24:27], v[60:63]
    s_waitcnt lgkmcnt(4)
    v_mfma_f32_16x16x32_bf16 v[64:67], v[132:135], v[28:31], v[64:67]
    s_add_u32 m0, s42, 112640
    s_add_u32 s45, s39, s5
    v_mfma_f32_16x16x32_bf16 v[68:71], v[204:207], v[28:31], v[68:71]
    s_add_u32 s45, s45, 256
    s_waitcnt lgkmcnt(3)
    v_mfma_f32_16x16x32_bf16 v[72:75], v[132:135], v[32:35], v[72:75]
    s_mov_b64 exec, s[64:65]
    buffer_load_dwordx4 v3, s[8:11], s45 offen lds
    s_mov_b64 exec, -1
    v_mfma_f32_16x16x32_bf16 v[76:79], v[204:207], v[32:35], v[76:79]
    s_waitcnt lgkmcnt(2)
    v_mfma_f32_16x16x32_bf16 v[80:83], v[132:135], v[36:39], v[80:83]
    v_mfma_f32_16x16x32_bf16 v[84:87], v[204:207], v[36:39], v[84:87]
    s_waitcnt lgkmcnt(1)
    v_mfma_f32_16x16x32_bf16 v[88:91], v[132:135], v[40:43], v[88:91]
    s_mov_b64 exec, s[64:65]
    buffer_load_dwordx4 v4, s[8:11], s45 offen offset:1024 lds
    s_mov_b64 exec, -1
    v_mfma_f32_16x16x32_bf16 v[92:95], v[204:207], v[40:43], v[92:95]
    s_waitcnt lgkmcnt(0)
    s_setprio 3
    s_barrier
    v_mfma_f32_16x16x32_bf16 v[96:99], v[132:135], v[44:47], v[96:99]
    v_mfma_f32_16x16x32_bf16 v[100:103], v[204:207], v[44:47], v[100:103]
    s_setprio 0
    s_add_u32 m0, s97, 65536
    s_add_u32 s21, s37, 1215488
    s_add_u32 s20, s37, 1179648
    buffer_load_dwordx4 v1, s[24:27], s20 offen lds
    buffer_load_dwordx4 v1, s[24:27], s21 offen offset:1024 lds
    ds_read_b64_tr_b16 v[136:137], v6 offset:0
    ds_read_b64_tr_b16 v[138:139], v6 offset:1024
    ds_read_b128 v[24:27], v7 offset:43008
    buffer_load_dwordx4 v2, s[24:27], s20 offen offset:2048 lds
    ds_read_b64_tr_b16 v[208:209], v6 offset:16384
    ds_read_b64_tr_b16 v[210:211], v6 offset:17408
    ds_read_b128 v[28:31], v7 offset:45056
    buffer_load_dwordx4 v2, s[24:27], s21 offen offset:3072 lds
    ds_read_b128 v[32:35], v7 offset:47104
    ds_read_b128 v[36:39], v7 offset:49152
    buffer_store_dwordx4 v[12:15], v16, s[56:59], s69 offen sc0 sc1
    s_add_u32 s69, s69, 1024
    ds_read_b128 v[40:43], v7 offset:51200
    ds_read_b128 v[44:47], v7 offset:53248
    ds_read_b64_tr_b16 v[140:141], v6 offset:8192
    ds_read_b64_tr_b16 v[142:143], v6 offset:9216
    ds_read_b64_tr_b16 v[212:213], v6 offset:24576
    ds_read_b64_tr_b16 v[214:215], v6 offset:25600
    s_waitcnt vmcnt(7) lgkmcnt(0)
    s_barrier
    s_setprio 1
    v_mfma_f32_16x16x32_bf16 v[48:51], v[136:139], v[24:27], v[48:51]
    v_mfma_f32_16x16x32_bf16 v[52:55], v[208:211], v[24:27], v[52:55]
    ds_read_b128 v[24:27], v7 offset:55296
    v_mfma_f32_16x16x32_bf16 v[56:59], v[136:139], v[28:31], v[56:59]
    v_mfma_f32_16x16x32_bf16 v[60:63], v[208:211], v[28:31], v[60:63]
    ds_read_b128 v[28:31], v8 offset:43008
    v_mfma_f32_16x16x32_bf16 v[64:67], v[136:139], v[32:35], v[64:67]
    v_mfma_f32_16x16x32_bf16 v[68:71], v[208:211], v[32:35], v[68:71]
    ds_read_b128 v[32:35], v8 offset:45056
    v_mfma_f32_16x16x32_bf16 v[72:75], v[136:139], v[36:39], v[72:75]
    v_mfma_f32_16x16x32_bf16 v[76:79], v[208:211], v[36:39], v[76:79]
    ds_read_b128 v[36:39], v8 offset:47104
    v_mfma_f32_16x16x32_bf16 v[80:83], v[136:139], v[40:43], v[80:83]
    v_mfma_f32_16x16x32_bf16 v[84:87], v[208:211], v[40:43], v[84:87]
    ds_read_b128 v[40:43], v8 offset:49152
    v_mfma_f32_16x16x32_bf16 v[88:91], v[136:139], v[44:47], v[88:91]
    v_mfma_f32_16x16x32_bf16 v[92:95], v[208:211], v[44:47], v[92:95]
    ds_read_b128 v[44:47], v8 offset:51200
    s_waitcnt lgkmcnt(5)
    v_mfma_f32_16x16x32_bf16 v[96:99], v[136:139], v[24:27], v[96:99]
    v_mfma_f32_16x16x32_bf16 v[100:103], v[208:211], v[24:27], v[100:103]
    ds_read_b128 v[24:27], v8 offset:53248
    s_waitcnt lgkmcnt(5)
    v_mfma_f32_16x16x32_bf16 v[48:51], v[140:143], v[28:31], v[48:51]
    v_mfma_f32_16x16x32_bf16 v[52:55], v[212:215], v[28:31], v[52:55]
    ds_read_b128 v[28:31], v8 offset:55296
    s_waitcnt lgkmcnt(5)
    v_mfma_f32_16x16x32_bf16 v[56:59], v[140:143], v[32:35], v[56:59]
    v_mfma_f32_16x16x32_bf16 v[60:63], v[212:215], v[32:35], v[60:63]
    s_waitcnt lgkmcnt(4)
    v_mfma_f32_16x16x32_bf16 v[64:67], v[140:143], v[36:39], v[64:67]
    s_add_u32 m0, s42, 126976
    s_add_u32 s45, s39, s48
    v_mfma_f32_16x16x32_bf16 v[68:71], v[212:215], v[36:39], v[68:71]
    s_add_u32 s45, s45, 0
    s_waitcnt lgkmcnt(3)
    v_mfma_f32_16x16x32_bf16 v[72:75], v[140:143], v[40:43], v[72:75]
    s_mov_b64 exec, s[64:65]
    buffer_load_dwordx4 v3, s[8:11], s45 offen lds
    s_mov_b64 exec, -1
    v_mfma_f32_16x16x32_bf16 v[76:79], v[212:215], v[40:43], v[76:79]
    s_waitcnt lgkmcnt(2)
    v_mfma_f32_16x16x32_bf16 v[80:83], v[140:143], v[44:47], v[80:83]
    v_mfma_f32_16x16x32_bf16 v[84:87], v[212:215], v[44:47], v[84:87]
    s_waitcnt lgkmcnt(1)
    v_mfma_f32_16x16x32_bf16 v[88:91], v[140:143], v[24:27], v[88:91]
    s_mov_b64 exec, s[64:65]
    buffer_load_dwordx4 v4, s[8:11], s45 offen offset:1024 lds
    s_mov_b64 exec, -1
    v_mfma_f32_16x16x32_bf16 v[92:95], v[212:215], v[24:27], v[92:95]
    s_waitcnt lgkmcnt(0)
    s_setprio 3
    s_barrier
    v_mfma_f32_16x16x32_bf16 v[96:99], v[140:143], v[28:31], v[96:99]
    v_mfma_f32_16x16x32_bf16 v[100:103], v[212:215], v[28:31], v[100:103]
    s_setprio 0
    s_add_u32 m0, s97, 0
    s_add_u32 s21, s38, 35840
    s_add_u32 s20, s38, 0
    buffer_load_dwordx4 v1, s[24:27], s20 offen lds
    buffer_load_dwordx4 v1, s[24:27], s21 offen offset:1024 lds
    ds_read_b64_tr_b16 v[144:145], v6 offset:32768
    ds_read_b64_tr_b16 v[146:147], v6 offset:33792
    ds_read_b128 v[32:35], v7 offset:0
    buffer_load_dwordx4 v2, s[24:27], s20 offen offset:2048 lds
    ds_read_b64_tr_b16 v[216:217], v6 offset:49152
    ds_read_b64_tr_b16 v[218:219], v6 offset:50176
    ds_read_b128 v[36:39], v7 offset:2048
    buffer_load_dwordx4 v2, s[24:27], s21 offen offset:3072 lds
    ds_read_b128 v[40:43], v7 offset:4096
    ds_read_b128 v[44:47], v7 offset:6144
    buffer_store_dwordx4 v[12:15], v16, s[56:59], s69 offen sc0 sc1
    s_add_u32 s69, s69, 1024
    ds_read_b128 v[24:27], v7 offset:8192
    ds_read_b128 v[28:31], v7 offset:10240
    ds_read_b64_tr_b16 v[148:149], v6 offset:40960
    ds_read_b64_tr_b16 v[150:151], v6 offset:41984
    ds_read_b64_tr_b16 v[220:221], v6 offset:57344
    ds_read_b64_tr_b16 v[222:223], v6 offset:58368
    s_waitcnt vmcnt(8) lgkmcnt(0)
    s_barrier
    s_setprio 1
    v_mfma_f32_16x16x32_bf16 v[48:51], v[144:147], v[32:35], v[48:51]
    v_mfma_f32_16x16x32_bf16 v[52:55], v[216:219], v[32:35], v[52:55]
    ds_read_b128 v[32:35], v7 offset:12288
    v_mfma_f32_16x16x32_bf16 v[56:59], v[144:147], v[36:39], v[56:59]
    v_mfma_f32_16x16x32_bf16 v[60:63], v[216:219], v[36:39], v[60:63]
    ds_read_b128 v[36:39], v8 offset:0
    v_mfma_f32_16x16x32_bf16 v[64:67], v[144:147], v[40:43], v[64:67]
    v_mfma_f32_16x16x32_bf16 v[68:71], v[216:219], v[40:43], v[68:71]
    ds_read_b128 v[40:43], v8 offset:2048
    v_mfma_f32_16x16x32_bf16 v[72:75], v[144:147], v[44:47], v[72:75]
    v_mfma_f32_16x16x32_bf16 v[76:79], v[216:219], v[44:47], v[76:79]
    ds_read_b128 v[44:47], v8 offset:4096
    v_mfma_f32_16x16x32_bf16 v[80:83], v[144:147], v[24:27], v[80:83]
    v_mfma_f32_16x16x32_bf16 v[84:87], v[216:219], v[24:27], v[84:87]
    ds_read_b128 v[24:27], v8 offset:6144
    v_mfma_f32_16x16x32_bf16 v[88:91], v[144:147], v[28:31], v[88:91]
    v_mfma_f32_16x16x32_bf16 v[92:95], v[216:219], v[28:31], v[92:95]
    ds_read_b128 v[28:31], v8 offset:8192
    s_waitcnt lgkmcnt(5)
    v_mfma_f32_16x16x32_bf16 v[96:99], v[144:147], v[32:35], v[96:99]
    v_mfma_f32_16x16x32_bf16 v[100:103], v[216:219], v[32:35], v[100:103]
    ds_read_b128 v[32:35], v8 offset:10240
    s_waitcnt lgkmcnt(5)
    v_mfma_f32_16x16x32_bf16 v[48:51], v[148:151], v[36:39], v[48:51]
    v_mfma_f32_16x16x32_bf16 v[52:55], v[220:223], v[36:39], v[52:55]
    ds_read_b128 v[36:39], v8 offset:12288
    s_waitcnt lgkmcnt(5)
    v_mfma_f32_16x16x32_bf16 v[56:59], v[148:151], v[40:43], v[56:59]
    v_mfma_f32_16x16x32_bf16 v[60:63], v[220:223], v[40:43], v[60:63]
    s_waitcnt lgkmcnt(4)
    v_mfma_f32_16x16x32_bf16 v[64:67], v[148:151], v[44:47], v[64:67]
    s_add_u32 m0, s42, 141312
    s_add_u32 s45, s39, s48
    v_mfma_f32_16x16x32_bf16 v[68:71], v[220:223], v[44:47], v[68:71]
    s_add_u32 s45, s45, 128
    s_waitcnt lgkmcnt(3)
    v_mfma_f32_16x16x32_bf16 v[72:75], v[148:151], v[24:27], v[72:75]
    s_mov_b64 exec, s[64:65]
    buffer_load_dwordx4 v3, s[8:11], s45 offen lds
    s_mov_b64 exec, -1
    v_mfma_f32_16x16x32_bf16 v[76:79], v[220:223], v[24:27], v[76:79]
    s_waitcnt lgkmcnt(2)
    v_mfma_f32_16x16x32_bf16 v[80:83], v[148:151], v[28:31], v[80:83]
    v_mfma_f32_16x16x32_bf16 v[84:87], v[220:223], v[28:31], v[84:87]
    s_waitcnt lgkmcnt(1)
    v_mfma_f32_16x16x32_bf16 v[88:91], v[148:151], v[32:35], v[88:91]
    s_mov_b64 exec, s[64:65]
    buffer_load_dwordx4 v4, s[8:11], s45 offen offset:1024 lds
    s_mov_b64 exec, -1
    v_mfma_f32_16x16x32_bf16 v[92:95], v[220:223], v[32:35], v[92:95]
    s_waitcnt lgkmcnt(0)
    s_setprio 3
    s_barrier
    v_mfma_f32_16x16x32_bf16 v[96:99], v[148:151], v[36:39], v[96:99]
    v_mfma_f32_16x16x32_bf16 v[100:103], v[220:223], v[36:39], v[100:103]
    s_setprio 0
    s_add_u32 m0, s97, 32768
    s_add_u32 s21, s38, 625664
    s_add_u32 s20, s38, 589824
    buffer_load_dwordx4 v1, s[24:27], s20 offen lds
    s_and_b64 exec, s[100:101], 1
    buffer_load_dword v9, off, s[92:95], 0 sc0 sc1
    s_mov_b64 exec, -1
    buffer_load_dwordx4 v1, s[24:27], s21 offen offset:1024 lds
    ds_read_b64_tr_b16 v[152:153], v22 offset:0
    ds_read_b64_tr_b16 v[154:155], v22 offset:1024
    ds_read_b128 v[40:43], v7 offset:14336
    buffer_load_dwordx4 v2, s[24:27], s20 offen offset:2048 lds
    ds_read_b64_tr_b16 v[224:225], v22 offset:16384
    ds_read_b64_tr_b16 v[226:227], v22 offset:17408
    ds_read_b128 v[44:47], v7 offset:16384
    buffer_load_dwordx4 v2, s[24:27], s21 offen offset:3072 lds
    ds_read_b128 v[24:27], v7 offset:18432
    ds_read_b128 v[28:31], v7 offset:20480
    buffer_store_dwordx4 v[12:15], v16, s[56:59], s69 offen sc0 sc1
    s_add_u32 s69, s69, 1024
    ds_read_b128 v[32:35], v7 offset:22528
    ds_read_b128 v[36:39], v7 offset:24576
    ds_read_b64_tr_b16 v[156:157], v22 offset:8192
    ds_read_b64_tr_b16 v[158:159], v22 offset:9216
    ds_read_b64_tr_b16 v[228:229], v22 offset:24576
    ds_read_b64_tr_b16 v[230:231], v22 offset:25600
    s_waitcnt vmcnt(9) lgkmcnt(0)
    s_barrier
    s_setprio 1
    v_mfma_f32_16x16x32_bf16 v[48:51], v[152:155], v[40:43], v[48:51]
    v_mfma_f32_16x16x32_bf16 v[52:55], v[224:227], v[40:43], v[52:55]
    ds_read_b128 v[40:43], v7 offset:26624
    v_mfma_f32_16x16x32_bf16 v[56:59], v[152:155], v[44:47], v[56:59]
    v_mfma_f32_16x16x32_bf16 v[60:63], v[224:227], v[44:47], v[60:63]
    ds_read_b128 v[44:47], v8 offset:14336
    v_mfma_f32_16x16x32_bf16 v[64:67], v[152:155], v[24:27], v[64:67]
    v_mfma_f32_16x16x32_bf16 v[68:71], v[224:227], v[24:27], v[68:71]
    ds_read_b128 v[24:27], v8 offset:16384
    v_mfma_f32_16x16x32_bf16 v[72:75], v[152:155], v[28:31], v[72:75]
    v_mfma_f32_16x16x32_bf16 v[76:79], v[224:227], v[28:31], v[76:79]
    ds_read_b128 v[28:31], v8 offset:18432
    v_mfma_f32_16x16x32_bf16 v[80:83], v[152:155], v[32:35], v[80:83]
    v_mfma_f32_16x16x32_bf16 v[84:87], v[224:227], v[32:35], v[84:87]
    ds_read_b128 v[32:35], v8 offset:20480
    v_mfma_f32_16x16x32_bf16 v[88:91], v[152:155], v[36:39], v[88:91]
    v_mfma_f32_16x16x32_bf16 v[92:95], v[224:227], v[36:39], v[92:95]
    ds_read_b128 v[36:39], v8 offset:22528
    s_waitcnt lgkmcnt(5)
    v_mfma_f32_16x16x32_bf16 v[96:99], v[152:155], v[40:43], v[96:99]
    v_mfma_f32_16x16x32_bf16 v[100:103], v[224:227], v[40:43], v[100:103]
    ds_read_b128 v[40:43], v8 offset:24576
    s_waitcnt lgkmcnt(5)
    v_mfma_f32_16x16x32_bf16 v[48:51], v[156:159], v[44:47], v[48:51]
    v_mfma_f32_16x16x32_bf16 v[52:55], v[228:231], v[44:47], v[52:55]
    ds_read_b128 v[44:47], v8 offset:26624
    s_waitcnt lgkmcnt(5)
    v_mfma_f32_16x16x32_bf16 v[56:59], v[156:159], v[24:27], v[56:59]
    v_mfma_f32_16x16x32_bf16 v[60:63], v[228:231], v[24:27], v[60:63]
    s_waitcnt lgkmcnt(4)
    v_mfma_f32_16x16x32_bf16 v[64:67], v[156:159], v[28:31], v[64:67]
    s_add_u32 m0, s42, 98304
    s_add_u32 s45, s39, s48
    v_mfma_f32_16x16x32_bf16 v[68:71], v[228:231], v[28:31], v[68:71]
    s_add_u32 s45, s45, 256
    s_waitcnt lgkmcnt(3)
    v_mfma_f32_16x16x32_bf16 v[72:75], v[156:159], v[32:35], v[72:75]
    s_mov_b64 exec, s[64:65]
    buffer_load_dwordx4 v3, s[8:11], s45 offen lds
    s_mov_b64 exec, -1
    v_mfma_f32_16x16x32_bf16 v[76:79], v[228:231], v[32:35], v[76:79]
    s_waitcnt lgkmcnt(2)
    v_mfma_f32_16x16x32_bf16 v[80:83], v[156:159], v[36:39], v[80:83]
    v_mfma_f32_16x16x32_bf16 v[84:87], v[228:231], v[36:39], v[84:87]
    s_waitcnt lgkmcnt(1)
    v_mfma_f32_16x16x32_bf16 v[88:91], v[156:159], v[40:43], v[88:91]
    s_mov_b64 exec, s[64:65]
    buffer_load_dwordx4 v4, s[8:11], s45 offen offset:1024 lds
    s_mov_b64 exec, -1
    v_mfma_f32_16x16x32_bf16 v[92:95], v[228:231], v[40:43], v[92:95]
    s_waitcnt lgkmcnt(0)
    s_setprio 3
    s_barrier
    v_mfma_f32_16x16x32_bf16 v[96:99], v[156:159], v[44:47], v[96:99]
    v_mfma_f32_16x16x32_bf16 v[100:103], v[228:231], v[44:47], v[100:103]
    s_setprio 0
    s_add_u32 m0, s97, 65536
    s_add_u32 s21, s38, 1215488
    s_add_u32 s20, s38, 1179648
    buffer_load_dwordx4 v1, s[24:27], s20 offen lds
    buffer_load_dwordx4 v1, s[24:27], s21 offen offset:1024 lds
    ds_read_b64_tr_b16 v[160:161], v6 offset:0
    ds_read_b64_tr_b16 v[162:163], v6 offset:1024
    ds_read_b128 v[24:27], v7 offset:28672
    buffer_load_dwordx4 v2, s[24:27], s20 offen offset:2048 lds
    ds_read_b64_tr_b16 v[232:233], v6 offset:16384
    ds_read_b64_tr_b16 v[234:235], v6 offset:17408
    ds_read_b128 v[28:31], v7 offset:30720
    buffer_load_dwordx4 v2, s[24:27], s21 offen offset:3072 lds
    ds_read_b128 v[32:35], v7 offset:32768
    ds_read_b128 v[36:39], v7 offset:34816
    buffer_store_dwordx4 v[12:15], v16, s[56:59], s69 offen sc0 sc1
    s_add_u32 s69, s69, 1024
    ds_read_b128 v[40:43], v7 offset:36864
    ds_read_b128 v[44:47], v7 offset:38912
    ds_read_b64_tr_b16 v[164:165], v6 offset:8192
    ds_read_b64_tr_b16 v[166:167], v6 offset:9216
    ds_read_b64_tr_b16 v[236:237], v6 offset:24576
    ds_read_b64_tr_b16 v[238:239], v6 offset:25600
    s_waitcnt vmcnt(8) lgkmcnt(0)
    s_barrier
    s_setprio 1
    v_mfma_f32_16x16x32_bf16 v[48:51], v[160:163], v[24:27], v[48:51]
    s_lshr_b32 s34, s2, 7
    v_mfma_f32_16x16x32_bf16 v[52:55], v[232:235], v[24:27], v[52:55]
    s_mul_i32 s35, s34, 9363
    ds_read_b128 v[24:27], v7 offset:40960
    v_mfma_f32_16x16x32_bf16 v[56:59], v[160:163], v[28:31], v[56:59]
    s_lshr_b32 s35, s35, 16
    v_mfma_f32_16x16x32_bf16 v[60:63], v[232:235], v[28:31], v[60:63]
    s_mul_i32 s35, s35, 3
    ds_read_b128 v[28:31], v8 offset:28672
    v_mfma_f32_16x16x32_bf16 v[64:67], v[160:163], v[32:35], v[64:67]
    s_sub_u32 s34, s34, s35
    v_mfma_f32_16x16x32_bf16 v[68:71], v[232:235], v[32:35], v[68:71]
    s_min_u32 s34, s34, 143
    ds_read_b128 v[32:35], v8 offset:30720
    v_mfma_f32_16x16x32_bf16 v[72:75], v[160:163], v[36:39], v[72:75]
    s_mul_i32 s35, s34, 7282
    v_mfma_f32_16x16x32_bf16 v[76:79], v[232:235], v[36:39], v[76:79]
    s_lshr_b32 s35, s35, 16
    ds_read_b128 v[36:39], v8 offset:32768
    v_mfma_f32_16x16x32_bf16 v[80:83], v[160:163], v[40:43], v[80:83]
    s_mul_i32 s4, s35, 9
    v_mfma_f32_16x16x32_bf16 v[84:87], v[232:235], v[40:43], v[84:87]
    s_sub_u32 s34, s34, s4
    ds_read_b128 v[40:43], v8 offset:34816
    v_mfma_f32_16x16x32_bf16 v[88:91], v[160:163], v[44:47], v[88:91]
    s_lshl_b32 s35, s35, 3
    v_mfma_f32_16x16x32_bf16 v[92:95], v[232:235], v[44:47], v[92:95]
    s_add_u32 s35, s35, s22
    ds_read_b128 v[44:47], v8 offset:36864
    s_waitcnt lgkmcnt(5)
    v_mfma_f32_16x16x32_bf16 v[96:99], v[160:163], v[24:27], v[96:99]
    s_mul_i32 s4, s35, 18432
    v_mfma_f32_16x16x32_bf16 v[100:103], v[232:235], v[24:27], v[100:103]
    s_lshl_b32 s5, s34, 7
    ds_read_b128 v[24:27], v8 offset:38912
    s_waitcnt lgkmcnt(5)
    v_mfma_f32_16x16x32_bf16 v[48:51], v[164:167], v[28:31], v[48:51]
    s_add_u32 s4, s4, s5
    v_mfma_f32_16x16x32_bf16 v[52:55], v[236:239], v[28:31], v[52:55]
    s_lshl_b32 s48, s34, 9
    ds_read_b128 v[28:31], v8 offset:40960
    s_waitcnt lgkmcnt(5)
    v_mfma_f32_16x16x32_bf16 v[56:59], v[164:167], v[32:35], v[56:59]
    s_sub_u32 s5, 127, s35
    v_mfma_f32_16x16x32_bf16 v[60:63], v[236:239], v[32:35], v[60:63]
    s_lshl_b32 s35, s5, 8
    s_waitcnt lgkmcnt(4)
    v_mfma_f32_16x16x32_bf16 v[64:67], v[164:167], v[36:39], v[64:67]
    s_lshl_b32 s34, s34, 18
    v_mfma_f32_16x16x32_bf16 v[68:71], v[236:239], v[36:39], v[68:71]
    s_add_u32 s34, s34, s35
    s_waitcnt lgkmcnt(3)
    v_mfma_f32_16x16x32_bf16 v[72:75], v[164:167], v[40:43], v[72:75]
    s_add_u32 s34, s34, 50331776
    v_mfma_f32_16x16x32_bf16 v[76:79], v[236:239], v[40:43], v[76:79]
    s_add_u32 s64, s6, s34
    s_waitcnt lgkmcnt(2)
    v_mfma_f32_16x16x32_bf16 v[80:83], v[164:167], v[44:47], v[80:83]
    s_addc_u32 s65, s7, 0
    v_mfma_f32_16x16x32_bf16 v[84:87], v[236:239], v[44:47], v[84:87]
    s_and_b32 s34, s22, 3
    s_waitcnt lgkmcnt(1)
    v_mfma_f32_16x16x32_bf16 v[88:91], v[164:167], v[24:27], v[88:91]
    s_lshl_b32 s35, s33, 15
    v_mfma_f32_16x16x32_bf16 v[92:95], v[236:239], v[24:27], v[92:95]
    s_lshl_b32 s3, s34, 11
    s_waitcnt lgkmcnt(0)
    s_setprio 3
    s_barrier
    v_mfma_f32_16x16x32_bf16 v[96:99], v[164:167], v[28:31], v[96:99]
    s_add_u32 s3, s3, s35
    v_mfma_f32_16x16x32_bf16 v[100:103], v[236:239], v[28:31], v[100:103]
    s_add_u32 s36, s3, 18944
    s_setprio 0
    s_mul_i32 s44, s50, 9
    s_add_u32 s68, s44, s49
    s_add_u32 s44, s44, s63
    s_add_u32 m0, s42, 0
    s_add_u32 s45, s44, 18432
    buffer_load_dwordx4 v3, s[8:11], s45 offen lds
    s_load_dwordx4 s[84:87], s[0:1], 8
    s_load_dwordx2 s[88:89], s[0:1], 24
    s_cmp_eq_u32 s100, 0
    s_cbranch_scc1 fused_kernel_dcc18_ok
    s_movk_i32 s98, 0x4000
fused_kernel_dcc18_l:
    v_readfirstlane_b32 s34, v9
    s_cmp_lg_u32 s34, 0
    s_cbranch_scc1 fused_kernel_dcc18_ok
    s_sleep 2
    s_mov_b64 exec, 1
    buffer_load_dword v9, off, s[92:95], 0 sc0 sc1
    s_mov_b64 exec, -1
    s_waitcnt vmcnt(0)
    s_sub_u32 s98, s98, 1
    s_cbranch_scc0 fused_kernel_dcc18_l
fused_kernel_dcc18_ok:
    s_add_u32 s92, s6, 31465472
    s_addc_u32 s93, s7, 0
    s_and_b32 s93, s93, 0xffff
    s_mov_b32 s94, 65536
    s_mov_b32 s95, 0x00020000
    buffer_load_dwordx4 v4, s[8:11], s45 offen offset:1024 lds
    ds_read_b64_tr_b16 v[168:169], v6 offset:32768
    ds_read_b64_tr_b16 v[170:171], v6 offset:33792
    ds_read_b128 v[32:35], v7 offset:43008
    s_add_u32 m0, s43, 0
    s_add_u32 s45, s68, 18432
    s_mov_b64 exec, 0xffff
    buffer_load_dwordx4 v5, s[8:11], s45 offen lds
    s_mov_b64 exec, -1
    ds_read_b64_tr_b16 v[240:241], v6 offset:49152
    ds_read_b64_tr_b16 v[242:243], v6 offset:50176
    ds_read_b128 v[36:39], v7 offset:45056
    buffer_store_dwordx4 v[12:15], v16, s[56:59], s69 offen sc0 sc1
    s_add_u32 s69, s69, 1024
    ds_read_b128 v[40:43], v7 offset:47104
    ds_read_b128 v[44:47], v7 offset:49152
    ds_read_b128 v[24:27], v7 offset:51200
    ds_read_b128 v[28:31], v7 offset:53248
    ds_read_b64_tr_b16 v[172:173], v6 offset:40960
    ds_read_b64_tr_b16 v[174:175], v6 offset:41984
    ds_read_b64_tr_b16 v[244:245], v6 offset:57344
    ds_read_b64_tr_b16 v[246:247], v6 offset:58368
    s_waitcnt vmcnt(5) lgkmcnt(0)
    s_barrier
    s_setprio 1
    v_mfma_f32_16x16x32_bf16 v[48:51], v[168:171], v[32:35], v[48:51]
    v_bfe_u32 v10, v0, 3, 3
    v_mfma_f32_16x16x32_bf16 v[52:55], v[240:243], v[32:35], v[52:55]
    v_mul_u32_u24 v10, 1152, v10
    ds_read_b128 v[32:35], v7 offset:55296
    v_mfma_f32_16x16x32_bf16 v[56:59], v[168:171], v[36:39], v[56:59]
    v_and_b32 v11, 7, v0
    v_mfma_f32_16x16x32_bf16 v[60:63], v[240:243], v[36:39], v[60:63]
    v_lshl_add_u32 v10, v11, 4, v10
    ds_read_b128 v[36:39], v8 offset:43008
    v_mfma_f32_16x16x32_bf16 v[64:67], v[168:171], v[40:43], v[64:67]
    v_add_u32 v10, s4, v10
    v_mfma_f32_16x16x32_bf16 v[68:71], v[240:243], v[40:43], v[68:71]
    v_add_u32 v11, 9216, v10
    ds_read_b128 v[40:43], v8 offset:45056
    v_mfma_f32_16x16x32_bf16 v[72:75], v[168:171], v[44:47], v[72:75]
    v_subrev_u32 v12, 4608, v10
    v_mfma_f32_16x16x32_bf16 v[76:79], v[240:243], v[44:47], v[76:79]
    v_max_i32 v12, 0, v12
    ds_read_b128 v[44:47], v8 offset:47104
    v_mfma_f32_16x16x32_bf16 v[80:83], v[168:171], v[24:27], v[80:83]
    v_mov_b32 v14, 0
    v_mfma_f32_16x16x32_bf16 v[84:87], v[240:243], v[24:27], v[84:87]
    v_mov_b32 v15, 0
    ds_read_b128 v[24:27], v8 offset:49152
    v_mfma_f32_16x16x32_bf16 v[88:91], v[168:171], v[28:31], v[88:91]
    v_and_b32 v13, 63, v0
    v_mfma_f32_16x16x32_bf16 v[92:95], v[240:243], v[28:31], v[92:95]
    v_lshlrev_b32 v13, 3, v13
    ds_read_b128 v[28:31], v8 offset:51200
    s_waitcnt lgkmcnt(5)
    v_mfma_f32_16x16x32_bf16 v[96:99], v[168:171], v[32:35], v[96:99]
    v_lshl_add_u32 v16, v13, 1, s48
    v_mfma_f32_16x16x32_bf16 v[100:103], v[240:243], v[32:35], v[100:103]
    s_and_b32 s34, s22, 3
    ds_read_b128 v[32:35], v8 offset:53248
    s_waitcnt lgkmcnt(5)
    v_mfma_f32_16x16x32_bf16 v[48:51], v[172:175], v[36:39], v[48:51]
    s_lshl_b32 s35, s33, 15
    v_mfma_f32_16x16x32_bf16 v[52:55], v[244:247], v[36:39], v[52:55]
    s_lshl_b32 s3, s34, 10
    ds_read_b128 v[36:39], v8 offset:55296
    s_waitcnt lgkmcnt(5)
    v_mfma_f32_16x16x32_bf16 v[56:59], v[172:175], v[40:43], v[56:59]
    s_add_u32 s3, s3, s35
    v_mfma_f32_16x16x32_bf16 v[60:63], v[244:247], v[40:43], v[60:63]
    s_add_u32 s37, s3, 27136
    s_waitcnt lgkmcnt(4)
    v_mfma_f32_16x16x32_bf16 v[64:67], v[172:175], v[44:47], v[64:67]
    s_add_u32 s38, s35, 18432
    v_mfma_f32_16x16x32_bf16 v[68:71], v[244:247], v[44:47], v[68:71]
    s_cmp_lt_u32 s4, 1152
    s_waitcnt lgkmcnt(3)
    v_mfma_f32_16x16x32_bf16 v[72:75], v[172:175], v[24:27], v[72:75]
    s_cselect_b64 s[20:21], -1, 0
    v_mfma_f32_16x16x32_bf16 v[76:79], v[244:247], v[24:27], v[76:79]
    s_cselect_b32 s34, 1, s34
    s_waitcnt lgkmcnt(2)
    v_mfma_f32_16x16x32_bf16 v[80:83], v[172:175], v[28:31], v[80:83]
    s_cmp_eq_u32 s34, 0
    v_mfma_f32_16x16x32_bf16 v[84:87], v[244:247], v[28:31], v[84:87]
    s_cselect_b32 s39, s66, 0
    s_waitcnt lgkmcnt(1)
    v_mfma_f32_16x16x32_bf16 v[88:91], v[172:175], v[32:35], v[88:91]
    v_mfma_f32_16x16x32_bf16 v[92:95], v[244:247], v[32:35], v[92:95]
    s_waitcnt lgkmcnt(0)
    s_setprio 3
    s_barrier
    v_mfma_f32_16x16x32_bf16 v[96:99], v[172:175], v[36:39], v[96:99]
    v_mfma_f32_16x16x32_bf16 v[100:103], v[244:247], v[36:39], v[100:103]
    s_setprio 0
    s_add_u32 m0, s42, 32768
    s_add_u32 s45, s44, 36864
    buffer_load_dwordx4 v3, s[8:11], s45 offen lds
    buffer_load_dwordx4 v4, s[8:11], s45 offen offset:1024 lds
    s_add_u32 m0, s43, 32768
    s_add_u32 s45, s68, 36864
    s_mov_b64 exec, 0xffff
    buffer_load_dwordx4 v5, s[8:11], s45 offen lds
    s_mov_b64 exec, -1
    s_mov_b32 m0, s36
    s_mov_b64 exec, s[66:67]
    global_load_lds_dwordx4 v10, s[84:85]
    s_add_u32 m0, m0, 1024
    s_nop 0
    global_load_lds_dwordx4 v11, s[84:85]
    s_mov_b32 m0, s37
    s_nop 0
    global_load_lds_dwordx4 v10, s[86:87]
    s_mov_b32 m0, s38
    s_mov_b64 exec, s[20:21]
    ds_write_b64 v13, v[14:15] offset:18432
    s_mov_b32 exec_lo, s39
    s_mov_b32 exec_hi, 0
    global_load_lds_dwordx4 v12, s[84:85]
    s_mov_b32 m0, 65024
    s_and_b64 exec, s[66:67], s[100:101]
    global_load_lds_dwordx4 v16, s[88:89]
    s_mov_b64 exec, -1
    ds_read_b64_tr_b16 v[176:177], v22 offset:0
    ds_read_b64_tr_b16 v[178:179], v22 offset:1024
    ds_read_b128 v[40:43], v7 offset:0
    ds_read_b64_tr_b16 v[248:249], v22 offset:16384
    ds_read_b64_tr_b16 v[250:251], v22 offset:17408
    ds_read_b128 v[44:47], v7 offset:2048
    ds_read_b128 v[24:27], v7 offset:4096
    ds_read_b128 v[28:31], v7 offset:6144
    ds_read_b128 v[32:35], v7 offset:8192
    ds_read_b128 v[36:39], v7 offset:10240
    ds_read_b64_tr_b16 v[180:181], v22 offset:8192
    ds_read_b64_tr_b16 v[182:183], v22 offset:9216
    ds_read_b64_tr_b16 v[252:253], v22 offset:24576
    ds_read_b64_tr_b16 v[254:255], v22 offset:25600
    s_waitcnt vmcnt(9) lgkmcnt(0)
    s_barrier
    s_setprio 1
    v_mfma_f32_16x16x32_bf16 v[48:51], v[176:179], v[40:43], v[48:51]
    v_mov_b32 v1, v104
    v_mfma_f32_16x16x32_bf16 v[52:55], v[248:251], v[40:43], v[52:55]
    v_mov_b32 v2, v105
    ds_read_b128 v[40:43], v7 offset:12288
    v_mfma_f32_16x16x32_bf16 v[56:59], v[176:179], v[44:47], v[56:59]
    v_mov_b32 v22, v107
    v_mfma_f32_16x16x32_bf16 v[60:63], v[248:251], v[44:47], v[60:63]
    s_lshl_b32 s39, s33, 15
    ds_read_b128 v[44:47], v8 offset:0
    v_mfma_f32_16x16x32_bf16 v[64:67], v[176:179], v[24:27], v[64:67]
    s_add_u32 s39, s39, 31232
    v_mfma_f32_16x16x32_bf16 v[68:71], v[248:251], v[24:27], v[68:71]
    s_sub_u32 s34, s22, s33
    ds_read_b128 v[24:27], v8 offset:2048
    v_mfma_f32_16x16x32_bf16 v[72:75], v[176:179], v[28:31], v[72:75]
    s_lshl_b32 s34, s34, 10
    v_mfma_f32_16x16x32_bf16 v[76:79], v[248:251], v[28:31], v[76:79]
    s_add_u32 s34, s34, 83968
    ds_read_b128 v[28:31], v8 offset:4096
    v_mfma_f32_16x16x32_bf16 v[80:83], v[176:179], v[32:35], v[80:83]
    s_and_b32 s3, s22, 3
    v_mfma_f32_16x16x32_bf16 v[84:87], v[248:251], v[32:35], v[84:87]
    s_cmp_eq_u32 s3, 3
    ds_read_b128 v[32:35], v8 offset:6144
    v_mfma_f32_16x16x32_bf16 v[88:91], v[176:179], v[36:39], v[88:91]
    s_cselect_b32 s39, s39, s34
    v_mfma_f32_16x16x32_bf16 v[92:95], v[248:251], v[36:39], v[92:95]
    ds_read_b128 v[36:39], v8 offset:8192
    s_waitcnt lgkmcnt(5)
    v_mfma_f32_16x16x32_bf16 v[96:99], v[176:179], v[40:43], v[96:99]
    v_mfma_f32_16x16x32_bf16 v[100:103], v[248:251], v[40:43], v[100:103]
    ds_read_b128 v[40:43], v8 offset:10240
    s_waitcnt lgkmcnt(5)
    v_mfma_f32_16x16x32_bf16 v[48:51], v[180:183], v[44:47], v[48:51]
    v_mfma_f32_16x16x32_bf16 v[52:55], v[252:255], v[44:47], v[52:55]
    ds_read_b128 v[44:47], v8 offset:12288
    s_waitcnt lgkmcnt(5)
    v_mfma_f32_16x16x32_bf16 v[56:59], v[180:183], v[24:27], v[56:59]
    v_mfma_f32_16x16x32_bf16 v[60:63], v[252:255], v[24:27], v[60:63]
    s_waitcnt lgkmcnt(4)
    v_mfma_f32_16x16x32_bf16 v[64:67], v[180:183], v[28:31], v[64:67]
    v_mfma_f32_16x16x32_bf16 v[68:71], v[252:255], v[28:31], v[68:71]
    s_waitcnt lgkmcnt(3)
    v_mfma_f32_16x16x32_bf16 v[72:75], v[180:183], v[32:35], v[72:75]
    v_mfma_f32_16x16x32_bf16 v[76:79], v[252:255], v[32:35], v[76:79]
    s_waitcnt lgkmcnt(2)
    v_mfma_f32_16x16x32_bf16 v[80:83], v[180:183], v[36:39], v[80:83]
    v_mfma_f32_16x16x32_bf16 v[84:87], v[252:255], v[36:39], v[84:87]
    s_waitcnt lgkmcnt(1)
    v_mfma_f32_16x16x32_bf16 v[88:91], v[180:183], v[40:43], v[88:91]
    v_mfma_f32_16x16x32_bf16 v[92:95], v[252:255], v[40:43], v[92:95]
    s_waitcnt lgkmcnt(0)
    s_setprio 3
    s_barrier
    v_mfma_f32_16x16x32_bf16 v[96:99], v[180:183], v[44:47], v[96:99]
    v_mfma_f32_16x16x32_bf16 v[100:103], v[252:255], v[44:47], v[100:103]
    s_setprio 0
    s_add_u32 m0, s42, 65536
    s_add_u32 s45, s44, 55296
    buffer_load_dwordx4 v3, s[8:11], s45 offen lds
    buffer_load_dwordx4 v4, s[8:11], s45 offen offset:1024 lds
    s_add_u32 m0, s43, 65536
    s_add_u32 s45, s68, 55296
    s_mov_b64 exec, 0xffff
    buffer_load_dwordx4 v5, s[8:11], s45 offen lds
    s_mov_b64 exec, -1
    s_mov_b32 m0, s39
    s_mov_b64 exec, s[66:67]
    global_load_lds_dwordx4 v11, s[86:87]
    s_mov_b64 exec, -1
    s_load_dwordx4 s[36:39], s[0:1], 32
    v_mul_f32 v10, s46, v48
    v_mul_f32 v11, s46, v49
    v_add_u32 v7, 4294868992, v7
    v_add_u32 v8, 4294868992, v8
    ds_read_b128 v[24:27], v7 offset:0
    v_mul_f32 v12, s46, v50
    v_mul_f32 v13, s46, v51
    ds_read_b128 v[28:31], v8 offset:0
    v_exp_f32 v10, v10
    ds_read_b128 v[32:35], v7 offset:2048
    v_exp_f32 v11, v11
    ds_read_b128 v[36:39], v8 offset:2048
    v_exp_f32 v12, v12
    ds_read_b128 v[40:43], v7 offset:4096
    v_exp_f32 v13, v13
    ds_read_b128 v[44:47], v8 offset:4096
    v_mul_f32 v14, v48, v52
    v_mul_f32 v15, v49, v53
    v_mul_f32 v16, v50, v54
    v_mul_f32 v17, v51, v55
    v_add_f32 v10, 1.0, v10
    v_add_f32 v11, 1.0, v11
    v_add_f32 v12, 1.0, v12
    v_add_f32 v13, 1.0, v13
    v_rcp_f32 v10, v10
    v_rcp_f32 v11, v11
    v_rcp_f32 v12, v12
    s_waitcnt vmcnt(9) lgkmcnt(0)
    s_barrier
    s_setprio 1
    v_mfma_f32_16x16x32_bf16 v[104:107], v[112:115], v[24:27], 0
    v_rcp_f32 v13, v13
    v_mfma_f32_16x16x32_bf16 v[108:111], v[184:187], v[24:27], 0
    ds_read_b128 v[24:27], v7 offset:6144
    v_mfma_f32_16x16x32_bf16 v[104:107], v[116:119], v[28:31], v[104:107]
    v_mul_f32 v14, v14, v10
    v_mul_f32 v15, v15, v11
    v_mfma_f32_16x16x32_bf16 v[108:111], v[188:191], v[28:31], v[108:111]
    ds_read_b128 v[28:31], v8 offset:6144
    v_mfma_f32_16x16x32_bf16 v[104:107], v[120:123], v[32:35], v[104:107]
    v_mul_f32 v16, v16, v12
    v_mul_f32 v17, v17, v13
    v_mfma_f32_16x16x32_bf16 v[108:111], v[192:195], v[32:35], v[108:111]
    ds_read_b128 v[32:35], v7 offset:8192
    v_mfma_f32_16x16x32_bf16 v[104:107], v[124:127], v[36:39], v[104:107]
    v_cvt_pk_bf16_f32 v18, v14, v15
    v_cvt_pk_bf16_f32 v19, v16, v17
    v_mfma_f32_16x16x32_bf16 v[108:111], v[196:199], v[36:39], v[108:111]
    ds_read_b128 v[36:39], v8 offset:8192
    v_mfma_f32_16x16x32_bf16 v[104:107], v[128:131], v[40:43], v[104:107]
    v_mul_f32 v10, s46, v56
    v_mul_f32 v11, s46, v57
    v_mfma_f32_16x16x32_bf16 v[108:111], v[200:203], v[40:43], v[108:111]
    ds_read_b128 v[40:43], v7 offset:10240
    v_mfma_f32_16x16x32_bf16 v[104:107], v[132:135], v[44:47], v[104:107]
    v_mul_f32 v12, s46, v58
    v_mul_f32 v13, s46, v59
    v_mfma_f32_16x16x32_bf16 v[108:111], v[204:207], v[44:47], v[108:111]
    ds_read_b128 v[44:47], v8 offset:10240
    s_waitcnt lgkmcnt(5)
    v_mfma_f32_16x16x32_bf16 v[104:107], v[136:139], v[24:27], v[104:107]
    v_exp_f32 v10, v10
    v_mfma_f32_16x16x32_bf16 v[108:111], v[208:211], v[24:27], v[108:111]
    ds_read_b128 v[24:27], v7 offset:12288
    s_waitcnt lgkmcnt(5)
    v_mfma_f32_16x16x32_bf16 v[104:107], v[140:143], v[28:31], v[104:107]
    v_exp_f32 v11, v11
    v_mfma_f32_16x16x32_bf16 v[108:111], v[212:215], v[28:31], v[108:111]
    ds_read_b128 v[28:31], v8 offset:12288
    s_waitcnt lgkmcnt(5)
    v_mfma_f32_16x16x32_bf16 v[104:107], v[144:147], v[32:35], v[104:107]
    v_exp_f32 v12, v12
    v_mfma_f32_16x16x32_bf16 v[108:111], v[216:219], v[32:35], v[108:111]
    ds_read_b128 v[32:35], v7 offset:14336
    s_waitcnt lgkmcnt(5)
    v_mfma_f32_16x16x32_bf16 v[104:107], v[148:151], v[36:39], v[104:107]
    v_exp_f32 v13, v13
    v_mfma_f32_16x16x32_bf16 v[108:111], v[220:223], v[36:39], v[108:111]
    ds_read_b128 v[36:39], v8 offset:14336
    s_waitcnt lgkmcnt(5)
    v_mfma_f32_16x16x32_bf16 v[104:107], v[152:155], v[40:43], v[104:107]
    v_mul_f32 v14, v56, v60
    v_mul_f32 v15, v57, v61
    v_mfma_f32_16x16x32_bf16 v[108:111], v[224:227], v[40:43], v[108:111]
    ds_read_b128 v[40:43], v7 offset:16384
    s_waitcnt lgkmcnt(5)
    v_mfma_f32_16x16x32_bf16 v[104:107], v[156:159], v[44:47], v[104:107]
    v_mul_f32 v16, v58, v62
    v_mul_f32 v17, v59, v63
    v_mfma_f32_16x16x32_bf16 v[108:111], v[228:231], v[44:47], v[108:111]
    ds_read_b128 v[44:47], v8 offset:16384
    s_waitcnt lgkmcnt(5)
    v_mfma_f32_16x16x32_bf16 v[104:107], v[160:163], v[24:27], v[104:107]
    v_add_f32 v10, 1.0, v10
    v_add_f32 v11, 1.0, v11
    v_mfma_f32_16x16x32_bf16 v[108:111], v[232:235], v[24:27], v[108:111]
    s_waitcnt lgkmcnt(4)
    v_mfma_f32_16x16x32_bf16 v[104:107], v[164:167], v[28:31], v[104:107]
    v_add_f32 v12, 1.0, v12
    v_add_f32 v13, 1.0, v13
    v_mfma_f32_16x16x32_bf16 v[108:111], v[236:239], v[28:31], v[108:111]
    s_waitcnt lgkmcnt(3)
    v_mfma_f32_16x16x32_bf16 v[104:107], v[168:171], v[32:35], v[104:107]
    v_rcp_f32 v10, v10
    v_mfma_f32_16x16x32_bf16 v[108:111], v[240:243], v[32:35], v[108:111]
    s_waitcnt lgkmcnt(2)
    v_mfma_f32_16x16x32_bf16 v[104:107], v[172:175], v[36:39], v[104:107]
    v_rcp_f32 v11, v11
    v_mfma_f32_16x16x32_bf16 v[108:111], v[244:247], v[36:39], v[108:111]
    s_waitcnt lgkmcnt(1)
    v_mfma_f32_16x16x32_bf16 v[104:107], v[176:179], v[40:43], v[104:107]
    v_rcp_f32 v12, v12
    v_mfma_f32_16x16x32_bf16 v[108:111], v[248:251], v[40:43], v[108:111]
    s_waitcnt lgkmcnt(0)
    s_setprio 3
    s_barrier
    v_mfma_f32_16x16x32_bf16 v[104:107], v[180:183], v[44:47], v[104:107]
    v_rcp_f32 v13, v13
    v_mfma_f32_16x16x32_bf16 v[108:111], v[252:255], v[44:47], v[108:111]
    s_setprio 0
    s_mul_i32 s44, s51, 9
    s_add_u32 s68, s44, s49
    s_add_u32 s44, s44, s63
    s_add_u32 m0, s42, 90112
    s_add_u32 s45, s44, 0
    buffer_load_dwordx4 v3, s[8:11], s45 offen lds
    v_mov_b32 v24, 1
    v_lshlrev_b32 v25, 2, v0
    v_and_b32 v25, 127, v25
    s_mov_b64 exec, s[100:101]
    buffer_store_dword v24, v25, s[92:95], s99 offen sc0 sc1
    s_mov_b64 exec, -1
    buffer_load_dwordx4 v4, s[8:11], s45 offen offset:1024 lds
    s_add_u32 m0, s43, 90112
    s_add_u32 s45, s68, 0
    s_mov_b64 exec, 0xffff
    buffer_load_dwordx4 v5, s[8:11], s45 offen lds
    s_mov_b64 exec, -1
    v_and_b32 v28, 63, v0
    v_lshlrev_b32 v28, 7, v28
    s_mov_b32 m0, 32256
    s_and_b32 s34, s22, 3
    s_cmp_eq_u32 s34, 0
    s_cselect_b64 exec, -1, 0
    buffer_load_dword v28, s[28:31], s91 offen lds
    s_mov_b64 exec, -1
    s_sub_u32 s24, s36, 16
    s_subb_u32 s25, s37, 0
    s_and_b32 s25, s25, 0xffff
    s_mov_b32 s26, 2359312
    s_mov_b32 s27, 0x00020000
    s_lshl_b32 s34, s78, 3
    s_add_u32 s34, s34, s22
    s_lshl_b32 s34, s34, 1
    s_and_b32 s34, s34, 0xfffffffc
    s_load_dword s60, s[38:39], s34
    s_lshl_b32 s34, s78, 1
    s_and_b32 s34, s34, 0xfffffffc
    s_add_u32 s34, s34, 1024
    s_load_dword s61, s[38:39], s34
    v_mul_f32 v14, v14, v10
    v_mul_f32 v15, v15, v11
    ds_read_b128 v[24:27], v7 offset:32768
    v_mul_f32 v16, v16, v12
    v_mul_f32 v17, v17, v13
    ds_read_b128 v[28:31], v8 offset:32768
    v_cvt_pk_bf16_f32 v20, v14, v15
    v_cvt_pk_bf16_f32 v21, v16, v17
    ds_read_b128 v[32:35], v7 offset:34816
    s_nop 0
    v_permlane16_swap_b32 v18, v20
    v_permlane16_swap_b32 v19, v21
    ds_read_b128 v[36:39], v8 offset:34816
    s_nop 0
    buffer_store_dwordx4 v[18:21], v23, s[16:19], s47 offen sc0 sc1
    s_add_u32 s47, s47, 4096
    v_mul_f32 v10, s46, v64
    v_mul_f32 v11, s46, v65
    ds_read_b128 v[40:43], v7 offset:36864
    v_mul_f32 v12, s46, v66
    v_mul_f32 v13, s46, v67
    ds_read_b128 v[44:47], v8 offset:36864
    v_exp_f32 v10, v10
    v_exp_f32 v11, v11
    v_exp_f32 v12, v12
    v_exp_f32 v13, v13
    v_mul_f32 v14, v64, v68
    v_mul_f32 v15, v65, v69
    v_mul_f32 v16, v66, v70
    v_mul_f32 v17, v67, v71
    v_add_f32 v10, 1.0, v10
    s_waitcnt vmcnt(7) lgkmcnt(0)
    s_barrier
    s_setprio 1
    v_mfma_f32_16x16x32_bf16 v[48:51], v[112:115], v[24:27], 0
    v_add_f32 v11, 1.0, v11
    v_add_f32 v12, 1.0, v12
    v_mfma_f32_16x16x32_bf16 v[52:55], v[184:187], v[24:27], 0
    ds_read_b128 v[24:27], v7 offset:38912
    v_mfma_f32_16x16x32_bf16 v[48:51], v[116:119], v[28:31], v[48:51]
    v_add_f32 v13, 1.0, v13
    v_mfma_f32_16x16x32_bf16 v[52:55], v[188:191], v[28:31], v[52:55]
    ds_read_b128 v[28:31], v8 offset:38912
    v_mfma_f32_16x16x32_bf16 v[48:51], v[120:123], v[32:35], v[48:51]
    v_rcp_f32 v10, v10
    v_mfma_f32_16x16x32_bf16 v[52:55], v[192:195], v[32:35], v[52:55]
    ds_read_b128 v[32:35], v7 offset:40960
    v_mfma_f32_16x16x32_bf16 v[48:51], v[124:127], v[36:39], v[48:51]
    v_rcp_f32 v11, v11
    v_mfma_f32_16x16x32_bf16 v[52:55], v[196:199], v[36:39], v[52:55]
    ds_read_b128 v[36:39], v8 offset:40960
    v_mfma_f32_16x16x32_bf16 v[48:51], v[128:131], v[40:43], v[48:51]
    v_rcp_f32 v12, v12
    v_mfma_f32_16x16x32_bf16 v[52:55], v[200:203], v[40:43], v[52:55]
    ds_read_b128 v[40:43], v7 offset:43008
    v_mfma_f32_16x16x32_bf16 v[48:51], v[132:135], v[44:47], v[48:51]
    v_rcp_f32 v13, v13
    v_mfma_f32_16x16x32_bf16 v[52:55], v[204:207], v[44:47], v[52:55]
    ds_read_b128 v[44:47], v8 offset:43008
    s_waitcnt lgkmcnt(5)
    v_mfma_f32_16x16x32_bf16 v[48:51], v[136:139], v[24:27], v[48:51]
    v_mul_f32 v14, v14, v10
    v_mul_f32 v15, v15, v11
    v_mfma_f32_16x16x32_bf16 v[52:55], v[208:211], v[24:27], v[52:55]
    ds_read_b128 v[24:27], v7 offset:45056
    s_waitcnt lgkmcnt(5)
    v_mfma_f32_16x16x32_bf16 v[48:51], v[140:143], v[28:31], v[48:51]
    v_mul_f32 v16, v16, v12
    v_mul_f32 v17, v17, v13
    v_mfma_f32_16x16x32_bf16 v[52:55], v[212:215], v[28:31], v[52:55]
    ds_read_b128 v[28:31], v8 offset:45056
    s_waitcnt lgkmcnt(5)
    v_mfma_f32_16x16x32_bf16 v[48:51], v[144:147], v[32:35], v[48:51]
    v_cvt_pk_bf16_f32 v18, v14, v15
    v_cvt_pk_bf16_f32 v19, v16, v17
    v_mfma_f32_16x16x32_bf16 v[52:55], v[216:219], v[32:35], v[52:55]
    ds_read_b128 v[32:35], v7 offset:47104
    s_waitcnt lgkmcnt(5)
    v_mfma_f32_16x16x32_bf16 v[48:51], v[148:151], v[36:39], v[48:51]
    v_mul_f32 v10, s46, v72
    v_mul_f32 v11, s46, v73
    v_mfma_f32_16x16x32_bf16 v[52:55], v[220:223], v[36:39], v[52:55]
    ds_read_b128 v[36:39], v8 offset:47104
    s_waitcnt lgkmcnt(5)
    v_mfma_f32_16x16x32_bf16 v[48:51], v[152:155], v[40:43], v[48:51]
    v_mul_f32 v12, s46, v74
    v_mul_f32 v13, s46, v75
    v_mfma_f32_16x16x32_bf16 v[52:55], v[224:227], v[40:43], v[52:55]
    ds_read_b128 v[40:43], v7 offset:49152
    s_waitcnt lgkmcnt(5)
    v_mfma_f32_16x16x32_bf16 v[48:51], v[156:159], v[44:47], v[48:51]
    v_exp_f32 v10, v10
    v_mfma_f32_16x16x32_bf16 v[52:55], v[228:231], v[44:47], v[52:55]
    ds_read_b128 v[44:47], v8 offset:49152
    s_waitcnt lgkmcnt(5)
    v_mfma_f32_16x16x32_bf16 v[48:51], v[160:163], v[24:27], v[48:51]
    v_exp_f32 v11, v11
    v_mfma_f32_16x16x32_bf16 v[52:55], v[232:235], v[24:27], v[52:55]
    s_waitcnt lgkmcnt(4)
    v_mfma_f32_16x16x32_bf16 v[48:51], v[164:167], v[28:31], v[48:51]
    v_exp_f32 v12, v12
    v_mfma_f32_16x16x32_bf16 v[52:55], v[236:239], v[28:31], v[52:55]
    s_waitcnt lgkmcnt(3)
    v_mfma_f32_16x16x32_bf16 v[48:51], v[168:171], v[32:35], v[48:51]
    v_exp_f32 v13, v13
    v_mfma_f32_16x16x32_bf16 v[52:55], v[240:243], v[32:35], v[52:55]
    s_waitcnt lgkmcnt(2)
    v_mfma_f32_16x16x32_bf16 v[48:51], v[172:175], v[36:39], v[48:51]
    v_mul_f32 v14, v72, v76
    v_mul_f32 v15, v73, v77
    v_mfma_f32_16x16x32_bf16 v[52:55], v[244:247], v[36:39], v[52:55]
    s_waitcnt lgkmcnt(1)
    v_mfma_f32_16x16x32_bf16 v[48:51], v[176:179], v[40:43], v[48:51]
    v_mul_f32 v16, v74, v78
    v_mul_f32 v17, v75, v79
    v_mfma_f32_16x16x32_bf16 v[52:55], v[248:251], v[40:43], v[52:55]
    s_waitcnt lgkmcnt(0)
    s_setprio 3
    s_barrier
    v_mfma_f32_16x16x32_bf16 v[48:51], v[180:183], v[44:47], v[48:51]
    v_add_f32 v10, 1.0, v10
    v_add_f32 v11, 1.0, v11
    v_mfma_f32_16x16x32_bf16 v[52:55], v[252:255], v[44:47], v[52:55]
    s_setprio 0
    v_and_b32 v29, 63, v0
    v_lshlrev_b32 v29, 3, v29
    ds_read_b64 v[24:25], v29 offset:65024
    v_bfe_u32 v26, v0, 2, 2
    v_xor_b32 v26, 3, v26
    v_bfe_u32 v27, v0, 4, 2
    v_lshlrev_b32 v27, 5, v27
    v_lshl_add_u32 v26, v26, 7, v27
    v_and_b32 v27, 3, v0
    v_lshl_add_u32 v26, v27, 3, v26
    s_and_b32 s34, s22, 3
    s_lshl_b32 s35, s33, 15
    s_lshl_b32 s3, s34, 11
    s_add_u32 s3, s3, s35
    v_add_u32 v29, s3, v26
    ds_read_b64_tr_b16 v[30:31], v29 offset:18432
    ds_read_b64_tr_b16 v[32:33], v29 offset:18944
    ds_read_b64_tr_b16 v[34:35], v29 offset:19456
    s_lshl_b32 s34, s34, 10
    s_add_u32 s35, s35, s34
    s_add_u32 s35, s35, 27136
    v_add_u32 v27, s35, v26
    ds_read_b64_tr_b16 v[38:39], v27 offset:0
    ds_read_b64_tr_b16 v[36:37], v27 offset:512
    s_add_u32 m0, s42, 108544
    s_add_u32 s45, s44, 18432
    buffer_load_dwordx4 v3, s[8:11], s45 offen lds
    buffer_load_dwordx4 v4, s[8:11], s45 offen offset:1024 lds
    s_add_u32 m0, s43, 108544
    s_add_u32 s45, s68, 18432
    s_mov_b64 exec, 0xffff
    buffer_load_dwordx4 v5, s[8:11], s45 offen lds
    s_mov_b64 exec, -1
    s_waitcnt lgkmcnt(0)
    s_cmp_eq_u32 s66, 0
    s_cbranch_scc1 fused_kernel_kps10
    v_lshlrev_b32 v26, 16, v24
    v_alignbit_b32 v27, v25, v24, 16
    v_lshrrev_b32 v28, 16, v25
    v_xor_b32 v29, s5, v0
    v_and_b32 v29, 7, v29
    v_dot2_f32_bf16 v46, v33, v24, 0
    v_dot2_f32_bf16 v44, v32, v24, 0
    v_dot2_f32_bf16 v42, v35, v24, 0
    v_dot2_f32_bf16 v40, v34, v24, 0
    v_dot2_f32_bf16 v47, v33, v26, 0
    v_dot2_f32_bf16 v45, v32, v26, 0
    v_dot2_f32_bf16 v43, v35, v26, 0
    v_dot2_f32_bf16 v41, v34, v26, 0
    v_dot2_f32_bf16 v46, v30, v25, v46
    v_dot2_f32_bf16 v44, v33, v25, v44
    v_dot2_f32_bf16 v42, v32, v25, v42
    v_dot2_f32_bf16 v40, v35, v25, v40
    v_dot2_f32_bf16 v47, v30, v27, v47
    v_dot2_f32_bf16 v45, v33, v27, v45
    v_dot2_f32_bf16 v43, v32, v27, v43
    v_dot2_f32_bf16 v41, v35, v27, v41
    v_dot2_f32_bf16 v47, v31, v28, v47
    v_dot2_f32_bf16 v45, v30, v28, v45
    v_dot2_f32_bf16 v43, v33, v28, v43
    v_dot2_f32_bf16 v41, v32, v28, v41
    v_bfe_u32 v28, v0, 3, 3
    v_lshlrev_b32 v28, 15, v28
    v_lshl_add_u32 v29, v29, 4, v28
    v_lshlrev_b32 v24, 16, v36
    v_and_b32 v25, 0xffff0000, v36
    v_lshlrev_b32 v26, 16, v37
    v_and_b32 v27, 0xffff0000, v37
    v_lshlrev_b32 v30, 16, v38
    v_and_b32 v31, 0xffff0000, v38
    v_lshlrev_b32 v32, 16, v39
    v_and_b32 v33, 0xffff0000, v39
    v_mul_f32 v40, v40, v24
    v_mul_f32 v41, v41, v25
    v_mul_f32 v42, v42, v26
    v_mul_f32 v43, v43, v27
    v_mul_f32 v44, v44, v30
    v_mul_f32 v45, v45, v31
    v_mul_f32 v46, v46, v32
    v_mul_f32 v47, v47, v33
    v_cvt_pk_bf16_f32 v36, v40, v41
    v_cvt_pk_bf16_f32 v37, v42, v43
    v_cvt_pk_bf16_f32 v38, v44, v45
    v_cvt_pk_bf16_f32 v39, v46, v47
fused_kernel_kps10:
    s_mov_b64 exec, s[66:67]
    global_store_dwordx4 v29, v[36:39], s[64:65] offset:0 sc0 sc1
    s_mov_b64 exec, -1
    v_and_b32 v28, 63, v0
    v_lshlrev_b32 v28, 7, v28
    s_mov_b32 m0, 32256
    s_and_b32 s34, s22, 3
    s_cmp_eq_u32 s34, 1
    s_cselect_b64 exec, -1, 0
    buffer_load_dword v28, s[28:31], s91 offen lds
    s_mov_b64 exec, -1
    v_add_u32 v7, 65536, v7
    v_add_u32 v8, 65536, v8
    ds_read_b128 v[24:27], v7 offset:0
    ds_read_b128 v[28:31], v8 offset:0
    ds_read_b128 v[32:35], v7 offset:2048
    ds_read_b128 v[36:39], v8 offset:2048
    ds_read_b128 v[40:43], v7 offset:4096
    ds_read_b128 v[44:47], v8 offset:4096
    s_waitcnt vmcnt(7) lgkmcnt(0)
    s_barrier
    s_setprio 1
    v_mfma_f32_16x16x32_bf16 v[56:59], v[112:115], v[24:27], 0
    v_add_f32 v12, 1.0, v12
    v_add_f32 v13, 1.0, v13
    v_mfma_f32_16x16x32_bf16 v[60:63], v[184:187], v[24:27], 0
    ds_read_b128 v[24:27], v7 offset:6144
    v_mfma_f32_16x16x32_bf16 v[56:59], v[116:119], v[28:31], v[56:59]
    v_rcp_f32 v10, v10
    v_mfma_f32_16x16x32_bf16 v[60:63], v[188:191], v[28:31], v[60:63]
    ds_read_b128 v[28:31], v8 offset:6144
    v_mfma_f32_16x16x32_bf16 v[56:59], v[120:123], v[32:35], v[56:59]
    v_rcp_f32 v11, v11
    v_mfma_f32_16x16x32_bf16 v[60:63], v[192:195], v[32:35], v[60:63]
    ds_read_b128 v[32:35], v7 offset:8192
    v_mfma_f32_16x16x32_bf16 v[56:59], v[124:127], v[36:39], v[56:59]
    v_rcp_f32 v12, v12
    v_mfma_f32_16x16x32_bf16 v[60:63], v[196:199], v[36:39], v[60:63]
    ds_read_b128 v[36:39], v8 offset:8192
    v_mfma_f32_16x16x32_bf16 v[56:59], v[128:131], v[40:43], v[56:59]
    v_rcp_f32 v13, v13
    v_mfma_f32_16x16x32_bf16 v[60:63], v[200:203], v[40:43], v[60:63]
    ds_read_b128 v[40:43], v7 offset:10240
    v_mfma_f32_16x16x32_bf16 v[56:59], v[132:135], v[44:47], v[56:59]
    v_mul_f32 v14, v14, v10
    v_mul_f32 v15, v15, v11
    v_mfma_f32_16x16x32_bf16 v[60:63], v[204:207], v[44:47], v[60:63]
    ds_read_b128 v[44:47], v8 offset:10240
    s_waitcnt lgkmcnt(5)
    v_mfma_f32_16x16x32_bf16 v[56:59], v[136:139], v[24:27], v[56:59]
    v_mul_f32 v16, v16, v12
    v_mul_f32 v17, v17, v13
    v_mfma_f32_16x16x32_bf16 v[60:63], v[208:211], v[24:27], v[60:63]
    ds_read_b128 v[24:27], v7 offset:12288
    s_waitcnt lgkmcnt(5)
    v_mfma_f32_16x16x32_bf16 v[56:59], v[140:143], v[28:31], v[56:59]
    v_cvt_pk_bf16_f32 v20, v14, v15
    v_cvt_pk_bf16_f32 v21, v16, v17
    v_mfma_f32_16x16x32_bf16 v[60:63], v[212:215], v[28:31], v[60:63]
    ds_read_b128 v[28:31], v8 offset:12288
    s_waitcnt lgkmcnt(5)
    v_mfma_f32_16x16x32_bf16 v[56:59], v[144:147], v[32:35], v[56:59]
    s_nop 0
    v_permlane16_swap_b32 v18, v20
    v_permlane16_swap_b32 v19, v21
    s_nop 0
    buffer_store_dwordx4 v[18:21], v23, s[16:19], s47 offen sc0 sc1
    s_add_u32 s47, s47, 4096
    v_mfma_f32_16x16x32_bf16 v[60:63], v[216:219], v[32:35], v[60:63]
    ds_read_b128 v[32:35], v7 offset:14336
    s_waitcnt lgkmcnt(5)
    v_mfma_f32_16x16x32_bf16 v[56:59], v[148:151], v[36:39], v[56:59]
    v_mul_f32 v10, s46, v80
    v_mul_f32 v11, s46, v81
    v_mfma_f32_16x16x32_bf16 v[60:63], v[220:223], v[36:39], v[60:63]
    ds_read_b128 v[36:39], v8 offset:14336
    s_waitcnt lgkmcnt(5)
    v_mfma_f32_16x16x32_bf16 v[56:59], v[152:155], v[40:43], v[56:59]
    v_mul_f32 v12, s46, v82
    v_mul_f32 v13, s46, v83
    v_mfma_f32_16x16x32_bf16 v[60:63], v[224:227], v[40:43], v[60:63]
    ds_read_b128 v[40:43], v7 offset:16384
    s_waitcnt lgkmcnt(5)
    v_mfma_f32_16x16x32_bf16 v[56:59], v[156:159], v[44:47], v[56:59]
    v_exp_f32 v10, v10
    v_mfma_f32_16x16x32_bf16 v[60:63], v[228:231], v[44:47], v[60:63]
    ds_read_b128 v[44:47], v8 offset:16384
    s_waitcnt lgkmcnt(5)
    v_mfma_f32_16x16x32_bf16 v[56:59], v[160:163], v[24:27], v[56:59]
    v_exp_f32 v11, v11
    v_mfma_f32_16x16x32_bf16 v[60:63], v[232:235], v[24:27], v[60:63]
    s_waitcnt lgkmcnt(4)
    v_mfma_f32_16x16x32_bf16 v[56:59], v[164:167], v[28:31], v[56:59]
    v_exp_f32 v12, v12
    v_mfma_f32_16x16x32_bf16 v[60:63], v[236:239], v[28:31], v[60:63]
    s_waitcnt lgkmcnt(3)
    v_mfma_f32_16x16x32_bf16 v[56:59], v[168:171], v[32:35], v[56:59]
    v_exp_f32 v13, v13
    v_mfma_f32_16x16x32_bf16 v[60:63], v[240:243], v[32:35], v[60:63]
    s_waitcnt lgkmcnt(2)
    v_mfma_f32_16x16x32_bf16 v[56:59], v[172:175], v[36:39], v[56:59]
    v_mul_f32 v14, v80, v84
    v_mul_f32 v15, v81, v85
    v_mfma_f32_16x16x32_bf16 v[60:63], v[244:247], v[36:39], v[60:63]
    s_waitcnt lgkmcnt(1)
    v_mfma_f32_16x16x32_bf16 v[56:59], v[176:179], v[40:43], v[56:59]
    v_mul_f32 v16, v82, v86
    v_mul_f32 v17, v83, v87
    v_mfma_f32_16x16x32_bf16 v[60:63], v[248:251], v[40:43], v[60:63]
    s_waitcnt lgkmcnt(0)
    s_setprio 3
    s_barrier
    v_mfma_f32_16x16x32_bf16 v[56:59], v[180:183], v[44:47], v[56:59]
    v_add_f32 v10, 1.0, v10
    v_add_f32 v11, 1.0, v11
    v_mfma_f32_16x16x32_bf16 v[60:63], v[252:255], v[44:47], v[60:63]
    s_setprio 0
    v_and_b32 v29, 63, v0
    v_lshlrev_b32 v29, 3, v29
    ds_read_b64 v[24:25], v29 offset:65024
    v_bfe_u32 v26, v0, 2, 2
    v_xor_b32 v26, 3, v26
    v_bfe_u32 v27, v0, 4, 2
    v_lshlrev_b32 v27, 5, v27
    v_lshl_add_u32 v26, v26, 7, v27
    v_and_b32 v27, 3, v0
    v_lshl_add_u32 v26, v27, 3, v26
    s_and_b32 s34, s22, 3
    s_lshl_b32 s35, s33, 15
    s_lshl_b32 s3, s34, 11
    s_add_u32 s3, s3, s35
    v_add_u32 v29, s3, v26
    ds_read_b64_tr_b16 v[30:31], v29 offset:19456
    ds_read_b64_tr_b16 v[32:33], v29 offset:19968
    ds_read_b64_tr_b16 v[34:35], v29 offset:20480
    s_lshl_b32 s35, s33, 15
    s_add_u32 s35, s35, 31232
    s_sub_u32 s34, s22, s33
    s_lshl_b32 s34, s34, 10
    s_add_u32 s34, s34, 83968
    s_and_b32 s3, s22, 3
    s_cmp_eq_u32 s3, 3
    s_cselect_b32 s35, s35, s34
    v_add_u32 v27, s35, v26
    ds_read_b64_tr_b16 v[38:39], v27 offset:0
    ds_read_b64_tr_b16 v[36:37], v27 offset:512
    s_add_u32 m0, s42, 126976
    s_add_u32 s45, s44, 36864
    buffer_load_dwordx4 v3, s[8:11], s45 offen lds
    buffer_load_dwordx4 v4, s[8:11], s45 offen offset:1024 lds
    s_add_u32 m0, s43, 126976
    s_add_u32 s45, s68, 36864
    s_mov_b64 exec, 0xffff
    buffer_load_dwordx4 v5, s[8:11], s45 offen lds
    s_mov_b64 exec, -1
    s_waitcnt lgkmcnt(0)
    s_cmp_eq_u32 s66, 0
    s_cbranch_scc1 fused_kernel_kps11
    v_lshlrev_b32 v26, 16, v24
    v_alignbit_b32 v27, v25, v24, 16
    v_lshrrev_b32 v28, 16, v25
    v_xor_b32 v29, s5, v0
    v_and_b32 v29, 7, v29
    v_dot2_f32_bf16 v46, v33, v24, 0
    v_dot2_f32_bf16 v44, v32, v24, 0
    v_dot2_f32_bf16 v42, v35, v24, 0
    v_dot2_f32_bf16 v40, v34, v24, 0
    v_dot2_f32_bf16 v47, v33, v26, 0
    v_dot2_f32_bf16 v45, v32, v26, 0
    v_dot2_f32_bf16 v43, v35, v26, 0
    v_dot2_f32_bf16 v41, v34, v26, 0
    v_dot2_f32_bf16 v46, v30, v25, v46
    v_dot2_f32_bf16 v44, v33, v25, v44
    v_dot2_f32_bf16 v42, v32, v25, v42
    v_dot2_f32_bf16 v40, v35, v25, v40
    v_dot2_f32_bf16 v47, v30, v27, v47
    v_dot2_f32_bf16 v45, v33, v27, v45
    v_dot2_f32_bf16 v43, v32, v27, v43
    v_dot2_f32_bf16 v41, v35, v27, v41
    v_dot2_f32_bf16 v47, v31, v28, v47
    v_dot2_f32_bf16 v45, v30, v28, v45
    v_dot2_f32_bf16 v43, v33, v28, v43
    v_dot2_f32_bf16 v41, v32, v28, v41
    v_bfe_u32 v28, v0, 3, 3
    v_lshlrev_b32 v28, 15, v28
    v_lshl_add_u32 v29, v29, 4, v28
    v_lshlrev_b32 v24, 16, v36
    v_and_b32 v25, 0xffff0000, v36
    v_lshlrev_b32 v26, 16, v37
    v_and_b32 v27, 0xffff0000, v37
    v_lshlrev_b32 v30, 16, v38
    v_and_b32 v31, 0xffff0000, v38
    v_lshlrev_b32 v32, 16, v39
    v_and_b32 v33, 0xffff0000, v39
    v_mul_f32 v40, v40, v24
    v_mul_f32 v41, v41, v25
    v_mul_f32 v42, v42, v26
    v_mul_f32 v43, v43, v27
    v_mul_f32 v44, v44, v30
    v_mul_f32 v45, v45, v31
    v_mul_f32 v46, v46, v32
    v_mul_f32 v47, v47, v33
    v_cvt_pk_bf16_f32 v36, v40, v41
    v_cvt_pk_bf16_f32 v37, v42, v43
    v_cvt_pk_bf16_f32 v38, v44, v45
    v_cvt_pk_bf16_f32 v39, v46, v47
fused_kernel_kps11:
    s_mov_b64 exec, s[66:67]
    global_store_dwordx4 v29, v[36:39], s[64:65] offset:-128 sc0 sc1
    s_mov_b64 exec, -1
    v_and_b32 v28, 63, v0
    v_lshlrev_b32 v28, 7, v28
    s_mov_b32 m0, 32256
    s_and_b32 s34, s22, 3
    s_cmp_eq_u32 s34, 2
    s_cselect_b64 exec, -1, 0
    buffer_load_dword v28, s[28:31], s91 offen lds
    s_mov_b64 exec, -1
    ds_read_b128 v[24:27], v7 offset:24576
    ds_read_b128 v[28:31], v8 offset:24576
    ds_read_b128 v[32:35], v7 offset:26624
    ds_read_b128 v[36:39], v8 offset:26624
    ds_read_b128 v[40:43], v7 offset:28672
    ds_read_b128 v[44:47], v8 offset:28672
    s_waitcnt vmcnt(8) lgkmcnt(0)
    s_barrier
    s_setprio 1
    v_mfma_f32_16x16x32_bf16 v[64:67], v[112:115], v[24:27], 0
    v_add_f32 v12, 1.0, v12
    v_add_f32 v13, 1.0, v13
    v_mfma_f32_16x16x32_bf16 v[68:71], v[184:187], v[24:27], 0
    ds_read_b128 v[24:27], v7 offset:30720
    v_mfma_f32_16x16x32_bf16 v[64:67], v[116:119], v[28:31], v[64:67]
    v_rcp_f32 v10, v10
    v_mfma_f32_16x16x32_bf16 v[68:71], v[188:191], v[28:31], v[68:71]
    ds_read_b128 v[28:31], v8 offset:30720
    v_mfma_f32_16x16x32_bf16 v[64:67], v[120:123], v[32:35], v[64:67]
    v_rcp_f32 v11, v11
    v_mfma_f32_16x16x32_bf16 v[68:71], v[192:195], v[32:35], v[68:71]
    ds_read_b128 v[32:35], v7 offset:32768
    v_mfma_f32_16x16x32_bf16 v[64:67], v[124:127], v[36:39], v[64:67]
    v_rcp_f32 v12, v12
    v_mfma_f32_16x16x32_bf16 v[68:71], v[196:199], v[36:39], v[68:71]
    ds_read_b128 v[36:39], v8 offset:32768
    v_mfma_f32_16x16x32_bf16 v[64:67], v[128:131], v[40:43], v[64:67]
    v_rcp_f32 v13, v13
    v_mfma_f32_16x16x32_bf16 v[68:71], v[200:203], v[40:43], v[68:71]
    ds_read_b128 v[40:43], v7 offset:34816
    v_mfma_f32_16x16x32_bf16 v[64:67], v[132:135], v[44:47], v[64:67]
    v_mul_f32 v14, v14, v10
    v_mul_f32 v15, v15, v11
    v_mfma_f32_16x16x32_bf16 v[68:71], v[204:207], v[44:47], v[68:71]
    ds_read_b128 v[44:47], v8 offset:34816
    s_waitcnt lgkmcnt(5)
    v_mfma_f32_16x16x32_bf16 v[64:67], v[136:139], v[24:27], v[64:67]
    v_mul_f32 v16, v16, v12
    v_mul_f32 v17, v17, v13
    v_mfma_f32_16x16x32_bf16 v[68:71], v[208:211], v[24:27], v[68:71]
    ds_read_b128 v[24:27], v7 offset:36864
    s_waitcnt lgkmcnt(5)
    v_mfma_f32_16x16x32_bf16 v[64:67], v[140:143], v[28:31], v[64:67]
    v_cvt_pk_bf16_f32 v18, v14, v15
    v_cvt_pk_bf16_f32 v19, v16, v17
    v_mfma_f32_16x16x32_bf16 v[68:71], v[212:215], v[28:31], v[68:71]
    ds_read_b128 v[28:31], v8 offset:36864
    s_waitcnt lgkmcnt(5)
    v_mfma_f32_16x16x32_bf16 v[64:67], v[144:147], v[32:35], v[64:67]
    v_mul_f32 v10, s46, v88
    v_mul_f32 v11, s46, v89
    v_mfma_f32_16x16x32_bf16 v[68:71], v[216:219], v[32:35], v[68:71]
    ds_read_b128 v[32:35], v7 offset:38912
    s_waitcnt lgkmcnt(5)
    v_mfma_f32_16x16x32_bf16 v[64:67], v[148:151], v[36:39], v[64:67]
    v_mul_f32 v12, s46, v90
    v_mul_f32 v13, s46, v91
    v_mfma_f32_16x16x32_bf16 v[68:71], v[220:223], v[36:39], v[68:71]
    ds_read_b128 v[36:39], v8 offset:38912
    s_waitcnt lgkmcnt(5)
    v_mfma_f32_16x16x32_bf16 v[64:67], v[152:155], v[40:43], v[64:67]
    v_exp_f32 v10, v10
    v_mfma_f32_16x16x32_bf16 v[68:71], v[224:227], v[40:43], v[68:71]
    ds_read_b128 v[40:43], v7 offset:40960
    s_waitcnt lgkmcnt(5)
    v_mfma_f32_16x16x32_bf16 v[64:67], v[156:159], v[44:47], v[64:67]
    v_exp_f32 v11, v11
    v_mfma_f32_16x16x32_bf16 v[68:71], v[228:231], v[44:47], v[68:71]
    ds_read_b128 v[44:47], v8 offset:40960
    s_waitcnt lgkmcnt(5)
    v_mfma_f32_16x16x32_bf16 v[64:67], v[160:163], v[24:27], v[64:67]
    v_exp_f32 v12, v12
    v_mfma_f32_16x16x32_bf16 v[68:71], v[232:235], v[24:27], v[68:71]
    s_waitcnt lgkmcnt(4)
    v_mfma_f32_16x16x32_bf16 v[64:67], v[164:167], v[28:31], v[64:67]
    v_exp_f32 v13, v13
    v_mfma_f32_16x16x32_bf16 v[68:71], v[236:239], v[28:31], v[68:71]
    s_waitcnt lgkmcnt(3)
    v_mfma_f32_16x16x32_bf16 v[64:67], v[168:171], v[32:35], v[64:67]
    v_mul_f32 v14, v88, v92
    v_mul_f32 v15, v89, v93
    v_mfma_f32_16x16x32_bf16 v[68:71], v[240:243], v[32:35], v[68:71]
    s_waitcnt lgkmcnt(2)
    v_mfma_f32_16x16x32_bf16 v[64:67], v[172:175], v[36:39], v[64:67]
    v_mul_f32 v16, v90, v94
    v_mul_f32 v17, v91, v95
    v_mfma_f32_16x16x32_bf16 v[68:71], v[244:247], v[36:39], v[68:71]
    s_waitcnt lgkmcnt(1)
    v_mfma_f32_16x16x32_bf16 v[64:67], v[176:179], v[40:43], v[64:67]
    v_add_f32 v10, 1.0, v10
    v_add_f32 v11, 1.0, v11
    v_mfma_f32_16x16x32_bf16 v[68:71], v[248:251], v[40:43], v[68:71]
    s_waitcnt lgkmcnt(0)
    s_setprio 3
    s_barrier
    v_mfma_f32_16x16x32_bf16 v[64:67], v[180:183], v[44:47], v[64:67]
    v_add_f32 v12, 1.0, v12
    v_add_f32 v13, 1.0, v13
    v_mfma_f32_16x16x32_bf16 v[68:71], v[252:255], v[44:47], v[68:71]
    s_setprio 0
    s_add_u32 m0, s42, 145408
    s_add_u32 s45, s44, 55296
    buffer_load_dwordx4 v3, s[8:11], s45 offen lds
    buffer_load_dwordx4 v4, s[8:11], s45 offen offset:1024 lds
    s_add_u32 m0, s43, 145408
    s_add_u32 s45, s68, 55296
    s_mov_b64 exec, 0xffff
    buffer_load_dwordx4 v5, s[8:11], s45 offen lds
    s_mov_b64 exec, -1
    v_and_b32 v28, 63, v0
    v_lshlrev_b32 v28, 7, v28
    s_mov_b32 m0, 32256
    s_and_b32 s34, s22, 3
    s_cmp_eq_u32 s34, 3
    s_cselect_b64 exec, -1, 0
    buffer_load_dword v28, s[28:31], s91 offen lds
    s_mov_b64 exec, -1
    s_mul_i32 s45, s22, 4128
    s_add_u32 m0, s45, 32
    s_lshl_b32 s45, s78, 3
    s_add_u32 s45, s45, s22
    s_lshl_b32 s45, s45, 12
    s_add_u32 s45, s45, 16
    buffer_load_dwordx4 v1, s[24:27], s45 offen lds
    v_rcp_f32 v10, v10
    ds_read_b128 v[24:27], v7 offset:43008
    v_rcp_f32 v11, v11
    ds_read_b128 v[28:31], v8 offset:43008
    v_rcp_f32 v12, v12
    ds_read_b128 v[32:35], v7 offset:45056
    v_rcp_f32 v13, v13
    ds_read_b128 v[36:39], v8 offset:45056
    v_mul_f32 v14, v14, v10
    v_mul_f32 v15, v15, v11
    ds_read_b128 v[40:43], v7 offset:47104
    v_mul_f32 v16, v16, v12
    v_mul_f32 v17, v17, v13
    ds_read_b128 v[44:47], v8 offset:47104
    v_cvt_pk_bf16_f32 v20, v14, v15
    v_cvt_pk_bf16_f32 v21, v16, v17
    s_add_u32 m0, m0, 37184
    s_sub_u32 s45, s45, 2
    s_mov_b64 exec, -2
    buffer_load_dwordx4 v1, s[24:27], s45 offen lds
    s_mov_b64 exec, -1
    s_nop 0
    v_permlane16_swap_b32 v18, v20
    v_permlane16_swap_b32 v19, v21
    s_mov_b32 s47, s52
    s_nop 0
    buffer_store_dwordx4 v[18:21], v23, s[16:19], s47 offen sc0 sc1
    s_add_u32 s47, s47, 4096
    v_mul_f32 v10, s46, v96
    v_mul_f32 v11, s46, v97
    v_mul_f32 v12, s46, v98
    v_mul_f32 v13, s46, v99
    v_exp_f32 v10, v10
    v_exp_f32 v11, v11
    v_exp_f32 v12, v12
    v_exp_f32 v13, v13
    v_mul_f32 v14, v96, v100
    v_mul_f32 v15, v97, v101
    v_mul_f32 v16, v98, v102
    v_mul_f32 v17, v99, v103
    v_add_f32 v10, 1.0, v10
    v_add_f32 v11, 1.0, v11
    s_waitcnt vmcnt(8) lgkmcnt(0)
    s_barrier
    s_setprio 1
    v_mfma_f32_16x16x32_bf16 v[72:75], v[112:115], v[24:27], 0
    v_add_f32 v12, 1.0, v12
    v_add_f32 v13, 1.0, v13
    v_mfma_f32_16x16x32_bf16 v[76:79], v[184:187], v[24:27], 0
    ds_read_b128 v[24:27], v7 offset:49152
    v_mfma_f32_16x16x32_bf16 v[72:75], v[116:119], v[28:31], v[72:75]
    v_rcp_f32 v10, v10
    v_mfma_f32_16x16x32_bf16 v[76:79], v[188:191], v[28:31], v[76:79]
    ds_read_b128 v[28:31], v8 offset:49152
    v_mfma_f32_16x16x32_bf16 v[72:75], v[120:123], v[32:35], v[72:75]
    v_rcp_f32 v11, v11
    v_mfma_f32_16x16x32_bf16 v[76:79], v[192:195], v[32:35], v[76:79]
    ds_read_b128 v[32:35], v7 offset:51200
    v_mfma_f32_16x16x32_bf16 v[72:75], v[124:127], v[36:39], v[72:75]
    v_rcp_f32 v12, v12
    v_mfma_f32_16x16x32_bf16 v[76:79], v[196:199], v[36:39], v[76:79]
    ds_read_b128 v[36:39], v8 offset:51200
    v_mfma_f32_16x16x32_bf16 v[72:75], v[128:131], v[40:43], v[72:75]
    v_rcp_f32 v13, v13
    v_mfma_f32_16x16x32_bf16 v[76:79], v[200:203], v[40:43], v[76:79]
    ds_read_b128 v[40:43], v7 offset:53248
    v_mfma_f32_16x16x32_bf16 v[72:75], v[132:135], v[44:47], v[72:75]
    v_mul_f32 v14, v14, v10
    v_mul_f32 v15, v15, v11
    v_mfma_f32_16x16x32_bf16 v[76:79], v[204:207], v[44:47], v[76:79]
    ds_read_b128 v[44:47], v8 offset:53248
    s_waitcnt lgkmcnt(5)
    v_mfma_f32_16x16x32_bf16 v[72:75], v[136:139], v[24:27], v[72:75]
    v_mul_f32 v16, v16, v12
    v_mul_f32 v17, v17, v13
    v_mfma_f32_16x16x32_bf16 v[76:79], v[208:211], v[24:27], v[76:79]
    ds_read_b128 v[24:27], v7 offset:55296
    s_waitcnt lgkmcnt(5)
    v_mfma_f32_16x16x32_bf16 v[72:75], v[140:143], v[28:31], v[72:75]
    v_cvt_pk_bf16_f32 v18, v14, v15
    v_cvt_pk_bf16_f32 v19, v16, v17
    v_mfma_f32_16x16x32_bf16 v[76:79], v[212:215], v[28:31], v[76:79]
    ds_read_b128 v[28:31], v8 offset:55296
    s_waitcnt lgkmcnt(5)
    v_mfma_f32_16x16x32_bf16 v[72:75], v[144:147], v[32:35], v[72:75]
    v_mul_f32 v10, s46, v104
    v_mul_f32 v11, s46, v105
    v_mfma_f32_16x16x32_bf16 v[76:79], v[216:219], v[32:35], v[76:79]
    ds_read_b128 v[32:35], v7 offset:57344
    s_waitcnt lgkmcnt(5)
    v_mfma_f32_16x16x32_bf16 v[72:75], v[148:151], v[36:39], v[72:75]
    v_mul_f32 v12, s46, v106
    v_mul_f32 v13, s46, v107
    v_mfma_f32_16x16x32_bf16 v[76:79], v[220:223], v[36:39], v[76:79]
    ds_read_b128 v[36:39], v8 offset:57344
    s_waitcnt lgkmcnt(5)
    v_mfma_f32_16x16x32_bf16 v[72:75], v[152:155], v[40:43], v[72:75]
    v_exp_f32 v10, v10
    v_mfma_f32_16x16x32_bf16 v[76:79], v[224:227], v[40:43], v[76:79]
    ds_read_b128 v[40:43], v7 offset:59392
    s_waitcnt lgkmcnt(5)
    v_mfma_f32_16x16x32_bf16 v[72:75], v[156:159], v[44:47], v[72:75]
    v_exp_f32 v11, v11
    v_mfma_f32_16x16x32_bf16 v[76:79], v[228:231], v[44:47], v[76:79]
    ds_read_b128 v[44:47], v8 offset:59392
    s_waitcnt lgkmcnt(5)
    v_mfma_f32_16x16x32_bf16 v[72:75], v[160:163], v[24:27], v[72:75]
    v_exp_f32 v12, v12
    v_mfma_f32_16x16x32_bf16 v[76:79], v[232:235], v[24:27], v[76:79]
    s_waitcnt lgkmcnt(4)
    v_mfma_f32_16x16x32_bf16 v[72:75], v[164:167], v[28:31], v[72:75]
    v_exp_f32 v13, v13
    v_mfma_f32_16x16x32_bf16 v[76:79], v[236:239], v[28:31], v[76:79]
    s_waitcnt lgkmcnt(3)
    v_mfma_f32_16x16x32_bf16 v[72:75], v[168:171], v[32:35], v[72:75]
    v_mul_f32 v14, v104, v108
    v_mul_f32 v15, v105, v109
    v_mfma_f32_16x16x32_bf16 v[76:79], v[240:243], v[32:35], v[76:79]
    s_waitcnt lgkmcnt(2)
    v_mfma_f32_16x16x32_bf16 v[72:75], v[172:175], v[36:39], v[72:75]
    v_mul_f32 v16, v106, v110
    v_mul_f32 v17, v107, v111
    v_mfma_f32_16x16x32_bf16 v[76:79], v[244:247], v[36:39], v[76:79]
    s_waitcnt lgkmcnt(1)
    v_mfma_f32_16x16x32_bf16 v[72:75], v[176:179], v[40:43], v[72:75]
    v_add_f32 v10, 1.0, v10
    v_add_f32 v11, 1.0, v11
    v_mfma_f32_16x16x32_bf16 v[76:79], v[248:251], v[40:43], v[76:79]
    s_waitcnt lgkmcnt(0)
    s_setprio 3
    s_barrier
    v_mfma_f32_16x16x32_bf16 v[72:75], v[180:183], v[44:47], v[72:75]
    v_add_f32 v12, 1.0, v12
    v_add_f32 v13, 1.0, v13
    v_mfma_f32_16x16x32_bf16 v[76:79], v[252:255], v[44:47], v[76:79]
    s_setprio 0
    s_mul_i32 s44, s90, 9
    s_add_u32 s68, s44, s49
    s_add_u32 s44, s44, s63
    s_add_u32 m0, s42, 90112
    s_add_u32 s45, s44, 0
    buffer_load_dwordx4 v3, s[8:11], s45 offen lds
    v_mov_b32 v26, 33
    v_lshlrev_b32 v27, 2, v0
    v_and_b32 v27, 127, v27
    s_mov_b64 exec, s[100:101]
    buffer_store_dword v26, v27, s[92:95], s2 offen sc0 sc1
    s_mov_b64 exec, -1
    buffer_load_dwordx4 v4, s[8:11], s45 offen offset:1024 lds
    v_rcp_f32 v10, v10
    v_add_u32 v7, 61440, v7
    v_add_u32 v8, 61440, v8
    ds_read_b128 v[24:27], v7 offset:0
    v_rcp_f32 v11, v11
    ds_read_b128 v[28:31], v8 offset:0
    v_rcp_f32 v12, v12
    ds_read_b128 v[32:35], v7 offset:2048
    v_rcp_f32 v13, v13
    s_add_u32 m0, s43, 90112
    s_add_u32 s45, s68, 0
    s_mov_b64 exec, 0xffff
    buffer_load_dwordx4 v5, s[8:11], s45 offen lds
    s_mov_b64 exec, -1
    v_mul_f32 v14, v14, v10
    ds_read_b128 v[36:39], v8 offset:2048
    v_mul_f32 v15, v15, v11
    v_mul_f32 v16, v16, v12
    ds_read_b128 v[40:43], v7 offset:4096
    v_mul_f32 v17, v17, v13
    v_cvt_pk_bf16_f32 v20, v14, v15
    ds_read_b128 v[44:47], v8 offset:4096
    v_cvt_pk_bf16_f32 v21, v16, v17
    s_nop 0
    v_permlane16_swap_b32 v18, v20
    v_permlane16_swap_b32 v19, v21
    s_mul_i32 s45, s22, 4128
    s_add_u32 m0, s45, 1056
    s_lshl_b32 s45, s78, 3
    s_add_u32 s45, s45, s22
    s_lshl_b32 s45, s45, 12
    s_add_u32 s45, s45, 1040
    buffer_load_dwordx4 v1, s[24:27], s45 offen lds
    s_mov_b32 s47, s50
    s_nop 0
    buffer_store_dwordx4 v[18:21], v23, s[16:19], s47 offen sc0 sc1
    s_add_u32 s47, s47, 4096
    v_mul_f32 v10, s46, v48
    v_mul_f32 v11, s46, v49
    v_mul_f32 v12, s46, v50
    v_mul_f32 v13, s46, v51
    v_exp_f32 v10, v10
    s_add_u32 m0, m0, 37184
    s_sub_u32 s45, s45, 2
    buffer_load_dwordx4 v1, s[24:27], s45 offen lds
    v_exp_f32 v11, v11
    v_exp_f32 v12, v12
    v_exp_f32 v13, v13
    v_mul_f32 v14, v48, v52
    v_mul_f32 v15, v49, v53
    v_mul_f32 v16, v50, v54
    v_mul_f32 v17, v51, v55
    s_waitcnt vmcnt(11) lgkmcnt(0)
    s_barrier
    s_setprio 1
    v_mfma_f32_16x16x32_bf16 v[80:83], v[112:115], v[24:27], 0
    v_add_f32 v10, 1.0, v10
    v_add_f32 v11, 1.0, v11
    v_mfma_f32_16x16x32_bf16 v[84:87], v[184:187], v[24:27], 0
    ds_read_b128 v[24:27], v7 offset:6144
    v_mfma_f32_16x16x32_bf16 v[80:83], v[116:119], v[28:31], v[80:83]
    v_add_f32 v12, 1.0, v12
    v_add_f32 v13, 1.0, v13
    v_mfma_f32_16x16x32_bf16 v[84:87], v[188:191], v[28:31], v[84:87]
    ds_read_b128 v[28:31], v8 offset:6144
    v_mfma_f32_16x16x32_bf16 v[80:83], v[120:123], v[32:35], v[80:83]
    v_rcp_f32 v10, v10
    v_mfma_f32_16x16x32_bf16 v[84:87], v[192:195], v[32:35], v[84:87]
    ds_read_b128 v[32:35], v7 offset:8192
    v_mfma_f32_16x16x32_bf16 v[80:83], v[124:127], v[36:39], v[80:83]
    v_rcp_f32 v11, v11
    v_mfma_f32_16x16x32_bf16 v[84:87], v[196:199], v[36:39], v[84:87]
    ds_read_b128 v[36:39], v8 offset:8192
    v_mfma_f32_16x16x32_bf16 v[80:83], v[128:131], v[40:43], v[80:83]
    v_rcp_f32 v12, v12
    v_mfma_f32_16x16x32_bf16 v[84:87], v[200:203], v[40:43], v[84:87]
    ds_read_b128 v[40:43], v7 offset:10240
    v_mfma_f32_16x16x32_bf16 v[80:83], v[132:135], v[44:47], v[80:83]
    v_rcp_f32 v13, v13
    v_mfma_f32_16x16x32_bf16 v[84:87], v[204:207], v[44:47], v[84:87]
    ds_read_b128 v[44:47], v8 offset:10240
    s_waitcnt lgkmcnt(5)
    v_mfma_f32_16x16x32_bf16 v[80:83], v[136:139], v[24:27], v[80:83]
    v_mul_f32 v14, v14, v10
    v_mul_f32 v15, v15, v11
    v_mfma_f32_16x16x32_bf16 v[84:87], v[208:211], v[24:27], v[84:87]
    ds_read_b128 v[24:27], v7 offset:12288
    s_waitcnt lgkmcnt(5)
    v_mfma_f32_16x16x32_bf16 v[80:83], v[140:143], v[28:31], v[80:83]
    v_mul_f32 v16, v16, v12
    v_mul_f32 v17, v17, v13
    v_mfma_f32_16x16x32_bf16 v[84:87], v[212:215], v[28:31], v[84:87]
    ds_read_b128 v[28:31], v8 offset:12288
    s_waitcnt lgkmcnt(5)
    v_mfma_f32_16x16x32_bf16 v[80:83], v[144:147], v[32:35], v[80:83]
    v_cvt_pk_bf16_f32 v18, v14, v15
    v_cvt_pk_bf16_f32 v19, v16, v17
    v_mfma_f32_16x16x32_bf16 v[84:87], v[216:219], v[32:35], v[84:87]
    ds_read_b128 v[32:35], v7 offset:14336
    s_waitcnt lgkmcnt(5)
    v_mfma_f32_16x16x32_bf16 v[80:83], v[148:151], v[36:39], v[80:83]
    v_mul_f32 v10, s46, v56
    v_mul_f32 v11, s46, v57
    v_mfma_f32_16x16x32_bf16 v[84:87], v[220:223], v[36:39], v[84:87]
    ds_read_b128 v[36:39], v8 offset:14336
    s_waitcnt lgkmcnt(5)
    v_mfma_f32_16x16x32_bf16 v[80:83], v[152:155], v[40:43], v[80:83]
    v_mul_f32 v12, s46, v58
    v_mul_f32 v13, s46, v59
    v_mfma_f32_16x16x32_bf16 v[84:87], v[224:227], v[40:43], v[84:87]
    ds_read_b128 v[40:43], v7 offset:16384
    s_waitcnt lgkmcnt(5)
    v_mfma_f32_16x16x32_bf16 v[80:83], v[156:159], v[44:47], v[80:83]
    v_exp_f32 v10, v10
    v_mfma_f32_16x16x32_bf16 v[84:87], v[228:231], v[44:47], v[84:87]
    ds_read_b128 v[44:47], v8 offset:16384
    s_waitcnt lgkmcnt(5)
    v_mfma_f32_16x16x32_bf16 v[80:83], v[160:163], v[24:27], v[80:83]
    v_exp_f32 v11, v11
    v_mfma_f32_16x16x32_bf16 v[84:87], v[232:235], v[24:27], v[84:87]
    s_waitcnt lgkmcnt(4)
    v_mfma_f32_16x16x32_bf16 v[80:83], v[164:167], v[28:31], v[80:83]
    v_exp_f32 v12, v12
    v_mfma_f32_16x16x32_bf16 v[84:87], v[236:239], v[28:31], v[84:87]
    s_waitcnt lgkmcnt(3)
    v_mfma_f32_16x16x32_bf16 v[80:83], v[168:171], v[32:35], v[80:83]
    v_exp_f32 v13, v13
    v_mfma_f32_16x16x32_bf16 v[84:87], v[240:243], v[32:35], v[84:87]
    s_waitcnt lgkmcnt(2)
    v_mfma_f32_16x16x32_bf16 v[80:83], v[172:175], v[36:39], v[80:83]
    v_mul_f32 v14, v56, v60
    v_mul_f32 v15, v57, v61
    v_mfma_f32_16x16x32_bf16 v[84:87], v[244:247], v[36:39], v[84:87]
    s_waitcnt lgkmcnt(1)
    v_mfma_f32_16x16x32_bf16 v[80:83], v[176:179], v[40:43], v[80:83]
    v_mul_f32 v16, v58, v62
    v_mul_f32 v17, v59, v63
    v_mfma_f32_16x16x32_bf16 v[84:87], v[248:251], v[40:43], v[84:87]
    s_waitcnt lgkmcnt(0)
    s_setprio 3
    s_barrier
    v_mfma_f32_16x16x32_bf16 v[80:83], v[180:183], v[44:47], v[80:83]
    v_add_f32 v10, 1.0, v10
    v_add_f32 v11, 1.0, v11
    v_mfma_f32_16x16x32_bf16 v[84:87], v[252:255], v[44:47], v[84:87]
    s_setprio 0
    s_add_u32 m0, s42, 108544
    s_add_u32 s45, s44, 18432
    buffer_load_dwordx4 v3, s[8:11], s45 offen lds
    buffer_load_dwordx4 v4, s[8:11], s45 offen offset:1024 lds
    v_add_f32 v12, 1.0, v12
    v_add_f32 v13, 1.0, v13
    ds_read_b128 v[24:27], v7 offset:18432
    v_rcp_f32 v10, v10
    ds_read_b128 v[28:31], v8 offset:18432
    v_rcp_f32 v11, v11
    ds_read_b128 v[32:35], v7 offset:20480
    v_rcp_f32 v12, v12
    s_add_u32 m0, s43, 108544
    s_add_u32 s45, s68, 18432
    s_mov_b64 exec, 0xffff
    buffer_load_dwordx4 v5, s[8:11], s45 offen lds
    s_mov_b64 exec, -1
    v_rcp_f32 v13, v13
    ds_read_b128 v[36:39], v8 offset:20480
    v_mul_f32 v14, v14, v10
    v_mul_f32 v15, v15, v11
    ds_read_b128 v[40:43], v7 offset:22528
    v_mul_f32 v16, v16, v12
    v_mul_f32 v17, v17, v13
    s_mul_i32 s45, s22, 4128
    s_add_u32 m0, s45, 2080
    s_lshl_b32 s45, s78, 3
    s_add_u32 s45, s45, s22
    s_lshl_b32 s45, s45, 12
    s_add_u32 s45, s45, 2064
    buffer_load_dwordx4 v1, s[24:27], s45 offen lds
    v_cvt_pk_bf16_f32 v20, v14, v15
    ds_read_b128 v[44:47], v8 offset:22528
    v_cvt_pk_bf16_f32 v21, v16, v17
    s_nop 0
    v_permlane16_swap_b32 v18, v20
    v_permlane16_swap_b32 v19, v21
    s_nop 0
    buffer_store_dwordx4 v[18:21], v23, s[16:19], s47 offen sc0 sc1
    s_add_u32 s47, s47, 4096
    v_mul_f32 v10, s46, v64
    v_mul_f32 v11, s46, v65
    v_mul_f32 v12, s46, v66
    s_add_u32 m0, m0, 37184
    s_sub_u32 s45, s45, 2
    buffer_load_dwordx4 v1, s[24:27], s45 offen lds
    v_mul_f32 v13, s46, v67
    v_exp_f32 v10, v10
    v_exp_f32 v11, v11
    v_exp_f32 v12, v12
    v_exp_f32 v13, v13
    v_mul_f32 v14, v64, v68
    s_waitcnt vmcnt(9) lgkmcnt(0)
    s_barrier
    s_setprio 1
    v_mfma_f32_16x16x32_bf16 v[88:91], v[112:115], v[24:27], 0
    v_mul_f32 v15, v65, v69
    v_mul_f32 v16, v66, v70
    v_mfma_f32_16x16x32_bf16 v[92:95], v[184:187], v[24:27], 0
    ds_read_b128 v[24:27], v7 offset:24576
    v_mfma_f32_16x16x32_bf16 v[88:91], v[116:119], v[28:31], v[88:91]
    v_mul_f32 v17, v67, v71
    v_add_f32 v10, 1.0, v10
    v_mfma_f32_16x16x32_bf16 v[92:95], v[188:191], v[28:31], v[92:95]
    ds_read_b128 v[28:31], v8 offset:24576
    v_mfma_f32_16x16x32_bf16 v[88:91], v[120:123], v[32:35], v[88:91]
    v_add_f32 v11, 1.0, v11
    v_add_f32 v12, 1.0, v12
    v_mfma_f32_16x16x32_bf16 v[92:95], v[192:195], v[32:35], v[92:95]
    ds_read_b128 v[32:35], v7 offset:26624
    v_mfma_f32_16x16x32_bf16 v[88:91], v[124:127], v[36:39], v[88:91]
    v_add_f32 v13, 1.0, v13
    v_mfma_f32_16x16x32_bf16 v[92:95], v[196:199], v[36:39], v[92:95]
    ds_read_b128 v[36:39], v8 offset:26624
    v_mfma_f32_16x16x32_bf16 v[88:91], v[128:131], v[40:43], v[88:91]
    v_rcp_f32 v10, v10
    v_mfma_f32_16x16x32_bf16 v[92:95], v[200:203], v[40:43], v[92:95]
    ds_read_b128 v[40:43], v7 offset:28672
    v_mfma_f32_16x16x32_bf16 v[88:91], v[132:135], v[44:47], v[88:91]
    v_rcp_f32 v11, v11
    v_mfma_f32_16x16x32_bf16 v[92:95], v[204:207], v[44:47], v[92:95]
    ds_read_b128 v[44:47], v8 offset:28672
    s_waitcnt lgkmcnt(5)
    v_mfma_f32_16x16x32_bf16 v[88:91], v[136:139], v[24:27], v[88:91]
    v_rcp_f32 v12, v12
    v_mfma_f32_16x16x32_bf16 v[92:95], v[208:211], v[24:27], v[92:95]
    ds_read_b128 v[24:27], v7 offset:30720
    s_waitcnt lgkmcnt(5)
    v_mfma_f32_16x16x32_bf16 v[88:91], v[140:143], v[28:31], v[88:91]
    v_rcp_f32 v13, v13
    v_mfma_f32_16x16x32_bf16 v[92:95], v[212:215], v[28:31], v[92:95]
    ds_read_b128 v[28:31], v8 offset:30720
    s_waitcnt lgkmcnt(5)
    v_mfma_f32_16x16x32_bf16 v[88:91], v[144:147], v[32:35], v[88:91]
    v_mul_f32 v14, v14, v10
    v_mul_f32 v15, v15, v11
    v_mfma_f32_16x16x32_bf16 v[92:95], v[216:219], v[32:35], v[92:95]
    ds_read_b128 v[32:35], v7 offset:32768
    s_waitcnt lgkmcnt(5)
    v_mfma_f32_16x16x32_bf16 v[88:91], v[148:151], v[36:39], v[88:91]
    v_mul_f32 v16, v16, v12
    v_mul_f32 v17, v17, v13
    v_mfma_f32_16x16x32_bf16 v[92:95], v[220:223], v[36:39], v[92:95]
    ds_read_b128 v[36:39], v8 offset:32768
    s_waitcnt lgkmcnt(5)
    v_mfma_f32_16x16x32_bf16 v[88:91], v[152:155], v[40:43], v[88:91]
    v_cvt_pk_bf16_f32 v18, v14, v15
    v_cvt_pk_bf16_f32 v19, v16, v17
    v_mfma_f32_16x16x32_bf16 v[92:95], v[224:227], v[40:43], v[92:95]
    ds_read_b128 v[40:43], v7 offset:34816
    s_waitcnt lgkmcnt(5)
    v_mfma_f32_16x16x32_bf16 v[88:91], v[156:159], v[44:47], v[88:91]
    v_mul_f32 v10, s46, v72
    v_mul_f32 v11, s46, v73
    v_mfma_f32_16x16x32_bf16 v[92:95], v[228:231], v[44:47], v[92:95]
    ds_read_b128 v[44:47], v8 offset:34816
    s_waitcnt lgkmcnt(5)
    v_mfma_f32_16x16x32_bf16 v[88:91], v[160:163], v[24:27], v[88:91]
    v_mul_f32 v12, s46, v74
    v_mul_f32 v13, s46, v75
    v_mfma_f32_16x16x32_bf16 v[92:95], v[232:235], v[24:27], v[92:95]
    s_waitcnt lgkmcnt(4)
    v_mfma_f32_16x16x32_bf16 v[88:91], v[164:167], v[28:31], v[88:91]
    v_exp_f32 v10, v10
    v_mfma_f32_16x16x32_bf16 v[92:95], v[236:239], v[28:31], v[92:95]
    s_waitcnt lgkmcnt(3)
    v_mfma_f32_16x16x32_bf16 v[88:91], v[168:171], v[32:35], v[88:91]
    v_exp_f32 v11, v11
    v_mfma_f32_16x16x32_bf16 v[92:95], v[240:243], v[32:35], v[92:95]
    s_waitcnt lgkmcnt(2)
    v_mfma_f32_16x16x32_bf16 v[88:91], v[172:175], v[36:39], v[88:91]
    v_exp_f32 v12, v12
    v_mfma_f32_16x16x32_bf16 v[92:95], v[244:247], v[36:39], v[92:95]
    s_waitcnt lgkmcnt(1)
    v_mfma_f32_16x16x32_bf16 v[88:91], v[176:179], v[40:43], v[88:91]
    v_exp_f32 v13, v13
    v_mfma_f32_16x16x32_bf16 v[92:95], v[248:251], v[40:43], v[92:95]
    s_waitcnt lgkmcnt(0)
    s_setprio 3
    s_barrier
    v_mfma_f32_16x16x32_bf16 v[88:91], v[180:183], v[44:47], v[88:91]
    v_mul_f32 v14, v72, v76
    v_mul_f32 v15, v73, v77
    v_mfma_f32_16x16x32_bf16 v[92:95], v[252:255], v[44:47], v[92:95]
    s_setprio 0
    s_add_u32 m0, s42, 126976
    s_add_u32 s45, s44, 36864
    buffer_load_dwordx4 v3, s[8:11], s45 offen lds
    v_mov_b32 v26, 37
    v_lshlrev_b32 v27, 2, v0
    v_and_b32 v27, 127, v27
    s_mov_b64 exec, s[100:101]
    buffer_store_dword v26, v27, s[92:95], s2 offen sc0 sc1
    s_mov_b64 exec, -1
    s_mov_b64 exec, s[100:101]
    buffer_load_dword v9, v22, s[92:95], 0 offen sc0 sc1
    s_mov_b64 exec, -1
    buffer_load_dwordx4 v4, s[8:11], s45 offen offset:1024 lds
    v_mul_f32 v16, v74, v78
    v_mul_f32 v17, v75, v79
    v_add_u32 v7, 4294930432, v7
    v_add_u32 v8, 4294930432, v8
    ds_read_b128 v[24:27], v7 offset:0
    v_add_f32 v10, 1.0, v10
    v_add_f32 v11, 1.0, v11
    ds_read_b128 v[28:31], v8 offset:0
    v_add_f32 v12, 1.0, v12
    v_add_f32 v13, 1.0, v13
    ds_read_b128 v[32:35], v7 offset:2048
    v_rcp_f32 v10, v10
    s_add_u32 m0, s43, 126976
    s_add_u32 s45, s68, 36864
    s_mov_b64 exec, 0xffff
    buffer_load_dwordx4 v5, s[8:11], s45 offen lds
    s_mov_b64 exec, -1
    v_rcp_f32 v11, v11
    ds_read_b128 v[36:39], v8 offset:2048
    v_rcp_f32 v12, v12
    ds_read_b128 v[40:43], v7 offset:4096
    v_rcp_f32 v13, v13
    s_mul_i32 s45, s22, 4128
    s_add_u32 m0, s45, 3104
    s_lshl_b32 s45, s78, 3
    s_add_u32 s45, s45, s22
    s_lshl_b32 s45, s45, 12
    s_add_u32 s45, s45, 3088
    buffer_load_dwordx4 v1, s[24:27], s45 offen lds
    v_mul_f32 v14, v14, v10
    ds_read_b128 v[44:47], v8 offset:4096
    v_mul_f32 v15, v15, v11
    v_mul_f32 v16, v16, v12
    v_mul_f32 v17, v17, v13
    v_cvt_pk_bf16_f32 v20, v14, v15
    v_cvt_pk_bf16_f32 v21, v16, v17
    s_add_u32 m0, m0, 37184
    s_sub_u32 s45, s45, 2
    buffer_load_dwordx4 v1, s[24:27], s45 offen lds
    s_nop 0
    v_permlane16_swap_b32 v18, v20
    v_permlane16_swap_b32 v19, v21
    s_mov_b32 s47, s51
    s_nop 0
    buffer_store_dwordx4 v[18:21], v23, s[16:19], s47 offen sc0 sc1
    s_add_u32 s47, s47, 4096
    v_mul_f32 v10, s46, v80
    v_mul_f32 v11, s46, v81
    v_mul_f32 v12, s46, v82
    v_mul_f32 v13, s46, v83
    v_exp_f32 v10, v10
    v_exp_f32 v11, v11
    s_waitcnt vmcnt(11) lgkmcnt(0)
    s_barrier
    s_setprio 1
    v_mfma_f32_16x16x32_bf16 v[96:99], v[112:115], v[24:27], 0
    v_exp_f32 v12, v12
    v_mfma_f32_16x16x32_bf16 v[100:103], v[184:187], v[24:27], 0
    ds_read_b128 v[24:27], v7 offset:6144
    v_mfma_f32_16x16x32_bf16 v[96:99], v[116:119], v[28:31], v[96:99]
    v_exp_f32 v13, v13
    v_mfma_f32_16x16x32_bf16 v[100:103], v[188:191], v[28:31], v[100:103]
    ds_read_b128 v[28:31], v8 offset:6144
    v_mfma_f32_16x16x32_bf16 v[96:99], v[120:123], v[32:35], v[96:99]
    v_mul_f32 v14, v80, v84
    v_mul_f32 v15, v81, v85
    v_mfma_f32_16x16x32_bf16 v[100:103], v[192:195], v[32:35], v[100:103]
    ds_read_b128 v[32:35], v7 offset:8192
    v_mfma_f32_16x16x32_bf16 v[96:99], v[124:127], v[36:39], v[96:99]
    v_mul_f32 v16, v82, v86
    v_mul_f32 v17, v83, v87
    v_mfma_f32_16x16x32_bf16 v[100:103], v[196:199], v[36:39], v[100:103]
    ds_read_b128 v[36:39], v8 offset:8192
    v_mfma_f32_16x16x32_bf16 v[96:99], v[128:131], v[40:43], v[96:99]
    v_add_f32 v10, 1.0, v10
    v_add_f32 v11, 1.0, v11
    v_mfma_f32_16x16x32_bf16 v[100:103], v[200:203], v[40:43], v[100:103]
    ds_read_b128 v[40:43], v7 offset:10240
    v_mfma_f32_16x16x32_bf16 v[96:99], v[132:135], v[44:47], v[96:99]
    v_add_f32 v12, 1.0, v12
    v_add_f32 v13, 1.0, v13
    v_mfma_f32_16x16x32_bf16 v[100:103], v[204:207], v[44:47], v[100:103]
    ds_read_b128 v[44:47], v8 offset:10240
    s_waitcnt lgkmcnt(5)
    v_mfma_f32_16x16x32_bf16 v[96:99], v[136:139], v[24:27], v[96:99]
    v_rcp_f32 v10, v10
    v_mfma_f32_16x16x32_bf16 v[100:103], v[208:211], v[24:27], v[100:103]
    ds_read_b128 v[24:27], v7 offset:12288
    s_waitcnt lgkmcnt(5)
    v_mfma_f32_16x16x32_bf16 v[96:99], v[140:143], v[28:31], v[96:99]
    v_rcp_f32 v11, v11
    v_mfma_f32_16x16x32_bf16 v[100:103], v[212:215], v[28:31], v[100:103]
    ds_read_b128 v[28:31], v8 offset:12288
    s_waitcnt lgkmcnt(5)
    v_mfma_f32_16x16x32_bf16 v[96:99], v[144:147], v[32:35], v[96:99]
    v_rcp_f32 v12, v12
    v_mfma_f32_16x16x32_bf16 v[100:103], v[216:219], v[32:35], v[100:103]
    ds_read_b128 v[32:35], v7 offset:14336
    s_waitcnt lgkmcnt(5)
    v_mfma_f32_16x16x32_bf16 v[96:99], v[148:151], v[36:39], v[96:99]
    v_rcp_f32 v13, v13
    v_mfma_f32_16x16x32_bf16 v[100:103], v[220:223], v[36:39], v[100:103]
    ds_read_b128 v[36:39], v8 offset:14336
    s_waitcnt lgkmcnt(5)
    v_mfma_f32_16x16x32_bf16 v[96:99], v[152:155], v[40:43], v[96:99]
    v_mul_f32 v14, v14, v10
    v_mul_f32 v15, v15, v11
    v_mfma_f32_16x16x32_bf16 v[100:103], v[224:227], v[40:43], v[100:103]
    ds_read_b128 v[40:43], v7 offset:16384
    s_waitcnt lgkmcnt(5)
    v_mfma_f32_16x16x32_bf16 v[96:99], v[156:159], v[44:47], v[96:99]
    v_mul_f32 v16, v16, v12
    v_mul_f32 v17, v17, v13
    v_mfma_f32_16x16x32_bf16 v[100:103], v[228:231], v[44:47], v[100:103]
    ds_read_b128 v[44:47], v8 offset:16384
    s_waitcnt lgkmcnt(5)
    v_mfma_f32_16x16x32_bf16 v[96:99], v[160:163], v[24:27], v[96:99]
    v_cvt_pk_bf16_f32 v18, v14, v15
    v_cvt_pk_bf16_f32 v19, v16, v17
    v_mfma_f32_16x16x32_bf16 v[100:103], v[232:235], v[24:27], v[100:103]
    s_waitcnt lgkmcnt(4)
    v_mfma_f32_16x16x32_bf16 v[96:99], v[164:167], v[28:31], v[96:99]
    v_mul_f32 v10, s46, v88
    v_mul_f32 v11, s46, v89
    v_mfma_f32_16x16x32_bf16 v[100:103], v[236:239], v[28:31], v[100:103]
    s_waitcnt lgkmcnt(3)
    v_mfma_f32_16x16x32_bf16 v[96:99], v[168:171], v[32:35], v[96:99]
    v_mul_f32 v12, s46, v90
    v_mul_f32 v13, s46, v91
    v_mfma_f32_16x16x32_bf16 v[100:103], v[240:243], v[32:35], v[100:103]
    s_waitcnt lgkmcnt(2)
    v_mfma_f32_16x16x32_bf16 v[96:99], v[172:175], v[36:39], v[96:99]
    v_exp_f32 v10, v10
    v_mfma_f32_16x16x32_bf16 v[100:103], v[244:247], v[36:39], v[100:103]
    s_waitcnt lgkmcnt(1)
    v_mfma_f32_16x16x32_bf16 v[96:99], v[176:179], v[40:43], v[96:99]
    v_exp_f32 v11, v11
    v_mfma_f32_16x16x32_bf16 v[100:103], v[248:251], v[40:43], v[100:103]
    s_waitcnt lgkmcnt(0)
    s_setprio 3
    s_barrier
    v_mfma_f32_16x16x32_bf16 v[96:99], v[180:183], v[44:47], v[96:99]
    v_exp_f32 v12, v12
    v_mfma_f32_16x16x32_bf16 v[100:103], v[252:255], v[44:47], v[100:103]
    s_setprio 0
    s_add_u32 m0, s42, 145408
    s_add_u32 s45, s44, 55296
    buffer_load_dwordx4 v3, s[8:11], s45 offen lds
    s_waitcnt vmcnt(6)
    s_cmp_eq_u32 s100, 0
    s_cbranch_scc1 fused_kernel_kw_ok
    s_movk_i32 s98, 0x4000
fused_kernel_kw_l:
    v_and_b32 v24, 32, v9
    v_cmp_ne_u32 vcc, 0, v24
    s_nop 1
    s_cmp_eq_u32 vcc_lo, -1
    s_cbranch_scc1 fused_kernel_kw_ok
    s_sleep 8
    s_andn2_b64 exec, s[100:101], vcc
    buffer_load_dword v9, v22, s[92:95], 0 offen sc0 sc1
    s_mov_b64 exec, -1
    s_waitcnt vmcnt(0)
    s_sub_u32 s98, s98, 1
    s_cbranch_scc0 fused_kernel_kw_l
fused_kernel_kw_ok:
    buffer_load_dwordx4 v4, s[8:11], s45 offen offset:1024 lds
    v_exp_f32 v13, v13
    ds_read_b128 v[24:27], v7 offset:18432
    v_mul_f32 v14, v88, v92
    v_mul_f32 v15, v89, v93
    ds_read_b128 v[28:31], v8 offset:18432
    v_mul_f32 v16, v90, v94
    v_mul_f32 v17, v91, v95
    s_add_u32 m0, s43, 145408
    s_add_u32 s45, s68, 55296
    s_mov_b64 exec, 0xffff
    buffer_load_dwordx4 v5, s[8:11], s45 offen lds
    s_mov_b64 exec, -1
    v_add_f32 v10, 1.0, v10
    ds_read_b128 v[32:35], v7 offset:20480
    v_add_f32 v11, 1.0, v11
    v_add_f32 v12, 1.0, v12
    ds_read_b128 v[36:39], v8 offset:20480
    v_add_f32 v13, 1.0, v13
    v_rcp_f32 v10, v10
    s_lshl_b32 s45, s22, 9
    s_add_u32 m0, s45, 33056
    s_lshl_b32 s34, s78, 12
    s_add_u32 s45, s45, s34
    s_add_u32 s45, s45, 2097168
    s_mov_b32 exec_hi, 0
    buffer_load_dwordx4 v1, s[24:27], s45 offen lds
    s_mov_b64 exec, -1
    v_rcp_f32 v11, v11
    ds_read_b128 v[40:43], v7 offset:22528
    v_rcp_f32 v12, v12
    ds_read_b128 v[44:47], v8 offset:22528
    v_rcp_f32 v13, v13
    s_add_u32 m0, m0, 37184
    s_sub_u32 s45, s45, 2
    s_mov_b32 exec_hi, 0
    buffer_load_dwordx4 v1, s[24:27], s45 offen lds
    s_mov_b64 exec, -1
    v_mul_f32 v14, v14, v10
    v_mul_f32 v15, v15, v11
    v_mul_f32 v16, v16, v12
    v_mul_f32 v17, v17, v13
    v_cvt_pk_bf16_f32 v20, v14, v15
    v_cvt_pk_bf16_f32 v21, v16, v17
    s_nop 0
    v_permlane16_swap_b32 v18, v20
    v_permlane16_swap_b32 v19, v21
    s_nop 0
    buffer_store_dwordx4 v[18:21], v23, s[16:19], s47 offen sc0 sc1
    s_add_u32 s47, s47, 4096
    s_waitcnt vmcnt(9) lgkmcnt(0)
    s_barrier
    s_setprio 1
    v_mfma_f32_16x16x32_bf16 v[104:107], v[112:115], v[24:27], 0
    v_mul_f32 v10, s46, v96
    v_mul_f32 v11, s46, v97
    v_mfma_f32_16x16x32_bf16 v[108:111], v[184:187], v[24:27], 0
    ds_read_b128 v[24:27], v7 offset:24576
    v_mfma_f32_16x16x32_bf16 v[104:107], v[116:119], v[28:31], v[104:107]
    v_mul_f32 v12, s46, v98
    v_mul_f32 v13, s46, v99
    v_mfma_f32_16x16x32_bf16 v[108:111], v[188:191], v[28:31], v[108:111]
    ds_read_b128 v[28:31], v8 offset:24576
    v_mfma_f32_16x16x32_bf16 v[104:107], v[120:123], v[32:35], v[104:107]
    v_exp_f32 v10, v10
    v_mfma_f32_16x16x32_bf16 v[108:111], v[192:195], v[32:35], v[108:111]
    ds_read_b128 v[32:35], v7 offset:26624
    v_mfma_f32_16x16x32_bf16 v[104:107], v[124:127], v[36:39], v[104:107]
    v_exp_f32 v11, v11
    v_mfma_f32_16x16x32_bf16 v[108:111], v[196:199], v[36:39], v[108:111]
    ds_read_b128 v[36:39], v8 offset:26624
    v_mfma_f32_16x16x32_bf16 v[104:107], v[128:131], v[40:43], v[104:107]
    v_exp_f32 v12, v12
    v_mfma_f32_16x16x32_bf16 v[108:111], v[200:203], v[40:43], v[108:111]
    ds_read_b128 v[40:43], v7 offset:28672
    v_mfma_f32_16x16x32_bf16 v[104:107], v[132:135], v[44:47], v[104:107]
    v_exp_f32 v13, v13
    v_mfma_f32_16x16x32_bf16 v[108:111], v[204:207], v[44:47], v[108:111]
    ds_read_b128 v[44:47], v8 offset:28672
    s_waitcnt lgkmcnt(5)
    v_mfma_f32_16x16x32_bf16 v[104:107], v[136:139], v[24:27], v[104:107]
    v_mul_f32 v14, v96, v100
    v_mul_f32 v15, v97, v101
    v_mfma_f32_16x16x32_bf16 v[108:111], v[208:211], v[24:27], v[108:111]
    ds_read_b128 v[24:27], v7 offset:30720
    s_waitcnt lgkmcnt(5)
    v_mfma_f32_16x16x32_bf16 v[104:107], v[140:143], v[28:31], v[104:107]
    v_mul_f32 v16, v98, v102
    v_mul_f32 v17, v99, v103
    v_mfma_f32_16x16x32_bf16 v[108:111], v[212:215], v[28:31], v[108:111]
    ds_read_b128 v[28:31], v8 offset:30720
    s_waitcnt lgkmcnt(5)
    v_mfma_f32_16x16x32_bf16 v[104:107], v[144:147], v[32:35], v[104:107]
    v_add_f32 v10, 1.0, v10
    v_add_f32 v11, 1.0, v11
    v_mfma_f32_16x16x32_bf16 v[108:111], v[216:219], v[32:35], v[108:111]
    ds_read_b128 v[32:35], v7 offset:32768
    s_waitcnt lgkmcnt(5)
    v_mfma_f32_16x16x32_bf16 v[104:107], v[148:151], v[36:39], v[104:107]
    v_add_f32 v12, 1.0, v12
    v_add_f32 v13, 1.0, v13
    v_mfma_f32_16x16x32_bf16 v[108:111], v[220:223], v[36:39], v[108:111]
    ds_read_b128 v[36:39], v8 offset:32768
    s_waitcnt lgkmcnt(5)
    v_mfma_f32_16x16x32_bf16 v[104:107], v[152:155], v[40:43], v[104:107]
    v_rcp_f32 v10, v10
    v_mfma_f32_16x16x32_bf16 v[108:111], v[224:227], v[40:43], v[108:111]
    ds_read_b128 v[40:43], v7 offset:34816
    s_waitcnt lgkmcnt(5)
    v_mfma_f32_16x16x32_bf16 v[104:107], v[156:159], v[44:47], v[104:107]
    v_rcp_f32 v11, v11
    v_mfma_f32_16x16x32_bf16 v[108:111], v[228:231], v[44:47], v[108:111]
    ds_read_b128 v[44:47], v8 offset:34816
    s_waitcnt lgkmcnt(5)
    v_mfma_f32_16x16x32_bf16 v[104:107], v[160:163], v[24:27], v[104:107]
    v_rcp_f32 v12, v12
    v_mfma_f32_16x16x32_bf16 v[108:111], v[232:235], v[24:27], v[108:111]
    s_waitcnt lgkmcnt(4)
    v_mfma_f32_16x16x32_bf16 v[104:107], v[164:167], v[28:31], v[104:107]
    v_rcp_f32 v13, v13
    v_mfma_f32_16x16x32_bf16 v[108:111], v[236:239], v[28:31], v[108:111]
    s_waitcnt lgkmcnt(3)
    v_mfma_f32_16x16x32_bf16 v[104:107], v[168:171], v[32:35], v[104:107]
    v_mul_f32 v14, v14, v10
    v_mul_f32 v15, v15, v11
    v_mfma_f32_16x16x32_bf16 v[108:111], v[240:243], v[32:35], v[108:111]
    s_waitcnt lgkmcnt(2)
    v_mfma_f32_16x16x32_bf16 v[104:107], v[172:175], v[36:39], v[104:107]
    v_mul_f32 v16, v16, v12
    v_mul_f32 v17, v17, v13
    v_mfma_f32_16x16x32_bf16 v[108:111], v[244:247], v[36:39], v[108:111]
    s_waitcnt lgkmcnt(1)
    v_mfma_f32_16x16x32_bf16 v[104:107], v[176:179], v[40:43], v[104:107]
    v_cvt_pk_bf16_f32 v18, v14, v15
    v_cvt_pk_bf16_f32 v19, v16, v17
    v_mfma_f32_16x16x32_bf16 v[108:111], v[248:251], v[40:43], v[108:111]
    s_waitcnt lgkmcnt(0)
    s_setprio 3
    s_barrier
    v_mfma_f32_16x16x32_bf16 v[104:107], v[180:183], v[44:47], v[104:107]
    v_mfma_f32_16x16x32_bf16 v[108:111], v[252:255], v[44:47], v[108:111]
    s_setprio 0
    v_mov_b32 v26, 39
    v_lshlrev_b32 v27, 2, v0
    v_and_b32 v27, 127, v27
    s_mov_b64 exec, s[100:101]
    buffer_store_dword v26, v27, s[92:95], s2 offen sc0 sc1
    s_mov_b64 exec, -1
    s_lshl_b32 s45, s22, 12
    s_add_u32 m0, s45, 74368
    s_nop 0
    buffer_load_dwordx4 v1, s[12:15], s79 offen sc0 sc1 lds
    v_mul_f32 v10, s46, v104
    v_mul_f32 v11, s46, v105
    ds_read_b128 v[24:27], v7 offset:36864
    v_mul_f32 v12, s46, v106
    buffer_load_dwordx4 v1, s[12:15], s79 offen offset:1024 sc0 sc1 lds
    ds_read_b128 v[28:31], v8 offset:36864
    ds_read_b128 v[32:35], v7 offset:38912
    buffer_load_dwordx4 v1, s[12:15], s79 offen offset:2048 sc0 sc1 lds
    ds_read_b128 v[36:39], v8 offset:38912
    ds_read_b128 v[40:43], v7 offset:40960
    buffer_load_dwordx4 v1, s[12:15], s79 offen offset:3072 sc0 sc1 lds
    ds_read_b128 v[44:47], v8 offset:40960
    s_waitcnt vmcnt(5) lgkmcnt(0)
    s_barrier
    s_setprio 1
    v_mfma_f32_16x16x32_bf16 v[48:51], v[112:115], v[24:27], 0
    v_mul_f32 v13, s46, v107
    v_mfma_f32_16x16x32_bf16 v[52:55], v[184:187], v[24:27], 0
    ds_read_b128 v[24:27], v7 offset:43008
    v_mfma_f32_16x16x32_bf16 v[48:51], v[116:119], v[28:31], v[48:51]
    v_exp_f32 v10, v10
    v_mfma_f32_16x16x32_bf16 v[52:55], v[188:191], v[28:31], v[52:55]
    ds_read_b128 v[28:31], v8 offset:43008
    v_mfma_f32_16x16x32_bf16 v[48:51], v[120:123], v[32:35], v[48:51]
    v_exp_f32 v11, v11
    v_mfma_f32_16x16x32_bf16 v[52:55], v[192:195], v[32:35], v[52:55]
    ds_read_b128 v[32:35], v7 offset:45056
    v_mfma_f32_16x16x32_bf16 v[48:51], v[124:127], v[36:39], v[48:51]
    v_exp_f32 v12, v12
    v_mfma_f32_16x16x32_bf16 v[52:55], v[196:199], v[36:39], v[52:55]
    ds_read_b128 v[36:39], v8 offset:45056
    v_mfma_f32_16x16x32_bf16 v[48:51], v[128:131], v[40:43], v[48:51]
    v_exp_f32 v13, v13
    v_mfma_f32_16x16x32_bf16 v[52:55], v[200:203], v[40:43], v[52:55]
    ds_read_b128 v[40:43], v7 offset:47104
    v_mfma_f32_16x16x32_bf16 v[48:51], v[132:135], v[44:47], v[48:51]
    v_mul_f32 v14, v104, v108
    v_mul_f32 v15, v105, v109
    v_mfma_f32_16x16x32_bf16 v[52:55], v[204:207], v[44:47], v[52:55]
    ds_read_b128 v[44:47], v8 offset:47104
    s_waitcnt lgkmcnt(5)
    v_mfma_f32_16x16x32_bf16 v[48:51], v[136:139], v[24:27], v[48:51]
    v_mul_f32 v16, v106, v110
    v_mul_f32 v17, v107, v111
    v_mfma_f32_16x16x32_bf16 v[52:55], v[208:211], v[24:27], v[52:55]
    ds_read_b128 v[24:27], v7 offset:49152
    s_waitcnt lgkmcnt(5)
    v_mfma_f32_16x16x32_bf16 v[48:51], v[140:143], v[28:31], v[48:51]
    v_add_f32 v10, 1.0, v10
    v_add_f32 v11, 1.0, v11
    v_mfma_f32_16x16x32_bf16 v[52:55], v[212:215], v[28:31], v[52:55]
    ds_read_b128 v[28:31], v8 offset:49152
    s_waitcnt lgkmcnt(5)
    v_mfma_f32_16x16x32_bf16 v[48:51], v[144:147], v[32:35], v[48:51]
    v_add_f32 v12, 1.0, v12
    v_add_f32 v13, 1.0, v13
    v_mfma_f32_16x16x32_bf16 v[52:55], v[216:219], v[32:35], v[52:55]
    ds_read_b128 v[32:35], v7 offset:51200
    s_waitcnt lgkmcnt(5)
    v_mfma_f32_16x16x32_bf16 v[48:51], v[148:151], v[36:39], v[48:51]
    v_rcp_f32 v10, v10
    v_mfma_f32_16x16x32_bf16 v[52:55], v[220:223], v[36:39], v[52:55]
    ds_read_b128 v[36:39], v8 offset:51200
    s_waitcnt lgkmcnt(5)
    v_mfma_f32_16x16x32_bf16 v[48:51], v[152:155], v[40:43], v[48:51]
    v_rcp_f32 v11, v11
    v_mfma_f32_16x16x32_bf16 v[52:55], v[224:227], v[40:43], v[52:55]
    ds_read_b128 v[40:43], v7 offset:53248
    s_waitcnt lgkmcnt(5)
    v_mfma_f32_16x16x32_bf16 v[48:51], v[156:159], v[44:47], v[48:51]
    v_rcp_f32 v12, v12
    v_mfma_f32_16x16x32_bf16 v[52:55], v[228:231], v[44:47], v[52:55]
    ds_read_b128 v[44:47], v8 offset:53248
    s_waitcnt lgkmcnt(5)
    v_mfma_f32_16x16x32_bf16 v[48:51], v[160:163], v[24:27], v[48:51]
    v_rcp_f32 v13, v13
    v_mfma_f32_16x16x32_bf16 v[52:55], v[232:235], v[24:27], v[52:55]
    s_waitcnt lgkmcnt(4)
    v_mfma_f32_16x16x32_bf16 v[48:51], v[164:167], v[28:31], v[48:51]
    v_mul_f32 v14, v14, v10
    v_mul_f32 v15, v15, v11
    v_mfma_f32_16x16x32_bf16 v[52:55], v[236:239], v[28:31], v[52:55]
    s_waitcnt lgkmcnt(3)
    v_mfma_f32_16x16x32_bf16 v[48:51], v[168:171], v[32:35], v[48:51]
    v_mul_f32 v16, v16, v12
    v_mul_f32 v17, v17, v13
    v_mfma_f32_16x16x32_bf16 v[52:55], v[240:243], v[32:35], v[52:55]
    s_waitcnt lgkmcnt(2)
    v_mfma_f32_16x16x32_bf16 v[48:51], v[172:175], v[36:39], v[48:51]
    v_cvt_pk_bf16_f32 v20, v14, v15
    v_cvt_pk_bf16_f32 v21, v16, v17
    v_mfma_f32_16x16x32_bf16 v[52:55], v[244:247], v[36:39], v[52:55]
    s_waitcnt lgkmcnt(1)
    v_mfma_f32_16x16x32_bf16 v[48:51], v[176:179], v[40:43], v[48:51]
    s_nop 0
    v_permlane16_swap_b32 v18, v20
    v_permlane16_swap_b32 v19, v21
    s_mov_b32 s47, s90
    s_nop 0
    buffer_store_dwordx4 v[18:21], v23, s[16:19], s47 offen sc0 sc1
    s_add_u32 s47, s47, 4096
    v_mfma_f32_16x16x32_bf16 v[52:55], v[248:251], v[40:43], v[52:55]
    s_waitcnt lgkmcnt(0)
    s_setprio 3
    s_barrier
    v_mfma_f32_16x16x32_bf16 v[48:51], v[180:183], v[44:47], v[48:51]
    v_mfma_f32_16x16x32_bf16 v[52:55], v[252:255], v[44:47], v[52:55]
    s_setprio 0
    v_mov_b32 v26, 47
    v_lshlrev_b32 v27, 2, v0
    v_and_b32 v27, 127, v27
    s_mov_b64 exec, s[100:101]
    buffer_store_dword v26, v27, s[92:95], s2 offen sc0 sc1
    s_mov_b64 exec, -1
    v_mov_b32 v24, 0
    v_mov_b32 v25, 0
    v_lshrrev_b32 v26, 1, v1
    v_add_u32 v26, 107136, v26
    ds_write_b64 v26, v[24:25] offset:7936
    s_mul_i32 s34, s22, 472
    v_add_u32 v27, s34, v26
    ds_write_b64 v27, v[24:25]
    ds_write_b64 v26, v[24:25] offset:3328
    s_lshl_b32 s45, s22, 9
    s_add_u32 m0, s45, 110976
    s_mov_b32 exec_hi, 0
    buffer_load_dwordx4 v2, s[12:15], s40 offen sc0 sc1 lds
    s_mov_b64 exec, -1
    v_mul_f32 v10, s46, v48
    v_mul_f32 v11, s46, v49
    v_add_u32 v7, 55296, v7
    v_add_u32 v8, 55296, v8
    ds_read_b128 v[24:27], v7 offset:0
    ds_read_b128 v[28:31], v8 offset:0
    ds_read_b128 v[32:35], v7 offset:2048
    ds_read_b128 v[36:39], v8 offset:2048
    ds_read_b128 v[40:43], v7 offset:4096
    ds_read_b128 v[44:47], v8 offset:4096
    s_waitcnt vmcnt(3) lgkmcnt(0)
    s_barrier
    s_setprio 1
    v_mfma_f32_16x16x32_bf16 v[64:67], v[112:115], v[24:27], 0
    v_mul_f32 v12, s46, v50
    v_mul_f32 v13, s46, v51
    v_mfma_f32_16x16x32_bf16 v[68:71], v[184:187], v[24:27], 0
    ds_read_b128 v[24:27], v7 offset:6144
    v_mfma_f32_16x16x32_bf16 v[64:67], v[116:119], v[28:31], v[64:67]
    v_exp_f32 v10, v10
    v_mfma_f32_16x16x32_bf16 v[68:71], v[188:191], v[28:31], v[68:71]
    ds_read_b128 v[28:31], v8 offset:6144
    v_mfma_f32_16x16x32_bf16 v[64:67], v[120:123], v[32:35], v[64:67]
    v_exp_f32 v11, v11
    v_mfma_f32_16x16x32_bf16 v[68:71], v[192:195], v[32:35], v[68:71]
    ds_read_b128 v[32:35], v7 offset:8192
    v_mfma_f32_16x16x32_bf16 v[64:67], v[124:127], v[36:39], v[64:67]
    v_exp_f32 v12, v12
    v_mfma_f32_16x16x32_bf16 v[68:71], v[196:199], v[36:39], v[68:71]
    ds_read_b128 v[36:39], v8 offset:8192
    v_mfma_f32_16x16x32_bf16 v[64:67], v[128:131], v[40:43], v[64:67]
    v_exp_f32 v13, v13
    v_mfma_f32_16x16x32_bf16 v[68:71], v[200:203], v[40:43], v[68:71]
    ds_read_b128 v[40:43], v7 offset:10240
    v_mfma_f32_16x16x32_bf16 v[64:67], v[132:135], v[44:47], v[64:67]
    v_mul_f32 v14, v48, v52
    v_mul_f32 v15, v49, v53
    v_mfma_f32_16x16x32_bf16 v[68:71], v[204:207], v[44:47], v[68:71]
    ds_read_b128 v[44:47], v8 offset:10240
    s_waitcnt lgkmcnt(5)
    v_mfma_f32_16x16x32_bf16 v[64:67], v[136:139], v[24:27], v[64:67]
    v_mul_f32 v16, v50, v54
    v_mul_f32 v17, v51, v55
    v_mfma_f32_16x16x32_bf16 v[68:71], v[208:211], v[24:27], v[68:71]
    ds_read_b128 v[24:27], v7 offset:12288
    s_waitcnt lgkmcnt(5)
    v_mfma_f32_16x16x32_bf16 v[64:67], v[140:143], v[28:31], v[64:67]
    v_add_f32 v10, 1.0, v10
    v_add_f32 v11, 1.0, v11
    v_mfma_f32_16x16x32_bf16 v[68:71], v[212:215], v[28:31], v[68:71]
    ds_read_b128 v[28:31], v8 offset:12288
    s_waitcnt lgkmcnt(5)
    v_mfma_f32_16x16x32_bf16 v[64:67], v[144:147], v[32:35], v[64:67]
    v_add_f32 v12, 1.0, v12
    v_add_f32 v13, 1.0, v13
    v_mfma_f32_16x16x32_bf16 v[68:71], v[216:219], v[32:35], v[68:71]
    ds_read_b128 v[32:35], v7 offset:14336
    s_waitcnt lgkmcnt(5)
    v_mfma_f32_16x16x32_bf16 v[64:67], v[148:151], v[36:39], v[64:67]
    v_rcp_f32 v10, v10
    v_mfma_f32_16x16x32_bf16 v[68:71], v[220:223], v[36:39], v[68:71]
    ds_read_b128 v[36:39], v8 offset:14336
    s_waitcnt lgkmcnt(5)
    v_mfma_f32_16x16x32_bf16 v[64:67], v[152:155], v[40:43], v[64:67]
    v_rcp_f32 v11, v11
    v_mfma_f32_16x16x32_bf16 v[68:71], v[224:227], v[40:43], v[68:71]
    ds_read_b128 v[40:43], v7 offset:16384
    s_waitcnt lgkmcnt(5)
    v_mfma_f32_16x16x32_bf16 v[64:67], v[156:159], v[44:47], v[64:67]
    v_rcp_f32 v12, v12
    v_mfma_f32_16x16x32_bf16 v[68:71], v[228:231], v[44:47], v[68:71]
    ds_read_b128 v[44:47], v8 offset:16384
    s_waitcnt lgkmcnt(5)
    v_mfma_f32_16x16x32_bf16 v[64:67], v[160:163], v[24:27], v[64:67]
    v_rcp_f32 v13, v13
    v_mfma_f32_16x16x32_bf16 v[68:71], v[232:235], v[24:27], v[68:71]
    s_waitcnt lgkmcnt(4)
    v_mfma_f32_16x16x32_bf16 v[64:67], v[164:167], v[28:31], v[64:67]
    v_mul_f32 v14, v14, v10
    v_mul_f32 v15, v15, v11
    v_mfma_f32_16x16x32_bf16 v[68:71], v[236:239], v[28:31], v[68:71]
    s_waitcnt lgkmcnt(3)
    v_mfma_f32_16x16x32_bf16 v[64:67], v[168:171], v[32:35], v[64:67]
    v_mul_f32 v16, v16, v12
    v_mul_f32 v17, v17, v13
    v_mfma_f32_16x16x32_bf16 v[68:71], v[240:243], v[32:35], v[68:71]
    s_waitcnt lgkmcnt(2)
    v_mfma_f32_16x16x32_bf16 v[64:67], v[172:175], v[36:39], v[64:67]
    v_cvt_pk_bf16_f32 v18, v14, v15
    v_cvt_pk_bf16_f32 v19, v16, v17
    v_mfma_f32_16x16x32_bf16 v[68:71], v[244:247], v[36:39], v[68:71]
    s_waitcnt lgkmcnt(1)
    v_mfma_f32_16x16x32_bf16 v[64:67], v[176:179], v[40:43], v[64:67]
    v_mfma_f32_16x16x32_bf16 v[68:71], v[248:251], v[40:43], v[68:71]
    s_waitcnt lgkmcnt(0)
    s_setprio 3
    s_cmp_eq_u32 s33, 0
    s_cbranch_scc0 fused_kernel_skipAc18
    s_barrier
fused_kernel_skipAc18:
    v_mfma_f32_16x16x32_bf16 v[64:67], v[180:183], v[44:47], v[64:67]
    v_mfma_f32_16x16x32_bf16 v[68:71], v[252:255], v[44:47], v[68:71]
    s_setprio 0
    s_nop 7
    s_cmp_eq_u32 s33, 0
    s_cbranch_scc0 fused_kernel_tYc18
    s_nop 1
    s_branch fused_kernel_conv
fused_kernel_tYc18:
    s_nop 1
    s_branch fused_kernel_conv
fused_kernel_g19:
    ds_read_b64_tr_b16 v[112:113], v6 offset:0
    ds_read_b64_tr_b16 v[114:115], v6 offset:1024
    ds_read_b128 v[24:27], v7 offset:0
    ds_read_b64_tr_b16 v[184:185], v6 offset:16384
    ds_read_b64_tr_b16 v[186:187], v6 offset:17408
    ds_read_b128 v[28:31], v7 offset:2048
    ds_read_b128 v[32:35], v7 offset:4096
    ds_read_b128 v[36:39], v7 offset:6144
    ds_read_b128 v[40:43], v7 offset:8192
    ds_read_b128 v[44:47], v7 offset:10240
    ds_read_b64_tr_b16 v[116:117], v6 offset:8192
    ds_read_b64_tr_b16 v[118:119], v6 offset:9216
    ds_read_b64_tr_b16 v[188:189], v6 offset:24576
    ds_read_b64_tr_b16 v[190:191], v6 offset:25600
    s_cmp_eq_u32 s33, 0
    s_cbranch_scc1 fused_kernel_skipYg19
    s_add_u32 m0, s97, 65536
    s_add_u32 s21, s36, 1215488
    s_add_u32 s20, s36, 1179648
    buffer_load_dwordx4 v1, s[24:27], s20 offen lds
    buffer_load_dwordx4 v1, s[24:27], s21 offen offset:1024 lds
    buffer_load_dwordx4 v2, s[24:27], s20 offen offset:2048 lds
    buffer_load_dwordx4 v2, s[24:27], s21 offen offset:3072 lds
    s_add_u32 m0, s42, 126976
    s_add_u32 s45, s39, s4
    s_add_u32 s45, s45, 256
    s_mov_b64 exec, s[64:65]
    buffer_load_dwordx4 v3, s[8:11], s45 offen lds
    s_mov_b64 exec, -1
    s_mov_b64 exec, s[64:65]
    buffer_load_dwordx4 v4, s[8:11], s45 offen offset:1024 lds
    s_mov_b64 exec, -1
    s_waitcnt vmcnt(6) lgkmcnt(0)
    s_barrier
fused_kernel_skipYg19:
    s_setprio 1
    s_waitcnt lgkmcnt(11)
    v_mfma_f32_16x16x32_bf16 v[48:51], v[112:115], v[24:27], 0
    s_waitcnt lgkmcnt(9)
    v_mfma_f32_16x16x32_bf16 v[52:55], v[184:187], v[24:27], 0
    ds_read_b128 v[24:27], v7 offset:12288
    s_waitcnt lgkmcnt(9)
    v_mfma_f32_16x16x32_bf16 v[56:59], v[112:115], v[28:31], 0
    v_mfma_f32_16x16x32_bf16 v[60:63], v[184:187], v[28:31], 0
    ds_read_b128 v[28:31], v8 offset:0
    s_waitcnt lgkmcnt(9)
    v_mfma_f32_16x16x32_bf16 v[64:67], v[112:115], v[32:35], 0
    v_mfma_f32_16x16x32_bf16 v[68:71], v[184:187], v[32:35], 0
    ds_read_b128 v[32:35], v8 offset:2048
    s_waitcnt lgkmcnt(9)
    v_mfma_f32_16x16x32_bf16 v[72:75], v[112:115], v[36:39], 0
    v_mfma_f32_16x16x32_bf16 v[76:79], v[184:187], v[36:39], 0
    ds_read_b128 v[36:39], v8 offset:4096
    s_waitcnt lgkmcnt(9)
    v_mfma_f32_16x16x32_bf16 v[80:83], v[112:115], v[40:43], 0
    v_mfma_f32_16x16x32_bf16 v[84:87], v[184:187], v[40:43], 0
    ds_read_b128 v[40:43], v8 offset:6144
    s_waitcnt lgkmcnt(9)
    v_mfma_f32_16x16x32_bf16 v[88:91], v[112:115], v[44:47], 0
    v_mfma_f32_16x16x32_bf16 v[92:95], v[184:187], v[44:47], 0
    ds_read_b128 v[44:47], v8 offset:8192
    s_waitcnt lgkmcnt(5)
    v_mfma_f32_16x16x32_bf16 v[96:99], v[112:115], v[24:27], 0
    v_mfma_f32_16x16x32_bf16 v[100:103], v[184:187], v[24:27], 0
    ds_read_b128 v[24:27], v8 offset:10240
    s_waitcnt lgkmcnt(5)
    v_mfma_f32_16x16x32_bf16 v[48:51], v[116:119], v[28:31], v[48:51]
    v_mfma_f32_16x16x32_bf16 v[52:55], v[188:191], v[28:31], v[52:55]
    ds_read_b128 v[28:31], v8 offset:12288
    s_waitcnt lgkmcnt(5)
    v_mfma_f32_16x16x32_bf16 v[56:59], v[116:119], v[32:35], v[56:59]
    v_mfma_f32_16x16x32_bf16 v[60:63], v[188:191], v[32:35], v[60:63]
    s_waitcnt lgkmcnt(4)
    v_mfma_f32_16x16x32_bf16 v[64:67], v[116:119], v[36:39], v[64:67]
    v_mfma_f32_16x16x32_bf16 v[68:71], v[188:191], v[36:39], v[68:71]
    s_waitcnt lgkmcnt(3)
    v_mfma_f32_16x16x32_bf16 v[72:75], v[116:119], v[40:43], v[72:75]
    v_mfma_f32_16x16x32_bf16 v[76:79], v[188:191], v[40:43], v[76:79]
    s_waitcnt lgkmcnt(2)
    v_mfma_f32_16x16x32_bf16 v[80:83], v[116:119], v[44:47], v[80:83]
    v_mfma_f32_16x16x32_bf16 v[84:87], v[188:191], v[44:47], v[84:87]
    s_waitcnt lgkmcnt(1)
    v_mfma_f32_16x16x32_bf16 v[88:91], v[116:119], v[24:27], v[88:91]
    v_mfma_f32_16x16x32_bf16 v[92:95], v[188:191], v[24:27], v[92:95]
    s_waitcnt lgkmcnt(0)
    s_setprio 3
    s_cmp_eq_u32 s33, 0
    s_cbranch_scc1 fused_kernel_skip0g19
    s_barrier
fused_kernel_skip0g19:
    v_mfma_f32_16x16x32_bf16 v[96:99], v[116:119], v[28:31], v[96:99]
    v_mfma_f32_16x16x32_bf16 v[100:103], v[188:191], v[28:31], v[100:103]
    s_setprio 0
    s_cmp_eq_u32 s33, 0
    s_cbranch_scc0 fused_kernel_skip1g19
    s_add_u32 m0, s97, 65536
    s_add_u32 s21, s36, 1215488
    s_add_u32 s20, s36, 1179648
    buffer_load_dwordx4 v1, s[24:27], s20 offen lds
    buffer_load_dwordx4 v1, s[24:27], s21 offen offset:1024 lds
    buffer_load_dwordx4 v2, s[24:27], s20 offen offset:2048 lds
    buffer_load_dwordx4 v2, s[24:27], s21 offen offset:3072 lds
    s_add_u32 m0, s42, 126976
    s_add_u32 s45, s39, s4
    s_add_u32 s45, s45, 256
    s_mov_b64 exec, s[64:65]
    buffer_load_dwordx4 v3, s[8:11], s45 offen lds
    s_mov_b64 exec, -1
    s_mov_b64 exec, s[64:65]
    buffer_load_dwordx4 v4, s[8:11], s45 offen offset:1024 lds
    s_mov_b64 exec, -1
    s_waitcnt vmcnt(6)
    s_barrier
fused_kernel_skip1g19:
    s_add_u32 m0, s97, 0
    s_add_u32 s21, s37, 35840
    s_add_u32 s20, s37, 0
    buffer_load_dwordx4 v1, s[24:27], s20 offen lds
    buffer_load_dwordx4 v1, s[24:27], s21 offen offset:1024 lds
    ds_read_b64_tr_b16 v[120:121], v6 offset:32768
    ds_read_b64_tr_b16 v[122:123], v6 offset:33792
    ds_read_b128 v[32:35], v7 offset:14336
    buffer_load_dwordx4 v2, s[24:27], s20 offen offset:2048 lds
    ds_read_b64_tr_b16 v[192:193], v6 offset:49152
    ds_read_b64_tr_b16 v[194:195], v6 offset:50176
    ds_read_b128 v[36:39], v7 offset:16384
    buffer_load_dwordx4 v2, s[24:27], s21 offen offset:3072 lds
    ds_read_b128 v[40:43], v7 offset:18432
    ds_read_b128 v[44:47], v7 offset:20480
    s_add_u32 m0, s42, 141312
    s_add_u32 s45, s39, s5
    s_add_u32 s45, s45, 0
    s_mov_b64 exec, s[64:65]
    buffer_load_dwordx4 v3, s[8:11], s45 offen lds
    s_mov_b64 exec, -1
    ds_read_b128 v[24:27], v7 offset:22528
    ds_read_b128 v[28:31], v7 offset:24576
    s_mov_b64 exec, s[64:65]
    buffer_load_dwordx4 v4, s[8:11], s45 offen offset:1024 lds
    s_mov_b64 exec, -1
    ds_read_b64_tr_b16 v[124:125], v6 offset:40960
    ds_read_b64_tr_b16 v[126:127], v6 offset:41984
    ds_read_b64_tr_b16 v[196:197], v6 offset:57344
    ds_read_b64_tr_b16 v[198:199], v6 offset:58368
    s_cmp_eq_u32 s33, 0
    s_cbranch_scc1 fused_kernel_xwg190
    s_waitcnt vmcnt(6)
fused_kernel_xwg190:
    s_waitcnt lgkmcnt(0)
    s_barrier
    s_setprio 1
    v_mfma_f32_16x16x32_bf16 v[48:51], v[120:123], v[32:35], v[48:51]
    v_mfma_f32_16x16x32_bf16 v[52:55], v[192:195], v[32:35], v[52:55]
    ds_read_b128 v[32:35], v7 offset:26624
    v_mfma_f32_16x16x32_bf16 v[56:59], v[120:123], v[36:39], v[56:59]
    v_mfma_f32_16x16x32_bf16 v[60:63], v[192:195], v[36:39], v[60:63]
    ds_read_b128 v[36:39], v8 offset:14336
    v_mfma_f32_16x16x32_bf16 v[64:67], v[120:123], v[40:43], v[64:67]
    v_mfma_f32_16x16x32_bf16 v[68:71], v[192:195], v[40:43], v[68:71]
    ds_read_b128 v[40:43], v8 offset:16384
    v_mfma_f32_16x16x32_bf16 v[72:75], v[120:123], v[44:47], v[72:75]
    v_mfma_f32_16x16x32_bf16 v[76:79], v[192:195], v[44:47], v[76:79]
    ds_read_b128 v[44:47], v8 offset:18432
    v_mfma_f32_16x16x32_bf16 v[80:83], v[120:123], v[24:27], v[80:83]
    v_mfma_f32_16x16x32_bf16 v[84:87], v[192:195], v[24:27], v[84:87]
    ds_read_b128 v[24:27], v8 offset:20480
    v_mfma_f32_16x16x32_bf16 v[88:91], v[120:123], v[28:31], v[88:91]
    v_mfma_f32_16x16x32_bf16 v[92:95], v[192:195], v[28:31], v[92:95]
    ds_read_b128 v[28:31], v8 offset:22528
    s_waitcnt lgkmcnt(5)
    v_mfma_f32_16x16x32_bf16 v[96:99], v[120:123], v[32:35], v[96:99]
    v_mfma_f32_16x16x32_bf16 v[100:103], v[192:195], v[32:35], v[100:103]
    ds_read_b128 v[32:35], v8 offset:24576
    s_waitcnt lgkmcnt(5)
    v_mfma_f32_16x16x32_bf16 v[48:51], v[124:127], v[36:39], v[48:51]
    v_mfma_f32_16x16x32_bf16 v[52:55], v[196:199], v[36:39], v[52:55]
    ds_read_b128 v[36:39], v8 offset:26624
    s_waitcnt lgkmcnt(5)
    v_mfma_f32_16x16x32_bf16 v[56:59], v[124:127], v[40:43], v[56:59]
    v_mfma_f32_16x16x32_bf16 v[60:63], v[196:199], v[40:43], v[60:63]
    s_waitcnt lgkmcnt(4)
    v_mfma_f32_16x16x32_bf16 v[64:67], v[124:127], v[44:47], v[64:67]
    s_add_u32 m0, s42, 98304
    s_add_u32 s45, s39, s5
    v_mfma_f32_16x16x32_bf16 v[68:71], v[196:199], v[44:47], v[68:71]
    s_add_u32 s45, s45, 128
    s_waitcnt lgkmcnt(3)
    v_mfma_f32_16x16x32_bf16 v[72:75], v[124:127], v[24:27], v[72:75]
    s_mov_b64 exec, s[64:65]
    buffer_load_dwordx4 v3, s[8:11], s45 offen lds
    s_mov_b64 exec, -1
    v_mfma_f32_16x16x32_bf16 v[76:79], v[196:199], v[24:27], v[76:79]
    s_waitcnt lgkmcnt(2)
    v_mfma_f32_16x16x32_bf16 v[80:83], v[124:127], v[28:31], v[80:83]
    v_mfma_f32_16x16x32_bf16 v[84:87], v[196:199], v[28:31], v[84:87]
    s_waitcnt lgkmcnt(1)
    v_mfma_f32_16x16x32_bf16 v[88:91], v[124:127], v[32:35], v[88:91]
    s_mov_b64 exec, s[64:65]
    buffer_load_dwordx4 v4, s[8:11], s45 offen offset:1024 lds
    s_mov_b64 exec, -1
    v_mfma_f32_16x16x32_bf16 v[92:95], v[196:199], v[32:35], v[92:95]
    s_waitcnt vmcnt(8) lgkmcnt(0)
    s_setprio 3
    s_barrier
    v_mfma_f32_16x16x32_bf16 v[96:99], v[124:127], v[36:39], v[96:99]
    v_mfma_f32_16x16x32_bf16 v[100:103], v[196:199], v[36:39], v[100:103]
    s_setprio 0
    s_add_u32 m0, s97, 32768
    s_add_u32 s21, s37, 625664
    s_add_u32 s20, s37, 589824
    buffer_load_dwordx4 v1, s[24:27], s20 offen lds
    buffer_load_dwordx4 v1, s[24:27], s21 offen offset:1024 lds
    ds_read_b64_tr_b16 v[128:129], v22 offset:0
    ds_read_b64_tr_b16 v[130:131], v22 offset:1024
    ds_read_b128 v[40:43], v7 offset:28672
    buffer_load_dwordx4 v2, s[24:27], s20 offen offset:2048 lds
    ds_read_b64_tr_b16 v[200:201], v22 offset:16384
    ds_read_b64_tr_b16 v[202:203], v22 offset:17408
    ds_read_b128 v[44:47], v7 offset:30720
    buffer_load_dwordx4 v2, s[24:27], s21 offen offset:3072 lds
    ds_read_b128 v[24:27], v7 offset:32768
    ds_read_b128 v[28:31], v7 offset:34816
    ds_read_b128 v[32:35], v7 offset:36864
    ds_read_b128 v[36:39], v7 offset:38912
    ds_read_b64_tr_b16 v[132:133], v22 offset:8192
    ds_read_b64_tr_b16 v[134:135], v22 offset:9216
    ds_read_b64_tr_b16 v[204:205], v22 offset:24576
    ds_read_b64_tr_b16 v[206:207], v22 offset:25600
    s_waitcnt vmcnt(6) lgkmcnt(0)
    s_barrier
    s_setprio 1
    v_mfma_f32_16x16x32_bf16 v[48:51], v[128:131], v[40:43], v[48:51]
    v_mfma_f32_16x16x32_bf16 v[52:55], v[200:203], v[40:43], v[52:55]
    ds_read_b128 v[40:43], v7 offset:40960
    v_mfma_f32_16x16x32_bf16 v[56:59], v[128:131], v[44:47], v[56:59]
    v_mfma_f32_16x16x32_bf16 v[60:63], v[200:203], v[44:47], v[60:63]
    ds_read_b128 v[44:47], v8 offset:28672
    v_mfma_f32_16x16x32_bf16 v[64:67], v[128:131], v[24:27], v[64:67]
    v_mfma_f32_16x16x32_bf16 v[68:71], v[200:203], v[24:27], v[68:71]
    ds_read_b128 v[24:27], v8 offset:30720
    v_mfma_f32_16x16x32_bf16 v[72:75], v[128:131], v[28:31], v[72:75]
    v_mfma_f32_16x16x32_bf16 v[76:79], v[200:203], v[28:31], v[76:79]
    ds_read_b128 v[28:31], v8 offset:32768
    v_mfma_f32_16x16x32_bf16 v[80:83], v[128:131], v[32:35], v[80:83]
    v_mfma_f32_16x16x32_bf16 v[84:87], v[200:203], v[32:35], v[84:87]
    ds_read_b128 v[32:35], v8 offset:34816
    v_mfma_f32_16x16x32_bf16 v[88:91], v[128:131], v[36:39], v[88:91]
    v_mfma_f32_16x16x32_bf16 v[92:95], v[200:203], v[36:39], v[92:95]
    ds_read_b128 v[36:39], v8 offset:36864
    s_waitcnt lgkmcnt(5)
    v_mfma_f32_16x16x32_bf16 v[96:99], v[128:131], v[40:43], v[96:99]
    v_mfma_f32_16x16x32_bf16 v[100:103], v[200:203], v[40:43], v[100:103]
    ds_read_b128 v[40:43], v8 offset:38912
    s_waitcnt lgkmcnt(5)
    v_mfma_f32_16x16x32_bf16 v[48:51], v[132:135], v[44:47], v[48:51]
    v_mfma_f32_16x16x32_bf16 v[52:55], v[204:207], v[44:47], v[52:55]
    ds_read_b128 v[44:47], v8 offset:40960
    s_waitcnt lgkmcnt(5)
    v_mfma_f32_16x16x32_bf16 v[56:59], v[132:135], v[24:27], v[56:59]
    v_mfma_f32_16x16x32_bf16 v[60:63], v[204:207], v[24:27], v[60:63]
    s_waitcnt lgkmcnt(4)
    v_mfma_f32_16x16x32_bf16 v[64:67], v[132:135], v[28:31], v[64:67]
    s_add_u32 m0, s42, 112640
    s_add_u32 s45, s39, s5
    v_mfma_f32_16x16x32_bf16 v[68:71], v[204:207], v[28:31], v[68:71]
    s_add_u32 s45, s45, 256
    s_waitcnt lgkmcnt(3)
    v_mfma_f32_16x16x32_bf16 v[72:75], v[132:135], v[32:35], v[72:75]
    s_mov_b64 exec, s[64:65]
    buffer_load_dwordx4 v3, s[8:11], s45 offen lds
    s_mov_b64 exec, -1
    v_mfma_f32_16x16x32_bf16 v[76:79], v[204:207], v[32:35], v[76:79]
    s_waitcnt lgkmcnt(2)
    v_mfma_f32_16x16x32_bf16 v[80:83], v[132:135], v[36:39], v[80:83]
    v_mfma_f32_16x16x32_bf16 v[84:87], v[204:207], v[36:39], v[84:87]
    s_waitcnt lgkmcnt(1)
    v_mfma_f32_16x16x32_bf16 v[88:91], v[132:135], v[40:43], v[88:91]
    s_mov_b64 exec, s[64:65]
    buffer_load_dwordx4 v4, s[8:11], s45 offen offset:1024 lds
    s_mov_b64 exec, -1
    v_mfma_f32_16x16x32_bf16 v[92:95], v[204:207], v[40:43], v[92:95]
    s_waitcnt lgkmcnt(0)
    s_setprio 3
    s_barrier
    v_mfma_f32_16x16x32_bf16 v[96:99], v[132:135], v[44:47], v[96:99]
    v_mfma_f32_16x16x32_bf16 v[100:103], v[204:207], v[44:47], v[100:103]
    s_setprio 0
    s_add_u32 m0, s97, 65536
    s_add_u32 s21, s37, 1215488
    s_add_u32 s20, s37, 1179648
    buffer_load_dwordx4 v1, s[24:27], s20 offen lds
    buffer_load_dwordx4 v1, s[24:27], s21 offen offset:1024 lds
    ds_read_b64_tr_b16 v[136:137], v6 offset:0
    ds_read_b64_tr_b16 v[138:139], v6 offset:1024
    ds_read_b128 v[24:27], v7 offset:43008
    buffer_load_dwordx4 v2, s[24:27], s20 offen offset:2048 lds
    ds_read_b64_tr_b16 v[208:209], v6 offset:16384
    ds_read_b64_tr_b16 v[210:211], v6 offset:17408
    ds_read_b128 v[28:31], v7 offset:45056
    buffer_load_dwordx4 v2, s[24:27], s21 offen offset:3072 lds
    ds_read_b128 v[32:35], v7 offset:47104
    ds_read_b128 v[36:39], v7 offset:49152
    buffer_store_dwordx4 v[12:15], v16, s[56:59], s69 offen sc0 sc1
    s_add_u32 s69, s69, 1024
    ds_read_b128 v[40:43], v7 offset:51200
    ds_read_b128 v[44:47], v7 offset:53248
    ds_read_b64_tr_b16 v[140:141], v6 offset:8192
    ds_read_b64_tr_b16 v[142:143], v6 offset:9216
    ds_read_b64_tr_b16 v[212:213], v6 offset:24576
    ds_read_b64_tr_b16 v[214:215], v6 offset:25600
    s_waitcnt vmcnt(7) lgkmcnt(0)
    s_barrier
    s_setprio 1
    v_mfma_f32_16x16x32_bf16 v[48:51], v[136:139], v[24:27], v[48:51]
    v_mfma_f32_16x16x32_bf16 v[52:55], v[208:211], v[24:27], v[52:55]
    ds_read_b128 v[24:27], v7 offset:55296
    v_mfma_f32_16x16x32_bf16 v[56:59], v[136:139], v[28:31], v[56:59]
    v_mfma_f32_16x16x32_bf16 v[60:63], v[208:211], v[28:31], v[60:63]
    ds_read_b128 v[28:31], v8 offset:43008
    v_mfma_f32_16x16x32_bf16 v[64:67], v[136:139], v[32:35], v[64:67]
    v_mfma_f32_16x16x32_bf16 v[68:71], v[208:211], v[32:35], v[68:71]
    ds_read_b128 v[32:35], v8 offset:45056
    v_mfma_f32_16x16x32_bf16 v[72:75], v[136:139], v[36:39], v[72:75]
    v_mfma_f32_16x16x32_bf16 v[76:79], v[208:211], v[36:39], v[76:79]
    ds_read_b128 v[36:39], v8 offset:47104
    v_mfma_f32_16x16x32_bf16 v[80:83], v[136:139], v[40:43], v[80:83]
    v_mfma_f32_16x16x32_bf16 v[84:87], v[208:211], v[40:43], v[84:87]
    ds_read_b128 v[40:43], v8 offset:49152
    v_mfma_f32_16x16x32_bf16 v[88:91], v[136:139], v[44:47], v[88:91]
    v_mfma_f32_16x16x32_bf16 v[92:95], v[208:211], v[44:47], v[92:95]
    ds_read_b128 v[44:47], v8 offset:51200
    s_waitcnt lgkmcnt(5)
    v_mfma_f32_16x16x32_bf16 v[96:99], v[136:139], v[24:27], v[96:99]
    v_mfma_f32_16x16x32_bf16 v[100:103], v[208:211], v[24:27], v[100:103]
    ds_read_b128 v[24:27], v8 offset:53248
    s_waitcnt lgkmcnt(5)
    v_mfma_f32_16x16x32_bf16 v[48:51], v[140:143], v[28:31], v[48:51]
    v_mfma_f32_16x16x32_bf16 v[52:55], v[212:215], v[28:31], v[52:55]
    ds_read_b128 v[28:31], v8 offset:55296
    s_waitcnt lgkmcnt(5)
    v_mfma_f32_16x16x32_bf16 v[56:59], v[140:143], v[32:35], v[56:59]
    v_mfma_f32_16x16x32_bf16 v[60:63], v[212:215], v[32:35], v[60:63]
    s_waitcnt lgkmcnt(4)
    v_mfma_f32_16x16x32_bf16 v[64:67], v[140:143], v[36:39], v[64:67]
    s_add_u32 m0, s42, 126976
    s_add_u32 s45, s39, s48
    v_mfma_f32_16x16x32_bf16 v[68:71], v[212:215], v[36:39], v[68:71]
    s_add_u32 s45, s45, 0
    s_waitcnt lgkmcnt(3)
    v_mfma_f32_16x16x32_bf16 v[72:75], v[140:143], v[40:43], v[72:75]
    s_mov_b64 exec, s[64:65]
    buffer_load_dwordx4 v3, s[8:11], s45 offen lds
    s_mov_b64 exec, -1
    v_mfma_f32_16x16x32_bf16 v[76:79], v[212:215], v[40:43], v[76:79]
    s_waitcnt lgkmcnt(2)
    v_mfma_f32_16x16x32_bf16 v[80:83], v[140:143], v[44:47], v[80:83]
    v_mfma_f32_16x16x32_bf16 v[84:87], v[212:215], v[44:47], v[84:87]
    s_waitcnt lgkmcnt(1)
    v_mfma_f32_16x16x32_bf16 v[88:91], v[140:143], v[24:27], v[88:91]
    s_mov_b64 exec, s[64:65]
    buffer_load_dwordx4 v4, s[8:11], s45 offen offset:1024 lds
    s_mov_b64 exec, -1
    v_mfma_f32_16x16x32_bf16 v[92:95], v[212:215], v[24:27], v[92:95]
    s_waitcnt lgkmcnt(0)
    s_setprio 3
    s_barrier
    v_mfma_f32_16x16x32_bf16 v[96:99], v[140:143], v[28:31], v[96:99]
    v_mfma_f32_16x16x32_bf16 v[100:103], v[212:215], v[28:31], v[100:103]
    s_setprio 0
    s_add_u32 m0, s97, 0
    s_add_u32 s21, s38, 35840
    s_add_u32 s20, s38, 0
    buffer_load_dwordx4 v1, s[24:27], s20 offen lds
    buffer_load_dwordx4 v1, s[24:27], s21 offen offset:1024 lds
    ds_read_b64_tr_b16 v[144:145], v6 offset:32768
    ds_read_b64_tr_b16 v[146:147], v6 offset:33792
    ds_read_b128 v[32:35], v7 offset:0
    buffer_load_dwordx4 v2, s[24:27], s20 offen offset:2048 lds
    ds_read_b64_tr_b16 v[216:217], v6 offset:49152
    ds_read_b64_tr_b16 v[218:219], v6 offset:50176
    ds_read_b128 v[36:39], v7 offset:2048
    buffer_load_dwordx4 v2, s[24:27], s21 offen offset:3072 lds
    ds_read_b128 v[40:43], v7 offset:4096
    ds_read_b128 v[44:47], v7 offset:6144
    buffer_store_dwordx4 v[12:15], v16, s[56:59], s69 offen sc0 sc1
    s_add_u32 s69, s69, 1024
    ds_read_b128 v[24:27], v7 offset:8192
    ds_read_b128 v[28:31], v7 offset:10240
    ds_read_b64_tr_b16 v[148:149], v6 offset:40960
    ds_read_b64_tr_b16 v[150:151], v6 offset:41984
    ds_read_b64_tr_b16 v[220:221], v6 offset:57344
    ds_read_b64_tr_b16 v[222:223], v6 offset:58368
    s_waitcnt vmcnt(8) lgkmcnt(0)
    s_barrier
    s_setprio 1
    v_mfma_f32_16x16x32_bf16 v[48:51], v[144:147], v[32:35], v[48:51]
    v_mfma_f32_16x16x32_bf16 v[52:55], v[216:219], v[32:35], v[52:55]
    ds_read_b128 v[32:35], v7 offset:12288
    v_mfma_f32_16x16x32_bf16 v[56:59], v[144:147], v[36:39], v[56:59]
    v_mfma_f32_16x16x32_bf16 v[60:63], v[216:219], v[36:39], v[60:63]
    ds_read_b128 v[36:39], v8 offset:0
    v_mfma_f32_16x16x32_bf16 v[64:67], v[144:147], v[40:43], v[64:67]
    v_mfma_f32_16x16x32_bf16 v[68:71], v[216:219], v[40:43], v[68:71]
    ds_read_b128 v[40:43], v8 offset:2048
    v_mfma_f32_16x16x32_bf16 v[72:75], v[144:147], v[44:47], v[72:75]
    v_mfma_f32_16x16x32_bf16 v[76:79], v[216:219], v[44:47], v[76:79]
    ds_read_b128 v[44:47], v8 offset:4096
    v_mfma_f32_16x16x32_bf16 v[80:83], v[144:147], v[24:27], v[80:83]
    v_mfma_f32_16x16x32_bf16 v[84:87], v[216:219], v[24:27], v[84:87]
    ds_read_b128 v[24:27], v8 offset:6144
    v_mfma_f32_16x16x32_bf16 v[88:91], v[144:147], v[28:31], v[88:91]
    v_mfma_f32_16x16x32_bf16 v[92:95], v[216:219], v[28:31], v[92:95]
    ds_read_b128 v[28:31], v8 offset:8192
    s_waitcnt lgkmcnt(5)
    v_mfma_f32_16x16x32_bf16 v[96:99], v[144:147], v[32:35], v[96:99]
    v_mfma_f32_16x16x32_bf16 v[100:103], v[216:219], v[32:35], v[100:103]
    ds_read_b128 v[32:35], v8 offset:10240
    s_waitcnt lgkmcnt(5)
    v_mfma_f32_16x16x32_bf16 v[48:51], v[148:151], v[36:39], v[48:51]
    v_mfma_f32_16x16x32_bf16 v[52:55], v[220:223], v[36:39], v[52:55]
    ds_read_b128 v[36:39], v8 offset:12288
    s_waitcnt lgkmcnt(5)
    v_mfma_f32_16x16x32_bf16 v[56:59], v[148:151], v[40:43], v[56:59]
    v_mfma_f32_16x16x32_bf16 v[60:63], v[220:223], v[40:43], v[60:63]
    s_waitcnt lgkmcnt(4)
    v_mfma_f32_16x16x32_bf16 v[64:67], v[148:151], v[44:47], v[64:67]
    s_add_u32 m0, s42, 141312
    s_add_u32 s45, s39, s48
    v_mfma_f32_16x16x32_bf16 v[68:71], v[220:223], v[44:47], v[68:71]
    s_add_u32 s45, s45, 128
    s_waitcnt lgkmcnt(3)
    v_mfma_f32_16x16x32_bf16 v[72:75], v[148:151], v[24:27], v[72:75]
    s_mov_b64 exec, s[64:65]
    buffer_load_dwordx4 v3, s[8:11], s45 offen lds
    s_mov_b64 exec, -1
    v_mfma_f32_16x16x32_bf16 v[76:79], v[220:223], v[24:27], v[76:79]
    s_waitcnt lgkmcnt(2)
    v_mfma_f32_16x16x32_bf16 v[80:83], v[148:151], v[28:31], v[80:83]
    v_mfma_f32_16x16x32_bf16 v[84:87], v[220:223], v[28:31], v[84:87]
    s_waitcnt lgkmcnt(1)
    v_mfma_f32_16x16x32_bf16 v[88:91], v[148:151], v[32:35], v[88:91]
    s_mov_b64 exec, s[64:65]
    buffer_load_dwordx4 v4, s[8:11], s45 offen offset:1024 lds
    s_mov_b64 exec, -1
    v_mfma_f32_16x16x32_bf16 v[92:95], v[220:223], v[32:35], v[92:95]
    s_waitcnt lgkmcnt(0)
    s_setprio 3
    s_barrier
    v_mfma_f32_16x16x32_bf16 v[96:99], v[148:151], v[36:39], v[96:99]
    v_mfma_f32_16x16x32_bf16 v[100:103], v[220:223], v[36:39], v[100:103]
    s_setprio 0
    s_add_u32 m0, s97, 32768
    s_add_u32 s21, s38, 625664
    s_add_u32 s20, s38, 589824
    buffer_load_dwordx4 v1, s[24:27], s20 offen lds
    s_and_b64 exec, s[100:101], 1
    buffer_load_dword v9, off, s[92:95], 0 sc0 sc1
    s_mov_b64 exec, -1
    buffer_load_dwordx4 v1, s[24:27], s21 offen offset:1024 lds
    ds_read_b64_tr_b16 v[152:153], v22 offset:0
    ds_read_b64_tr_b16 v[154:155], v22 offset:1024
    ds_read_b128 v[40:43], v7 offset:14336
    buffer_load_dwordx4 v2, s[24:27], s20 offen offset:2048 lds
    ds_read_b64_tr_b16 v[224:225], v22 offset:16384
    ds_read_b64_tr_b16 v[226:227], v22 offset:17408
    ds_read_b128 v[44:47], v7 offset:16384
    buffer_load_dwordx4 v2, s[24:27], s21 offen offset:3072 lds
    ds_read_b128 v[24:27], v7 offset:18432
    ds_read_b128 v[28:31], v7 offset:20480
    buffer_store_dwordx4 v[12:15], v16, s[56:59], s69 offen sc0 sc1
    s_add_u32 s69, s69, 1024
    ds_read_b128 v[32:35], v7 offset:22528
    ds_read_b128 v[36:39], v7 offset:24576
    ds_read_b64_tr_b16 v[156:157], v22 offset:8192
    ds_read_b64_tr_b16 v[158:159], v22 offset:9216
    ds_read_b64_tr_b16 v[228:229], v22 offset:24576
    ds_read_b64_tr_b16 v[230:231], v22 offset:25600
    s_waitcnt vmcnt(9) lgkmcnt(0)
    s_barrier
    s_setprio 1
    v_mfma_f32_16x16x32_bf16 v[48:51], v[152:155], v[40:43], v[48:51]
    v_mfma_f32_16x16x32_bf16 v[52:55], v[224:227], v[40:43], v[52:55]
    ds_read_b128 v[40:43], v7 offset:26624
    v_mfma_f32_16x16x32_bf16 v[56:59], v[152:155], v[44:47], v[56:59]
    v_mfma_f32_16x16x32_bf16 v[60:63], v[224:227], v[44:47], v[60:63]
    ds_read_b128 v[44:47], v8 offset:14336
    v_mfma_f32_16x16x32_bf16 v[64:67], v[152:155], v[24:27], v[64:67]
    v_mfma_f32_16x16x32_bf16 v[68:71], v[224:227], v[24:27], v[68:71]
    ds_read_b128 v[24:27], v8 offset:16384
    v_mfma_f32_16x16x32_bf16 v[72:75], v[152:155], v[28:31], v[72:75]
    v_mfma_f32_16x16x32_bf16 v[76:79], v[224:227], v[28:31], v[76:79]
    ds_read_b128 v[28:31], v8 offset:18432
    v_mfma_f32_16x16x32_bf16 v[80:83], v[152:155], v[32:35], v[80:83]
    v_mfma_f32_16x16x32_bf16 v[84:87], v[224:227], v[32:35], v[84:87]
    ds_read_b128 v[32:35], v8 offset:20480
    v_mfma_f32_16x16x32_bf16 v[88:91], v[152:155], v[36:39], v[88:91]
    v_mfma_f32_16x16x32_bf16 v[92:95], v[224:227], v[36:39], v[92:95]
    ds_read_b128 v[36:39], v8 offset:22528
    s_waitcnt lgkmcnt(5)
    v_mfma_f32_16x16x32_bf16 v[96:99], v[152:155], v[40:43], v[96:99]
    v_mfma_f32_16x16x32_bf16 v[100:103], v[224:227], v[40:43], v[100:103]
    ds_read_b128 v[40:43], v8 offset:24576
    s_waitcnt lgkmcnt(5)
    v_mfma_f32_16x16x32_bf16 v[48:51], v[156:159], v[44:47], v[48:51]
    v_mfma_f32_16x16x32_bf16 v[52:55], v[228:231], v[44:47], v[52:55]
    ds_read_b128 v[44:47], v8 offset:26624
    s_waitcnt lgkmcnt(5)
    v_mfma_f32_16x16x32_bf16 v[56:59], v[156:159], v[24:27], v[56:59]
    v_mfma_f32_16x16x32_bf16 v[60:63], v[228:231], v[24:27], v[60:63]
    s_waitcnt lgkmcnt(4)
    v_mfma_f32_16x16x32_bf16 v[64:67], v[156:159], v[28:31], v[64:67]
    s_add_u32 m0, s42, 98304
    s_add_u32 s45, s39, s48
    v_mfma_f32_16x16x32_bf16 v[68:71], v[228:231], v[28:31], v[68:71]
    s_add_u32 s45, s45, 256
    s_waitcnt lgkmcnt(3)
    v_mfma_f32_16x16x32_bf16 v[72:75], v[156:159], v[32:35], v[72:75]
    s_mov_b64 exec, s[64:65]
    buffer_load_dwordx4 v3, s[8:11], s45 offen lds
    s_mov_b64 exec, -1
    v_mfma_f32_16x16x32_bf16 v[76:79], v[228:231], v[32:35], v[76:79]
    s_waitcnt lgkmcnt(2)
    v_mfma_f32_16x16x32_bf16 v[80:83], v[156:159], v[36:39], v[80:83]
    v_mfma_f32_16x16x32_bf16 v[84:87], v[228:231], v[36:39], v[84:87]
    s_waitcnt lgkmcnt(1)
    v_mfma_f32_16x16x32_bf16 v[88:91], v[156:159], v[40:43], v[88:91]
    s_mov_b64 exec, s[64:65]
    buffer_load_dwordx4 v4, s[8:11], s45 offen offset:1024 lds
    s_mov_b64 exec, -1
    v_mfma_f32_16x16x32_bf16 v[92:95], v[228:231], v[40:43], v[92:95]
    s_waitcnt lgkmcnt(0)
    s_setprio 3
    s_barrier
    v_mfma_f32_16x16x32_bf16 v[96:99], v[156:159], v[44:47], v[96:99]
    v_mfma_f32_16x16x32_bf16 v[100:103], v[228:231], v[44:47], v[100:103]
    s_setprio 0
    s_add_u32 m0, s97, 65536
    s_add_u32 s21, s38, 1215488
    s_add_u32 s20, s38, 1179648
    buffer_load_dwordx4 v1, s[24:27], s20 offen lds
    buffer_load_dwordx4 v1, s[24:27], s21 offen offset:1024 lds
    ds_read_b64_tr_b16 v[160:161], v6 offset:0
    ds_read_b64_tr_b16 v[162:163], v6 offset:1024
    ds_read_b128 v[24:27], v7 offset:28672
    buffer_load_dwordx4 v2, s[24:27], s20 offen offset:2048 lds
    ds_read_b64_tr_b16 v[232:233], v6 offset:16384
    ds_read_b64_tr_b16 v[234:235], v6 offset:17408
    ds_read_b128 v[28:31], v7 offset:30720
    buffer_load_dwordx4 v2, s[24:27], s21 offen offset:3072 lds
    ds_read_b128 v[32:35], v7 offset:32768
    ds_read_b128 v[36:39], v7 offset:34816
    buffer_store_dwordx4 v[12:15], v16, s[56:59], s69 offen sc0 sc1
    s_add_u32 s69, s69, 1024
    ds_read_b128 v[40:43], v7 offset:36864
    ds_read_b128 v[44:47], v7 offset:38912
    ds_read_b64_tr_b16 v[164:165], v6 offset:8192
    ds_read_b64_tr_b16 v[166:167], v6 offset:9216
    ds_read_b64_tr_b16 v[236:237], v6 offset:24576
    ds_read_b64_tr_b16 v[238:239], v6 offset:25600
    s_waitcnt vmcnt(8) lgkmcnt(0)
    s_barrier
    s_setprio 1
    v_mfma_f32_16x16x32_bf16 v[48:51], v[160:163], v[24:27], v[48:51]
    v_mfma_f32_16x16x32_bf16 v[52:55], v[232:235], v[24:27], v[52:55]
    ds_read_b128 v[24:27], v7 offset:40960
    v_mfma_f32_16x16x32_bf16 v[56:59], v[160:163], v[28:31], v[56:59]
    v_mfma_f32_16x16x32_bf16 v[60:63], v[232:235], v[28:31], v[60:63]
    ds_read_b128 v[28:31], v8 offset:28672
    v_mfma_f32_16x16x32_bf16 v[64:67], v[160:163], v[32:35], v[64:67]
    v_mfma_f32_16x16x32_bf16 v[68:71], v[232:235], v[32:35], v[68:71]
    ds_read_b128 v[32:35], v8 offset:30720
    v_mfma_f32_16x16x32_bf16 v[72:75], v[160:163], v[36:39], v[72:75]
    v_mfma_f32_16x16x32_bf16 v[76:79], v[232:235], v[36:39], v[76:79]
    ds_read_b128 v[36:39], v8 offset:32768
    v_mfma_f32_16x16x32_bf16 v[80:83], v[160:163], v[40:43], v[80:83]
    v_mfma_f32_16x16x32_bf16 v[84:87], v[232:235], v[40:43], v[84:87]
    ds_read_b128 v[40:43], v8 offset:34816
    v_mfma_f32_16x16x32_bf16 v[88:91], v[160:163], v[44:47], v[88:91]
    v_mfma_f32_16x16x32_bf16 v[92:95], v[232:235], v[44:47], v[92:95]
    ds_read_b128 v[44:47], v8 offset:36864
    s_waitcnt lgkmcnt(5)
    v_mfma_f32_16x16x32_bf16 v[96:99], v[160:163], v[24:27], v[96:99]
    v_mfma_f32_16x16x32_bf16 v[100:103], v[232:235], v[24:27], v[100:103]
    ds_read_b128 v[24:27], v8 offset:38912
    s_waitcnt lgkmcnt(5)
    v_mfma_f32_16x16x32_bf16 v[48:51], v[164:167], v[28:31], v[48:51]
    v_mfma_f32_16x16x32_bf16 v[52:55], v[236:239], v[28:31], v[52:55]
    ds_read_b128 v[28:31], v8 offset:40960
    s_waitcnt lgkmcnt(5)
    v_mfma_f32_16x16x32_bf16 v[56:59], v[164:167], v[32:35], v[56:59]
    v_mfma_f32_16x16x32_bf16 v[60:63], v[236:239], v[32:35], v[60:63]
    s_waitcnt lgkmcnt(4)
    v_mfma_f32_16x16x32_bf16 v[64:67], v[164:167], v[36:39], v[64:67]
    v_mfma_f32_16x16x32_bf16 v[68:71], v[236:239], v[36:39], v[68:71]
    s_waitcnt lgkmcnt(3)
    v_mfma_f32_16x16x32_bf16 v[72:75], v[164:167], v[40:43], v[72:75]
    v_mfma_f32_16x16x32_bf16 v[76:79], v[236:239], v[40:43], v[76:79]
    s_waitcnt lgkmcnt(2)
    v_mfma_f32_16x16x32_bf16 v[80:83], v[164:167], v[44:47], v[80:83]
    v_mfma_f32_16x16x32_bf16 v[84:87], v[236:239], v[44:47], v[84:87]
    s_waitcnt lgkmcnt(1)
    v_mfma_f32_16x16x32_bf16 v[88:91], v[164:167], v[24:27], v[88:91]
    v_mfma_f32_16x16x32_bf16 v[92:95], v[236:239], v[24:27], v[92:95]
    s_waitcnt lgkmcnt(0)
    s_setprio 3
    s_barrier
    v_mfma_f32_16x16x32_bf16 v[96:99], v[164:167], v[28:31], v[96:99]
    v_mfma_f32_16x16x32_bf16 v[100:103], v[236:239], v[28:31], v[100:103]
    s_setprio 0
    s_mul_i32 s44, s50, 9
    s_add_u32 s68, s44, s49
    s_add_u32 s44, s44, s63
    s_add_u32 m0, s42, 0
    s_add_u32 s45, s44, 0
    buffer_load_dwordx4 v3, s[8:11], s45 offen lds
    s_cmp_eq_u32 s100, 0
    s_cbranch_scc1 fused_kernel_dcg19_ok
    s_movk_i32 s98, 0x4000
fused_kernel_dcg19_l:
    v_readfirstlane_b32 s34, v9
    s_cmp_lg_u32 s34, 0
    s_cbranch_scc1 fused_kernel_dcg19_ok
    s_sleep 2
    s_mov_b64 exec, 1
    buffer_load_dword v9, off, s[92:95], 0 sc0 sc1
    s_mov_b64 exec, -1
    s_waitcnt vmcnt(0)
    s_sub_u32 s98, s98, 1
    s_cbranch_scc0 fused_kernel_dcg19_l
fused_kernel_dcg19_ok:
    s_add_u32 s92, s6, 31465472
    s_addc_u32 s93, s7, 0
    s_and_b32 s93, s93, 0xffff
    s_mov_b32 s94, 65536
    s_mov_b32 s95, 0x00020000
    buffer_load_dwordx4 v4, s[8:11], s45 offen offset:1024 lds
    ds_read_b64_tr_b16 v[168:169], v6 offset:32768
    ds_read_b64_tr_b16 v[170:171], v6 offset:33792
    ds_read_b128 v[32:35], v7 offset:43008
    s_add_u32 m0, s43, 0
    s_add_u32 s45, s68, 0
    s_mov_b64 exec, 0xffff
    buffer_load_dwordx4 v5, s[8:11], s45 offen lds
    s_mov_b64 exec, -1
    ds_read_b64_tr_b16 v[240:241], v6 offset:49152
    ds_read_b64_tr_b16 v[242:243], v6 offset:50176
    ds_read_b128 v[36:39], v7 offset:45056
    buffer_store_dwordx4 v[12:15], v16, s[56:59], s69 offen sc0 sc1
    s_add_u32 s69, s69, 1024
    ds_read_b128 v[40:43], v7 offset:47104
    ds_read_b128 v[44:47], v7 offset:49152
    ds_read_b128 v[24:27], v7 offset:51200
    ds_read_b128 v[28:31], v7 offset:53248
    ds_read_b64_tr_b16 v[172:173], v6 offset:40960
    ds_read_b64_tr_b16 v[174:175], v6 offset:41984
    ds_read_b64_tr_b16 v[244:245], v6 offset:57344
    ds_read_b64_tr_b16 v[246:247], v6 offset:58368
    s_waitcnt vmcnt(5) lgkmcnt(0)
    s_barrier
    s_setprio 1
    v_mfma_f32_16x16x32_bf16 v[48:51], v[168:171], v[32:35], v[48:51]
    v_mfma_f32_16x16x32_bf16 v[52:55], v[240:243], v[32:35], v[52:55]
    ds_read_b128 v[32:35], v7 offset:55296
    v_mfma_f32_16x16x32_bf16 v[56:59], v[168:171], v[36:39], v[56:59]
    v_mfma_f32_16x16x32_bf16 v[60:63], v[240:243], v[36:39], v[60:63]
    ds_read_b128 v[36:39], v8 offset:43008
    v_mfma_f32_16x16x32_bf16 v[64:67], v[168:171], v[40:43], v[64:67]
    v_mfma_f32_16x16x32_bf16 v[68:71], v[240:243], v[40:43], v[68:71]
    ds_read_b128 v[40:43], v8 offset:45056
    v_mfma_f32_16x16x32_bf16 v[72:75], v[168:171], v[44:47], v[72:75]
    v_mfma_f32_16x16x32_bf16 v[76:79], v[240:243], v[44:47], v[76:79]
    ds_read_b128 v[44:47], v8 offset:47104
    v_mfma_f32_16x16x32_bf16 v[80:83], v[168:171], v[24:27], v[80:83]
    v_mfma_f32_16x16x32_bf16 v[84:87], v[240:243], v[24:27], v[84:87]
    ds_read_b128 v[24:27], v8 offset:49152
    v_mfma_f32_16x16x32_bf16 v[88:91], v[168:171], v[28:31], v[88:91]
    v_mfma_f32_16x16x32_bf16 v[92:95], v[240:243], v[28:31], v[92:95]
    ds_read_b128 v[28:31], v8 offset:51200
    s_waitcnt lgkmcnt(5)
    v_mfma_f32_16x16x32_bf16 v[96:99], v[168:171], v[32:35], v[96:99]
    v_mfma_f32_16x16x32_bf16 v[100:103], v[240:243], v[32:35], v[100:103]
    ds_read_b128 v[32:35], v8 offset:53248
    s_waitcnt lgkmcnt(5)
    v_mfma_f32_16x16x32_bf16 v[48:51], v[172:175], v[36:39], v[48:51]
    v_mfma_f32_16x16x32_bf16 v[52:55], v[244:247], v[36:39], v[52:55]
    ds_read_b128 v[36:39], v8 offset:55296
    s_waitcnt lgkmcnt(5)
    v_mfma_f32_16x16x32_bf16 v[56:59], v[172:175], v[40:43], v[56:59]
    v_mfma_f32_16x16x32_bf16 v[60:63], v[244:247], v[40:43], v[60:63]
    s_waitcnt lgkmcnt(4)
    v_mfma_f32_16x16x32_bf16 v[64:67], v[172:175], v[44:47], v[64:67]
    v_mfma_f32_16x16x32_bf16 v[68:71], v[244:247], v[44:47], v[68:71]
    s_waitcnt lgkmcnt(3)
    v_mfma_f32_16x16x32_bf16 v[72:75], v[172:175], v[24:27], v[72:75]
    v_mfma_f32_16x16x32_bf16 v[76:79], v[244:247], v[24:27], v[76:79]
    s_waitcnt lgkmcnt(2)
    v_mfma_f32_16x16x32_bf16 v[80:83], v[172:175], v[28:31], v[80:83]
    v_mfma_f32_16x16x32_bf16 v[84:87], v[244:247], v[28:31], v[84:87]
    s_waitcnt lgkmcnt(1)
    v_mfma_f32_16x16x32_bf16 v[88:91], v[172:175], v[32:35], v[88:91]
    v_mfma_f32_16x16x32_bf16 v[92:95], v[244:247], v[32:35], v[92:95]
    s_waitcnt lgkmcnt(0)
    s_setprio 3
    s_barrier
    v_mfma_f32_16x16x32_bf16 v[96:99], v[172:175], v[36:39], v[96:99]
    v_mfma_f32_16x16x32_bf16 v[100:103], v[244:247], v[36:39], v[100:103]
    s_setprio 0
    s_add_u32 m0, s42, 32768
    s_add_u32 s45, s44, 18432
    buffer_load_dwordx4 v3, s[8:11], s45 offen lds
    buffer_load_dwordx4 v4, s[8:11], s45 offen offset:1024 lds
    ds_read_b64_tr_b16 v[176:177], v22 offset:0
    ds_read_b64_tr_b16 v[178:179], v22 offset:1024
    ds_read_b128 v[40:43], v7 offset:0
    s_add_u32 m0, s43, 32768
    s_add_u32 s45, s68, 18432
    s_mov_b64 exec, 0xffff
    buffer_load_dwordx4 v5, s[8:11], s45 offen lds
    s_mov_b64 exec, -1
    ds_read_b64_tr_b16 v[248:249], v22 offset:16384
    ds_read_b64_tr_b16 v[250:251], v22 offset:17408
    ds_read_b128 v[44:47], v7 offset:2048
    ds_read_b128 v[24:27], v7 offset:4096
    ds_read_b128 v[28:31], v7 offset:6144
    ds_read_b128 v[32:35], v7 offset:8192
    ds_read_b128 v[36:39], v7 offset:10240
    ds_read_b64_tr_b16 v[180:181], v22 offset:8192
    ds_read_b64_tr_b16 v[182:183], v22 offset:9216
    ds_read_b64_tr_b16 v[252:253], v22 offset:24576
    ds_read_b64_tr_b16 v[254:255], v22 offset:25600
    s_waitcnt vmcnt(4) lgkmcnt(0)
    s_barrier
    s_setprio 1
    v_mfma_f32_16x16x32_bf16 v[48:51], v[176:179], v[40:43], v[48:51]
    v_mov_b32 v1, v104
    v_mfma_f32_16x16x32_bf16 v[52:55], v[248:251], v[40:43], v[52:55]
    v_mov_b32 v2, v105
    ds_read_b128 v[40:43], v7 offset:12288
    v_mfma_f32_16x16x32_bf16 v[56:59], v[176:179], v[44:47], v[56:59]
    v_mov_b32 v6, v106
    v_mfma_f32_16x16x32_bf16 v[60:63], v[248:251], v[44:47], v[60:63]
    v_mov_b32 v22, v107
    ds_read_b128 v[44:47], v8 offset:0
    v_mfma_f32_16x16x32_bf16 v[64:67], v[176:179], v[24:27], v[64:67]
    v_mov_b32 v9, v110
    v_mfma_f32_16x16x32_bf16 v[68:71], v[248:251], v[24:27], v[68:71]
    ds_read_b128 v[24:27], v8 offset:2048
    v_mfma_f32_16x16x32_bf16 v[72:75], v[176:179], v[28:31], v[72:75]
    v_mfma_f32_16x16x32_bf16 v[76:79], v[248:251], v[28:31], v[76:79]
    ds_read_b128 v[28:31], v8 offset:4096
    v_mfma_f32_16x16x32_bf16 v[80:83], v[176:179], v[32:35], v[80:83]
    v_mfma_f32_16x16x32_bf16 v[84:87], v[248:251], v[32:35], v[84:87]
    ds_read_b128 v[32:35], v8 offset:6144
    v_mfma_f32_16x16x32_bf16 v[88:91], v[176:179], v[36:39], v[88:91]
    v_mfma_f32_16x16x32_bf16 v[92:95], v[248:251], v[36:39], v[92:95]
    ds_read_b128 v[36:39], v8 offset:8192
    s_waitcnt lgkmcnt(5)
    v_mfma_f32_16x16x32_bf16 v[96:99], v[176:179], v[40:43], v[96:99]
    v_mfma_f32_16x16x32_bf16 v[100:103], v[248:251], v[40:43], v[100:103]
    ds_read_b128 v[40:43], v8 offset:10240
    s_waitcnt lgkmcnt(5)
    v_mfma_f32_16x16x32_bf16 v[48:51], v[180:183], v[44:47], v[48:51]
    v_mfma_f32_16x16x32_bf16 v[52:55], v[252:255], v[44:47], v[52:55]
    ds_read_b128 v[44:47], v8 offset:12288
    s_waitcnt lgkmcnt(5)
    v_mfma_f32_16x16x32_bf16 v[56:59], v[180:183], v[24:27], v[56:59]
    v_mfma_f32_16x16x32_bf16 v[60:63], v[252:255], v[24:27], v[60:63]
    s_waitcnt lgkmcnt(4)
    v_mfma_f32_16x16x32_bf16 v[64:67], v[180:183], v[28:31], v[64:67]
    v_mfma_f32_16x16x32_bf16 v[68:71], v[252:255], v[28:31], v[68:71]
    s_waitcnt lgkmcnt(3)
    v_mfma_f32_16x16x32_bf16 v[72:75], v[180:183], v[32:35], v[72:75]
    v_mfma_f32_16x16x32_bf16 v[76:79], v[252:255], v[32:35], v[76:79]
    s_waitcnt lgkmcnt(2)
    v_mfma_f32_16x16x32_bf16 v[80:83], v[180:183], v[36:39], v[80:83]
    v_mfma_f32_16x16x32_bf16 v[84:87], v[252:255], v[36:39], v[84:87]
    s_waitcnt lgkmcnt(1)
    v_mfma_f32_16x16x32_bf16 v[88:91], v[180:183], v[40:43], v[88:91]
    v_mfma_f32_16x16x32_bf16 v[92:95], v[252:255], v[40:43], v[92:95]
    s_waitcnt lgkmcnt(0)
    s_setprio 3
    s_barrier
    v_mfma_f32_16x16x32_bf16 v[96:99], v[180:183], v[44:47], v[96:99]
    v_mfma_f32_16x16x32_bf16 v[100:103], v[252:255], v[44:47], v[100:103]
    s_setprio 0
    s_add_u32 m0, s42, 65536
    s_add_u32 s45, s44, 36864
    buffer_load_dwordx4 v3, s[8:11], s45 offen lds
    buffer_load_dwordx4 v4, s[8:11], s45 offen offset:1024 lds
    v_mul_f32 v10, s46, v48
    v_mul_f32 v11, s46, v49
    v_add_u32 v7, 4294868992, v7
    v_add_u32 v8, 4294868992, v8
    ds_read_b128 v[24:27], v7 offset:0
    v_mul_f32 v12, s46, v50
    v_mul_f32 v13, s46, v51
    ds_read_b128 v[28:31], v8 offset:0
    v_exp_f32 v10, v10
    ds_read_b128 v[32:35], v7 offset:2048
    v_exp_f32 v11, v11
    ds_read_b128 v[36:39], v8 offset:2048
    v_exp_f32 v12, v12
    s_add_u32 m0, s43, 65536
    s_add_u32 s45, s68, 36864
    s_mov_b64 exec, 0xffff
    buffer_load_dwordx4 v5, s[8:11], s45 offen lds
    s_mov_b64 exec, -1
    v_exp_f32 v13, v13
    ds_read_b128 v[40:43], v7 offset:4096
    v_mul_f32 v14, v48, v52
    v_mul_f32 v15, v49, v53
    ds_read_b128 v[44:47], v8 offset:4096
    v_mul_f32 v16, v50, v54
    v_mul_f32 v17, v51, v55
    v_add_f32 v10, 1.0, v10
    v_add_f32 v11, 1.0, v11
    v_add_f32 v12, 1.0, v12
    v_add_f32 v13, 1.0, v13
    v_rcp_f32 v10, v10
    v_rcp_f32 v11, v11
    s_waitcnt vmcnt(3) lgkmcnt(0)
    s_barrier
    s_setprio 1
    v_mfma_f32_16x16x32_bf16 v[104:107], v[112:115], v[24:27], 0
    v_rcp_f32 v12, v12
    v_mfma_f32_16x16x32_bf16 v[108:111], v[184:187], v[24:27], 0
    ds_read_b128 v[24:27], v7 offset:6144
    v_mfma_f32_16x16x32_bf16 v[104:107], v[116:119], v[28:31], v[104:107]
    v_rcp_f32 v13, v13
    v_mfma_f32_16x16x32_bf16 v[108:111], v[188:191], v[28:31], v[108:111]
    ds_read_b128 v[28:31], v8 offset:6144
    v_mfma_f32_16x16x32_bf16 v[104:107], v[120:123], v[32:35], v[104:107]
    v_mul_f32 v14, v14, v10
    v_mul_f32 v15, v15, v11
    v_mfma_f32_16x16x32_bf16 v[108:111], v[192:195], v[32:35], v[108:111]
    ds_read_b128 v[32:35], v7 offset:8192
    v_mfma_f32_16x16x32_bf16 v[104:107], v[124:127], v[36:39], v[104:107]
    v_mul_f32 v16, v16, v12
    v_mul_f32 v17, v17, v13
    v_mfma_f32_16x16x32_bf16 v[108:111], v[196:199], v[36:39], v[108:111]
    ds_read_b128 v[36:39], v8 offset:8192
    v_mfma_f32_16x16x32_bf16 v[104:107], v[128:131], v[40:43], v[104:107]
    v_cvt_pk_bf16_f32 v18, v14, v15
    v_cvt_pk_bf16_f32 v19, v16, v17
    v_mfma_f32_16x16x32_bf16 v[108:111], v[200:203], v[40:43], v[108:111]
    ds_read_b128 v[40:43], v7 offset:10240
    v_mfma_f32_16x16x32_bf16 v[104:107], v[132:135], v[44:47], v[104:107]
    v_mul_f32 v10, s46, v56
    v_mul_f32 v11, s46, v57
    v_mfma_f32_16x16x32_bf16 v[108:111], v[204:207], v[44:47], v[108:111]
    ds_read_b128 v[44:47], v8 offset:10240
    s_waitcnt lgkmcnt(5)
    v_mfma_f32_16x16x32_bf16 v[104:107], v[136:139], v[24:27], v[104:107]
    v_mul_f32 v12, s46, v58
    v_mul_f32 v13, s46, v59
    v_mfma_f32_16x16x32_bf16 v[108:111], v[208:211], v[24:27], v[108:111]
    ds_read_b128 v[24:27], v7 offset:12288
    s_waitcnt lgkmcnt(5)
    v_mfma_f32_16x16x32_bf16 v[104:107], v[140:143], v[28:31], v[104:107]
    v_exp_f32 v10, v10
    v_mfma_f32_16x16x32_bf16 v[108:111], v[212:215], v[28:31], v[108:111]
    ds_read_b128 v[28:31], v8 offset:12288
    s_waitcnt lgkmcnt(5)
    v_mfma_f32_16x16x32_bf16 v[104:107], v[144:147], v[32:35], v[104:107]
    v_exp_f32 v11, v11
    v_mfma_f32_16x16x32_bf16 v[108:111], v[216:219], v[32:35], v[108:111]
    ds_read_b128 v[32:35], v7 offset:14336
    s_waitcnt lgkmcnt(5)
    v_mfma_f32_16x16x32_bf16 v[104:107], v[148:151], v[36:39], v[104:107]
    v_exp_f32 v12, v12
    v_mfma_f32_16x16x32_bf16 v[108:111], v[220:223], v[36:39], v[108:111]
    ds_read_b128 v[36:39], v8 offset:14336
    s_waitcnt lgkmcnt(5)
    v_mfma_f32_16x16x32_bf16 v[104:107], v[152:155], v[40:43], v[104:107]
    v_exp_f32 v13, v13
    v_mfma_f32_16x16x32_bf16 v[108:111], v[224:227], v[40:43], v[108:111]
    ds_read_b128 v[40:43], v7 offset:16384
    s_waitcnt lgkmcnt(5)
    v_mfma_f32_16x16x32_bf16 v[104:107], v[156:159], v[44:47], v[104:107]
    v_mul_f32 v14, v56, v60
    v_mul_f32 v15, v57, v61
    v_mfma_f32_16x16x32_bf16 v[108:111], v[228:231], v[44:47], v[108:111]
    ds_read_b128 v[44:47], v8 offset:16384
    s_waitcnt lgkmcnt(5)
    v_mfma_f32_16x16x32_bf16 v[104:107], v[160:163], v[24:27], v[104:107]
    v_mul_f32 v16, v58, v62
    v_mul_f32 v17, v59, v63
    v_mfma_f32_16x16x32_bf16 v[108:111], v[232:235], v[24:27], v[108:111]
    s_waitcnt lgkmcnt(4)
    v_mfma_f32_16x16x32_bf16 v[104:107], v[164:167], v[28:31], v[104:107]
    v_add_f32 v10, 1.0, v10
    v_add_f32 v11, 1.0, v11
    v_mfma_f32_16x16x32_bf16 v[108:111], v[236:239], v[28:31], v[108:111]
    s_waitcnt lgkmcnt(3)
    v_mfma_f32_16x16x32_bf16 v[104:107], v[168:171], v[32:35], v[104:107]
    v_add_f32 v12, 1.0, v12
    v_add_f32 v13, 1.0, v13
    v_mfma_f32_16x16x32_bf16 v[108:111], v[240:243], v[32:35], v[108:111]
    s_waitcnt lgkmcnt(2)
    v_mfma_f32_16x16x32_bf16 v[104:107], v[172:175], v[36:39], v[104:107]
    v_rcp_f32 v10, v10
    v_mfma_f32_16x16x32_bf16 v[108:111], v[244:247], v[36:39], v[108:111]
    s_waitcnt lgkmcnt(1)
    v_mfma_f32_16x16x32_bf16 v[104:107], v[176:179], v[40:43], v[104:107]
    v_rcp_f32 v11, v11
    v_mfma_f32_16x16x32_bf16 v[108:111], v[248:251], v[40:43], v[108:111]
    s_waitcnt lgkmcnt(0)
    s_setprio 3
    s_barrier
    v_mfma_f32_16x16x32_bf16 v[104:107], v[180:183], v[44:47], v[104:107]
    v_rcp_f32 v12, v12
    v_mfma_f32_16x16x32_bf16 v[108:111], v[252:255], v[44:47], v[108:111]
    s_setprio 0
    s_add_u32 m0, s42, 145408
    s_add_u32 s45, s44, 55296
    buffer_load_dwordx4 v3, s[8:11], s45 offen lds
    v_mov_b32 v24, 1
    v_lshlrev_b32 v25, 2, v0
    v_and_b32 v25, 127, v25
    s_mov_b64 exec, s[100:101]
    buffer_store_dword v24, v25, s[92:95], s99 offen sc0 sc1
    s_mov_b64 exec, -1
    buffer_load_dwordx4 v4, s[8:11], s45 offen offset:1024 lds
    s_add_u32 m0, s43, 145408
    s_add_u32 s45, s68, 55296
    s_mov_b64 exec, 0xffff
    buffer_load_dwordx4 v5, s[8:11], s45 offen lds
    s_mov_b64 exec, -1
    v_and_b32 v28, 63, v0
    v_lshlrev_b32 v28, 7, v28
    s_mov_b32 m0, 32256
    s_and_b32 s34, s22, 3
    s_cmp_eq_u32 s34, 0
    s_cselect_b64 exec, -1, 0
    buffer_load_dword v28, s[28:31], s91 offen lds
    s_mov_b64 exec, -1
    v_rcp_f32 v13, v13
    ds_read_b128 v[24:27], v7 offset:32768
    v_mul_f32 v14, v14, v10
    v_mul_f32 v15, v15, v11
    ds_read_b128 v[28:31], v8 offset:32768
    v_mul_f32 v16, v16, v12
    v_mul_f32 v17, v17, v13
    ds_read_b128 v[32:35], v7 offset:34816
    v_cvt_pk_bf16_f32 v20, v14, v15
    v_cvt_pk_bf16_f32 v21, v16, v17
    ds_read_b128 v[36:39], v8 offset:34816
    s_nop 0
    v_permlane16_swap_b32 v18, v20
    v_permlane16_swap_b32 v19, v21
    ds_read_b128 v[40:43], v7 offset:36864
    s_nop 0
    buffer_store_dwordx4 v[18:21], v23, s[16:19], s47 offen sc0 sc1
    s_add_u32 s47, s47, 4096
    v_mul_f32 v10, s46, v64
    v_mul_f32 v11, s46, v65
    ds_read_b128 v[44:47], v8 offset:36864
    v_mul_f32 v12, s46, v66
    v_mul_f32 v13, s46, v67
    v_exp_f32 v10, v10
    v_exp_f32 v11, v11
    v_exp_f32 v12, v12
    v_exp_f32 v13, v13
    v_mul_f32 v14, v64, v68
    s_waitcnt vmcnt(6) lgkmcnt(0)
    s_barrier
    s_setprio 1
    v_mfma_f32_16x16x32_bf16 v[48:51], v[112:115], v[24:27], 0
    v_mul_f32 v15, v65, v69
    v_mul_f32 v16, v66, v70
    v_mfma_f32_16x16x32_bf16 v[52:55], v[184:187], v[24:27], 0
    ds_read_b128 v[24:27], v7 offset:38912
    v_mfma_f32_16x16x32_bf16 v[48:51], v[116:119], v[28:31], v[48:51]
    v_mul_f32 v17, v67, v71
    v_add_f32 v10, 1.0, v10
    v_mfma_f32_16x16x32_bf16 v[52:55], v[188:191], v[28:31], v[52:55]
    ds_read_b128 v[28:31], v8 offset:38912
    v_mfma_f32_16x16x32_bf16 v[48:51], v[120:123], v[32:35], v[48:51]
    v_add_f32 v11, 1.0, v11
    v_add_f32 v12, 1.0, v12
    v_mfma_f32_16x16x32_bf16 v[52:55], v[192:195], v[32:35], v[52:55]
    ds_read_b128 v[32:35], v7 offset:40960
    v_mfma_f32_16x16x32_bf16 v[48:51], v[124:127], v[36:39], v[48:51]
    v_add_f32 v13, 1.0, v13
    v_mfma_f32_16x16x32_bf16 v[52:55], v[196:199], v[36:39], v[52:55]
    ds_read_b128 v[36:39], v8 offset:40960
    v_mfma_f32_16x16x32_bf16 v[48:51], v[128:131], v[40:43], v[48:51]
    v_rcp_f32 v10, v10
    v_mfma_f32_16x16x32_bf16 v[52:55], v[200:203], v[40:43], v[52:55]
    ds_read_b128 v[40:43], v7 offset:43008
    v_mfma_f32_16x16x32_bf16 v[48:51], v[132:135], v[44:47], v[48:51]
    v_rcp_f32 v11, v11
    v_mfma_f32_16x16x32_bf16 v[52:55], v[204:207], v[44:47], v[52:55]
    ds_read_b128 v[44:47], v8 offset:43008
    s_waitcnt lgkmcnt(5)
    v_mfma_f32_16x16x32_bf16 v[48:51], v[136:139], v[24:27], v[48:51]
    v_rcp_f32 v12, v12
    v_mfma_f32_16x16x32_bf16 v[52:55], v[208:211], v[24:27], v[52:55]
    ds_read_b128 v[24:27], v7 offset:45056
    s_waitcnt lgkmcnt(5)
    v_mfma_f32_16x16x32_bf16 v[48:51], v[140:143], v[28:31], v[48:51]
    v_rcp_f32 v13, v13
    v_mfma_f32_16x16x32_bf16 v[52:55], v[212:215], v[28:31], v[52:55]
    ds_read_b128 v[28:31], v8 offset:45056
    s_waitcnt lgkmcnt(5)
    v_mfma_f32_16x16x32_bf16 v[48:51], v[144:147], v[32:35], v[48:51]
    v_mul_f32 v14, v14, v10
    v_mul_f32 v15, v15, v11
    v_mfma_f32_16x16x32_bf16 v[52:55], v[216:219], v[32:35], v[52:55]
    ds_read_b128 v[32:35], v7 offset:47104
    s_waitcnt lgkmcnt(5)
    v_mfma_f32_16x16x32_bf16 v[48:51], v[148:151], v[36:39], v[48:51]
    v_mul_f32 v16, v16, v12
    v_mul_f32 v17, v17, v13
    v_mfma_f32_16x16x32_bf16 v[52:55], v[220:223], v[36:39], v[52:55]
    ds_read_b128 v[36:39], v8 offset:47104
    s_waitcnt lgkmcnt(5)
    v_mfma_f32_16x16x32_bf16 v[48:51], v[152:155], v[40:43], v[48:51]
    v_cvt_pk_bf16_f32 v18, v14, v15
    v_cvt_pk_bf16_f32 v19, v16, v17
    v_mfma_f32_16x16x32_bf16 v[52:55], v[224:227], v[40:43], v[52:55]
    ds_read_b128 v[40:43], v7 offset:49152
    s_waitcnt lgkmcnt(5)
    v_mfma_f32_16x16x32_bf16 v[48:51], v[156:159], v[44:47], v[48:51]
    v_mul_f32 v10, s46, v72
    v_mul_f32 v11, s46, v73
    v_mfma_f32_16x16x32_bf16 v[52:55], v[228:231], v[44:47], v[52:55]
    ds_read_b128 v[44:47], v8 offset:49152
    s_waitcnt lgkmcnt(5)
    v_mfma_f32_16x16x32_bf16 v[48:51], v[160:163], v[24:27], v[48:51]
    v_mul_f32 v12, s46, v74
    v_mul_f32 v13, s46, v75
    v_mfma_f32_16x16x32_bf16 v[52:55], v[232:235], v[24:27], v[52:55]
    s_waitcnt lgkmcnt(4)
    v_mfma_f32_16x16x32_bf16 v[48:51], v[164:167], v[28:31], v[48:51]
    v_exp_f32 v10, v10
    v_mfma_f32_16x16x32_bf16 v[52:55], v[236:239], v[28:31], v[52:55]
    s_waitcnt lgkmcnt(3)
    v_mfma_f32_16x16x32_bf16 v[48:51], v[168:171], v[32:35], v[48:51]
    v_exp_f32 v11, v11
    v_mfma_f32_16x16x32_bf16 v[52:55], v[240:243], v[32:35], v[52:55]
    s_waitcnt lgkmcnt(2)
    v_mfma_f32_16x16x32_bf16 v[48:51], v[172:175], v[36:39], v[48:51]
    v_exp_f32 v12, v12
    v_mfma_f32_16x16x32_bf16 v[52:55], v[244:247], v[36:39], v[52:55]
    s_waitcnt lgkmcnt(1)
    v_mfma_f32_16x16x32_bf16 v[48:51], v[176:179], v[40:43], v[48:51]
    v_exp_f32 v13, v13
    v_mfma_f32_16x16x32_bf16 v[52:55], v[248:251], v[40:43], v[52:55]
    s_waitcnt lgkmcnt(0)
    s_setprio 3
    s_barrier
    v_mfma_f32_16x16x32_bf16 v[48:51], v[180:183], v[44:47], v[48:51]
    v_mul_f32 v14, v72, v76
    v_mul_f32 v15, v73, v77
    v_mfma_f32_16x16x32_bf16 v[52:55], v[252:255], v[44:47], v[52:55]
    s_setprio 0
    s_mul_i32 s44, s51, 9
    s_add_u32 s68, s44, s49
    s_add_u32 s44, s44, s63
    s_add_u32 m0, s42, 90112
    s_add_u32 s45, s44, 0
    buffer_load_dwordx4 v3, s[8:11], s45 offen lds
    buffer_load_dwordx4 v4, s[8:11], s45 offen offset:1024 lds
    s_add_u32 m0, s43, 90112
    s_add_u32 s45, s68, 0
    s_mov_b64 exec, 0xffff
    buffer_load_dwordx4 v5, s[8:11], s45 offen lds
    s_mov_b64 exec, -1
    v_and_b32 v28, 63, v0
    v_lshlrev_b32 v28, 7, v28
    s_mov_b32 m0, 32256
    s_and_b32 s34, s22, 3
    s_cmp_eq_u32 s34, 1
    s_cselect_b64 exec, -1, 0
    buffer_load_dword v28, s[28:31], s91 offen lds
    s_mov_b64 exec, -1
    v_mul_f32 v16, v74, v78
    v_mul_f32 v17, v75, v79
    v_add_u32 v7, 65536, v7
    v_add_u32 v8, 65536, v8
    ds_read_b128 v[24:27], v7 offset:0
    v_add_f32 v10, 1.0, v10
    v_add_f32 v11, 1.0, v11
    ds_read_b128 v[28:31], v8 offset:0
    v_add_f32 v12, 1.0, v12
    v_add_f32 v13, 1.0, v13
    ds_read_b128 v[32:35], v7 offset:2048
    v_rcp_f32 v10, v10
    ds_read_b128 v[36:39], v8 offset:2048
    v_rcp_f32 v11, v11
    ds_read_b128 v[40:43], v7 offset:4096
    v_rcp_f32 v12, v12
    ds_read_b128 v[44:47], v8 offset:4096
    v_rcp_f32 v13, v13
    v_mul_f32 v14, v14, v10
    v_mul_f32 v15, v15, v11
    v_mul_f32 v16, v16, v12
    v_mul_f32 v17, v17, v13
    v_cvt_pk_bf16_f32 v20, v14, v15
    v_cvt_pk_bf16_f32 v21, v16, v17
    s_nop 0
    v_permlane16_swap_b32 v18, v20
    v_permlane16_swap_b32 v19, v21
    s_nop 0
    buffer_store_dwordx4 v[18:21], v23, s[16:19], s47 offen sc0 sc1
    s_add_u32 s47, s47, 4096
    v_mul_f32 v10, s46, v80
    s_waitcnt vmcnt(7) lgkmcnt(0)
    s_barrier
    s_setprio 1
    v_mfma_f32_16x16x32_bf16 v[56:59], v[112:115], v[24:27], 0
    v_mul_f32 v11, s46, v81
    v_mul_f32 v12, s46, v82
    v_mfma_f32_16x16x32_bf16 v[60:63], v[184:187], v[24:27], 0
    ds_read_b128 v[24:27], v7 offset:6144
    v_mfma_f32_16x16x32_bf16 v[56:59], v[116:119], v[28:31], v[56:59]
    v_mul_f32 v13, s46, v83
    v_mfma_f32_16x16x32_bf16 v[60:63], v[188:191], v[28:31], v[60:63]
    ds_read_b128 v[28:31], v8 offset:6144
    v_mfma_f32_16x16x32_bf16 v[56:59], v[120:123], v[32:35], v[56:59]
    v_exp_f32 v10, v10
    v_mfma_f32_16x16x32_bf16 v[60:63], v[192:195], v[32:35], v[60:63]
    ds_read_b128 v[32:35], v7 offset:8192
    v_mfma_f32_16x16x32_bf16 v[56:59], v[124:127], v[36:39], v[56:59]
    v_exp_f32 v11, v11
    v_mfma_f32_16x16x32_bf16 v[60:63], v[196:199], v[36:39], v[60:63]
    ds_read_b128 v[36:39], v8 offset:8192
    v_mfma_f32_16x16x32_bf16 v[56:59], v[128:131], v[40:43], v[56:59]
    v_exp_f32 v12, v12
    v_mfma_f32_16x16x32_bf16 v[60:63], v[200:203], v[40:43], v[60:63]
    ds_read_b128 v[40:43], v7 offset:10240
    v_mfma_f32_16x16x32_bf16 v[56:59], v[132:135], v[44:47], v[56:59]
    v_exp_f32 v13, v13
    v_mfma_f32_16x16x32_bf16 v[60:63], v[204:207], v[44:47], v[60:63]
    ds_read_b128 v[44:47], v8 offset:10240
    s_waitcnt lgkmcnt(5)
    v_mfma_f32_16x16x32_bf16 v[56:59], v[136:139], v[24:27], v[56:59]
    v_mul_f32 v14, v80, v84
    v_mul_f32 v15, v81, v85
    v_mfma_f32_16x16x32_bf16 v[60:63], v[208:211], v[24:27], v[60:63]
    ds_read_b128 v[24:27], v7 offset:12288
    s_waitcnt lgkmcnt(5)
    v_mfma_f32_16x16x32_bf16 v[56:59], v[140:143], v[28:31], v[56:59]
    v_mul_f32 v16, v82, v86
    v_mul_f32 v17, v83, v87
    v_mfma_f32_16x16x32_bf16 v[60:63], v[212:215], v[28:31], v[60:63]
    ds_read_b128 v[28:31], v8 offset:12288
    s_waitcnt lgkmcnt(5)
    v_mfma_f32_16x16x32_bf16 v[56:59], v[144:147], v[32:35], v[56:59]
    v_add_f32 v10, 1.0, v10
    v_add_f32 v11, 1.0, v11
    v_mfma_f32_16x16x32_bf16 v[60:63], v[216:219], v[32:35], v[60:63]
    ds_read_b128 v[32:35], v7 offset:14336
    s_waitcnt lgkmcnt(5)
    v_mfma_f32_16x16x32_bf16 v[56:59], v[148:151], v[36:39], v[56:59]
    v_add_f32 v12, 1.0, v12
    v_add_f32 v13, 1.0, v13
    v_mfma_f32_16x16x32_bf16 v[60:63], v[220:223], v[36:39], v[60:63]
    ds_read_b128 v[36:39], v8 offset:14336
    s_waitcnt lgkmcnt(5)
    v_mfma_f32_16x16x32_bf16 v[56:59], v[152:155], v[40:43], v[56:59]
    v_rcp_f32 v10, v10
    v_mfma_f32_16x16x32_bf16 v[60:63], v[224:227], v[40:43], v[60:63]
    ds_read_b128 v[40:43], v7 offset:16384
    s_waitcnt lgkmcnt(5)
    v_mfma_f32_16x16x32_bf16 v[56:59], v[156:159], v[44:47], v[56:59]
    v_rcp_f32 v11, v11
    v_mfma_f32_16x16x32_bf16 v[60:63], v[228:231], v[44:47], v[60:63]
    ds_read_b128 v[44:47], v8 offset:16384
    s_waitcnt lgkmcnt(5)
    v_mfma_f32_16x16x32_bf16 v[56:59], v[160:163], v[24:27], v[56:59]
    v_rcp_f32 v12, v12
    v_mfma_f32_16x16x32_bf16 v[60:63], v[232:235], v[24:27], v[60:63]
    s_waitcnt lgkmcnt(4)
    v_mfma_f32_16x16x32_bf16 v[56:59], v[164:167], v[28:31], v[56:59]
    v_rcp_f32 v13, v13
    v_mfma_f32_16x16x32_bf16 v[60:63], v[236:239], v[28:31], v[60:63]
    s_waitcnt lgkmcnt(3)
    v_mfma_f32_16x16x32_bf16 v[56:59], v[168:171], v[32:35], v[56:59]
    v_mul_f32 v14, v14, v10
    v_mul_f32 v15, v15, v11
    v_mfma_f32_16x16x32_bf16 v[60:63], v[240:243], v[32:35], v[60:63]
    s_waitcnt lgkmcnt(2)
    v_mfma_f32_16x16x32_bf16 v[56:59], v[172:175], v[36:39], v[56:59]
    v_mul_f32 v16, v16, v12
    v_mul_f32 v17, v17, v13
    v_mfma_f32_16x16x32_bf16 v[60:63], v[244:247], v[36:39], v[60:63]
    s_waitcnt lgkmcnt(1)
    v_mfma_f32_16x16x32_bf16 v[56:59], v[176:179], v[40:43], v[56:59]
    v_cvt_pk_bf16_f32 v18, v14, v15
    v_cvt_pk_bf16_f32 v19, v16, v17
    v_mfma_f32_16x16x32_bf16 v[60:63], v[248:251], v[40:43], v[60:63]
    s_waitcnt lgkmcnt(0)
    s_setprio 3
    s_barrier
    v_mfma_f32_16x16x32_bf16 v[56:59], v[180:183], v[44:47], v[56:59]
    v_mul_f32 v10, s46, v88
    v_mul_f32 v11, s46, v89
    v_mfma_f32_16x16x32_bf16 v[60:63], v[252:255], v[44:47], v[60:63]
    s_setprio 0
    s_add_u32 m0, s42, 108544
    s_add_u32 s45, s44, 18432
    buffer_load_dwordx4 v3, s[8:11], s45 offen lds
    buffer_load_dwordx4 v4, s[8:11], s45 offen offset:1024 lds
    s_add_u32 m0, s43, 108544
    s_add_u32 s45, s68, 18432
    s_mov_b64 exec, 0xffff
    buffer_load_dwordx4 v5, s[8:11], s45 offen lds
    s_mov_b64 exec, -1
    v_and_b32 v28, 63, v0
    v_lshlrev_b32 v28, 7, v28
    s_mov_b32 m0, 32256
    s_and_b32 s34, s22, 3
    s_cmp_eq_u32 s34, 2
    s_cselect_b64 exec, -1, 0
    buffer_load_dword v28, s[28:31], s91 offen lds
    s_mov_b64 exec, -1
    v_mul_f32 v12, s46, v90
    v_mul_f32 v13, s46, v91
    v_add_u32 v7, 79872, v7
    v_add_u32 v8, 79872, v8
    ds_read_b128 v[24:27], v7 offset:0
    v_exp_f32 v10, v10
    ds_read_b128 v[28:31], v8 offset:0
    v_exp_f32 v11, v11
    ds_read_b128 v[32:35], v7 offset:2048
    v_exp_f32 v12, v12
    ds_read_b128 v[36:39], v8 offset:2048
    v_exp_f32 v13, v13
    ds_read_b128 v[40:43], v7 offset:4096
    v_mul_f32 v14, v88, v92
    v_mul_f32 v15, v89, v93
    ds_read_b128 v[44:47], v8 offset:4096
    v_mul_f32 v16, v90, v94
    v_mul_f32 v17, v91, v95
    v_add_f32 v10, 1.0, v10
    v_add_f32 v11, 1.0, v11
    v_add_f32 v12, 1.0, v12
    v_add_f32 v13, 1.0, v13
    v_rcp_f32 v10, v10
    v_rcp_f32 v11, v11
    s_waitcnt vmcnt(6) lgkmcnt(0)
    s_barrier
    s_setprio 1
    v_mfma_f32_16x16x32_bf16 v[64:67], v[112:115], v[24:27], 0
    v_rcp_f32 v12, v12
    v_mfma_f32_16x16x32_bf16 v[68:71], v[184:187], v[24:27], 0
    ds_read_b128 v[24:27], v7 offset:6144
    v_mfma_f32_16x16x32_bf16 v[64:67], v[116:119], v[28:31], v[64:67]
    v_rcp_f32 v13, v13
    v_mfma_f32_16x16x32_bf16 v[68:71], v[188:191], v[28:31], v[68:71]
    ds_read_b128 v[28:31], v8 offset:6144
    v_mfma_f32_16x16x32_bf16 v[64:67], v[120:123], v[32:35], v[64:67]
    v_mul_f32 v14, v14, v10
    v_mul_f32 v15, v15, v11
    v_mfma_f32_16x16x32_bf16 v[68:71], v[192:195], v[32:35], v[68:71]
    ds_read_b128 v[32:35], v7 offset:8192
    v_mfma_f32_16x16x32_bf16 v[64:67], v[124:127], v[36:39], v[64:67]
    v_mul_f32 v16, v16, v12
    v_mul_f32 v17, v17, v13
    v_mfma_f32_16x16x32_bf16 v[68:71], v[196:199], v[36:39], v[68:71]
    ds_read_b128 v[36:39], v8 offset:8192
    v_mfma_f32_16x16x32_bf16 v[64:67], v[128:131], v[40:43], v[64:67]
    v_cvt_pk_bf16_f32 v20, v14, v15
    v_cvt_pk_bf16_f32 v21, v16, v17
    v_mfma_f32_16x16x32_bf16 v[68:71], v[200:203], v[40:43], v[68:71]
    ds_read_b128 v[40:43], v7 offset:10240
    v_mfma_f32_16x16x32_bf16 v[64:67], v[132:135], v[44:47], v[64:67]
    s_nop 0
    v_permlane16_swap_b32 v18, v20
    v_permlane16_swap_b32 v19, v21
    s_mov_b32 s47, s52
    s_nop 0
    buffer_store_dwordx4 v[18:21], v23, s[16:19], s47 offen sc0 sc1
    s_add_u32 s47, s47, 4096
    v_mfma_f32_16x16x32_bf16 v[68:71], v[204:207], v[44:47], v[68:71]
    ds_read_b128 v[44:47], v8 offset:10240
    s_waitcnt lgkmcnt(5)
    v_mfma_f32_16x16x32_bf16 v[64:67], v[136:139], v[24:27], v[64:67]
    v_mul_f32 v10, s46, v96
    v_mul_f32 v11, s46, v97
    v_mfma_f32_16x16x32_bf16 v[68:71], v[208:211], v[24:27], v[68:71]
    ds_read_b128 v[24:27], v7 offset:12288
    s_waitcnt lgkmcnt(5)
    v_mfma_f32_16x16x32_bf16 v[64:67], v[140:143], v[28:31], v[64:67]
    v_mul_f32 v12, s46, v98
    v_mul_f32 v13, s46, v99
    v_mfma_f32_16x16x32_bf16 v[68:71], v[212:215], v[28:31], v[68:71]
    ds_read_b128 v[28:31], v8 offset:12288
    s_waitcnt lgkmcnt(5)
    v_mfma_f32_16x16x32_bf16 v[64:67], v[144:147], v[32:35], v[64:67]
    v_exp_f32 v10, v10
    v_mfma_f32_16x16x32_bf16 v[68:71], v[216:219], v[32:35], v[68:71]
    ds_read_b128 v[32:35], v7 offset:14336
    s_waitcnt lgkmcnt(5)
    v_mfma_f32_16x16x32_bf16 v[64:67], v[148:151], v[36:39], v[64:67]
    v_exp_f32 v11, v11
    v_mfma_f32_16x16x32_bf16 v[68:71], v[220:223], v[36:39], v[68:71]
    ds_read_b128 v[36:39], v8 offset:14336
    s_waitcnt lgkmcnt(5)
    v_mfma_f32_16x16x32_bf16 v[64:67], v[152:155], v[40:43], v[64:67]
    v_exp_f32 v12, v12
    v_mfma_f32_16x16x32_bf16 v[68:71], v[224:227], v[40:43], v[68:71]
    ds_read_b128 v[40:43], v7 offset:16384
    s_waitcnt lgkmcnt(5)
    v_mfma_f32_16x16x32_bf16 v[64:67], v[156:159], v[44:47], v[64:67]
    v_exp_f32 v13, v13
    v_mfma_f32_16x16x32_bf16 v[68:71], v[228:231], v[44:47], v[68:71]
    ds_read_b128 v[44:47], v8 offset:16384
    s_waitcnt lgkmcnt(5)
    v_mfma_f32_16x16x32_bf16 v[64:67], v[160:163], v[24:27], v[64:67]
    v_mul_f32 v14, v96, v100
    v_mul_f32 v15, v97, v101
    v_mfma_f32_16x16x32_bf16 v[68:71], v[232:235], v[24:27], v[68:71]
    s_waitcnt lgkmcnt(4)
    v_mfma_f32_16x16x32_bf16 v[64:67], v[164:167], v[28:31], v[64:67]
    v_mul_f32 v16, v98, v102
    v_mul_f32 v17, v99, v103
    v_mfma_f32_16x16x32_bf16 v[68:71], v[236:239], v[28:31], v[68:71]
    s_waitcnt lgkmcnt(3)
    v_mfma_f32_16x16x32_bf16 v[64:67], v[168:171], v[32:35], v[64:67]
    v_add_f32 v10, 1.0, v10
    v_add_f32 v11, 1.0, v11
    v_mfma_f32_16x16x32_bf16 v[68:71], v[240:243], v[32:35], v[68:71]
    s_waitcnt lgkmcnt(2)
    v_mfma_f32_16x16x32_bf16 v[64:67], v[172:175], v[36:39], v[64:67]
    v_add_f32 v12, 1.0, v12
    v_add_f32 v13, 1.0, v13
    v_mfma_f32_16x16x32_bf16 v[68:71], v[244:247], v[36:39], v[68:71]
    s_waitcnt lgkmcnt(1)
    v_mfma_f32_16x16x32_bf16 v[64:67], v[176:179], v[40:43], v[64:67]
    v_rcp_f32 v10, v10
    v_mfma_f32_16x16x32_bf16 v[68:71], v[248:251], v[40:43], v[68:71]
    s_waitcnt lgkmcnt(0)
    s_setprio 3
    s_barrier
    v_mfma_f32_16x16x32_bf16 v[64:67], v[180:183], v[44:47], v[64:67]
    v_rcp_f32 v11, v11
    v_mfma_f32_16x16x32_bf16 v[68:71], v[252:255], v[44:47], v[68:71]
    s_setprio 0
    s_add_u32 m0, s42, 126976
    s_add_u32 s45, s44, 36864
    buffer_load_dwordx4 v3, s[8:11], s45 offen lds
    buffer_load_dwordx4 v4, s[8:11], s45 offen offset:1024 lds
    s_add_u32 m0, s43, 126976
    s_add_u32 s45, s68, 36864
    s_mov_b64 exec, 0xffff
    buffer_load_dwordx4 v5, s[8:11], s45 offen lds
    s_mov_b64 exec, -1
    v_and_b32 v28, 63, v0
    v_lshlrev_b32 v28, 7, v28
    s_mov_b32 m0, 32256
    s_and_b32 s34, s22, 3
    s_cmp_eq_u32 s34, 3
    s_cselect_b64 exec, -1, 0
    buffer_load_dword v28, s[28:31], s91 offen lds
    s_mov_b64 exec, -1
    v_rcp_f32 v12, v12
    v_add_u32 v7, 4294912000, v7
    v_add_u32 v8, 4294912000, v8
    ds_read_b128 v[24:27], v7 offset:0
    v_rcp_f32 v13, v13
    ds_read_b128 v[28:31], v8 offset:0
    v_mul_f32 v14, v14, v10
    v_mul_f32 v15, v15, v11
    ds_read_b128 v[32:35], v7 offset:2048
    v_mul_f32 v16, v16, v12
    v_mul_f32 v17, v17, v13
    ds_read_b128 v[36:39], v8 offset:2048
    v_cvt_pk_bf16_f32 v18, v14, v15
    v_cvt_pk_bf16_f32 v19, v16, v17
    ds_read_b128 v[40:43], v7 offset:4096
    v_bfe_u32 v10, v0, 4, 1
    v_mul_u32_u24 v10, 2040, v10
    ds_read_b128 v[44:47], v8 offset:4096
    v_sub_u32 v10, v23, v10
    s_mov_b32 s47, s53
    buffer_store_dwordx2 v[18:19], v10, s[16:19], s47 offen sc0 sc1
    s_nop 0
    v_mul_f32 v10, s46, v104
    v_mul_f32 v11, s46, v105
    v_mul_f32 v12, s46, v106
    v_mul_f32 v13, s46, v107
    v_exp_f32 v10, v10
    v_exp_f32 v11, v11
    s_waitcnt vmcnt(7) lgkmcnt(0)
    s_barrier
    s_setprio 1
    v_mfma_f32_16x16x32_bf16 v[72:75], v[112:115], v[24:27], 0
    v_exp_f32 v12, v12
    v_mfma_f32_16x16x32_bf16 v[76:79], v[184:187], v[24:27], 0
    ds_read_b128 v[24:27], v7 offset:6144
    v_mfma_f32_16x16x32_bf16 v[72:75], v[116:119], v[28:31], v[72:75]
    v_exp_f32 v13, v13
    v_mfma_f32_16x16x32_bf16 v[76:79], v[188:191], v[28:31], v[76:79]
    ds_read_b128 v[28:31], v8 offset:6144
    v_mfma_f32_16x16x32_bf16 v[72:75], v[120:123], v[32:35], v[72:75]
    v_mul_f32 v14, v104, v108
    v_mul_f32 v15, v105, v109
    v_mfma_f32_16x16x32_bf16 v[76:79], v[192:195], v[32:35], v[76:79]
    ds_read_b128 v[32:35], v7 offset:8192
    v_mfma_f32_16x16x32_bf16 v[72:75], v[124:127], v[36:39], v[72:75]
    v_mul_f32 v16, v106, v110
    v_mul_f32 v17, v107, v111
    v_mfma_f32_16x16x32_bf16 v[76:79], v[196:199], v[36:39], v[76:79]
    ds_read_b128 v[36:39], v8 offset:8192
    v_mfma_f32_16x16x32_bf16 v[72:75], v[128:131], v[40:43], v[72:75]
    v_add_f32 v10, 1.0, v10
    v_add_f32 v11, 1.0, v11
    v_mfma_f32_16x16x32_bf16 v[76:79], v[200:203], v[40:43], v[76:79]
    ds_read_b128 v[40:43], v7 offset:10240
    v_mfma_f32_16x16x32_bf16 v[72:75], v[132:135], v[44:47], v[72:75]
    v_add_f32 v12, 1.0, v12
    v_add_f32 v13, 1.0, v13
    v_mfma_f32_16x16x32_bf16 v[76:79], v[204:207], v[44:47], v[76:79]
    ds_read_b128 v[44:47], v8 offset:10240
    s_waitcnt lgkmcnt(5)
    v_mfma_f32_16x16x32_bf16 v[72:75], v[136:139], v[24:27], v[72:75]
    v_rcp_f32 v10, v10
    v_mfma_f32_16x16x32_bf16 v[76:79], v[208:211], v[24:27], v[76:79]
    ds_read_b128 v[24:27], v7 offset:12288
    s_waitcnt lgkmcnt(5)
    v_mfma_f32_16x16x32_bf16 v[72:75], v[140:143], v[28:31], v[72:75]
    v_rcp_f32 v11, v11
    v_mfma_f32_16x16x32_bf16 v[76:79], v[212:215], v[28:31], v[76:79]
    ds_read_b128 v[28:31], v8 offset:12288
    s_waitcnt lgkmcnt(5)
    v_mfma_f32_16x16x32_bf16 v[72:75], v[144:147], v[32:35], v[72:75]
    v_rcp_f32 v12, v12
    v_mfma_f32_16x16x32_bf16 v[76:79], v[216:219], v[32:35], v[76:79]
    ds_read_b128 v[32:35], v7 offset:14336
    s_waitcnt lgkmcnt(5)
    v_mfma_f32_16x16x32_bf16 v[72:75], v[148:151], v[36:39], v[72:75]
    v_rcp_f32 v13, v13
    v_mfma_f32_16x16x32_bf16 v[76:79], v[220:223], v[36:39], v[76:79]
    ds_read_b128 v[36:39], v8 offset:14336
    s_waitcnt lgkmcnt(5)
    v_mfma_f32_16x16x32_bf16 v[72:75], v[152:155], v[40:43], v[72:75]
    v_mul_f32 v14, v14, v10
    v_mul_f32 v15, v15, v11
    v_mfma_f32_16x16x32_bf16 v[76:79], v[224:227], v[40:43], v[76:79]
    ds_read_b128 v[40:43], v7 offset:16384
    s_waitcnt lgkmcnt(5)
    v_mfma_f32_16x16x32_bf16 v[72:75], v[156:159], v[44:47], v[72:75]
    v_mul_f32 v16, v16, v12
    v_mul_f32 v17, v17, v13
    v_mfma_f32_16x16x32_bf16 v[76:79], v[228:231], v[44:47], v[76:79]
    ds_read_b128 v[44:47], v8 offset:16384
    s_waitcnt lgkmcnt(5)
    v_mfma_f32_16x16x32_bf16 v[72:75], v[160:163], v[24:27], v[72:75]
    v_cvt_pk_bf16_f32 v18, v14, v15
    v_cvt_pk_bf16_f32 v19, v16, v17
    v_mfma_f32_16x16x32_bf16 v[76:79], v[232:235], v[24:27], v[76:79]
    s_waitcnt lgkmcnt(4)
    v_mfma_f32_16x16x32_bf16 v[72:75], v[164:167], v[28:31], v[72:75]
    v_mul_f32 v10, s46, v48
    v_mul_f32 v11, s46, v49
    v_mfma_f32_16x16x32_bf16 v[76:79], v[236:239], v[28:31], v[76:79]
    s_waitcnt lgkmcnt(3)
    v_mfma_f32_16x16x32_bf16 v[72:75], v[168:171], v[32:35], v[72:75]
    v_mul_f32 v12, s46, v50
    v_mul_f32 v13, s46, v51
    v_mfma_f32_16x16x32_bf16 v[76:79], v[240:243], v[32:35], v[76:79]
    s_waitcnt lgkmcnt(2)
    v_mfma_f32_16x16x32_bf16 v[72:75], v[172:175], v[36:39], v[72:75]
    v_exp_f32 v10, v10
    v_mfma_f32_16x16x32_bf16 v[76:79], v[244:247], v[36:39], v[76:79]
    s_waitcnt lgkmcnt(1)
    v_mfma_f32_16x16x32_bf16 v[72:75], v[176:179], v[40:43], v[72:75]
    v_exp_f32 v11, v11
    v_mfma_f32_16x16x32_bf16 v[76:79], v[248:251], v[40:43], v[76:79]
    s_waitcnt lgkmcnt(0)
    s_setprio 3
    s_barrier
    v_mfma_f32_16x16x32_bf16 v[72:75], v[180:183], v[44:47], v[72:75]
    v_exp_f32 v12, v12
    v_mfma_f32_16x16x32_bf16 v[76:79], v[252:255], v[44:47], v[76:79]
    s_setprio 0
    s_add_u32 m0, s42, 145408
    s_add_u32 s45, s44, 55296
    buffer_load_dwordx4 v3, s[8:11], s45 offen lds
    v_mov_b32 v26, 1
    v_lshlrev_b32 v27, 2, v0
    v_and_b32 v27, 127, v27
    s_mov_b64 exec, s[100:101]
    buffer_store_dword v26, v27, s[92:95], s2 offen sc0 sc1
    s_mov_b64 exec, -1
    buffer_load_dwordx4 v4, s[8:11], s45 offen offset:1024 lds
    v_exp_f32 v13, v13
    ds_read_b128 v[24:27], v7 offset:18432
    v_mul_f32 v14, v48, v52
    v_mul_f32 v15, v49, v53
    ds_read_b128 v[28:31], v8 offset:18432
    v_mul_f32 v16, v50, v54
    v_mul_f32 v17, v51, v55
    ds_read_b128 v[32:35], v7 offset:20480
    v_add_f32 v10, 1.0, v10
    v_add_f32 v11, 1.0, v11
    ds_read_b128 v[36:39], v8 offset:20480
    v_add_f32 v12, 1.0, v12
    s_add_u32 m0, s43, 145408
    s_add_u32 s45, s68, 55296
    s_mov_b64 exec, 0xffff
    buffer_load_dwordx4 v5, s[8:11], s45 offen lds
    s_mov_b64 exec, -1
    v_add_f32 v13, 1.0, v13
    ds_read_b128 v[40:43], v7 offset:22528
    v_rcp_f32 v10, v10
    ds_read_b128 v[44:47], v8 offset:22528
    v_rcp_f32 v11, v11
    v_rcp_f32 v12, v12
    v_rcp_f32 v13, v13
    v_mul_f32 v14, v14, v10
    v_mul_f32 v15, v15, v11
    v_mul_f32 v16, v16, v12
    v_mul_f32 v17, v17, v13
    s_waitcnt vmcnt(6) lgkmcnt(0)
    s_barrier
    s_setprio 1
    v_mfma_f32_16x16x32_bf16 v[80:83], v[112:115], v[24:27], 0
    v_cvt_pk_bf16_f32 v20, v14, v15
    v_cvt_pk_bf16_f32 v21, v16, v17
    v_mfma_f32_16x16x32_bf16 v[84:87], v[184:187], v[24:27], 0
    ds_read_b128 v[24:27], v7 offset:24576
    v_mfma_f32_16x16x32_bf16 v[80:83], v[116:119], v[28:31], v[80:83]
    s_nop 0
    v_permlane16_swap_b32 v18, v20
    v_permlane16_swap_b32 v19, v21
    s_mov_b32 s47, s50
    s_nop 0
    buffer_store_dwordx4 v[18:21], v23, s[16:19], s47 offen sc0 sc1
    s_add_u32 s47, s47, 4096
    v_mfma_f32_16x16x32_bf16 v[84:87], v[188:191], v[28:31], v[84:87]
    ds_read_b128 v[28:31], v8 offset:24576
    v_mfma_f32_16x16x32_bf16 v[80:83], v[120:123], v[32:35], v[80:83]
    v_mul_f32 v10, s46, v56
    v_mul_f32 v11, s46, v57
    v_mfma_f32_16x16x32_bf16 v[84:87], v[192:195], v[32:35], v[84:87]
    ds_read_b128 v[32:35], v7 offset:26624
    v_mfma_f32_16x16x32_bf16 v[80:83], v[124:127], v[36:39], v[80:83]
    v_mul_f32 v12, s46, v58
    v_mul_f32 v13, s46, v59
    v_mfma_f32_16x16x32_bf16 v[84:87], v[196:199], v[36:39], v[84:87]
    ds_read_b128 v[36:39], v8 offset:26624
    v_mfma_f32_16x16x32_bf16 v[80:83], v[128:131], v[40:43], v[80:83]
    v_exp_f32 v10, v10
    v_mfma_f32_16x16x32_bf16 v[84:87], v[200:203], v[40:43], v[84:87]
    ds_read_b128 v[40:43], v7 offset:28672
    v_mfma_f32_16x16x32_bf16 v[80:83], v[132:135], v[44:47], v[80:83]
    v_exp_f32 v11, v11
    v_mfma_f32_16x16x32_bf16 v[84:87], v[204:207], v[44:47], v[84:87]
    ds_read_b128 v[44:47], v8 offset:28672
    s_waitcnt lgkmcnt(5)
    v_mfma_f32_16x16x32_bf16 v[80:83], v[136:139], v[24:27], v[80:83]
    v_exp_f32 v12, v12
    v_mfma_f32_16x16x32_bf16 v[84:87], v[208:211], v[24:27], v[84:87]
    ds_read_b128 v[24:27], v7 offset:30720
    s_waitcnt lgkmcnt(5)
    v_mfma_f32_16x16x32_bf16 v[80:83], v[140:143], v[28:31], v[80:83]
    v_exp_f32 v13, v13
    v_mfma_f32_16x16x32_bf16 v[84:87], v[212:215], v[28:31], v[84:87]
    ds_read_b128 v[28:31], v8 offset:30720
    s_waitcnt lgkmcnt(5)
    v_mfma_f32_16x16x32_bf16 v[80:83], v[144:147], v[32:35], v[80:83]
    v_mul_f32 v14, v56, v60
    v_mul_f32 v15, v57, v61
    v_mfma_f32_16x16x32_bf16 v[84:87], v[216:219], v[32:35], v[84:87]
    ds_read_b128 v[32:35], v7 offset:32768
    s_waitcnt lgkmcnt(5)
    v_mfma_f32_16x16x32_bf16 v[80:83], v[148:151], v[36:39], v[80:83]
    v_mul_f32 v16, v58, v62
    v_mul_f32 v17, v59, v63
    v_mfma_f32_16x16x32_bf16 v[84:87], v[220:223], v[36:39], v[84:87]
    ds_read_b128 v[36:39], v8 offset:32768
    s_waitcnt lgkmcnt(5)
    v_mfma_f32_16x16x32_bf16 v[80:83], v[152:155], v[40:43], v[80:83]
    v_add_f32 v10, 1.0, v10
    v_add_f32 v11, 1.0, v11
    v_mfma_f32_16x16x32_bf16 v[84:87], v[224:227], v[40:43], v[84:87]
    ds_read_b128 v[40:43], v7 offset:34816
    s_waitcnt lgkmcnt(5)
    v_mfma_f32_16x16x32_bf16 v[80:83], v[156:159], v[44:47], v[80:83]
    v_add_f32 v12, 1.0, v12
    v_add_f32 v13, 1.0, v13
    v_mfma_f32_16x16x32_bf16 v[84:87], v[228:231], v[44:47], v[84:87]
    ds_read_b128 v[44:47], v8 offset:34816
    s_waitcnt lgkmcnt(5)
    v_mfma_f32_16x16x32_bf16 v[80:83], v[160:163], v[24:27], v[80:83]
    v_rcp_f32 v10, v10
    v_mfma_f32_16x16x32_bf16 v[84:87], v[232:235], v[24:27], v[84:87]
    s_waitcnt lgkmcnt(4)
    v_mfma_f32_16x16x32_bf16 v[80:83], v[164:167], v[28:31], v[80:83]
    v_rcp_f32 v11, v11
    v_mfma_f32_16x16x32_bf16 v[84:87], v[236:239], v[28:31], v[84:87]
    s_waitcnt lgkmcnt(3)
    v_mfma_f32_16x16x32_bf16 v[80:83], v[168:171], v[32:35], v[80:83]
    v_rcp_f32 v12, v12
    v_mfma_f32_16x16x32_bf16 v[84:87], v[240:243], v[32:35], v[84:87]
    s_waitcnt lgkmcnt(2)
    v_mfma_f32_16x16x32_bf16 v[80:83], v[172:175], v[36:39], v[80:83]
    v_rcp_f32 v13, v13
    v_mfma_f32_16x16x32_bf16 v[84:87], v[244:247], v[36:39], v[84:87]
    s_waitcnt lgkmcnt(1)
    v_mfma_f32_16x16x32_bf16 v[80:83], v[176:179], v[40:43], v[80:83]
    v_mul_f32 v14, v14, v10
    v_mul_f32 v15, v15, v11
    v_mfma_f32_16x16x32_bf16 v[84:87], v[248:251], v[40:43], v[84:87]
    s_waitcnt lgkmcnt(0)
    s_setprio 3
    s_barrier
    v_mfma_f32_16x16x32_bf16 v[80:83], v[180:183], v[44:47], v[80:83]
    v_mul_f32 v16, v16, v12
    v_mul_f32 v17, v17, v13
    v_mfma_f32_16x16x32_bf16 v[84:87], v[252:255], v[44:47], v[84:87]
    s_setprio 0
    s_mul_i32 s44, s90, 9
    s_add_u32 s68, s44, s49
    s_add_u32 s44, s44, s63
    s_add_u32 m0, s42, 90112
    s_add_u32 s45, s44, 0
    buffer_load_dwordx4 v3, s[8:11], s45 offen lds
    buffer_load_dwordx4 v4, s[8:11], s45 offen offset:1024 lds
    v_cvt_pk_bf16_f32 v18, v14, v15
    v_cvt_pk_bf16_f32 v19, v16, v17
    ds_read_b128 v[24:27], v7 offset:36864
    v_mul_f32 v10, s46, v64
    v_mul_f32 v11, s46, v65
    ds_read_b128 v[28:31], v8 offset:36864
    v_mul_f32 v12, s46, v66
    v_mul_f32 v13, s46, v67
    ds_read_b128 v[32:35], v7 offset:38912
    v_exp_f32 v10, v10
    ds_read_b128 v[36:39], v8 offset:38912
    v_exp_f32 v11, v11
    s_add_u32 m0, s43, 90112
    s_add_u32 s45, s68, 0
    s_mov_b64 exec, 0xffff
    buffer_load_dwordx4 v5, s[8:11], s45 offen lds
    s_mov_b64 exec, -1
    v_exp_f32 v12, v12
    ds_read_b128 v[40:43], v7 offset:40960
    v_exp_f32 v13, v13
    ds_read_b128 v[44:47], v8 offset:40960
    v_mul_f32 v14, v64, v68
    v_mul_f32 v15, v65, v69
    v_mul_f32 v16, v66, v70
    v_mul_f32 v17, v67, v71
    v_add_f32 v10, 1.0, v10
    v_add_f32 v11, 1.0, v11
    s_waitcnt vmcnt(4) lgkmcnt(0)
    s_barrier
    s_setprio 1
    v_mfma_f32_16x16x32_bf16 v[88:91], v[112:115], v[24:27], 0
    v_add_f32 v12, 1.0, v12
    v_add_f32 v13, 1.0, v13
    v_mfma_f32_16x16x32_bf16 v[92:95], v[184:187], v[24:27], 0
    ds_read_b128 v[24:27], v7 offset:43008
    v_mfma_f32_16x16x32_bf16 v[88:91], v[116:119], v[28:31], v[88:91]
    v_rcp_f32 v10, v10
    v_mfma_f32_16x16x32_bf16 v[92:95], v[188:191], v[28:31], v[92:95]
    ds_read_b128 v[28:31], v8 offset:43008
    v_mfma_f32_16x16x32_bf16 v[88:91], v[120:123], v[32:35], v[88:91]
    v_rcp_f32 v11, v11
    v_mfma_f32_16x16x32_bf16 v[92:95], v[192:195], v[32:35], v[92:95]
    ds_read_b128 v[32:35], v7 offset:45056
    v_mfma_f32_16x16x32_bf16 v[88:91], v[124:127], v[36:39], v[88:91]
    v_rcp_f32 v12, v12
    v_mfma_f32_16x16x32_bf16 v[92:95], v[196:199], v[36:39], v[92:95]
    ds_read_b128 v[36:39], v8 offset:45056
    v_mfma_f32_16x16x32_bf16 v[88:91], v[128:131], v[40:43], v[88:91]
    v_rcp_f32 v13, v13
    v_mfma_f32_16x16x32_bf16 v[92:95], v[200:203], v[40:43], v[92:95]
    ds_read_b128 v[40:43], v7 offset:47104
    v_mfma_f32_16x16x32_bf16 v[88:91], v[132:135], v[44:47], v[88:91]
    v_mul_f32 v14, v14, v10
    v_mul_f32 v15, v15, v11
    v_mfma_f32_16x16x32_bf16 v[92:95], v[204:207], v[44:47], v[92:95]
    ds_read_b128 v[44:47], v8 offset:47104
    s_waitcnt lgkmcnt(5)
    v_mfma_f32_16x16x32_bf16 v[88:91], v[136:139], v[24:27], v[88:91]
    v_mul_f32 v16, v16, v12
    v_mul_f32 v17, v17, v13
    v_mfma_f32_16x16x32_bf16 v[92:95], v[208:211], v[24:27], v[92:95]
    ds_read_b128 v[24:27], v7 offset:49152
    s_waitcnt lgkmcnt(5)
    v_mfma_f32_16x16x32_bf16 v[88:91], v[140:143], v[28:31], v[88:91]
    v_cvt_pk_bf16_f32 v20, v14, v15
    v_cvt_pk_bf16_f32 v21, v16, v17
    v_mfma_f32_16x16x32_bf16 v[92:95], v[212:215], v[28:31], v[92:95]
    ds_read_b128 v[28:31], v8 offset:49152
    s_waitcnt lgkmcnt(5)
    v_mfma_f32_16x16x32_bf16 v[88:91], v[144:147], v[32:35], v[88:91]
    s_nop 0
    v_permlane16_swap_b32 v18, v20
    v_permlane16_swap_b32 v19, v21
    s_nop 0
    buffer_store_dwordx4 v[18:21], v23, s[16:19], s47 offen sc0 sc1
    s_add_u32 s47, s47, 4096
    v_mfma_f32_16x16x32_bf16 v[92:95], v[216:219], v[32:35], v[92:95]
    ds_read_b128 v[32:35], v7 offset:51200
    s_waitcnt lgkmcnt(5)
    v_mfma_f32_16x16x32_bf16 v[88:91], v[148:151], v[36:39], v[88:91]
    v_mul_f32 v10, s46, v72
    v_mul_f32 v11, s46, v73
    v_mfma_f32_16x16x32_bf16 v[92:95], v[220:223], v[36:39], v[92:95]
    ds_read_b128 v[36:39], v8 offset:51200
    s_waitcnt lgkmcnt(5)
    v_mfma_f32_16x16x32_bf16 v[88:91], v[152:155], v[40:43], v[88:91]
    v_mul_f32 v12, s46, v74
    v_mul_f32 v13, s46, v75
    v_mfma_f32_16x16x32_bf16 v[92:95], v[224:227], v[40:43], v[92:95]
    ds_read_b128 v[40:43], v7 offset:53248
    s_waitcnt lgkmcnt(5)
    v_mfma_f32_16x16x32_bf16 v[88:91], v[156:159], v[44:47], v[88:91]
    v_exp_f32 v10, v10
    v_mfma_f32_16x16x32_bf16 v[92:95], v[228:231], v[44:47], v[92:95]
    ds_read_b128 v[44:47], v8 offset:53248
    s_waitcnt lgkmcnt(5)
    v_mfma_f32_16x16x32_bf16 v[88:91], v[160:163], v[24:27], v[88:91]
    v_exp_f32 v11, v11
    v_mfma_f32_16x16x32_bf16 v[92:95], v[232:235], v[24:27], v[92:95]
    s_waitcnt lgkmcnt(4)
    v_mfma_f32_16x16x32_bf16 v[88:91], v[164:167], v[28:31], v[88:91]
    v_exp_f32 v12, v12
    v_mfma_f32_16x16x32_bf16 v[92:95], v[236:239], v[28:31], v[92:95]
    s_waitcnt lgkmcnt(3)
    v_mfma_f32_16x16x32_bf16 v[88:91], v[168:171], v[32:35], v[88:91]
    v_exp_f32 v13, v13
    v_mfma_f32_16x16x32_bf16 v[92:95], v[240:243], v[32:35], v[92:95]
    s_waitcnt lgkmcnt(2)
    v_mfma_f32_16x16x32_bf16 v[88:91], v[172:175], v[36:39], v[88:91]
    v_mul_f32 v14, v72, v76
    v_mul_f32 v15, v73, v77
    v_mfma_f32_16x16x32_bf16 v[92:95], v[244:247], v[36:39], v[92:95]
    s_waitcnt lgkmcnt(1)
    v_mfma_f32_16x16x32_bf16 v[88:91], v[176:179], v[40:43], v[88:91]
    v_mul_f32 v16, v74, v78
    v_mul_f32 v17, v75, v79
    v_mfma_f32_16x16x32_bf16 v[92:95], v[248:251], v[40:43], v[92:95]
    s_waitcnt lgkmcnt(0)
    s_setprio 3
    s_barrier
    v_mfma_f32_16x16x32_bf16 v[88:91], v[180:183], v[44:47], v[88:91]
    v_add_f32 v10, 1.0, v10
    v_add_f32 v11, 1.0, v11
    v_mfma_f32_16x16x32_bf16 v[92:95], v[252:255], v[44:47], v[92:95]
    s_setprio 0
    s_add_u32 m0, s42, 108544
    s_add_u32 s45, s44, 18432
    buffer_load_dwordx4 v3, s[8:11], s45 offen lds
    v_mov_b32 v26, 5
    v_lshlrev_b32 v27, 2, v0
    v_and_b32 v27, 127, v27
    s_mov_b64 exec, s[100:101]
    buffer_store_dword v26, v27, s[92:95], s2 offen sc0 sc1
    s_mov_b64 exec, -1
    buffer_load_dwordx4 v4, s[8:11], s45 offen offset:1024 lds
    v_add_f32 v12, 1.0, v12
    v_add_f32 v13, 1.0, v13
    v_add_u32 v7, 55296, v7
    v_add_u32 v8, 55296, v8
    ds_read_b128 v[24:27], v7 offset:0
    v_rcp_f32 v10, v10
    ds_read_b128 v[28:31], v8 offset:0
    v_rcp_f32 v11, v11
    ds_read_b128 v[32:35], v7 offset:2048
    v_rcp_f32 v12, v12
    s_add_u32 m0, s43, 108544
    s_add_u32 s45, s68, 18432
    s_mov_b64 exec, 0xffff
    buffer_load_dwordx4 v5, s[8:11], s45 offen lds
    s_mov_b64 exec, -1
    v_rcp_f32 v13, v13
    ds_read_b128 v[36:39], v8 offset:2048
    v_mul_f32 v14, v14, v10
    v_mul_f32 v15, v15, v11
    ds_read_b128 v[40:43], v7 offset:4096
    v_mul_f32 v16, v16, v12
    v_mul_f32 v17, v17, v13
    ds_read_b128 v[44:47], v8 offset:4096
    v_cvt_pk_bf16_f32 v18, v14, v15
    v_cvt_pk_bf16_f32 v19, v16, v17
    v_mul_f32 v10, s46, v80
    v_mul_f32 v11, s46, v81
    v_mul_f32 v12, s46, v82
    s_waitcnt vmcnt(5) lgkmcnt(0)
    s_barrier
    s_setprio 1
    v_mfma_f32_16x16x32_bf16 v[96:99], v[112:115], v[24:27], 0
    v_mul_f32 v13, s46, v83
    v_mfma_f32_16x16x32_bf16 v[100:103], v[184:187], v[24:27], 0
    ds_read_b128 v[24:27], v7 offset:6144
    v_mfma_f32_16x16x32_bf16 v[96:99], v[116:119], v[28:31], v[96:99]
    v_exp_f32 v10, v10
    v_mfma_f32_16x16x32_bf16 v[100:103], v[188:191], v[28:31], v[100:103]
    ds_read_b128 v[28:31], v8 offset:6144
    v_mfma_f32_16x16x32_bf16 v[96:99], v[120:123], v[32:35], v[96:99]
    v_exp_f32 v11, v11
    v_mfma_f32_16x16x32_bf16 v[100:103], v[192:195], v[32:35], v[100:103]
    ds_read_b128 v[32:35], v7 offset:8192
    v_mfma_f32_16x16x32_bf16 v[96:99], v[124:127], v[36:39], v[96:99]
    v_exp_f32 v12, v12
    v_mfma_f32_16x16x32_bf16 v[100:103], v[196:199], v[36:39], v[100:103]
    ds_read_b128 v[36:39], v8 offset:8192
    v_mfma_f32_16x16x32_bf16 v[96:99], v[128:131], v[40:43], v[96:99]
    v_exp_f32 v13, v13
    v_mfma_f32_16x16x32_bf16 v[100:103], v[200:203], v[40:43], v[100:103]
    ds_read_b128 v[40:43], v7 offset:10240
    v_mfma_f32_16x16x32_bf16 v[96:99], v[132:135], v[44:47], v[96:99]
    v_mul_f32 v14, v80, v84
    v_mul_f32 v15, v81, v85
    v_mfma_f32_16x16x32_bf16 v[100:103], v[204:207], v[44:47], v[100:103]
    ds_read_b128 v[44:47], v8 offset:10240
    s_waitcnt lgkmcnt(5)
    v_mfma_f32_16x16x32_bf16 v[96:99], v[136:139], v[24:27], v[96:99]
    v_mul_f32 v16, v82, v86
    v_mul_f32 v17, v83, v87
    v_mfma_f32_16x16x32_bf16 v[100:103], v[208:211], v[24:27], v[100:103]
    ds_read_b128 v[24:27], v7 offset:12288
    s_waitcnt lgkmcnt(5)
    v_mfma_f32_16x16x32_bf16 v[96:99], v[140:143], v[28:31], v[96:99]
    v_add_f32 v10, 1.0, v10
    v_add_f32 v11, 1.0, v11
    v_mfma_f32_16x16x32_bf16 v[100:103], v[212:215], v[28:31], v[100:103]
    ds_read_b128 v[28:31], v8 offset:12288
    s_waitcnt lgkmcnt(5)
    v_mfma_f32_16x16x32_bf16 v[96:99], v[144:147], v[32:35], v[96:99]
    v_add_f32 v12, 1.0, v12
    v_add_f32 v13, 1.0, v13
    v_mfma_f32_16x16x32_bf16 v[100:103], v[216:219], v[32:35], v[100:103]
    ds_read_b128 v[32:35], v7 offset:14336
    s_waitcnt lgkmcnt(5)
    v_mfma_f32_16x16x32_bf16 v[96:99], v[148:151], v[36:39], v[96:99]
    v_rcp_f32 v10, v10
    v_mfma_f32_16x16x32_bf16 v[100:103], v[220:223], v[36:39], v[100:103]
    ds_read_b128 v[36:39], v8 offset:14336
    s_waitcnt lgkmcnt(5)
    v_mfma_f32_16x16x32_bf16 v[96:99], v[152:155], v[40:43], v[96:99]
    v_rcp_f32 v11, v11
    v_mfma_f32_16x16x32_bf16 v[100:103], v[224:227], v[40:43], v[100:103]
    ds_read_b128 v[40:43], v7 offset:16384
    s_waitcnt lgkmcnt(5)
    v_mfma_f32_16x16x32_bf16 v[96:99], v[156:159], v[44:47], v[96:99]
    v_rcp_f32 v12, v12
    v_mfma_f32_16x16x32_bf16 v[100:103], v[228:231], v[44:47], v[100:103]
    ds_read_b128 v[44:47], v8 offset:16384
    s_waitcnt lgkmcnt(5)
    v_mfma_f32_16x16x32_bf16 v[96:99], v[160:163], v[24:27], v[96:99]
    v_rcp_f32 v13, v13
    v_mfma_f32_16x16x32_bf16 v[100:103], v[232:235], v[24:27], v[100:103]
    s_waitcnt lgkmcnt(4)
    v_mfma_f32_16x16x32_bf16 v[96:99], v[164:167], v[28:31], v[96:99]
    v_mul_f32 v14, v14, v10
    v_mul_f32 v15, v15, v11
    v_mfma_f32_16x16x32_bf16 v[100:103], v[236:239], v[28:31], v[100:103]
    s_waitcnt lgkmcnt(3)
    v_mfma_f32_16x16x32_bf16 v[96:99], v[168:171], v[32:35], v[96:99]
    v_mul_f32 v16, v16, v12
    v_mul_f32 v17, v17, v13
    v_mfma_f32_16x16x32_bf16 v[100:103], v[240:243], v[32:35], v[100:103]
    s_waitcnt lgkmcnt(2)
    v_mfma_f32_16x16x32_bf16 v[96:99], v[172:175], v[36:39], v[96:99]
    v_cvt_pk_bf16_f32 v20, v14, v15
    v_cvt_pk_bf16_f32 v21, v16, v17
    v_mfma_f32_16x16x32_bf16 v[100:103], v[244:247], v[36:39], v[100:103]
    s_waitcnt lgkmcnt(1)
    v_mfma_f32_16x16x32_bf16 v[96:99], v[176:179], v[40:43], v[96:99]
    s_nop 0
    v_permlane16_swap_b32 v18, v20
    v_permlane16_swap_b32 v19, v21
    s_mov_b32 s47, s51
    s_nop 0
    buffer_store_dwordx4 v[18:21], v23, s[16:19], s47 offen sc0 sc1
    s_add_u32 s47, s47, 4096
    v_mfma_f32_16x16x32_bf16 v[100:103], v[248:251], v[40:43], v[100:103]
    s_waitcnt lgkmcnt(0)
    s_setprio 3
    s_barrier
    v_mfma_f32_16x16x32_bf16 v[96:99], v[180:183], v[44:47], v[96:99]
    v_mul_f32 v10, s46, v88
    v_mul_f32 v11, s46, v89
    v_mfma_f32_16x16x32_bf16 v[100:103], v[252:255], v[44:47], v[100:103]
    s_setprio 0
    s_add_u32 m0, s42, 126976
    s_add_u32 s45, s44, 36864
    buffer_load_dwordx4 v3, s[8:11], s45 offen lds
    buffer_load_dwordx4 v4, s[8:11], s45 offen offset:1024 lds
    v_mul_f32 v12, s46, v90
    v_mul_f32 v13, s46, v91
    v_add_u32 v7, 4294912000, v7
    v_add_u32 v8, 4294912000, v8
    ds_read_b128 v[24:27], v7 offset:0
    v_exp_f32 v10, v10
    s_add_u32 m0, s43, 126976
    s_add_u32 s45, s68, 36864
    s_mov_b64 exec, 0xffff
    buffer_load_dwordx4 v5, s[8:11], s45 offen lds
    s_mov_b64 exec, -1
    v_exp_f32 v11, v11
    ds_read_b128 v[28:31], v8 offset:0
    v_exp_f32 v12, v12
    s_and_b32 s3, s54, 15
    s_lshl_b32 s3, s3, 1
    s_add_u32 s3, s3, s33
    s_mul_i32 s3, s3, 73728
    s_add_u32 s3, s3, s62
    s_mul_i32 s21, s33, 40960
    s_add_u32 s21, s21, s41
    s_add_u32 m0, s21, 0
    s_nop 0
    buffer_load_dwordx4 v1, s[12:15], s3 offen offset:0 lds
    v_exp_f32 v13, v13
    buffer_load_dwordx4 v2, s[12:15], s3 offen offset:1024 lds
    v_mul_f32 v14, v88, v92
    ds_read_b128 v[32:35], v7 offset:2048
    v_mul_f32 v15, v89, v93
    v_mul_f32 v16, v90, v94
    buffer_load_dwordx4 v6, s[12:15], s3 offen offset:2048 lds
    v_mul_f32 v17, v91, v95
    ds_read_b128 v[36:39], v8 offset:2048
    v_add_f32 v10, 1.0, v10
    v_add_f32 v11, 1.0, v11
    ds_read_b128 v[40:43], v7 offset:4096
    v_add_f32 v12, 1.0, v12
    v_add_f32 v13, 1.0, v13
    ds_read_b128 v[44:47], v8 offset:4096
    s_waitcnt vmcnt(7) lgkmcnt(0)
    s_barrier
    s_setprio 1
    v_mfma_f32_16x16x32_bf16 v[104:107], v[112:115], v[24:27], 0
    v_rcp_f32 v10, v10
    v_mfma_f32_16x16x32_bf16 v[108:111], v[184:187], v[24:27], 0
    ds_read_b128 v[24:27], v7 offset:6144
    v_mfma_f32_16x16x32_bf16 v[104:107], v[116:119], v[28:31], v[104:107]
    v_rcp_f32 v11, v11
    v_mfma_f32_16x16x32_bf16 v[108:111], v[188:191], v[28:31], v[108:111]
    ds_read_b128 v[28:31], v8 offset:6144
    v_mfma_f32_16x16x32_bf16 v[104:107], v[120:123], v[32:35], v[104:107]
    v_rcp_f32 v12, v12
    v_mfma_f32_16x16x32_bf16 v[108:111], v[192:195], v[32:35], v[108:111]
    ds_read_b128 v[32:35], v7 offset:8192
    v_mfma_f32_16x16x32_bf16 v[104:107], v[124:127], v[36:39], v[104:107]
    v_rcp_f32 v13, v13
    v_mfma_f32_16x16x32_bf16 v[108:111], v[196:199], v[36:39], v[108:111]
    ds_read_b128 v[36:39], v8 offset:8192
    v_mfma_f32_16x16x32_bf16 v[104:107], v[128:131], v[40:43], v[104:107]
    v_mul_f32 v14, v14, v10
    v_mul_f32 v15, v15, v11
    v_mfma_f32_16x16x32_bf16 v[108:111], v[200:203], v[40:43], v[108:111]
    ds_read_b128 v[40:43], v7 offset:10240
    v_mfma_f32_16x16x32_bf16 v[104:107], v[132:135], v[44:47], v[104:107]
    v_mul_f32 v16, v16, v12
    v_mul_f32 v17, v17, v13
    v_mfma_f32_16x16x32_bf16 v[108:111], v[204:207], v[44:47], v[108:111]
    ds_read_b128 v[44:47], v8 offset:10240
    s_waitcnt lgkmcnt(5)
    v_mfma_f32_16x16x32_bf16 v[104:107], v[136:139], v[24:27], v[104:107]
    v_cvt_pk_bf16_f32 v18, v14, v15
    v_cvt_pk_bf16_f32 v19, v16, v17
    v_mfma_f32_16x16x32_bf16 v[108:111], v[208:211], v[24:27], v[108:111]
    ds_read_b128 v[24:27], v7 offset:12288
    s_waitcnt lgkmcnt(5)
    v_mfma_f32_16x16x32_bf16 v[104:107], v[140:143], v[28:31], v[104:107]
    v_mul_f32 v10, s46, v96
    v_mul_f32 v11, s46, v97
    v_mfma_f32_16x16x32_bf16 v[108:111], v[212:215], v[28:31], v[108:111]
    ds_read_b128 v[28:31], v8 offset:12288
    s_waitcnt lgkmcnt(5)
    v_mfma_f32_16x16x32_bf16 v[104:107], v[144:147], v[32:35], v[104:107]
    v_mul_f32 v12, s46, v98
    v_mul_f32 v13, s46, v99
    v_mfma_f32_16x16x32_bf16 v[108:111], v[216:219], v[32:35], v[108:111]
    ds_read_b128 v[32:35], v7 offset:14336
    s_waitcnt lgkmcnt(5)
    v_mfma_f32_16x16x32_bf16 v[104:107], v[148:151], v[36:39], v[104:107]
    v_exp_f32 v10, v10
    v_mfma_f32_16x16x32_bf16 v[108:111], v[220:223], v[36:39], v[108:111]
    ds_read_b128 v[36:39], v8 offset:14336
    s_waitcnt lgkmcnt(5)
    v_mfma_f32_16x16x32_bf16 v[104:107], v[152:155], v[40:43], v[104:107]
    v_exp_f32 v11, v11
    v_mfma_f32_16x16x32_bf16 v[108:111], v[224:227], v[40:43], v[108:111]
    ds_read_b128 v[40:43], v7 offset:16384
    s_waitcnt lgkmcnt(5)
    v_mfma_f32_16x16x32_bf16 v[104:107], v[156:159], v[44:47], v[104:107]
    v_exp_f32 v12, v12
    v_mfma_f32_16x16x32_bf16 v[108:111], v[228:231], v[44:47], v[108:111]
    ds_read_b128 v[44:47], v8 offset:16384
    s_waitcnt lgkmcnt(5)
    v_mfma_f32_16x16x32_bf16 v[104:107], v[160:163], v[24:27], v[104:107]
    v_exp_f32 v13, v13
    v_mfma_f32_16x16x32_bf16 v[108:111], v[232:235], v[24:27], v[108:111]
    s_waitcnt lgkmcnt(4)
    v_mfma_f32_16x16x32_bf16 v[104:107], v[164:167], v[28:31], v[104:107]
    v_mul_f32 v14, v96, v100
    v_mul_f32 v15, v97, v101
    v_mfma_f32_16x16x32_bf16 v[108:111], v[236:239], v[28:31], v[108:111]
    s_waitcnt lgkmcnt(3)
    v_mfma_f32_16x16x32_bf16 v[104:107], v[168:171], v[32:35], v[104:107]
    v_mul_f32 v16, v98, v102
    v_mul_f32 v17, v99, v103
    v_mfma_f32_16x16x32_bf16 v[108:111], v[240:243], v[32:35], v[108:111]
    s_waitcnt lgkmcnt(2)
    v_mfma_f32_16x16x32_bf16 v[104:107], v[172:175], v[36:39], v[104:107]
    v_add_f32 v10, 1.0, v10
    v_add_f32 v11, 1.0, v11
    v_mfma_f32_16x16x32_bf16 v[108:111], v[244:247], v[36:39], v[108:111]
    s_waitcnt lgkmcnt(1)
    v_mfma_f32_16x16x32_bf16 v[104:107], v[176:179], v[40:43], v[104:107]
    v_add_f32 v12, 1.0, v12
    v_add_f32 v13, 1.0, v13
    v_mfma_f32_16x16x32_bf16 v[108:111], v[248:251], v[40:43], v[108:111]
    s_waitcnt lgkmcnt(0)
    s_setprio 3
    s_barrier
    v_mfma_f32_16x16x32_bf16 v[104:107], v[180:183], v[44:47], v[104:107]
    v_rcp_f32 v10, v10
    v_mfma_f32_16x16x32_bf16 v[108:111], v[252:255], v[44:47], v[108:111]
    s_setprio 0
    s_add_u32 m0, s42, 145408
    s_add_u32 s45, s44, 55296
    buffer_load_dwordx4 v3, s[8:11], s45 offen lds
    v_mov_b32 v26, 7
    v_lshlrev_b32 v27, 2, v0
    v_and_b32 v27, 127, v27
    s_mov_b64 exec, s[100:101]
    buffer_store_dword v26, v27, s[92:95], s2 offen sc0 sc1
    s_mov_b64 exec, -1
    s_mov_b32 s67, 0
    s_andn2_b32 exec_lo, 0x70007, s76
    s_mov_b32 exec_hi, 0
    buffer_load_dword v9, v22, s[92:95], 0 offen sc0 sc1
    s_mov_b64 exec, -1
    buffer_load_dwordx4 v4, s[8:11], s45 offen offset:1024 lds
    v_rcp_f32 v11, v11
    ds_read_b128 v[24:27], v7 offset:18432
    v_rcp_f32 v12, v12
    s_add_u32 m0, s43, 145408
    s_add_u32 s45, s68, 55296
    s_mov_b64 exec, 0xffff
    buffer_load_dwordx4 v5, s[8:11], s45 offen lds
    s_mov_b64 exec, -1
    v_rcp_f32 v13, v13
    s_and_b32 s3, s54, 15
    s_lshl_b32 s3, s3, 1
    s_add_u32 s3, s3, s33
    s_mul_i32 s3, s3, 73728
    s_add_u32 s3, s3, s62
    s_mul_i32 s21, s33, 40960
    s_add_u32 s21, s21, s41
    s_add_u32 s3, s3, 18432
    s_add_u32 m0, s21, 6144
    s_nop 0
    buffer_load_dwordx4 v1, s[12:15], s3 offen offset:0 lds
    v_mul_f32 v14, v14, v10
    ds_read_b128 v[28:31], v8 offset:18432
    v_mul_f32 v15, v15, v11
    buffer_load_dwordx4 v2, s[12:15], s3 offen offset:1024 lds
    v_mul_f32 v16, v16, v12
    ds_read_b128 v[32:35], v7 offset:20480
    v_mul_f32 v17, v17, v13
    v_cvt_pk_bf16_f32 v20, v14, v15
    buffer_load_dwordx4 v6, s[12:15], s3 offen offset:2048 lds
    v_cvt_pk_bf16_f32 v21, v16, v17
    ds_read_b128 v[36:39], v8 offset:20480
    s_nop 0
    v_permlane16_swap_b32 v18, v20
    v_permlane16_swap_b32 v19, v21
    ds_read_b128 v[40:43], v7 offset:22528
    s_nop 0
    buffer_store_dwordx4 v[18:21], v23, s[16:19], s47 offen sc0 sc1
    s_add_u32 s47, s47, 4096
    ds_read_b128 v[44:47], v8 offset:22528
    s_waitcnt vmcnt(12) lgkmcnt(0)
    s_barrier
    s_setprio 1
    v_mfma_f32_16x16x32_bf16 v[48:51], v[112:115], v[24:27], 0
    v_mul_f32 v10, s46, v104
    v_mul_f32 v11, s46, v105
    v_mfma_f32_16x16x32_bf16 v[52:55], v[184:187], v[24:27], 0
    ds_read_b128 v[24:27], v7 offset:24576
    v_mfma_f32_16x16x32_bf16 v[48:51], v[116:119], v[28:31], v[48:51]
    v_mul_f32 v12, s46, v106
    v_mul_f32 v13, s46, v107
    v_mfma_f32_16x16x32_bf16 v[52:55], v[188:191], v[28:31], v[52:55]
    ds_read_b128 v[28:31], v8 offset:24576
    v_mfma_f32_16x16x32_bf16 v[48:51], v[120:123], v[32:35], v[48:51]
    v_exp_f32 v10, v10
    v_mfma_f32_16x16x32_bf16 v[52:55], v[192:195], v[32:35], v[52:55]
    ds_read_b128 v[32:35], v7 offset:26624
    v_mfma_f32_16x16x32_bf16 v[48:51], v[124:127], v[36:39], v[48:51]
    v_exp_f32 v11, v11
    v_mfma_f32_16x16x32_bf16 v[52:55], v[196:199], v[36:39], v[52:55]
    ds_read_b128 v[36:39], v8 offset:26624
    v_mfma_f32_16x16x32_bf16 v[48:51], v[128:131], v[40:43], v[48:51]
    v_exp_f32 v12, v12
    v_mfma_f32_16x16x32_bf16 v[52:55], v[200:203], v[40:43], v[52:55]
    ds_read_b128 v[40:43], v7 offset:28672
    v_mfma_f32_16x16x32_bf16 v[48:51], v[132:135], v[44:47], v[48:51]
    v_exp_f32 v13, v13
    v_mfma_f32_16x16x32_bf16 v[52:55], v[204:207], v[44:47], v[52:55]
    ds_read_b128 v[44:47], v8 offset:28672
    s_waitcnt lgkmcnt(5)
    v_mfma_f32_16x16x32_bf16 v[48:51], v[136:139], v[24:27], v[48:51]
    v_mul_f32 v14, v104, v108
    v_mul_f32 v15, v105, v109
    v_mfma_f32_16x16x32_bf16 v[52:55], v[208:211], v[24:27], v[52:55]
    ds_read_b128 v[24:27], v7 offset:30720
    s_waitcnt lgkmcnt(5)
    v_mfma_f32_16x16x32_bf16 v[48:51], v[140:143], v[28:31], v[48:51]
    v_mul_f32 v16, v106, v110
    v_mul_f32 v17, v107, v111
    v_mfma_f32_16x16x32_bf16 v[52:55], v[212:215], v[28:31], v[52:55]
    ds_read_b128 v[28:31], v8 offset:30720
    s_waitcnt lgkmcnt(5)
    v_mfma_f32_16x16x32_bf16 v[48:51], v[144:147], v[32:35], v[48:51]
    v_add_f32 v10, 1.0, v10
    v_add_f32 v11, 1.0, v11
    v_mfma_f32_16x16x32_bf16 v[52:55], v[216:219], v[32:35], v[52:55]
    ds_read_b128 v[32:35], v7 offset:32768
    s_waitcnt lgkmcnt(5)
    v_mfma_f32_16x16x32_bf16 v[48:51], v[148:151], v[36:39], v[48:51]
    v_add_f32 v12, 1.0, v12
    v_add_f32 v13, 1.0, v13
    v_mfma_f32_16x16x32_bf16 v[52:55], v[220:223], v[36:39], v[52:55]
    ds_read_b128 v[36:39], v8 offset:32768
    s_waitcnt lgkmcnt(5)
    v_mfma_f32_16x16x32_bf16 v[48:51], v[152:155], v[40:43], v[48:51]
    v_rcp_f32 v10, v10
    v_mfma_f32_16x16x32_bf16 v[52:55], v[224:227], v[40:43], v[52:55]
    ds_read_b128 v[40:43], v7 offset:34816
    s_waitcnt lgkmcnt(5)
    v_mfma_f32_16x16x32_bf16 v[48:51], v[156:159], v[44:47], v[48:51]
    v_rcp_f32 v11, v11
    v_mfma_f32_16x16x32_bf16 v[52:55], v[228:231], v[44:47], v[52:55]
    ds_read_b128 v[44:47], v8 offset:34816
    s_waitcnt lgkmcnt(5)
    v_mfma_f32_16x16x32_bf16 v[48:51], v[160:163], v[24:27], v[48:51]
    v_rcp_f32 v12, v12
    v_mfma_f32_16x16x32_bf16 v[52:55], v[232:235], v[24:27], v[52:55]
    s_waitcnt lgkmcnt(4)
    v_mfma_f32_16x16x32_bf16 v[48:51], v[164:167], v[28:31], v[48:51]
    v_rcp_f32 v13, v13
    v_mfma_f32_16x16x32_bf16 v[52:55], v[236:239], v[28:31], v[52:55]
    s_waitcnt lgkmcnt(3)
    v_mfma_f32_16x16x32_bf16 v[48:51], v[168:171], v[32:35], v[48:51]
    v_mul_f32 v14, v14, v10
    v_mul_f32 v15, v15, v11
    v_mfma_f32_16x16x32_bf16 v[52:55], v[240:243], v[32:35], v[52:55]
    s_waitcnt lgkmcnt(2)
    v_mfma_f32_16x16x32_bf16 v[48:51], v[172:175], v[36:39], v[48:51]
    v_mul_f32 v16, v16, v12
    v_mul_f32 v17, v17, v13
    v_mfma_f32_16x16x32_bf16 v[52:55], v[244:247], v[36:39], v[52:55]
    s_waitcnt lgkmcnt(1)
    v_mfma_f32_16x16x32_bf16 v[48:51], v[176:179], v[40:43], v[48:51]
    v_cvt_pk_bf16_f32 v18, v14, v15
    v_cvt_pk_bf16_f32 v19, v16, v17
    v_mfma_f32_16x16x32_bf16 v[52:55], v[248:251], v[40:43], v[52:55]
    s_waitcnt lgkmcnt(0)
    s_setprio 3
    s_barrier
    v_mfma_f32_16x16x32_bf16 v[48:51], v[180:183], v[44:47], v[48:51]
    v_mfma_f32_16x16x32_bf16 v[52:55], v[252:255], v[44:47], v[52:55]
    s_setprio 0
    s_waitcnt vmcnt(6)
    v_bfe_u32 v24, v22, 2, 3
    v_bfe_u32 v24, v9, v24, 1
    v_cmp_ne_u32 vcc, 0, v24
    s_nop 1
    s_mov_b32 s76, vcc_lo
    s_lshr_b32 s66, vcc_lo, 16
    s_and_b32 s66, s66, vcc_lo
    s_and_b32 s34, s66, 1
    s_or_b32 s67, s67, s34
    s_andn2_b32 exec_lo, 0x70007, s76
    s_mov_b32 exec_hi, 0
    buffer_load_dword v9, v22, s[92:95], 0 offen sc0 sc1
    s_mov_b64 exec, -1
    v_and_b32 v3, 63, v0
    v_lshlrev_b32 v3, 4, v3
    s_and_b32 s3, s54, 15
    s_lshl_b32 s3, s3, 1
    s_add_u32 s3, s3, s33
    s_lshl_b32 s21, s3, 18
    s_add_u32 s20, s21, s60
    s_add_u32 s21, s21, s61
    s_mul_i32 s34, s33, 40960
    s_add_u32 m0, s40, s34
    s_nop 0
    buffer_load_dwordx4 v3, s[16:19], s20 offen sc0 sc1 lds
    v_mul_f32 v10, s46, v48
    v_mul_f32 v11, s46, v49
    ds_read_b128 v[24:27], v7 offset:36864
    v_mul_f32 v12, s46, v50
    buffer_load_dwordx4 v3, s[16:19], s20 offen offset:1024 sc0 sc1 lds
    ds_read_b128 v[28:31], v8 offset:36864
    ds_read_b128 v[32:35], v7 offset:38912
    buffer_load_dwordx4 v3, s[16:19], s21 offen offset:2048 sc0 sc1 lds
    ds_read_b128 v[36:39], v8 offset:38912
    ds_read_b128 v[40:43], v7 offset:40960
    buffer_load_dwordx4 v3, s[16:19], s21 offen offset:3072 sc0 sc1 lds
    ds_read_b128 v[44:47], v8 offset:40960
    s_waitcnt vmcnt(5) lgkmcnt(0)
    s_barrier
    s_setprio 1
    v_mfma_f32_16x16x32_bf16 v[56:59], v[112:115], v[24:27], 0
    v_mul_f32 v13, s46, v51
    v_mfma_f32_16x16x32_bf16 v[60:63], v[184:187], v[24:27], 0
    ds_read_b128 v[24:27], v7 offset:43008
    v_mfma_f32_16x16x32_bf16 v[56:59], v[116:119], v[28:31], v[56:59]
    v_exp_f32 v10, v10
    v_mfma_f32_16x16x32_bf16 v[60:63], v[188:191], v[28:31], v[60:63]
    ds_read_b128 v[28:31], v8 offset:43008
    v_mfma_f32_16x16x32_bf16 v[56:59], v[120:123], v[32:35], v[56:59]
    v_exp_f32 v11, v11
    v_mfma_f32_16x16x32_bf16 v[60:63], v[192:195], v[32:35], v[60:63]
    ds_read_b128 v[32:35], v7 offset:45056
    v_mfma_f32_16x16x32_bf16 v[56:59], v[124:127], v[36:39], v[56:59]
    v_exp_f32 v12, v12
    v_mfma_f32_16x16x32_bf16 v[60:63], v[196:199], v[36:39], v[60:63]
    ds_read_b128 v[36:39], v8 offset:45056
    v_mfma_f32_16x16x32_bf16 v[56:59], v[128:131], v[40:43], v[56:59]
    v_exp_f32 v13, v13
    v_mfma_f32_16x16x32_bf16 v[60:63], v[200:203], v[40:43], v[60:63]
    ds_read_b128 v[40:43], v7 offset:47104
    v_mfma_f32_16x16x32_bf16 v[56:59], v[132:135], v[44:47], v[56:59]
    v_mul_f32 v14, v48, v52
    v_mul_f32 v15, v49, v53
    v_mfma_f32_16x16x32_bf16 v[60:63], v[204:207], v[44:47], v[60:63]
    ds_read_b128 v[44:47], v8 offset:47104
    s_waitcnt lgkmcnt(5)
    v_mfma_f32_16x16x32_bf16 v[56:59], v[136:139], v[24:27], v[56:59]
    v_mul_f32 v16, v50, v54
    v_mul_f32 v17, v51, v55
    v_mfma_f32_16x16x32_bf16 v[60:63], v[208:211], v[24:27], v[60:63]
    ds_read_b128 v[24:27], v7 offset:49152
    s_waitcnt lgkmcnt(5)
    v_mfma_f32_16x16x32_bf16 v[56:59], v[140:143], v[28:31], v[56:59]
    v_add_f32 v10, 1.0, v10
    v_add_f32 v11, 1.0, v11
    v_mfma_f32_16x16x32_bf16 v[60:63], v[212:215], v[28:31], v[60:63]
    ds_read_b128 v[28:31], v8 offset:49152
    s_waitcnt lgkmcnt(5)
    v_mfma_f32_16x16x32_bf16 v[56:59], v[144:147], v[32:35], v[56:59]
    v_add_f32 v12, 1.0, v12
    v_add_f32 v13, 1.0, v13
    v_mfma_f32_16x16x32_bf16 v[60:63], v[216:219], v[32:35], v[60:63]
    ds_read_b128 v[32:35], v7 offset:51200
    s_waitcnt lgkmcnt(5)
    v_mfma_f32_16x16x32_bf16 v[56:59], v[148:151], v[36:39], v[56:59]
    v_rcp_f32 v10, v10
    v_mfma_f32_16x16x32_bf16 v[60:63], v[220:223], v[36:39], v[60:63]
    ds_read_b128 v[36:39], v8 offset:51200
    s_waitcnt lgkmcnt(5)
    v_mfma_f32_16x16x32_bf16 v[56:59], v[152:155], v[40:43], v[56:59]
    v_rcp_f32 v11, v11
    v_mfma_f32_16x16x32_bf16 v[60:63], v[224:227], v[40:43], v[60:63]
    ds_read_b128 v[40:43], v7 offset:53248
    s_waitcnt lgkmcnt(5)
    v_mfma_f32_16x16x32_bf16 v[56:59], v[156:159], v[44:47], v[56:59]
    v_rcp_f32 v12, v12
    v_mfma_f32_16x16x32_bf16 v[60:63], v[228:231], v[44:47], v[60:63]
    ds_read_b128 v[44:47], v8 offset:53248
    s_waitcnt lgkmcnt(5)
    v_mfma_f32_16x16x32_bf16 v[56:59], v[160:163], v[24:27], v[56:59]
    v_rcp_f32 v13, v13
    v_mfma_f32_16x16x32_bf16 v[60:63], v[232:235], v[24:27], v[60:63]
    s_waitcnt lgkmcnt(4)
    v_mfma_f32_16x16x32_bf16 v[56:59], v[164:167], v[28:31], v[56:59]
    v_mul_f32 v14, v14, v10
    v_mul_f32 v15, v15, v11
    v_mfma_f32_16x16x32_bf16 v[60:63], v[236:239], v[28:31], v[60:63]
    s_waitcnt lgkmcnt(3)
    v_mfma_f32_16x16x32_bf16 v[56:59], v[168:171], v[32:35], v[56:59]
    v_mul_f32 v16, v16, v12
    v_mul_f32 v17, v17, v13
    v_mfma_f32_16x16x32_bf16 v[60:63], v[240:243], v[32:35], v[60:63]
    s_waitcnt lgkmcnt(2)
    v_mfma_f32_16x16x32_bf16 v[56:59], v[172:175], v[36:39], v[56:59]
    v_cvt_pk_bf16_f32 v20, v14, v15
    v_cvt_pk_bf16_f32 v21, v16, v17
    v_mfma_f32_16x16x32_bf16 v[60:63], v[244:247], v[36:39], v[60:63]
    s_waitcnt lgkmcnt(1)
    v_mfma_f32_16x16x32_bf16 v[56:59], v[176:179], v[40:43], v[56:59]
    s_nop 0
    v_permlane16_swap_b32 v18, v20
    v_permlane16_swap_b32 v19, v21
    s_mov_b32 s47, s90
    s_nop 0
    buffer_store_dwordx4 v[18:21], v23, s[16:19], s47 offen sc0 sc1
    s_add_u32 s47, s47, 4096
    v_mfma_f32_16x16x32_bf16 v[60:63], v[248:251], v[40:43], v[60:63]
    s_waitcnt lgkmcnt(0)
    s_setprio 3
    s_barrier
    v_mfma_f32_16x16x32_bf16 v[56:59], v[180:183], v[44:47], v[56:59]
    v_mfma_f32_16x16x32_bf16 v[60:63], v[252:255], v[44:47], v[60:63]
    s_setprio 0
    v_mov_b32 v26, 15
    v_lshlrev_b32 v27, 2, v0
    v_and_b32 v27, 127, v27
    s_mov_b64 exec, s[100:101]
    buffer_store_dword v26, v27, s[92:95], s2 offen sc0 sc1
    s_mov_b64 exec, -1
    s_waitcnt vmcnt(6)
    v_bfe_u32 v24, v22, 2, 3
    v_bfe_u32 v24, v9, v24, 1
    v_cmp_ne_u32 vcc, 0, v24
    s_nop 1
    s_mov_b32 s76, vcc_lo
    s_lshr_b32 s66, vcc_lo, 16
    s_and_b32 s66, s66, vcc_lo
    s_bitcmp1_b32 s67, 0
    s_cbranch_scc1 fused_kernel_a0g19
    s_bitcmp1_b32 s66, 0
    s_cbranch_scc1 fused_kernel_a0sg19_ok
    s_movk_i32 s98, 0x4000
fused_kernel_a0sg19_l:
    s_andn2_b32 exec_lo, 0x10001, s76
    s_mov_b32 exec_hi, 0
    buffer_load_dword v9, v22, s[92:95], 0 offen sc0 sc1
    s_mov_b64 exec, -1
    s_waitcnt vmcnt(0)
    v_bfe_u32 v24, v22, 2, 3
    v_bfe_u32 v24, v9, v24, 1
    v_cmp_ne_u32 vcc, 0, v24
    s_nop 1
    s_mov_b32 s76, vcc_lo
    s_lshr_b32 s66, vcc_lo, 16
    s_and_b32 s66, s66, vcc_lo
    s_bitcmp1_b32 s66, 0
    s_cbranch_scc1 fused_kernel_a0sg19_ok
    s_sleep 2
    s_sub_u32 s98, s98, 1
    s_cbranch_scc0 fused_kernel_a0sg19_l
fused_kernel_a0sg19_ok:
    s_and_b32 s3, s54, 15
    s_lshl_b32 s3, s3, 1
    s_add_u32 s3, s3, s33
    s_lshl_b32 s21, s3, 18
    s_add_u32 s20, s21, s60
    s_add_u32 s21, s21, s61
    s_mul_i32 s34, s33, 40960
    s_add_u32 m0, s40, s34
    s_nop 0
    buffer_load_dwordx4 v3, s[16:19], s20 offen sc0 sc1 lds
    buffer_load_dwordx4 v3, s[16:19], s20 offen offset:1024 sc0 sc1 lds
    buffer_load_dwordx4 v3, s[16:19], s21 offen offset:2048 sc0 sc1 lds
    buffer_load_dwordx4 v3, s[16:19], s21 offen offset:3072 sc0 sc1 lds
    s_waitcnt vmcnt(0)
fused_kernel_a0g19:
    s_and_b32 s34, s66, 2
    s_or_b32 s67, s67, s34
    s_andn2_b32 exec_lo, 0x70007, s76
    s_mov_b32 exec_hi, 0
    buffer_load_dword v9, v22, s[92:95], 0 offen sc0 sc1
    s_mov_b64 exec, -1
    s_bfe_u32 s3, s54, 0x40004
    s_lshl_b32 s3, s3, 1
    s_lshl_b32 s21, s3, 18
    s_add_u32 s20, s21, s60
    s_add_u32 s21, s21, s61
    s_mul_i32 s3, s3, 73728
    s_add_u32 s3, s3, s62
    s_add_u32 s21, s21, 2048
    s_cmp_eq_u32 s33, 0
    s_cselect_b32 s20, s20, s21
    s_lshl_b32 s21, s33, 11
    s_add_u32 s21, s21, s40
    s_add_u32 m0, s21, 81920
    s_nop 0
    buffer_load_dwordx4 v3, s[16:19], s20 offen sc0 sc1 lds
    v_mul_f32 v10, s46, v56
    v_mul_f32 v11, s46, v57
    buffer_load_dwordx4 v3, s[16:19], s20 offen offset:1024 sc0 sc1 lds
    v_add_u32 v7, 55296, v7
    v_add_u32 v8, 55296, v8
    ds_read_b128 v[24:27], v7 offset:0
    ds_read_b128 v[28:31], v8 offset:0
    s_mul_i32 s21, s33, 18432
    s_add_u32 s3, s3, s21
    s_mul_i32 s21, s33, 6144
    s_add_u32 s21, s21, s41
    s_add_u32 m0, s21, 81920
    s_nop 0
    buffer_load_dwordx4 v1, s[12:15], s3 offen lds
    ds_read_b128 v[32:35], v7 offset:2048
    ds_read_b128 v[36:39], v8 offset:2048
    buffer_load_dwordx4 v2, s[12:15], s3 offen offset:1024 lds
    ds_read_b128 v[40:43], v7 offset:4096
    ds_read_b128 v[44:47], v8 offset:4096
    buffer_load_dwordx4 v6, s[12:15], s3 offen offset:2048 lds
    s_waitcnt lgkmcnt(0)
    s_barrier
    s_setprio 1
    v_mfma_f32_16x16x32_bf16 v[64:67], v[112:115], v[24:27], 0
    v_mul_f32 v12, s46, v58
    v_mul_f32 v13, s46, v59
    v_mfma_f32_16x16x32_bf16 v[68:71], v[184:187], v[24:27], 0
    ds_read_b128 v[24:27], v7 offset:6144
    v_mfma_f32_16x16x32_bf16 v[64:67], v[116:119], v[28:31], v[64:67]
    v_exp_f32 v10, v10
    v_mfma_f32_16x16x32_bf16 v[68:71], v[188:191], v[28:31], v[68:71]
    ds_read_b128 v[28:31], v8 offset:6144
    v_mfma_f32_16x16x32_bf16 v[64:67], v[120:123], v[32:35], v[64:67]
    v_exp_f32 v11, v11
    v_mfma_f32_16x16x32_bf16 v[68:71], v[192:195], v[32:35], v[68:71]
    ds_read_b128 v[32:35], v7 offset:8192
    v_mfma_f32_16x16x32_bf16 v[64:67], v[124:127], v[36:39], v[64:67]
    v_exp_f32 v12, v12
    v_mfma_f32_16x16x32_bf16 v[68:71], v[196:199], v[36:39], v[68:71]
    ds_read_b128 v[36:39], v8 offset:8192
    v_mfma_f32_16x16x32_bf16 v[64:67], v[128:131], v[40:43], v[64:67]
    v_exp_f32 v13, v13
    v_mfma_f32_16x16x32_bf16 v[68:71], v[200:203], v[40:43], v[68:71]
    ds_read_b128 v[40:43], v7 offset:10240
    v_mfma_f32_16x16x32_bf16 v[64:67], v[132:135], v[44:47], v[64:67]
    v_mul_f32 v14, v56, v60
    v_mul_f32 v15, v57, v61
    v_mfma_f32_16x16x32_bf16 v[68:71], v[204:207], v[44:47], v[68:71]
    ds_read_b128 v[44:47], v8 offset:10240
    s_waitcnt lgkmcnt(5)
    v_mfma_f32_16x16x32_bf16 v[64:67], v[136:139], v[24:27], v[64:67]
    v_mul_f32 v16, v58, v62
    v_mul_f32 v17, v59, v63
    v_mfma_f32_16x16x32_bf16 v[68:71], v[208:211], v[24:27], v[68:71]
    ds_read_b128 v[24:27], v7 offset:12288
    s_waitcnt lgkmcnt(5)
    v_mfma_f32_16x16x32_bf16 v[64:67], v[140:143], v[28:31], v[64:67]
    v_add_f32 v10, 1.0, v10
    v_add_f32 v11, 1.0, v11
    v_mfma_f32_16x16x32_bf16 v[68:71], v[212:215], v[28:31], v[68:71]
    ds_read_b128 v[28:31], v8 offset:12288
    s_waitcnt lgkmcnt(5)
    v_mfma_f32_16x16x32_bf16 v[64:67], v[144:147], v[32:35], v[64:67]
    v_add_f32 v12, 1.0, v12
    v_add_f32 v13, 1.0, v13
    v_mfma_f32_16x16x32_bf16 v[68:71], v[216:219], v[32:35], v[68:71]
    ds_read_b128 v[32:35], v7 offset:14336
    s_waitcnt lgkmcnt(5)
    v_mfma_f32_16x16x32_bf16 v[64:67], v[148:151], v[36:39], v[64:67]
    v_rcp_f32 v10, v10
    v_mfma_f32_16x16x32_bf16 v[68:71], v[220:223], v[36:39], v[68:71]
    ds_read_b128 v[36:39], v8 offset:14336
    s_waitcnt lgkmcnt(5)
    v_mfma_f32_16x16x32_bf16 v[64:67], v[152:155], v[40:43], v[64:67]
    v_rcp_f32 v11, v11
    v_mfma_f32_16x16x32_bf16 v[68:71], v[224:227], v[40:43], v[68:71]
    ds_read_b128 v[40:43], v7 offset:16384
    s_waitcnt lgkmcnt(5)
    v_mfma_f32_16x16x32_bf16 v[64:67], v[156:159], v[44:47], v[64:67]
    v_rcp_f32 v12, v12
    v_mfma_f32_16x16x32_bf16 v[68:71], v[228:231], v[44:47], v[68:71]
    ds_read_b128 v[44:47], v8 offset:16384
    s_waitcnt lgkmcnt(5)
    v_mfma_f32_16x16x32_bf16 v[64:67], v[160:163], v[24:27], v[64:67]
    v_rcp_f32 v13, v13
    v_mfma_f32_16x16x32_bf16 v[68:71], v[232:235], v[24:27], v[68:71]
    s_waitcnt lgkmcnt(4)
    v_mfma_f32_16x16x32_bf16 v[64:67], v[164:167], v[28:31], v[64:67]
    v_mul_f32 v14, v14, v10
    v_mul_f32 v15, v15, v11
    v_mfma_f32_16x16x32_bf16 v[68:71], v[236:239], v[28:31], v[68:71]
    s_waitcnt lgkmcnt(3)
    v_mfma_f32_16x16x32_bf16 v[64:67], v[168:171], v[32:35], v[64:67]
    v_mul_f32 v16, v16, v12
    v_mul_f32 v17, v17, v13
    v_mfma_f32_16x16x32_bf16 v[68:71], v[240:243], v[32:35], v[68:71]
    s_waitcnt lgkmcnt(2)
    v_mfma_f32_16x16x32_bf16 v[64:67], v[172:175], v[36:39], v[64:67]
    v_cvt_pk_bf16_f32 v18, v14, v15
    v_cvt_pk_bf16_f32 v19, v16, v17
    v_mfma_f32_16x16x32_bf16 v[68:71], v[244:247], v[36:39], v[68:71]
    s_waitcnt vmcnt(8) lgkmcnt(0)
    s_setprio 3
    s_cmp_eq_u32 s33, 0
    s_cbranch_scc1 fused_kernel_skipBg19
    s_barrier
fused_kernel_skipBg19:
    v_mfma_f32_16x16x32_bf16 v[64:67], v[176:179], v[40:43], v[64:67]
    v_mfma_f32_16x16x32_bf16 v[68:71], v[248:251], v[40:43], v[68:71]
    s_waitcnt lgkmcnt(0)
    s_setprio 3
    s_cmp_eq_u32 s33, 0
    s_cbranch_scc0 fused_kernel_skipAg19
    s_barrier
fused_kernel_skipAg19:
    v_mfma_f32_16x16x32_bf16 v[64:67], v[180:183], v[44:47], v[64:67]
    v_mfma_f32_16x16x32_bf16 v[68:71], v[252:255], v[44:47], v[68:71]
    s_setprio 0
    s_nop 7
    s_cmp_eq_u32 s33, 0
    s_cbranch_scc0 fused_kernel_tYg19
    s_nop 1
    s_bitcmp1_b32 s67, 1
    s_cbranch_scc0 fused_kernel_xlate
    s_branch fused_kernel_cons
fused_kernel_tYg19:
    s_nop 1
    s_bitcmp1_b32 s67, 1
    s_cbranch_scc0 fused_kernel_ylate
    s_branch fused_kernel_prod
fused_kernel_gate:
    s_load_dwordx2 s[8:9], s[0:1], 0
    s_load_dwordx2 s[16:17], s[0:1], 80
    s_load_dwordx2 s[6:7], s[0:1], 104
    s_load_dwordx2 s[28:29], s[0:1], 96
    s_load_dwordx4 s[36:39], s[0:1], 32
    s_load_dwordx4 s[84:87], s[0:1], 8
    s_load_dwordx2 s[88:89], s[0:1], 24
    v_lshrrev_b32 v1, 6, v0
    v_and_b32 v2, 63, v0
    v_readfirstlane_b32 s22, v1
    v_and_b32 v3, 7, v2
    v_lshrrev_b32 v4, 3, v2
    s_lshl_b32 s50, s49, 3
    s_add_u32 s50, s50, s22
    s_mul_i32 s51, s50, 73728
    s_lshr_b32 s33, s22, 2
    v_mul_u32_u24 v5, 1152, v4
    v_lshl_add_u32 v5, v3, 4, v5
    v_lshlrev_b32 v6, 4, v3
    v_mov_b32 v12, -1
    v_mov_b32 v13, -1
    v_mov_b32 v14, -1
    v_mov_b32 v15, -1
    v_lshlrev_b32 v7, 4, v2
    s_waitcnt lgkmcnt(0)
    s_and_b32 s9, s9, 0xffff
    s_mov_b32 s10, 2359296
    s_mov_b32 s11, 0x00020000
    s_and_b32 s17, s17, 0xffff
    s_mov_b32 s18, 1152
    s_mov_b32 s19, 0x00020000
    s_and_b32 s29, s29, 0xffff
    s_mov_b32 s30, 256
    s_mov_b32 s31, 0x00020000
    s_lshr_b32 s34, s96, 3
    s_bitcmp1_b32 s96, 0
    s_mov_b32 s35, 50727960
    s_cselect_b32 s35, 2418041025, s35
    s_lshr_b32 s76, s35, s34
    s_and_b32 s76, s76, 1
    s_bfm_b32 s78, s34, 0
    s_and_b32 s78, s78, s35
    s_bcnt1_i32_b32 s78, s78
    s_sub_u32 s34, s34, s78
    s_and_b32 s35, s96, 7
    s_mul_i32 s77, s35, 24
    s_add_u32 s77, s77, s34
    s_lshl_b32 s35, s35, 3
    s_add_u32 s78, s78, s35
    s_add_u32 s35, s78, 192
    s_cmp_eq_u32 s76, 1
    s_cselect_b32 s78, s78, s34
    s_cselect_b32 s77, s35, s77
    s_lshl_b32 s99, s77, 7
    s_add_u32 s99, s99, 32768
    s_mul_i32 s69, s77, 40960
    s_mul_i32 s34, s22, 5120
    s_add_u32 s69, s69, s34
    s_add_u32 s56, s6, 20971520
    s_addc_u32 s57, s7, 0
    s_and_b32 s57, s57, 0xffff
    s_mov_b32 s58, 10493952
    s_mov_b32 s59, 0x00020000
    s_add_u32 s92, s6, 31465472
    s_addc_u32 s93, s7, 0
    s_and_b32 s93, s93, 0xffff
    s_mov_b32 s94, 65536
    s_mov_b32 s95, 0x00020000
    s_cmp_eq_u32 s22, 0
    s_cselect_b32 s100, -1, 0
    s_mov_b32 s101, 0
    s_cmp_eq_u32 s49, 0
    s_cbranch_scc0 fused_kernel_gnc
    v_mov_b32 v16, 0
    v_mov_b32 v17, 0
    v_mov_b32 v18, 0
    v_mov_b32 v19, 0
    s_lshl_b32 s34, s22, 13
    s_add_u32 s35, s34, 4096
    buffer_store_dwordx4 v[16:19], v7, s[92:95], s34 offen offset:0 sc0 sc1
    buffer_store_dwordx4 v[16:19], v7, s[92:95], s34 offen offset:1024 sc0 sc1
    buffer_store_dwordx4 v[16:19], v7, s[92:95], s34 offen offset:2048 sc0 sc1
    buffer_store_dwordx4 v[16:19], v7, s[92:95], s34 offen offset:3072 sc0 sc1
    buffer_store_dwordx4 v[16:19], v7, s[92:95], s35 offen offset:0 sc0 sc1
    buffer_store_dwordx4 v[16:19], v7, s[92:95], s35 offen offset:1024 sc0 sc1
    buffer_store_dwordx4 v[16:19], v7, s[92:95], s35 offen offset:2048 sc0 sc1
    buffer_store_dwordx4 v[16:19], v7, s[92:95], s35 offen offset:3072 sc0 sc1
    s_waitcnt vmcnt(0)
    s_barrier
    s_and_b64 exec, s[100:101], 1
    buffer_store_dword v12, off, s[28:31], 0 sc0 sc1
    s_mov_b64 exec, -1
fused_kernel_gnc:
    buffer_load_dwordx4 v[16:19], v6, s[16:19], 0 offen offset:0
    buffer_load_dwordx4 v[20:23], v6, s[16:19], 0 offen offset:128
    buffer_load_dwordx4 v[24:27], v6, s[16:19], 0 offen offset:256
    buffer_load_dwordx4 v[28:31], v6, s[16:19], 0 offen offset:384
    buffer_load_dwordx4 v[32:35], v6, s[16:19], 0 offen offset:512
    buffer_load_dwordx4 v[36:39], v6, s[16:19], 0 offen offset:640
    buffer_load_dwordx4 v[40:43], v6, s[16:19], 0 offen offset:768
    buffer_load_dwordx4 v[44:47], v6, s[16:19], 0 offen offset:896
    buffer_load_dwordx4 v[48:51], v6, s[16:19], 0 offen offset:1024
    buffer_load_dwordx4 v[64:67], v5, s[8:11], s51 offen offset:0
    buffer_load_dwordx4 v[68:71], v5, s[8:11], s51 offen offset:128
    buffer_load_dwordx4 v[72:75], v5, s[8:11], s51 offen offset:256
    buffer_load_dwordx4 v[76:79], v5, s[8:11], s51 offen offset:384
    buffer_load_dwordx4 v[80:83], v5, s[8:11], s51 offen offset:512
    buffer_load_dwordx4 v[84:87], v5, s[8:11], s51 offen offset:640
    buffer_load_dwordx4 v[88:91], v5, s[8:11], s51 offen offset:768
    buffer_load_dwordx4 v[92:95], v5, s[8:11], s51 offen offset:896
    buffer_load_dwordx4 v[96:99], v5, s[8:11], s51 offen offset:1024
    s_add_u32 s51, s51, 9216
    buffer_load_dwordx4 v[100:103], v5, s[8:11], s51 offen offset:0
    buffer_load_dwordx4 v[104:107], v5, s[8:11], s51 offen offset:128
    buffer_load_dwordx4 v[108:111], v5, s[8:11], s51 offen offset:256
    buffer_load_dwordx4 v[112:115], v5, s[8:11], s51 offen offset:384
    buffer_load_dwordx4 v[116:119], v5, s[8:11], s51 offen offset:512
    buffer_load_dwordx4 v[120:123], v5, s[8:11], s51 offen offset:640
    buffer_load_dwordx4 v[124:127], v5, s[8:11], s51 offen offset:768
    buffer_load_dwordx4 v[128:131], v5, s[8:11], s51 offen offset:896
    buffer_load_dwordx4 v[132:135], v5, s[8:11], s51 offen offset:1024
    s_add_u32 s51, s51, 9216
    buffer_load_dwordx4 v[136:139], v5, s[8:11], s51 offen offset:0
    buffer_load_dwordx4 v[140:143], v5, s[8:11], s51 offen offset:128
    buffer_load_dwordx4 v[144:147], v5, s[8:11], s51 offen offset:256
    buffer_load_dwordx4 v[148:151], v5, s[8:11], s51 offen offset:384
    buffer_load_dwordx4 v[152:155], v5, s[8:11], s51 offen offset:512
    buffer_load_dwordx4 v[156:159], v5, s[8:11], s51 offen offset:640
    buffer_load_dwordx4 v[160:163], v5, s[8:11], s51 offen offset:768
    buffer_load_dwordx4 v[164:167], v5, s[8:11], s51 offen offset:896
    buffer_load_dwordx4 v[168:171], v5, s[8:11], s51 offen offset:1024
    s_add_u32 s51, s51, 9216
    buffer_load_dwordx4 v[172:175], v5, s[8:11], s51 offen offset:0
    buffer_load_dwordx4 v[176:179], v5, s[8:11], s51 offen offset:128
    buffer_load_dwordx4 v[180:183], v5, s[8:11], s51 offen offset:256
    buffer_load_dwordx4 v[184:187], v5, s[8:11], s51 offen offset:384
    buffer_load_dwordx4 v[188:191], v5, s[8:11], s51 offen offset:512
    buffer_load_dwordx4 v[192:195], v5, s[8:11], s51 offen offset:640
    buffer_load_dwordx4 v[196:199], v5, s[8:11], s51 offen offset:768
    buffer_load_dwordx4 v[200:203], v5, s[8:11], s51 offen offset:896
    buffer_load_dwordx4 v[204:207], v5, s[8:11], s51 offen offset:1024
    s_add_u32 s51, s51, 9216
    s_waitcnt vmcnt(50)
    buffer_load_dwordx4 v[208:211], v5, s[8:11], s51 offen offset:0
    buffer_load_dwordx4 v[212:215], v5, s[8:11], s51 offen offset:128
    buffer_load_dwordx4 v[216:219], v5, s[8:11], s51 offen offset:256
    buffer_load_dwordx4 v[220:223], v5, s[8:11], s51 offen offset:384
    buffer_load_dwordx4 v[224:227], v5, s[8:11], s51 offen offset:512
    buffer_load_dwordx4 v[228:231], v5, s[8:11], s51 offen offset:640
    buffer_load_dwordx4 v[232:235], v5, s[8:11], s51 offen offset:768
    buffer_load_dwordx4 v[236:239], v5, s[8:11], s51 offen offset:896
    buffer_load_dwordx4 v[240:243], v5, s[8:11], s51 offen offset:1024
    s_add_u32 s51, s51, 9216
    v_mov_b32 v10, 0
    s_waitcnt vmcnt(36)
    v_mov_b32 v8, 0
    v_mov_b32 v9, 0
    v_dot2_f32_bf16 v8, v64, v16, v8
    v_dot2_f32_bf16 v9, v65, v17, v9
    v_dot2_f32_bf16 v8, v66, v18, v8
    v_dot2_f32_bf16 v9, v67, v19, v9
    v_dot2_f32_bf16 v8, v68, v20, v8
    v_dot2_f32_bf16 v9, v69, v21, v9
    v_dot2_f32_bf16 v8, v70, v22, v8
    v_dot2_f32_bf16 v9, v71, v23, v9
    v_dot2_f32_bf16 v8, v72, v24, v8
    v_dot2_f32_bf16 v9, v73, v25, v9
    v_dot2_f32_bf16 v8, v74, v26, v8
    v_dot2_f32_bf16 v9, v75, v27, v9
    v_dot2_f32_bf16 v8, v76, v28, v8
    v_dot2_f32_bf16 v9, v77, v29, v9
    v_dot2_f32_bf16 v8, v78, v30, v8
    v_dot2_f32_bf16 v9, v79, v31, v9
    v_dot2_f32_bf16 v8, v80, v32, v8
    v_dot2_f32_bf16 v9, v81, v33, v9
    v_dot2_f32_bf16 v8, v82, v34, v8
    v_dot2_f32_bf16 v9, v83, v35, v9
    v_dot2_f32_bf16 v8, v84, v36, v8
    v_dot2_f32_bf16 v9, v85, v37, v9
    v_dot2_f32_bf16 v8, v86, v38, v8
    v_dot2_f32_bf16 v9, v87, v39, v9
    v_dot2_f32_bf16 v8, v88, v40, v8
    v_dot2_f32_bf16 v9, v89, v41, v9
    v_dot2_f32_bf16 v8, v90, v42, v8
    v_dot2_f32_bf16 v9, v91, v43, v9
    v_dot2_f32_bf16 v8, v92, v44, v8
    v_dot2_f32_bf16 v9, v93, v45, v9
    v_dot2_f32_bf16 v8, v94, v46, v8
    v_dot2_f32_bf16 v9, v95, v47, v9
    v_dot2_f32_bf16 v8, v96, v48, v8
    v_dot2_f32_bf16 v9, v97, v49, v9
    v_dot2_f32_bf16 v8, v98, v50, v8
    v_dot2_f32_bf16 v9, v99, v51, v9
    s_nop 3
    buffer_load_dwordx4 v[64:67], v5, s[8:11], s51 offen offset:0
    buffer_load_dwordx4 v[68:71], v5, s[8:11], s51 offen offset:128
    buffer_load_dwordx4 v[72:75], v5, s[8:11], s51 offen offset:256
    buffer_load_dwordx4 v[76:79], v5, s[8:11], s51 offen offset:384
    buffer_load_dwordx4 v[80:83], v5, s[8:11], s51 offen offset:512
    buffer_load_dwordx4 v[84:87], v5, s[8:11], s51 offen offset:640
    buffer_load_dwordx4 v[88:91], v5, s[8:11], s51 offen offset:768
    buffer_load_dwordx4 v[92:95], v5, s[8:11], s51 offen offset:896
    buffer_load_dwordx4 v[96:99], v5, s[8:11], s51 offen offset:1024
    s_add_u32 s51, s51, 9216
    v_add_f32 v8, v8, v9
    s_nop 1
    v_add_f32_dpp v8, v8, v8 quad_perm:[1,0,3,2] row_mask:0xf bank_mask:0xf
    s_nop 1
    v_add_f32_dpp v8, v8, v8 quad_perm:[2,3,0,1] row_mask:0xf bank_mask:0xf
    s_nop 1
    v_add_f32_dpp v8, v8, v8 row_half_mirror row_mask:0xf bank_mask:0xf
    v_cmp_eq_u32 vcc, 0, v3
    s_nop 1
    v_cndmask_b32 v10, v10, v8, vcc
    s_waitcnt vmcnt(36)
    v_mov_b32 v8, 0
    v_mov_b32 v9, 0
    v_dot2_f32_bf16 v8, v100, v16, v8
    v_dot2_f32_bf16 v9, v101, v17, v9
    v_dot2_f32_bf16 v8, v102, v18, v8
    v_dot2_f32_bf16 v9, v103, v19, v9
    v_dot2_f32_bf16 v8, v104, v20, v8
    v_dot2_f32_bf16 v9, v105, v21, v9
    v_dot2_f32_bf16 v8, v106, v22, v8
    v_dot2_f32_bf16 v9, v107, v23, v9
    v_dot2_f32_bf16 v8, v108, v24, v8
    v_dot2_f32_bf16 v9, v109, v25, v9
    v_dot2_f32_bf16 v8, v110, v26, v8
    v_dot2_f32_bf16 v9, v111, v27, v9
    v_dot2_f32_bf16 v8, v112, v28, v8
    v_dot2_f32_bf16 v9, v113, v29, v9
    v_dot2_f32_bf16 v8, v114, v30, v8
    v_dot2_f32_bf16 v9, v115, v31, v9
    v_dot2_f32_bf16 v8, v116, v32, v8
    v_dot2_f32_bf16 v9, v117, v33, v9
    v_dot2_f32_bf16 v8, v118, v34, v8
    v_dot2_f32_bf16 v9, v119, v35, v9
    v_dot2_f32_bf16 v8, v120, v36, v8
    v_dot2_f32_bf16 v9, v121, v37, v9
    v_dot2_f32_bf16 v8, v122, v38, v8
    v_dot2_f32_bf16 v9, v123, v39, v9
    v_dot2_f32_bf16 v8, v124, v40, v8
    v_dot2_f32_bf16 v9, v125, v41, v9
    v_dot2_f32_bf16 v8, v126, v42, v8
    v_dot2_f32_bf16 v9, v127, v43, v9
    v_dot2_f32_bf16 v8, v128, v44, v8
    v_dot2_f32_bf16 v9, v129, v45, v9
    v_dot2_f32_bf16 v8, v130, v46, v8
    v_dot2_f32_bf16 v9, v131, v47, v9
    v_dot2_f32_bf16 v8, v132, v48, v8
    v_dot2_f32_bf16 v9, v133, v49, v9
    v_dot2_f32_bf16 v8, v134, v50, v8
    v_dot2_f32_bf16 v9, v135, v51, v9
    s_nop 3
    buffer_load_dwordx4 v[100:103], v5, s[8:11], s51 offen offset:0
    buffer_load_dwordx4 v[104:107], v5, s[8:11], s51 offen offset:128
    buffer_load_dwordx4 v[108:111], v5, s[8:11], s51 offen offset:256
    buffer_load_dwordx4 v[112:115], v5, s[8:11], s51 offen offset:384
    buffer_load_dwordx4 v[116:119], v5, s[8:11], s51 offen offset:512
    buffer_load_dwordx4 v[120:123], v5, s[8:11], s51 offen offset:640
    buffer_load_dwordx4 v[124:127], v5, s[8:11], s51 offen offset:768
    buffer_load_dwordx4 v[128:131], v5, s[8:11], s51 offen offset:896
    buffer_load_dwordx4 v[132:135], v5, s[8:11], s51 offen offset:1024
    s_add_u32 s51, s51, 9216
    v_add_f32 v8, v8, v9
    s_nop 1
    v_add_f32_dpp v8, v8, v8 quad_perm:[1,0,3,2] row_mask:0xf bank_mask:0xf
    s_nop 1
    v_add_f32_dpp v8, v8, v8 quad_perm:[2,3,0,1] row_mask:0xf bank_mask:0xf
    s_nop 1
    v_add_f32_dpp v8, v8, v8 row_half_mirror row_mask:0xf bank_mask:0xf
    v_cmp_eq_u32 vcc, 1, v3
    s_nop 1
    v_cndmask_b32 v10, v10, v8, vcc
    s_waitcnt vmcnt(36)
    v_mov_b32 v8, 0
    v_mov_b32 v9, 0
    v_dot2_f32_bf16 v8, v136, v16, v8
    v_dot2_f32_bf16 v9, v137, v17, v9
    v_dot2_f32_bf16 v8, v138, v18, v8
    v_dot2_f32_bf16 v9, v139, v19, v9
    v_dot2_f32_bf16 v8, v140, v20, v8
    v_dot2_f32_bf16 v9, v141, v21, v9
    v_dot2_f32_bf16 v8, v142, v22, v8
    v_dot2_f32_bf16 v9, v143, v23, v9
    v_dot2_f32_bf16 v8, v144, v24, v8
    v_dot2_f32_bf16 v9, v145, v25, v9
    v_dot2_f32_bf16 v8, v146, v26, v8
    v_dot2_f32_bf16 v9, v147, v27, v9
    v_dot2_f32_bf16 v8, v148, v28, v8
    v_dot2_f32_bf16 v9, v149, v29, v9
    v_dot2_f32_bf16 v8, v150, v30, v8
    v_dot2_f32_bf16 v9, v151, v31, v9
    v_dot2_f32_bf16 v8, v152, v32, v8
    v_dot2_f32_bf16 v9, v153, v33, v9
    v_dot2_f32_bf16 v8, v154, v34, v8
    v_dot2_f32_bf16 v9, v155, v35, v9
    v_dot2_f32_bf16 v8, v156, v36, v8
    v_dot2_f32_bf16 v9, v157, v37, v9
    v_dot2_f32_bf16 v8, v158, v38, v8
    v_dot2_f32_bf16 v9, v159, v39, v9
    v_dot2_f32_bf16 v8, v160, v40, v8
    v_dot2_f32_bf16 v9, v161, v41, v9
    v_dot2_f32_bf16 v8, v162, v42, v8
    v_dot2_f32_bf16 v9, v163, v43, v9
    v_dot2_f32_bf16 v8, v164, v44, v8
    v_dot2_f32_bf16 v9, v165, v45, v9
    v_dot2_f32_bf16 v8, v166, v46, v8
    v_dot2_f32_bf16 v9, v167, v47, v9
    v_dot2_f32_bf16 v8, v168, v48, v8
    v_dot2_f32_bf16 v9, v169, v49, v9
    v_dot2_f32_bf16 v8, v170, v50, v8
    v_dot2_f32_bf16 v9, v171, v51, v9
    s_nop 3
    buffer_load_dwordx4 v[136:139], v5, s[8:11], s51 offen offset:0
    buffer_load_dwordx4 v[140:143], v5, s[8:11], s51 offen offset:128
    buffer_load_dwordx4 v[144:147], v5, s[8:11], s51 offen offset:256
    buffer_load_dwordx4 v[148:151], v5, s[8:11], s51 offen offset:384
    buffer_load_dwordx4 v[152:155], v5, s[8:11], s51 offen offset:512
    buffer_load_dwordx4 v[156:159], v5, s[8:11], s51 offen offset:640
    buffer_load_dwordx4 v[160:163], v5, s[8:11], s51 offen offset:768
    buffer_load_dwordx4 v[164:167], v5, s[8:11], s51 offen offset:896
    buffer_load_dwordx4 v[168:171], v5, s[8:11], s51 offen offset:1024
    s_add_u32 s51, s51, 9216
    v_add_f32 v8, v8, v9
    s_nop 1
    v_add_f32_dpp v8, v8, v8 quad_perm:[1,0,3,2] row_mask:0xf bank_mask:0xf
    s_nop 1
    v_add_f32_dpp v8, v8, v8 quad_perm:[2,3,0,1] row_mask:0xf bank_mask:0xf
    s_nop 1
    v_add_f32_dpp v8, v8, v8 row_half_mirror row_mask:0xf bank_mask:0xf
    v_cmp_eq_u32 vcc, 2, v3
    s_nop 1
    v_cndmask_b32 v10, v10, v8, vcc
    s_waitcnt vmcnt(36)
    v_mov_b32 v8, 0
    v_mov_b32 v9, 0
    v_dot2_f32_bf16 v8, v172, v16, v8
    v_dot2_f32_bf16 v9, v173, v17, v9
    v_dot2_f32_bf16 v8, v174, v18, v8
    v_dot2_f32_bf16 v9, v175, v19, v9
    v_dot2_f32_bf16 v8, v176, v20, v8
    v_dot2_f32_bf16 v9, v177, v21, v9
    v_dot2_f32_bf16 v8, v178, v22, v8
    v_dot2_f32_bf16 v9, v179, v23, v9
    v_dot2_f32_bf16 v8, v180, v24, v8
    v_dot2_f32_bf16 v9, v181, v25, v9
    v_dot2_f32_bf16 v8, v182, v26, v8
    v_dot2_f32_bf16 v9, v183, v27, v9
    v_dot2_f32_bf16 v8, v184, v28, v8
    v_dot2_f32_bf16 v9, v185, v29, v9
    v_dot2_f32_bf16 v8, v186, v30, v8
    v_dot2_f32_bf16 v9, v187, v31, v9
    v_dot2_f32_bf16 v8, v188, v32, v8
    v_dot2_f32_bf16 v9, v189, v33, v9
    v_dot2_f32_bf16 v8, v190, v34, v8
    v_dot2_f32_bf16 v9, v191, v35, v9
    v_dot2_f32_bf16 v8, v192, v36, v8
    v_dot2_f32_bf16 v9, v193, v37, v9
    v_dot2_f32_bf16 v8, v194, v38, v8
    v_dot2_f32_bf16 v9, v195, v39, v9
    v_dot2_f32_bf16 v8, v196, v40, v8
    v_dot2_f32_bf16 v9, v197, v41, v9
    v_dot2_f32_bf16 v8, v198, v42, v8
    v_dot2_f32_bf16 v9, v199, v43, v9
    v_dot2_f32_bf16 v8, v200, v44, v8
    v_dot2_f32_bf16 v9, v201, v45, v9
    v_dot2_f32_bf16 v8, v202, v46, v8
    v_dot2_f32_bf16 v9, v203, v47, v9
    v_dot2_f32_bf16 v8, v204, v48, v8
    v_dot2_f32_bf16 v9, v205, v49, v9
    v_dot2_f32_bf16 v8, v206, v50, v8
    v_dot2_f32_bf16 v9, v207, v51, v9
    s_nop 3
    v_add_f32 v8, v8, v9
    s_nop 1
    v_add_f32_dpp v8, v8, v8 quad_perm:[1,0,3,2] row_mask:0xf bank_mask:0xf
    s_nop 1
    v_add_f32_dpp v8, v8, v8 quad_perm:[2,3,0,1] row_mask:0xf bank_mask:0xf
    s_nop 1
    v_add_f32_dpp v8, v8, v8 row_half_mirror row_mask:0xf bank_mask:0xf
    v_cmp_eq_u32 vcc, 3, v3
    s_nop 1
    v_cndmask_b32 v10, v10, v8, vcc
    s_waitcnt vmcnt(27)
    v_mov_b32 v8, 0
    v_mov_b32 v9, 0
    v_dot2_f32_bf16 v8, v208, v16, v8
    v_dot2_f32_bf16 v9, v209, v17, v9
    v_dot2_f32_bf16 v8, v210, v18, v8
    v_dot2_f32_bf16 v9, v211, v19, v9
    v_dot2_f32_bf16 v8, v212, v20, v8
    v_dot2_f32_bf16 v9, v213, v21, v9
    v_dot2_f32_bf16 v8, v214, v22, v8
    v_dot2_f32_bf16 v9, v215, v23, v9
    v_dot2_f32_bf16 v8, v216, v24, v8
    v_dot2_f32_bf16 v9, v217, v25, v9
    v_dot2_f32_bf16 v8, v218, v26, v8
    v_dot2_f32_bf16 v9, v219, v27, v9
    v_dot2_f32_bf16 v8, v220, v28, v8
    v_dot2_f32_bf16 v9, v221, v29, v9
    v_dot2_f32_bf16 v8, v222, v30, v8
    v_dot2_f32_bf16 v9, v223, v31, v9
    v_dot2_f32_bf16 v8, v224, v32, v8
    v_dot2_f32_bf16 v9, v225, v33, v9
    v_dot2_f32_bf16 v8, v226, v34, v8
    v_dot2_f32_bf16 v9, v227, v35, v9
    v_dot2_f32_bf16 v8, v228, v36, v8
    v_dot2_f32_bf16 v9, v229, v37, v9
    v_dot2_f32_bf16 v8, v230, v38, v8
    v_dot2_f32_bf16 v9, v231, v39, v9
    v_dot2_f32_bf16 v8, v232, v40, v8
    v_dot2_f32_bf16 v9, v233, v41, v9
    v_dot2_f32_bf16 v8, v234, v42, v8
    v_dot2_f32_bf16 v9, v235, v43, v9
    v_dot2_f32_bf16 v8, v236, v44, v8
    v_dot2_f32_bf16 v9, v237, v45, v9
    v_dot2_f32_bf16 v8, v238, v46, v8
    v_dot2_f32_bf16 v9, v239, v47, v9
    v_dot2_f32_bf16 v8, v240, v48, v8
    v_dot2_f32_bf16 v9, v241, v49, v9
    v_dot2_f32_bf16 v8, v242, v50, v8
    v_dot2_f32_bf16 v9, v243, v51, v9
    s_nop 3
    v_add_f32 v8, v8, v9
    s_nop 1
    v_add_f32_dpp v8, v8, v8 quad_perm:[1,0,3,2] row_mask:0xf bank_mask:0xf
    s_nop 1
    v_add_f32_dpp v8, v8, v8 quad_perm:[2,3,0,1] row_mask:0xf bank_mask:0xf
    s_nop 1
    v_add_f32_dpp v8, v8, v8 row_half_mirror row_mask:0xf bank_mask:0xf
    v_cmp_eq_u32 vcc, 4, v3
    s_nop 1
    v_cndmask_b32 v10, v10, v8, vcc
    s_waitcnt vmcnt(18)
    v_mov_b32 v8, 0
    v_mov_b32 v9, 0
    v_dot2_f32_bf16 v8, v64, v16, v8
    v_dot2_f32_bf16 v9, v65, v17, v9
    v_dot2_f32_bf16 v8, v66, v18, v8
    v_dot2_f32_bf16 v9, v67, v19, v9
    v_dot2_f32_bf16 v8, v68, v20, v8
    v_dot2_f32_bf16 v9, v69, v21, v9
    v_dot2_f32_bf16 v8, v70, v22, v8
    v_dot2_f32_bf16 v9, v71, v23, v9
    v_dot2_f32_bf16 v8, v72, v24, v8
    v_dot2_f32_bf16 v9, v73, v25, v9
    v_dot2_f32_bf16 v8, v74, v26, v8
    v_dot2_f32_bf16 v9, v75, v27, v9
    v_dot2_f32_bf16 v8, v76, v28, v8
    v_dot2_f32_bf16 v9, v77, v29, v9
    v_dot2_f32_bf16 v8, v78, v30, v8
    v_dot2_f32_bf16 v9, v79, v31, v9
    v_dot2_f32_bf16 v8, v80, v32, v8
    v_dot2_f32_bf16 v9, v81, v33, v9
    v_dot2_f32_bf16 v8, v82, v34, v8
    v_dot2_f32_bf16 v9, v83, v35, v9
    v_dot2_f32_bf16 v8, v84, v36, v8
    v_dot2_f32_bf16 v9, v85, v37, v9
    v_dot2_f32_bf16 v8, v86, v38, v8
    v_dot2_f32_bf16 v9, v87, v39, v9
    v_dot2_f32_bf16 v8, v88, v40, v8
    v_dot2_f32_bf16 v9, v89, v41, v9
    v_dot2_f32_bf16 v8, v90, v42, v8
    v_dot2_f32_bf16 v9, v91, v43, v9
    v_dot2_f32_bf16 v8, v92, v44, v8
    v_dot2_f32_bf16 v9, v93, v45, v9
    v_dot2_f32_bf16 v8, v94, v46, v8
    v_dot2_f32_bf16 v9, v95, v47, v9
    v_dot2_f32_bf16 v8, v96, v48, v8
    v_dot2_f32_bf16 v9, v97, v49, v9
    v_dot2_f32_bf16 v8, v98, v50, v8
    v_dot2_f32_bf16 v9, v99, v51, v9
    s_nop 3
    v_add_f32 v8, v8, v9
    s_nop 1
    v_add_f32_dpp v8, v8, v8 quad_perm:[1,0,3,2] row_mask:0xf bank_mask:0xf
    s_nop 1
    v_add_f32_dpp v8, v8, v8 quad_perm:[2,3,0,1] row_mask:0xf bank_mask:0xf
    s_nop 1
    v_add_f32_dpp v8, v8, v8 row_half_mirror row_mask:0xf bank_mask:0xf
    v_cmp_eq_u32 vcc, 5, v3
    s_nop 1
    v_cndmask_b32 v10, v10, v8, vcc
    s_waitcnt vmcnt(9)
    v_mov_b32 v8, 0
    v_mov_b32 v9, 0
    v_dot2_f32_bf16 v8, v100, v16, v8
    v_dot2_f32_bf16 v9, v101, v17, v9
    v_dot2_f32_bf16 v8, v102, v18, v8
    v_dot2_f32_bf16 v9, v103, v19, v9
    v_dot2_f32_bf16 v8, v104, v20, v8
    v_dot2_f32_bf16 v9, v105, v21, v9
    v_dot2_f32_bf16 v8, v106, v22, v8
    v_dot2_f32_bf16 v9, v107, v23, v9
    v_dot2_f32_bf16 v8, v108, v24, v8
    v_dot2_f32_bf16 v9, v109, v25, v9
    v_dot2_f32_bf16 v8, v110, v26, v8
    v_dot2_f32_bf16 v9, v111, v27, v9
    v_dot2_f32_bf16 v8, v112, v28, v8
    v_dot2_f32_bf16 v9, v113, v29, v9
    v_dot2_f32_bf16 v8, v114, v30, v8
    v_dot2_f32_bf16 v9, v115, v31, v9
    v_dot2_f32_bf16 v8, v116, v32, v8
    v_dot2_f32_bf16 v9, v117, v33, v9
    v_dot2_f32_bf16 v8, v118, v34, v8
    v_dot2_f32_bf16 v9, v119, v35, v9
    v_dot2_f32_bf16 v8, v120, v36, v8
    v_dot2_f32_bf16 v9, v121, v37, v9
    v_dot2_f32_bf16 v8, v122, v38, v8
    v_dot2_f32_bf16 v9, v123, v39, v9
    v_dot2_f32_bf16 v8, v124, v40, v8
    v_dot2_f32_bf16 v9, v125, v41, v9
    v_dot2_f32_bf16 v8, v126, v42, v8
    v_dot2_f32_bf16 v9, v127, v43, v9
    v_dot2_f32_bf16 v8, v128, v44, v8
    v_dot2_f32_bf16 v9, v129, v45, v9
    v_dot2_f32_bf16 v8, v130, v46, v8
    v_dot2_f32_bf16 v9, v131, v47, v9
    v_dot2_f32_bf16 v8, v132, v48, v8
    v_dot2_f32_bf16 v9, v133, v49, v9
    v_dot2_f32_bf16 v8, v134, v50, v8
    v_dot2_f32_bf16 v9, v135, v51, v9
    s_nop 3
    v_add_f32 v8, v8, v9
    s_nop 1
    v_add_f32_dpp v8, v8, v8 quad_perm:[1,0,3,2] row_mask:0xf bank_mask:0xf
    s_nop 1
    v_add_f32_dpp v8, v8, v8 quad_perm:[2,3,0,1] row_mask:0xf bank_mask:0xf
    s_nop 1
    v_add_f32_dpp v8, v8, v8 row_half_mirror row_mask:0xf bank_mask:0xf
    v_cmp_eq_u32 vcc, 6, v3
    s_nop 1
    v_cndmask_b32 v10, v10, v8, vcc
    s_waitcnt vmcnt(0)
    v_mov_b32 v8, 0
    v_mov_b32 v9, 0
    v_dot2_f32_bf16 v8, v136, v16, v8
    v_dot2_f32_bf16 v9, v137, v17, v9
    v_dot2_f32_bf16 v8, v138, v18, v8
    v_dot2_f32_bf16 v9, v139, v19, v9
    v_dot2_f32_bf16 v8, v140, v20, v8
    v_dot2_f32_bf16 v9, v141, v21, v9
    v_dot2_f32_bf16 v8, v142, v22, v8
    v_dot2_f32_bf16 v9, v143, v23, v9
    v_dot2_f32_bf16 v8, v144, v24, v8
    v_dot2_f32_bf16 v9, v145, v25, v9
    v_dot2_f32_bf16 v8, v146, v26, v8
    v_dot2_f32_bf16 v9, v147, v27, v9
    v_dot2_f32_bf16 v8, v148, v28, v8
    v_dot2_f32_bf16 v9, v149, v29, v9
    v_dot2_f32_bf16 v8, v150, v30, v8
    v_dot2_f32_bf16 v9, v151, v31, v9
    v_dot2_f32_bf16 v8, v152, v32, v8
    v_dot2_f32_bf16 v9, v153, v33, v9
    v_dot2_f32_bf16 v8, v154, v34, v8
    v_dot2_f32_bf16 v9, v155, v35, v9
    v_dot2_f32_bf16 v8, v156, v36, v8
    v_dot2_f32_bf16 v9, v157, v37, v9
    v_dot2_f32_bf16 v8, v158, v38, v8
    v_dot2_f32_bf16 v9, v159, v39, v9
    v_dot2_f32_bf16 v8, v160, v40, v8
    v_dot2_f32_bf16 v9, v161, v41, v9
    v_dot2_f32_bf16 v8, v162, v42, v8
    v_dot2_f32_bf16 v9, v163, v43, v9
    v_dot2_f32_bf16 v8, v164, v44, v8
    v_dot2_f32_bf16 v9, v165, v45, v9
    v_dot2_f32_bf16 v8, v166, v46, v8
    v_dot2_f32_bf16 v9, v167, v47, v9
    v_dot2_f32_bf16 v8, v168, v48, v8
    v_dot2_f32_bf16 v9, v169, v49, v9
    v_dot2_f32_bf16 v8, v170, v50, v8
    v_dot2_f32_bf16 v9, v171, v51, v9
    s_nop 3
    v_add_f32 v8, v8, v9
    s_nop 1
    v_add_f32_dpp v8, v8, v8 quad_perm:[1,0,3,2] row_mask:0xf bank_mask:0xf
    s_nop 1
    v_add_f32_dpp v8, v8, v8 quad_perm:[2,3,0,1] row_mask:0xf bank_mask:0xf
    s_nop 1
    v_add_f32_dpp v8, v8, v8 row_half_mirror row_mask:0xf bank_mask:0xf
    v_cmp_eq_u32 vcc, 7, v3
    s_nop 1
    v_cndmask_b32 v10, v10, v8, vcc
    buffer_store_dwordx4 v[12:15], v7, s[56:59], s69 offen sc0 sc1
    s_add_u32 s69, s69, 1024
    buffer_store_dwordx4 v[12:15], v7, s[56:59], s69 offen sc0 sc1
    s_add_u32 s69, s69, 1024
    buffer_store_dwordx4 v[12:15], v7, s[56:59], s69 offen sc0 sc1
    s_add_u32 s69, s69, 1024
    buffer_store_dwordx4 v[12:15], v7, s[56:59], s69 offen sc0 sc1
    s_add_u32 s69, s69, 1024
    buffer_store_dwordx4 v[12:15], v7, s[56:59], s69 offen sc0 sc1
    s_add_u32 s69, s69, 1024
    v_cvt_pk_bf16_f32 v11, v10, v10
    v_lshlrev_b32 v10, 16, v11
    v_mul_f32 v10, 0xbfb8aa3b, v10
    v_exp_f32 v10, v10
    s_nop 0
    v_add_f32 v10, 1.0, v10
    v_rcp_f32 v10, v10
    s_nop 0
    v_cvt_pk_bf16_f32 v11, v10, v10
    v_lshlrev_b32 v10, 16, v11
    v_lshl_add_u32 v11, v3, 3, v4
    v_lshlrev_b32 v11, 2, v11
    s_lshl_b32 s50, s50, 8
    s_add_u32 s50, s50, 10485760
    buffer_store_dword v10, v11, s[56:59], s50 offen sc0 sc1
    s_add_u32 s12, s6, 50331648
    s_addc_u32 s13, s7, 0
    s_and_b32 s13, s13, 0xffff
    s_mov_b32 s14, 2359296
    s_mov_b32 s15, 0x00020000
    s_lshl_b32 s79, s78, 3
    s_add_u32 s79, s79, s22
    s_lshl_b32 s79, s79, 12
    s_lshr_b32 s34, s78, 3
    s_add_u32 s34, s34, 64
    s_lshl_b32 s34, s34, 3
    s_add_u32 s34, s34, s22
    s_lshl_b32 s40, s34, 12
    v_and_b32 v24, 63, v0
    v_lshlrev_b32 v19, 4, v24
    v_lshrrev_b32 v25, 1, v24
    v_xor_b32 v25, s78, v25
    v_and_b32 v25, 7, v25
    v_lshlrev_b32 v24, 7, v24
    v_lshl_add_u32 v20, v25, 4, v24
    s_lshr_b32 s34, s78, 3
    v_mov_b32 v24, s34
    v_and_b32 v25, 16, v0
    v_cmp_eq_u32 vcc, 0, v25
    s_nop 1
    v_cndmask_b32 v24, 8, v24, vcc
    v_and_b32 v25, 15, v0
    v_mad_u32_u24 v24, v25, 9, v24
    v_lshrrev_b32 v25, 2, v24
    v_and_b32 v24, 3, v24
    v_mul_u32_u24 v26, 57, v25
    v_lshrrev_b32 v26, 9, v26
    v_mul_u32_u24 v27, 9, v26
    v_sub_u32 v27, v25, v27
    s_movk_i32 s34, 0
    v_bfe_u32 v27, s34, v27, 1
    v_add_u32 v27, v27, v24
    v_cmp_eq_u32 vcc, 4, v27
    v_add_u32 v26, 252, v26
    v_mad_u32_u24 v24, v25, 7, v24
    v_cndmask_b32 v24, v24, v26, vcc
    v_lshlrev_b32 v22, 7, v24
    s_sub_u32 s24, s36, 16
    s_subb_u32 s25, s37, 0
    s_and_b32 s25, s25, 0xffff
    s_mov_b32 s26, 2359312
    s_mov_b32 s27, 0x00020000
    s_lshl_b32 s34, s78, 3
    s_add_u32 s34, s34, s22
    s_lshl_b32 s34, s34, 1
    s_and_b32 s34, s34, 0xfffffffc
    s_load_dword s60, s[38:39], s34
    s_lshl_b32 s34, s78, 1
    s_and_b32 s34, s34, 0xfffffffc
    s_add_u32 s34, s34, 1024
    s_load_dword s61, s[38:39], s34
    v_mov_b32 v1, v19
    v_mov_b32 v2, v20
    v_mov_b32 v24, 0
    v_mov_b32 v25, 0
    v_lshrrev_b32 v26, 1, v1
    v_add_u32 v26, 107136, v26
    ds_write_b64 v26, v[24:25] offset:7936
    s_mul_i32 s34, s22, 472
    v_add_u32 v27, s34, v26
    ds_write_b64 v27, v[24:25]
    ds_write_b64 v26, v[24:25] offset:3328
    s_mul_i32 s45, s22, 4128
    s_add_u32 m0, s45, 32
    s_lshl_b32 s45, s78, 3
    s_add_u32 s45, s45, s22
    s_lshl_b32 s45, s45, 12
    s_add_u32 s45, s45, 16
    buffer_load_dwordx4 v1, s[24:27], s45 offen lds
    s_add_u32 m0, m0, 37184
    s_sub_u32 s45, s45, 2
    s_mov_b64 exec, -2
    buffer_load_dwordx4 v1, s[24:27], s45 offen lds
    s_mov_b64 exec, -1
    s_mul_i32 s45, s22, 4128
    s_add_u32 m0, s45, 1056
    s_lshl_b32 s45, s78, 3
    s_add_u32 s45, s45, s22
    s_lshl_b32 s45, s45, 12
    s_add_u32 s45, s45, 1040
    buffer_load_dwordx4 v1, s[24:27], s45 offen lds
    s_add_u32 m0, m0, 37184
    s_sub_u32 s45, s45, 2
    buffer_load_dwordx4 v1, s[24:27], s45 offen lds
    s_mul_i32 s45, s22, 4128
    s_add_u32 m0, s45, 2080
    s_lshl_b32 s45, s78, 3
    s_add_u32 s45, s45, s22
    s_lshl_b32 s45, s45, 12
    s_add_u32 s45, s45, 2064
    buffer_load_dwordx4 v1, s[24:27], s45 offen lds
    s_add_u32 m0, m0, 37184
    s_sub_u32 s45, s45, 2
    buffer_load_dwordx4 v1, s[24:27], s45 offen lds
    s_mul_i32 s45, s22, 4128
    s_add_u32 m0, s45, 3104
    s_lshl_b32 s45, s78, 3
    s_add_u32 s45, s45, s22
    s_lshl_b32 s45, s45, 12
    s_add_u32 s45, s45, 3088
    buffer_load_dwordx4 v1, s[24:27], s45 offen lds
    s_add_u32 m0, m0, 37184
    s_sub_u32 s45, s45, 2
    buffer_load_dwordx4 v1, s[24:27], s45 offen lds
    s_lshl_b32 s45, s22, 9
    s_add_u32 m0, s45, 33056
    s_lshl_b32 s34, s78, 12
    s_add_u32 s45, s45, s34
    s_add_u32 s45, s45, 2097168
    s_mov_b32 exec_hi, 0
    buffer_load_dwordx4 v1, s[24:27], s45 offen lds
    s_mov_b64 exec, -1
    s_add_u32 m0, m0, 37184
    s_sub_u32 s45, s45, 2
    s_mov_b32 exec_hi, 0
    buffer_load_dwordx4 v1, s[24:27], s45 offen lds
    s_mov_b64 exec, -1
    s_movk_i32 s98, 0x4000
fused_kernel_gl:
    s_mov_b64 exec, 1
    buffer_load_dword v9, off, s[28:31], 0 sc0 sc1
    s_mov_b64 exec, -1
    s_waitcnt vmcnt(0)
    v_readfirstlane_b32 s34, v9
    s_cmp_lg_u32 s34, 0
    s_cbranch_scc1 fused_kernel_gok
    s_sleep 2
    s_sub_u32 s98, s98, 1
    s_cbranch_scc0 fused_kernel_gl
fused_kernel_gok:
    s_waitcnt lgkmcnt(0)
    s_barrier
    s_lshl_b32 s2, s49, 7
    s_add_u32 s2, s2, 32256
    v_mov_b32 v24, 1
    v_lshlrev_b32 v25, 2, v0
    v_and_b32 v25, 127, v25
    s_mov_b64 exec, s[100:101]
    buffer_store_dword v24, v25, s[92:95], s99 offen sc0 sc1
    s_mov_b64 exec, -1
    v_mov_b32 v26, 32
    v_lshlrev_b32 v27, 2, v0
    v_and_b32 v27, 127, v27
    s_mov_b64 exec, s[100:101]
    buffer_store_dword v26, v27, s[92:95], s2 offen sc0 sc1
    s_mov_b64 exec, -1
    v_mov_b32 v9, 0
    s_cmp_eq_u32 s100, 0
    s_cbranch_scc1 fused_kernel_gkw_ok
    s_movk_i32 s98, 0x4000
fused_kernel_gkw_l:
    v_and_b32 v24, 32, v9
    v_cmp_ne_u32 vcc, 0, v24
    s_nop 1
    s_cmp_eq_u32 vcc_lo, -1
    s_cbranch_scc1 fused_kernel_gkw_ok
    s_sleep 8
    s_andn2_b64 exec, s[100:101], vcc
    buffer_load_dword v9, v22, s[92:95], 0 offen sc0 sc1
    s_mov_b64 exec, -1
    s_waitcnt vmcnt(0)
    s_sub_u32 s98, s98, 1
    s_cbranch_scc0 fused_kernel_gkw_l
fused_kernel_gkw_ok:
    s_mov_b64 s[100:101], 0
    s_barrier
    s_lshl_b32 s45, s22, 12
    s_add_u32 m0, s45, 74368
    s_nop 0
    buffer_load_dwordx4 v1, s[12:15], s79 offen sc0 sc1 lds
    buffer_load_dwordx4 v1, s[12:15], s79 offen offset:1024 sc0 sc1 lds
    buffer_load_dwordx4 v1, s[12:15], s79 offen offset:2048 sc0 sc1 lds
    buffer_load_dwordx4 v1, s[12:15], s79 offen offset:3072 sc0 sc1 lds
    s_lshl_b32 s45, s22, 9
    s_add_u32 m0, s45, 110976
    s_mov_b32 exec_hi, 0
    buffer_load_dwordx4 v2, s[12:15], s40 offen sc0 sc1 lds
    s_mov_b64 exec, -1
    s_waitcnt vmcnt(0)
    s_barrier
    s_add_u32 s16, s6, 0
    s_addc_u32 s17, s7, 0
    s_and_b32 s17, s17, 0xffff
    s_mov_b32 s18, 0
    s_mov_b32 s19, 0x00020000
    s_mov_b32 s47, 0
    v_mov_b32 v23, 0
    s_branch fused_kernel_conv
fused_kernel_xlate:
    s_bitcmp1_b32 s66, 1
    s_cbranch_scc1 fused_kernel_xl_s1_ok
    s_movk_i32 s98, 0x4000
fused_kernel_xl_s1_l:
    s_andn2_b32 exec_lo, 0x30003, s76
    s_mov_b32 exec_hi, 0
    buffer_load_dword v9, v22, s[92:95], 0 offen sc0 sc1
    s_mov_b64 exec, -1
    s_waitcnt vmcnt(0)
    v_bfe_u32 v24, v22, 2, 3
    v_bfe_u32 v24, v9, v24, 1
    v_cmp_ne_u32 vcc, 0, v24
    s_nop 1
    s_mov_b32 s76, vcc_lo
    s_lshr_b32 s66, vcc_lo, 16
    s_and_b32 s66, s66, vcc_lo
    s_bitcmp1_b32 s66, 1
    s_cbranch_scc1 fused_kernel_xl_s1_ok
    s_sleep 2
    s_sub_u32 s98, s98, 1
    s_cbranch_scc0 fused_kernel_xl_s1_l
fused_kernel_xl_s1_ok:
    s_bfe_u32 s3, s54, 0x40004
    s_lshl_b32 s3, s3, 1
    s_lshl_b32 s21, s3, 18
    s_add_u32 s20, s21, s60
    s_add_u32 s21, s21, s61
    s_add_u32 s21, s21, 2048
    s_cmp_eq_u32 s33, 0
    s_cselect_b32 s20, s20, s21
    s_lshl_b32 s21, s33, 11
    s_add_u32 s21, s21, s40
    s_add_u32 m0, s21, 81920
    s_nop 0
    buffer_load_dwordx4 v3, s[16:19], s20 offen sc0 sc1 lds
    buffer_load_dwordx4 v3, s[16:19], s20 offen offset:1024 sc0 sc1 lds
    s_waitcnt vmcnt(0)
fused_kernel_cons:
    s_setprio 2
    s_and_b32 s42, s22, 1
    s_lshr_b32 s43, s22, 1
    v_bfe_u32 v3, v0, 4, 2
    v_and_b32 v4, 15, v0
    v_lshrrev_b32 v5, 1, v3
    v_lshlrev_b32 v5, 9, v5
    v_and_b32 v6, 1, v3
    v_lshl_add_u32 v5, v6, 4, v5
    s_lshl_b32 s34, s42, 13
    v_lshl_add_u32 v7, v4, 5, v5
    v_add_u32 v24, s34, v7
    v_lshrrev_b32 v5, 2, v4
    v_lshl_add_u32 v6, v3, 3, v5
    v_mul_u32_u24 v6, 384, v6
    v_and_b32 v7, 1, v0
    v_lshl_add_u32 v6, v7, 4, v6
    v_add_u32 v6, 16384, v6
    v_lshrrev_b32 v5, 1, v5
    v_and_b32 v7, 1, v3
    v_lshl_add_u32 v5, v7, 1, v5
    v_bfe_u32 v8, v0, 1, 1
    v_xor_b32 v5, v5, v8
    s_mul_i32 s34, s43, 3
    s_add_u32 s34, s34, 0
    s_and_b32 s35, s34, 1
    s_lshl_b32 s35, s35, 1
    s_lshr_b32 s34, s34, 1
    s_lshl_b32 s34, s34, 7
    v_xor_b32 v7, s35, v5
    v_lshl_add_u32 v7, v7, 5, v6
    v_lshl_add_u32 v7, v8, 3, v7
    v_add_u32 v26, s34, v7
    v_xor_b32 v27, 8, v26
    s_mul_i32 s34, s43, 3
    s_add_u32 s34, s34, 1
    s_and_b32 s35, s34, 1
    s_lshl_b32 s35, s35, 1
    s_lshr_b32 s34, s34, 1
    s_lshl_b32 s34, s34, 7
    v_xor_b32 v7, s35, v5
    v_lshl_add_u32 v7, v7, 5, v6
    v_lshl_add_u32 v7, v8, 3, v7
    v_add_u32 v28, s34, v7
    v_xor_b32 v29, 8, v28
    ds_read_b128 v[80:83], v24 offset:0
    ds_read_b64_tr_b16 v[96:97], v26 offset:0
    ds_read_b64_tr_b16 v[98:99], v26 offset:1536
    ds_read_b128 v[84:87], v24 offset:2048
    ds_read_b128 v[88:91], v24 offset:4096
    ds_read_b128 v[92:95], v24 offset:6144
    ds_read_b64_tr_b16 v[100:101], v27 offset:0
    ds_read_b64_tr_b16 v[102:103], v27 offset:1536
    ds_read_b64_tr_b16 v[104:105], v28 offset:0
    ds_read_b64_tr_b16 v[106:107], v28 offset:1536
    ds_read_b64_tr_b16 v[108:109], v29 offset:0
    ds_read_b64_tr_b16 v[110:111], v29 offset:1536
    ds_read_b64_tr_b16 v[112:113], v26 offset:128
    ds_read_b64_tr_b16 v[114:115], v26 offset:1664
    ds_read_b64_tr_b16 v[116:117], v27 offset:128
    ds_read_b64_tr_b16 v[118:119], v27 offset:1664
    ds_read_b128 v[120:123], v24 offset:1024
    ds_read_b64_tr_b16 v[136:137], v26 offset:12288
    ds_read_b64_tr_b16 v[138:139], v26 offset:13824
    ds_read_b128 v[124:127], v24 offset:3072
    ds_read_b128 v[128:131], v24 offset:5120
    ds_read_b128 v[132:135], v24 offset:7168
    ds_read_b64_tr_b16 v[140:141], v27 offset:12288
    ds_read_b64_tr_b16 v[142:143], v27 offset:13824
    ds_read_b64_tr_b16 v[144:145], v28 offset:12288
    ds_read_b64_tr_b16 v[146:147], v28 offset:13824
    ds_read_b64_tr_b16 v[148:149], v29 offset:12288
    ds_read_b64_tr_b16 v[150:151], v29 offset:13824
    ds_read_b64_tr_b16 v[152:153], v26 offset:12416
    ds_read_b64_tr_b16 v[154:155], v26 offset:13952
    ds_read_b64_tr_b16 v[156:157], v27 offset:12416
    ds_read_b64_tr_b16 v[158:159], v27 offset:13952
    s_setprio 1
    s_waitcnt lgkmcnt(0)
    s_barrier
    v_mfma_f32_16x16x32_bf16 v[160:163], v[96:99], v[80:83], 0
    v_mul_f32 v10, s46, v64
    v_mfma_f32_16x16x32_bf16 v[184:187], v[96:99], v[84:87], 0
    v_mul_f32 v11, s46, v65
    v_mfma_f32_16x16x32_bf16 v[208:211], v[96:99], v[88:91], 0
    v_mul_f32 v12, s46, v66
    v_mfma_f32_16x16x32_bf16 v[232:235], v[96:99], v[92:95], 0
    v_mul_f32 v13, s46, v67
    v_mfma_f32_16x16x32_bf16 v[164:167], v[100:103], v[80:83], 0
    v_exp_f32 v10, v10
    v_mfma_f32_16x16x32_bf16 v[188:191], v[100:103], v[84:87], 0
    v_exp_f32 v11, v11
    v_mfma_f32_16x16x32_bf16 v[212:215], v[100:103], v[88:91], 0
    v_exp_f32 v12, v12
    v_mfma_f32_16x16x32_bf16 v[236:239], v[100:103], v[92:95], 0
    v_exp_f32 v13, v13
    v_mfma_f32_16x16x32_bf16 v[168:171], v[104:107], v[80:83], 0
    v_mul_f32 v14, v64, v68
    v_mfma_f32_16x16x32_bf16 v[192:195], v[104:107], v[84:87], 0
    v_mul_f32 v15, v65, v69
    v_mfma_f32_16x16x32_bf16 v[216:219], v[104:107], v[88:91], 0
    v_mul_f32 v16, v66, v70
    v_mfma_f32_16x16x32_bf16 v[240:243], v[104:107], v[92:95], 0
    v_mul_f32 v17, v67, v71
    v_mfma_f32_16x16x32_bf16 v[172:175], v[108:111], v[80:83], 0
    v_add_f32 v10, 1.0, v10
    v_mfma_f32_16x16x32_bf16 v[196:199], v[108:111], v[84:87], 0
    v_add_f32 v11, 1.0, v11
    v_mfma_f32_16x16x32_bf16 v[220:223], v[108:111], v[88:91], 0
    v_add_f32 v12, 1.0, v12
    v_mfma_f32_16x16x32_bf16 v[244:247], v[108:111], v[92:95], 0
    v_add_f32 v13, 1.0, v13
    v_mfma_f32_16x16x32_bf16 v[176:179], v[112:115], v[80:83], 0
    v_rcp_f32 v10, v10
    v_mfma_f32_16x16x32_bf16 v[200:203], v[112:115], v[84:87], 0
    v_rcp_f32 v11, v11
    v_mfma_f32_16x16x32_bf16 v[224:227], v[112:115], v[88:91], 0
    v_rcp_f32 v12, v12
    v_mfma_f32_16x16x32_bf16 v[248:251], v[112:115], v[92:95], 0
    v_rcp_f32 v13, v13
    v_mfma_f32_16x16x32_bf16 v[180:183], v[116:119], v[80:83], 0
    v_mul_f32 v14, v14, v10
    v_mfma_f32_16x16x32_bf16 v[204:207], v[116:119], v[84:87], 0
    v_mul_f32 v15, v15, v11
    v_mfma_f32_16x16x32_bf16 v[228:231], v[116:119], v[88:91], 0
    v_mul_f32 v16, v16, v12
    v_mfma_f32_16x16x32_bf16 v[252:255], v[116:119], v[92:95], 0
    v_mul_f32 v17, v17, v13
    v_mfma_f32_16x16x32_bf16 v[160:163], v[136:139], v[120:123], v[160:163]
    ds_read_b128 v[80:83], v24 offset:40960
    v_cvt_pk_bf16_f32 v20, v14, v15
    v_mfma_f32_16x16x32_bf16 v[184:187], v[136:139], v[124:127], v[184:187]
    ds_read_b64_tr_b16 v[96:97], v26 offset:40960
    v_cvt_pk_bf16_f32 v21, v16, v17
    v_mfma_f32_16x16x32_bf16 v[208:211], v[136:139], v[128:131], v[208:211]
    ds_read_b64_tr_b16 v[98:99], v26 offset:42496
    s_nop 0
    v_permlane16_swap_b32 v18, v20
    v_permlane16_swap_b32 v19, v21
    v_mfma_f32_16x16x32_bf16 v[232:235], v[136:139], v[132:135], v[232:235]
    ds_read_b128 v[84:87], v24 offset:43008
    s_nop 0
    buffer_store_dwordx4 v[18:21], v23, s[16:19], s47 offen sc0 sc1
    s_add_u32 s47, s47, 4096
    v_mfma_f32_16x16x32_bf16 v[164:167], v[140:143], v[120:123], v[164:167]
    ds_read_b128 v[88:91], v24 offset:45056
    v_mfma_f32_16x16x32_bf16 v[188:191], v[140:143], v[124:127], v[188:191]
    ds_read_b128 v[92:95], v24 offset:47104
    v_mfma_f32_16x16x32_bf16 v[212:215], v[140:143], v[128:131], v[212:215]
    ds_read_b64_tr_b16 v[100:101], v27 offset:40960
    v_mfma_f32_16x16x32_bf16 v[236:239], v[140:143], v[132:135], v[236:239]
    ds_read_b64_tr_b16 v[102:103], v27 offset:42496
    v_mfma_f32_16x16x32_bf16 v[168:171], v[144:147], v[120:123], v[168:171]
    ds_read_b64_tr_b16 v[104:105], v28 offset:40960
    v_mfma_f32_16x16x32_bf16 v[192:195], v[144:147], v[124:127], v[192:195]
    ds_read_b64_tr_b16 v[106:107], v28 offset:42496
    v_mfma_f32_16x16x32_bf16 v[216:219], v[144:147], v[128:131], v[216:219]
    ds_read_b64_tr_b16 v[108:109], v29 offset:40960
    v_mfma_f32_16x16x32_bf16 v[240:243], v[144:147], v[132:135], v[240:243]
    ds_read_b64_tr_b16 v[110:111], v29 offset:42496
    v_mfma_f32_16x16x32_bf16 v[172:175], v[148:151], v[120:123], v[172:175]
    ds_read_b64_tr_b16 v[112:113], v26 offset:41088
    v_mfma_f32_16x16x32_bf16 v[196:199], v[148:151], v[124:127], v[196:199]
    ds_read_b64_tr_b16 v[114:115], v26 offset:42624
    v_mfma_f32_16x16x32_bf16 v[220:223], v[148:151], v[128:131], v[220:223]
    ds_read_b64_tr_b16 v[116:117], v27 offset:41088
    v_mfma_f32_16x16x32_bf16 v[244:247], v[148:151], v[132:135], v[244:247]
    ds_read_b64_tr_b16 v[118:119], v27 offset:42624
    v_mfma_f32_16x16x32_bf16 v[176:179], v[152:155], v[120:123], v[176:179]
    v_add_u32 v25, 81920, v24
    v_mfma_f32_16x16x32_bf16 v[200:203], v[152:155], v[124:127], v[200:203]
    v_add_u32 v30, 81920, v26
    v_mfma_f32_16x16x32_bf16 v[224:227], v[152:155], v[128:131], v[224:227]
    v_add_u32 v31, 81920, v27
    v_mfma_f32_16x16x32_bf16 v[248:251], v[152:155], v[132:135], v[248:251]
    v_add_u32 v32, 81920, v28
    v_mfma_f32_16x16x32_bf16 v[180:183], v[156:159], v[120:123], v[180:183]
    v_add_u32 v33, 81920, v29
    v_mfma_f32_16x16x32_bf16 v[204:207], v[156:159], v[124:127], v[204:207]
    s_add_u32 s56, s6, 20971520
    v_mfma_f32_16x16x32_bf16 v[228:231], v[156:159], v[128:131], v[228:231]
    s_addc_u32 s57, s7, 0
    v_mfma_f32_16x16x32_bf16 v[252:255], v[156:159], v[132:135], v[252:255]
    s_and_b32 s57, s57, 0xffff
    s_waitcnt lgkmcnt(0)
    v_mfma_f32_16x16x32_bf16 v[160:163], v[96:99], v[80:83], v[160:163]
    ds_read_b128 v[120:123], v24 offset:41984
    v_mfma_f32_16x16x32_bf16 v[184:187], v[96:99], v[84:87], v[184:187]
    ds_read_b64_tr_b16 v[136:137], v26 offset:53248
    v_mfma_f32_16x16x32_bf16 v[208:211], v[96:99], v[88:91], v[208:211]
    ds_read_b64_tr_b16 v[138:139], v26 offset:54784
    v_mfma_f32_16x16x32_bf16 v[232:235], v[96:99], v[92:95], v[232:235]
    ds_read_b128 v[124:127], v24 offset:44032
    v_mfma_f32_16x16x32_bf16 v[164:167], v[100:103], v[80:83], v[164:167]
    ds_read_b128 v[128:131], v24 offset:46080
    v_mfma_f32_16x16x32_bf16 v[188:191], v[100:103], v[84:87], v[188:191]
    ds_read_b128 v[132:135], v24 offset:48128
    v_mfma_f32_16x16x32_bf16 v[212:215], v[100:103], v[88:91], v[212:215]
    ds_read_b64_tr_b16 v[140:141], v27 offset:53248
    v_mfma_f32_16x16x32_bf16 v[236:239], v[100:103], v[92:95], v[236:239]
    ds_read_b64_tr_b16 v[142:143], v27 offset:54784
    v_mfma_f32_16x16x32_bf16 v[168:171], v[104:107], v[80:83], v[168:171]
    ds_read_b64_tr_b16 v[144:145], v28 offset:53248
    v_mfma_f32_16x16x32_bf16 v[192:195], v[104:107], v[84:87], v[192:195]
    ds_read_b64_tr_b16 v[146:147], v28 offset:54784
    v_mfma_f32_16x16x32_bf16 v[216:219], v[104:107], v[88:91], v[216:219]
    ds_read_b64_tr_b16 v[148:149], v29 offset:53248
    v_mfma_f32_16x16x32_bf16 v[240:243], v[104:107], v[92:95], v[240:243]
    ds_read_b64_tr_b16 v[150:151], v29 offset:54784
    v_mfma_f32_16x16x32_bf16 v[172:175], v[108:111], v[80:83], v[172:175]
    ds_read_b64_tr_b16 v[152:153], v26 offset:53376
    v_mfma_f32_16x16x32_bf16 v[196:199], v[108:111], v[84:87], v[196:199]
    ds_read_b64_tr_b16 v[154:155], v26 offset:54912
    v_mfma_f32_16x16x32_bf16 v[220:223], v[108:111], v[88:91], v[220:223]
    ds_read_b64_tr_b16 v[156:157], v27 offset:53376
    v_mfma_f32_16x16x32_bf16 v[244:247], v[108:111], v[92:95], v[244:247]
    ds_read_b64_tr_b16 v[158:159], v27 offset:54912
    v_mfma_f32_16x16x32_bf16 v[176:179], v[112:115], v[80:83], v[176:179]
    s_mov_b32 s58, 10493952
    v_mfma_f32_16x16x32_bf16 v[200:203], v[112:115], v[84:87], v[200:203]
    s_mov_b32 s59, 0x00020000
    v_mfma_f32_16x16x32_bf16 v[224:227], v[112:115], v[88:91], v[224:227]
    s_mul_i32 s44, s77, 40960
    v_mfma_f32_16x16x32_bf16 v[248:251], v[112:115], v[92:95], v[248:251]
    s_mul_i32 s34, s22, 9216
    v_mfma_f32_16x16x32_bf16 v[180:183], v[116:119], v[80:83], v[180:183]
    s_add_u32 s44, s44, s34
    v_mfma_f32_16x16x32_bf16 v[204:207], v[116:119], v[84:87], v[204:207]
    v_and_b32 v5, 63, v0
    v_mfma_f32_16x16x32_bf16 v[228:231], v[116:119], v[88:91], v[228:231]
    v_lshlrev_b32 v5, 4, v5
    v_mfma_f32_16x16x32_bf16 v[252:255], v[116:119], v[92:95], v[252:255]
    s_mul_i32 s34, s22, 6144
    s_waitcnt lgkmcnt(0)
    s_waitcnt vmcnt(1)
    s_barrier
    v_mfma_f32_16x16x32_bf16 v[160:163], v[136:139], v[120:123], v[160:163]
    ds_read_b128 v[80:83], v25 offset:0
    v_mfma_f32_16x16x32_bf16 v[184:187], v[136:139], v[124:127], v[184:187]
    ds_read_b64_tr_b16 v[96:97], v30 offset:0
    v_mfma_f32_16x16x32_bf16 v[208:211], v[136:139], v[128:131], v[208:211]
    ds_read_b64_tr_b16 v[98:99], v30 offset:1536
    v_mfma_f32_16x16x32_bf16 v[232:235], v[136:139], v[132:135], v[232:235]
    ds_read_b128 v[84:87], v25 offset:2048
    v_mfma_f32_16x16x32_bf16 v[164:167], v[140:143], v[120:123], v[164:167]
    ds_read_b128 v[88:91], v25 offset:4096
    v_mfma_f32_16x16x32_bf16 v[188:191], v[140:143], v[124:127], v[188:191]
    ds_read_b128 v[92:95], v25 offset:6144
    v_mfma_f32_16x16x32_bf16 v[212:215], v[140:143], v[128:131], v[212:215]
    ds_read_b64_tr_b16 v[100:101], v31 offset:0
    v_mfma_f32_16x16x32_bf16 v[236:239], v[140:143], v[132:135], v[236:239]
    ds_read_b64_tr_b16 v[102:103], v31 offset:1536
    v_mfma_f32_16x16x32_bf16 v[168:171], v[144:147], v[120:123], v[168:171]
    ds_read_b64_tr_b16 v[104:105], v32 offset:0
    v_mfma_f32_16x16x32_bf16 v[192:195], v[144:147], v[124:127], v[192:195]
    ds_read_b64_tr_b16 v[106:107], v32 offset:1536
    v_mfma_f32_16x16x32_bf16 v[216:219], v[144:147], v[128:131], v[216:219]
    ds_read_b64_tr_b16 v[108:109], v33 offset:0
    v_mfma_f32_16x16x32_bf16 v[240:243], v[144:147], v[132:135], v[240:243]
    ds_read_b64_tr_b16 v[110:111], v33 offset:1536
    v_mfma_f32_16x16x32_bf16 v[172:175], v[148:151], v[120:123], v[172:175]
    ds_read_b64_tr_b16 v[112:113], v30 offset:128
    v_mfma_f32_16x16x32_bf16 v[196:199], v[148:151], v[124:127], v[196:199]
    ds_read_b64_tr_b16 v[114:115], v30 offset:1664
    v_mfma_f32_16x16x32_bf16 v[220:223], v[148:151], v[128:131], v[220:223]
    ds_read_b64_tr_b16 v[116:117], v31 offset:128
    v_mfma_f32_16x16x32_bf16 v[244:247], v[148:151], v[132:135], v[244:247]
    ds_read_b64_tr_b16 v[118:119], v31 offset:1664
    v_mfma_f32_16x16x32_bf16 v[176:179], v[152:155], v[120:123], v[176:179]
    s_add_u32 s34, s34, 81920
    v_mfma_f32_16x16x32_bf16 v[200:203], v[152:155], v[124:127], v[200:203]
    v_add_u32 v6, s34, v5
    v_mfma_f32_16x16x32_bf16 v[224:227], v[152:155], v[128:131], v[224:227]
    v_mfma_f32_16x16x32_bf16 v[248:251], v[152:155], v[132:135], v[248:251]
    v_mfma_f32_16x16x32_bf16 v[180:183], v[156:159], v[120:123], v[180:183]
    v_mfma_f32_16x16x32_bf16 v[204:207], v[156:159], v[124:127], v[204:207]
    v_mfma_f32_16x16x32_bf16 v[228:231], v[156:159], v[128:131], v[228:231]
    v_mfma_f32_16x16x32_bf16 v[252:255], v[156:159], v[132:135], v[252:255]
    s_waitcnt lgkmcnt(0)
    v_mfma_f32_16x16x32_bf16 v[160:163], v[96:99], v[80:83], v[160:163]
    ds_read_b128 v[120:123], v25 offset:1024
    v_mfma_f32_16x16x32_bf16 v[184:187], v[96:99], v[84:87], v[184:187]
    ds_read_b64_tr_b16 v[136:137], v30 offset:12288
    v_mfma_f32_16x16x32_bf16 v[208:211], v[96:99], v[88:91], v[208:211]
    ds_read_b64_tr_b16 v[138:139], v30 offset:13824
    v_mfma_f32_16x16x32_bf16 v[232:235], v[96:99], v[92:95], v[232:235]
    ds_read_b128 v[124:127], v25 offset:3072
    v_mfma_f32_16x16x32_bf16 v[164:167], v[100:103], v[80:83], v[164:167]
    ds_read_b128 v[128:131], v25 offset:5120
    v_mfma_f32_16x16x32_bf16 v[188:191], v[100:103], v[84:87], v[188:191]
    ds_read_b128 v[132:135], v25 offset:7168
    v_mfma_f32_16x16x32_bf16 v[212:215], v[100:103], v[88:91], v[212:215]
    ds_read_b64_tr_b16 v[140:141], v31 offset:12288
    v_mfma_f32_16x16x32_bf16 v[236:239], v[100:103], v[92:95], v[236:239]
    ds_read_b64_tr_b16 v[142:143], v31 offset:13824
    v_mfma_f32_16x16x32_bf16 v[168:171], v[104:107], v[80:83], v[168:171]
    ds_read_b64_tr_b16 v[144:145], v32 offset:12288
    v_mfma_f32_16x16x32_bf16 v[192:195], v[104:107], v[84:87], v[192:195]
    ds_read_b64_tr_b16 v[146:147], v32 offset:13824
    v_mfma_f32_16x16x32_bf16 v[216:219], v[104:107], v[88:91], v[216:219]
    ds_read_b64_tr_b16 v[148:149], v33 offset:12288
    v_mfma_f32_16x16x32_bf16 v[240:243], v[104:107], v[92:95], v[240:243]
    ds_read_b64_tr_b16 v[150:151], v33 offset:13824
    v_mfma_f32_16x16x32_bf16 v[172:175], v[108:111], v[80:83], v[172:175]
    ds_read_b64_tr_b16 v[152:153], v30 offset:12416
    v_mfma_f32_16x16x32_bf16 v[196:199], v[108:111], v[84:87], v[196:199]
    ds_read_b64_tr_b16 v[154:155], v30 offset:13952
    v_mfma_f32_16x16x32_bf16 v[220:223], v[108:111], v[88:91], v[220:223]
    ds_read_b64_tr_b16 v[156:157], v31 offset:12416
    v_mfma_f32_16x16x32_bf16 v[244:247], v[108:111], v[92:95], v[244:247]
    ds_read_b64_tr_b16 v[158:159], v31 offset:13952
    v_mfma_f32_16x16x32_bf16 v[176:179], v[112:115], v[80:83], v[176:179]
    v_mfma_f32_16x16x32_bf16 v[200:203], v[112:115], v[84:87], v[200:203]
    v_mfma_f32_16x16x32_bf16 v[224:227], v[112:115], v[88:91], v[224:227]
    v_mfma_f32_16x16x32_bf16 v[248:251], v[112:115], v[92:95], v[248:251]
    v_mfma_f32_16x16x32_bf16 v[180:183], v[116:119], v[80:83], v[180:183]
    v_mfma_f32_16x16x32_bf16 v[204:207], v[116:119], v[84:87], v[204:207]
    v_mfma_f32_16x16x32_bf16 v[228:231], v[116:119], v[88:91], v[228:231]
    v_mfma_f32_16x16x32_bf16 v[252:255], v[116:119], v[92:95], v[252:255]
    s_waitcnt lgkmcnt(0)
    s_barrier
    v_mfma_f32_16x16x32_bf16 v[160:163], v[136:139], v[120:123], v[160:163]
    ds_read_b128 v[80:83], v25 offset:40960
    v_mfma_f32_16x16x32_bf16 v[184:187], v[136:139], v[124:127], v[184:187]
    ds_read_b64_tr_b16 v[96:97], v30 offset:40960
    v_mfma_f32_16x16x32_bf16 v[208:211], v[136:139], v[128:131], v[208:211]
    ds_read_b64_tr_b16 v[98:99], v30 offset:42496
    v_mfma_f32_16x16x32_bf16 v[232:235], v[136:139], v[132:135], v[232:235]
    ds_read_b128 v[84:87], v25 offset:43008
    v_mfma_f32_16x16x32_bf16 v[164:167], v[140:143], v[120:123], v[164:167]
    ds_read_b128 v[88:91], v25 offset:45056
    v_mfma_f32_16x16x32_bf16 v[188:191], v[140:143], v[124:127], v[188:191]
    ds_read_b128 v[92:95], v25 offset:47104
    v_mfma_f32_16x16x32_bf16 v[212:215], v[140:143], v[128:131], v[212:215]
    ds_read_b64_tr_b16 v[100:101], v31 offset:40960
    v_mfma_f32_16x16x32_bf16 v[236:239], v[140:143], v[132:135], v[236:239]
    ds_read_b64_tr_b16 v[102:103], v31 offset:42496
    v_mfma_f32_16x16x32_bf16 v[168:171], v[144:147], v[120:123], v[168:171]
    ds_read_b64_tr_b16 v[104:105], v32 offset:40960
    v_mfma_f32_16x16x32_bf16 v[192:195], v[144:147], v[124:127], v[192:195]
    ds_read_b64_tr_b16 v[106:107], v32 offset:42496
    v_mfma_f32_16x16x32_bf16 v[216:219], v[144:147], v[128:131], v[216:219]
    ds_read_b64_tr_b16 v[108:109], v33 offset:40960
    v_mfma_f32_16x16x32_bf16 v[240:243], v[144:147], v[132:135], v[240:243]
    ds_read_b64_tr_b16 v[110:111], v33 offset:42496
    v_mfma_f32_16x16x32_bf16 v[172:175], v[148:151], v[120:123], v[172:175]
    ds_read_b64_tr_b16 v[112:113], v30 offset:41088
    v_mfma_f32_16x16x32_bf16 v[196:199], v[148:151], v[124:127], v[196:199]
    ds_read_b64_tr_b16 v[114:115], v30 offset:42624
    v_mfma_f32_16x16x32_bf16 v[220:223], v[148:151], v[128:131], v[220:223]
    ds_read_b64_tr_b16 v[116:117], v31 offset:41088
    v_mfma_f32_16x16x32_bf16 v[244:247], v[148:151], v[132:135], v[244:247]
    ds_read_b64_tr_b16 v[118:119], v31 offset:42624
    v_mfma_f32_16x16x32_bf16 v[176:179], v[152:155], v[120:123], v[176:179]
    v_mfma_f32_16x16x32_bf16 v[200:203], v[152:155], v[124:127], v[200:203]
    v_mfma_f32_16x16x32_bf16 v[224:227], v[152:155], v[128:131], v[224:227]
    v_mfma_f32_16x16x32_bf16 v[248:251], v[152:155], v[132:135], v[248:251]
    v_mfma_f32_16x16x32_bf16 v[180:183], v[156:159], v[120:123], v[180:183]
    v_mfma_f32_16x16x32_bf16 v[204:207], v[156:159], v[124:127], v[204:207]
    v_mfma_f32_16x16x32_bf16 v[228:231], v[156:159], v[128:131], v[228:231]
    v_mfma_f32_16x16x32_bf16 v[252:255], v[156:159], v[132:135], v[252:255]
    s_waitcnt lgkmcnt(0)
    v_mfma_f32_16x16x32_bf16 v[160:163], v[96:99], v[80:83], v[160:163]
    ds_read_b128 v[120:123], v25 offset:41984
    v_mfma_f32_16x16x32_bf16 v[184:187], v[96:99], v[84:87], v[184:187]
    ds_read_b64_tr_b16 v[136:137], v30 offset:53248
    v_mfma_f32_16x16x32_bf16 v[208:211], v[96:99], v[88:91], v[208:211]
    ds_read_b64_tr_b16 v[138:139], v30 offset:54784
    v_mfma_f32_16x16x32_bf16 v[232:235], v[96:99], v[92:95], v[232:235]
    ds_read_b128 v[124:127], v25 offset:44032
    v_mfma_f32_16x16x32_bf16 v[164:167], v[100:103], v[80:83], v[164:167]
    ds_read_b128 v[128:131], v25 offset:46080
    v_mfma_f32_16x16x32_bf16 v[188:191], v[100:103], v[84:87], v[188:191]
    ds_read_b128 v[132:135], v25 offset:48128
    v_mfma_f32_16x16x32_bf16 v[212:215], v[100:103], v[88:91], v[212:215]
    ds_read_b64_tr_b16 v[140:141], v31 offset:53248
    v_mfma_f32_16x16x32_bf16 v[236:239], v[100:103], v[92:95], v[236:239]
    ds_read_b64_tr_b16 v[142:143], v31 offset:54784
    v_mfma_f32_16x16x32_bf16 v[168:171], v[104:107], v[80:83], v[168:171]
    ds_read_b64_tr_b16 v[144:145], v32 offset:53248
    v_mfma_f32_16x16x32_bf16 v[192:195], v[104:107], v[84:87], v[192:195]
    ds_read_b64_tr_b16 v[146:147], v32 offset:54784
    v_mfma_f32_16x16x32_bf16 v[216:219], v[104:107], v[88:91], v[216:219]
    ds_read_b64_tr_b16 v[148:149], v33 offset:53248
    v_mfma_f32_16x16x32_bf16 v[240:243], v[104:107], v[92:95], v[240:243]
    ds_read_b64_tr_b16 v[150:151], v33 offset:54784
    v_mfma_f32_16x16x32_bf16 v[172:175], v[108:111], v[80:83], v[172:175]
    ds_read_b64_tr_b16 v[152:153], v30 offset:53376
    v_mfma_f32_16x16x32_bf16 v[196:199], v[108:111], v[84:87], v[196:199]
    ds_read_b64_tr_b16 v[154:155], v30 offset:54912
    v_mfma_f32_16x16x32_bf16 v[220:223], v[108:111], v[88:91], v[220:223]
    ds_read_b64_tr_b16 v[156:157], v31 offset:53376
    v_mfma_f32_16x16x32_bf16 v[244:247], v[108:111], v[92:95], v[244:247]
    ds_read_b64_tr_b16 v[158:159], v31 offset:54912
    v_mfma_f32_16x16x32_bf16 v[176:179], v[112:115], v[80:83], v[176:179]
    v_mfma_f32_16x16x32_bf16 v[200:203], v[112:115], v[84:87], v[200:203]
    v_mfma_f32_16x16x32_bf16 v[224:227], v[112:115], v[88:91], v[224:227]
    v_mfma_f32_16x16x32_bf16 v[248:251], v[112:115], v[92:95], v[248:251]
    v_mfma_f32_16x16x32_bf16 v[180:183], v[116:119], v[80:83], v[180:183]
    v_mfma_f32_16x16x32_bf16 v[204:207], v[116:119], v[84:87], v[204:207]
    v_mfma_f32_16x16x32_bf16 v[228:231], v[116:119], v[88:91], v[228:231]
    v_mfma_f32_16x16x32_bf16 v[252:255], v[116:119], v[92:95], v[252:255]
    s_waitcnt lgkmcnt(0)
    s_waitcnt vmcnt(0)
    s_barrier
    v_mfma_f32_16x16x32_bf16 v[160:163], v[136:139], v[120:123], v[160:163]
    ds_read_b128 v[80:83], v24 offset:0
    v_mfma_f32_16x16x32_bf16 v[184:187], v[136:139], v[124:127], v[184:187]
    ds_read_b64_tr_b16 v[96:97], v26 offset:0
    v_mfma_f32_16x16x32_bf16 v[208:211], v[136:139], v[128:131], v[208:211]
    ds_read_b64_tr_b16 v[98:99], v26 offset:1536
    v_mfma_f32_16x16x32_bf16 v[232:235], v[136:139], v[132:135], v[232:235]
    ds_read_b128 v[84:87], v24 offset:2048
    v_mfma_f32_16x16x32_bf16 v[164:167], v[140:143], v[120:123], v[164:167]
    ds_read_b128 v[88:91], v24 offset:4096
    v_mfma_f32_16x16x32_bf16 v[188:191], v[140:143], v[124:127], v[188:191]
    ds_read_b128 v[92:95], v24 offset:6144
    v_mfma_f32_16x16x32_bf16 v[212:215], v[140:143], v[128:131], v[212:215]
    ds_read_b64_tr_b16 v[100:101], v27 offset:0
    v_mfma_f32_16x16x32_bf16 v[236:239], v[140:143], v[132:135], v[236:239]
    ds_read_b64_tr_b16 v[102:103], v27 offset:1536
    v_mfma_f32_16x16x32_bf16 v[168:171], v[144:147], v[120:123], v[168:171]
    ds_read_b64_tr_b16 v[104:105], v28 offset:0
    v_mfma_f32_16x16x32_bf16 v[192:195], v[144:147], v[124:127], v[192:195]
    ds_read_b64_tr_b16 v[106:107], v28 offset:1536
    v_mfma_f32_16x16x32_bf16 v[216:219], v[144:147], v[128:131], v[216:219]
    ds_read_b64_tr_b16 v[108:109], v29 offset:0
    v_mfma_f32_16x16x32_bf16 v[240:243], v[144:147], v[132:135], v[240:243]
    ds_read_b64_tr_b16 v[110:111], v29 offset:1536
    v_mfma_f32_16x16x32_bf16 v[172:175], v[148:151], v[120:123], v[172:175]
    ds_read_b64_tr_b16 v[112:113], v26 offset:128
    v_mfma_f32_16x16x32_bf16 v[196:199], v[148:151], v[124:127], v[196:199]
    ds_read_b64_tr_b16 v[114:115], v26 offset:1664
    v_mfma_f32_16x16x32_bf16 v[220:223], v[148:151], v[128:131], v[220:223]
    ds_read_b64_tr_b16 v[116:117], v27 offset:128
    v_mfma_f32_16x16x32_bf16 v[244:247], v[148:151], v[132:135], v[244:247]
    ds_read_b64_tr_b16 v[118:119], v27 offset:1664
    v_mfma_f32_16x16x32_bf16 v[176:179], v[152:155], v[120:123], v[176:179]
    v_mfma_f32_16x16x32_bf16 v[200:203], v[152:155], v[124:127], v[200:203]
    v_mfma_f32_16x16x32_bf16 v[224:227], v[152:155], v[128:131], v[224:227]
    v_mfma_f32_16x16x32_bf16 v[248:251], v[152:155], v[132:135], v[248:251]
    v_mfma_f32_16x16x32_bf16 v[180:183], v[156:159], v[120:123], v[180:183]
    v_mfma_f32_16x16x32_bf16 v[204:207], v[156:159], v[124:127], v[204:207]
    v_mfma_f32_16x16x32_bf16 v[228:231], v[156:159], v[128:131], v[228:231]
    v_mfma_f32_16x16x32_bf16 v[252:255], v[156:159], v[132:135], v[252:255]
    s_waitcnt lgkmcnt(0)
    v_mfma_f32_16x16x32_bf16 v[160:163], v[96:99], v[80:83], v[160:163]
    ds_read_b128 v[120:123], v24 offset:1024
    v_mfma_f32_16x16x32_bf16 v[184:187], v[96:99], v[84:87], v[184:187]
    ds_read_b64_tr_b16 v[136:137], v26 offset:12288
    v_mfma_f32_16x16x32_bf16 v[208:211], v[96:99], v[88:91], v[208:211]
    ds_read_b64_tr_b16 v[138:139], v26 offset:13824
    v_mfma_f32_16x16x32_bf16 v[232:235], v[96:99], v[92:95], v[232:235]
    ds_read_b128 v[124:127], v24 offset:3072
    v_mfma_f32_16x16x32_bf16 v[164:167], v[100:103], v[80:83], v[164:167]
    ds_read_b128 v[128:131], v24 offset:5120
    v_mfma_f32_16x16x32_bf16 v[188:191], v[100:103], v[84:87], v[188:191]
    ds_read_b128 v[132:135], v24 offset:7168
    v_mfma_f32_16x16x32_bf16 v[212:215], v[100:103], v[88:91], v[212:215]
    ds_read_b64_tr_b16 v[140:141], v27 offset:12288
    v_mfma_f32_16x16x32_bf16 v[236:239], v[100:103], v[92:95], v[236:239]
    ds_read_b64_tr_b16 v[142:143], v27 offset:13824
    v_mfma_f32_16x16x32_bf16 v[168:171], v[104:107], v[80:83], v[168:171]
    ds_read_b64_tr_b16 v[144:145], v28 offset:12288
    v_mfma_f32_16x16x32_bf16 v[192:195], v[104:107], v[84:87], v[192:195]
    ds_read_b64_tr_b16 v[146:147], v28 offset:13824
    v_mfma_f32_16x16x32_bf16 v[216:219], v[104:107], v[88:91], v[216:219]
    ds_read_b64_tr_b16 v[148:149], v29 offset:12288
    v_mfma_f32_16x16x32_bf16 v[240:243], v[104:107], v[92:95], v[240:243]
    ds_read_b64_tr_b16 v[150:151], v29 offset:13824
    v_mfma_f32_16x16x32_bf16 v[172:175], v[108:111], v[80:83], v[172:175]
    ds_read_b64_tr_b16 v[152:153], v26 offset:12416
    v_mfma_f32_16x16x32_bf16 v[196:199], v[108:111], v[84:87], v[196:199]
    ds_read_b64_tr_b16 v[154:155], v26 offset:13952
    v_mfma_f32_16x16x32_bf16 v[220:223], v[108:111], v[88:91], v[220:223]
    ds_read_b64_tr_b16 v[156:157], v27 offset:12416
    v_mfma_f32_16x16x32_bf16 v[244:247], v[108:111], v[92:95], v[244:247]
    ds_read_b64_tr_b16 v[158:159], v27 offset:13952
    v_mfma_f32_16x16x32_bf16 v[176:179], v[112:115], v[80:83], v[176:179]
    v_mfma_f32_16x16x32_bf16 v[200:203], v[112:115], v[84:87], v[200:203]
    v_mfma_f32_16x16x32_bf16 v[224:227], v[112:115], v[88:91], v[224:227]
    v_mfma_f32_16x16x32_bf16 v[248:251], v[112:115], v[92:95], v[248:251]
    v_mfma_f32_16x16x32_bf16 v[180:183], v[116:119], v[80:83], v[180:183]
    v_mfma_f32_16x16x32_bf16 v[204:207], v[116:119], v[84:87], v[204:207]
    v_mfma_f32_16x16x32_bf16 v[228:231], v[116:119], v[88:91], v[228:231]
    v_mfma_f32_16x16x32_bf16 v[252:255], v[116:119], v[92:95], v[252:255]
    s_waitcnt lgkmcnt(0)
    s_barrier
    v_mfma_f32_16x16x32_bf16 v[160:163], v[136:139], v[120:123], v[160:163]
    ds_read_b128 v[80:83], v24 offset:40960
    v_mfma_f32_16x16x32_bf16 v[184:187], v[136:139], v[124:127], v[184:187]
    ds_read_b64_tr_b16 v[96:97], v26 offset:40960
    v_mfma_f32_16x16x32_bf16 v[208:211], v[136:139], v[128:131], v[208:211]
    ds_read_b64_tr_b16 v[98:99], v26 offset:42496
    v_mfma_f32_16x16x32_bf16 v[232:235], v[136:139], v[132:135], v[232:235]
    ds_read_b128 v[84:87], v24 offset:43008
    v_mfma_f32_16x16x32_bf16 v[164:167], v[140:143], v[120:123], v[164:167]
    ds_read_b128 v[88:91], v24 offset:45056
    v_mfma_f32_16x16x32_bf16 v[188:191], v[140:143], v[124:127], v[188:191]
    ds_read_b128 v[92:95], v24 offset:47104
    v_mfma_f32_16x16x32_bf16 v[212:215], v[140:143], v[128:131], v[212:215]
    ds_read_b64_tr_b16 v[100:101], v27 offset:40960
    v_mfma_f32_16x16x32_bf16 v[236:239], v[140:143], v[132:135], v[236:239]
    ds_read_b64_tr_b16 v[102:103], v27 offset:42496
    v_mfma_f32_16x16x32_bf16 v[168:171], v[144:147], v[120:123], v[168:171]
    ds_read_b64_tr_b16 v[104:105], v28 offset:40960
    v_mfma_f32_16x16x32_bf16 v[192:195], v[144:147], v[124:127], v[192:195]
    ds_read_b64_tr_b16 v[106:107], v28 offset:42496
    v_mfma_f32_16x16x32_bf16 v[216:219], v[144:147], v[128:131], v[216:219]
    ds_read_b64_tr_b16 v[108:109], v29 offset:40960
    v_mfma_f32_16x16x32_bf16 v[240:243], v[144:147], v[132:135], v[240:243]
    ds_read_b64_tr_b16 v[110:111], v29 offset:42496
    v_mfma_f32_16x16x32_bf16 v[172:175], v[148:151], v[120:123], v[172:175]
    ds_read_b64_tr_b16 v[112:113], v26 offset:41088
    v_mfma_f32_16x16x32_bf16 v[196:199], v[148:151], v[124:127], v[196:199]
    ds_read_b64_tr_b16 v[114:115], v26 offset:42624
    v_mfma_f32_16x16x32_bf16 v[220:223], v[148:151], v[128:131], v[220:223]
    ds_read_b64_tr_b16 v[116:117], v27 offset:41088
    v_mfma_f32_16x16x32_bf16 v[244:247], v[148:151], v[132:135], v[244:247]
    ds_read_b64_tr_b16 v[118:119], v27 offset:42624
    v_mfma_f32_16x16x32_bf16 v[176:179], v[152:155], v[120:123], v[176:179]
    v_mfma_f32_16x16x32_bf16 v[200:203], v[152:155], v[124:127], v[200:203]
    v_mfma_f32_16x16x32_bf16 v[224:227], v[152:155], v[128:131], v[224:227]
    v_mfma_f32_16x16x32_bf16 v[248:251], v[152:155], v[132:135], v[248:251]
    v_mfma_f32_16x16x32_bf16 v[180:183], v[156:159], v[120:123], v[180:183]
    v_mfma_f32_16x16x32_bf16 v[204:207], v[156:159], v[124:127], v[204:207]
    v_mfma_f32_16x16x32_bf16 v[228:231], v[156:159], v[128:131], v[228:231]
    v_mfma_f32_16x16x32_bf16 v[252:255], v[156:159], v[132:135], v[252:255]
    s_waitcnt lgkmcnt(0)
    v_mfma_f32_16x16x32_bf16 v[160:163], v[96:99], v[80:83], v[160:163]
    ds_read_b128 v[120:123], v24 offset:41984
    v_mfma_f32_16x16x32_bf16 v[184:187], v[96:99], v[84:87], v[184:187]
    ds_read_b64_tr_b16 v[136:137], v26 offset:53248
    v_mfma_f32_16x16x32_bf16 v[208:211], v[96:99], v[88:91], v[208:211]
    ds_read_b64_tr_b16 v[138:139], v26 offset:54784
    v_mfma_f32_16x16x32_bf16 v[232:235], v[96:99], v[92:95], v[232:235]
    ds_read_b128 v[124:127], v24 offset:44032
    v_mfma_f32_16x16x32_bf16 v[164:167], v[100:103], v[80:83], v[164:167]
    ds_read_b128 v[128:131], v24 offset:46080
    v_mfma_f32_16x16x32_bf16 v[188:191], v[100:103], v[84:87], v[188:191]
    ds_read_b128 v[132:135], v24 offset:48128
    v_mfma_f32_16x16x32_bf16 v[212:215], v[100:103], v[88:91], v[212:215]
    ds_read_b64_tr_b16 v[140:141], v27 offset:53248
    v_mfma_f32_16x16x32_bf16 v[236:239], v[100:103], v[92:95], v[236:239]
    ds_read_b64_tr_b16 v[142:143], v27 offset:54784
    v_mfma_f32_16x16x32_bf16 v[168:171], v[104:107], v[80:83], v[168:171]
    ds_read_b64_tr_b16 v[144:145], v28 offset:53248
    v_mfma_f32_16x16x32_bf16 v[192:195], v[104:107], v[84:87], v[192:195]
    ds_read_b64_tr_b16 v[146:147], v28 offset:54784
    v_mfma_f32_16x16x32_bf16 v[216:219], v[104:107], v[88:91], v[216:219]
    ds_read_b64_tr_b16 v[148:149], v29 offset:53248
    v_mfma_f32_16x16x32_bf16 v[240:243], v[104:107], v[92:95], v[240:243]
    ds_read_b64_tr_b16 v[150:151], v29 offset:54784
    v_mfma_f32_16x16x32_bf16 v[172:175], v[108:111], v[80:83], v[172:175]
    ds_read_b64_tr_b16 v[152:153], v26 offset:53376
    v_mfma_f32_16x16x32_bf16 v[196:199], v[108:111], v[84:87], v[196:199]
    ds_read_b64_tr_b16 v[154:155], v26 offset:54912
    v_mfma_f32_16x16x32_bf16 v[220:223], v[108:111], v[88:91], v[220:223]
    ds_read_b64_tr_b16 v[156:157], v27 offset:53376
    v_mfma_f32_16x16x32_bf16 v[244:247], v[108:111], v[92:95], v[244:247]
    ds_read_b64_tr_b16 v[158:159], v27 offset:54912
    v_mfma_f32_16x16x32_bf16 v[176:179], v[112:115], v[80:83], v[176:179]
    v_mfma_f32_16x16x32_bf16 v[200:203], v[112:115], v[84:87], v[200:203]
    v_mfma_f32_16x16x32_bf16 v[224:227], v[112:115], v[88:91], v[224:227]
    v_mfma_f32_16x16x32_bf16 v[248:251], v[112:115], v[92:95], v[248:251]
    v_mfma_f32_16x16x32_bf16 v[180:183], v[116:119], v[80:83], v[180:183]
    v_mfma_f32_16x16x32_bf16 v[204:207], v[116:119], v[84:87], v[204:207]
    v_mfma_f32_16x16x32_bf16 v[228:231], v[116:119], v[88:91], v[228:231]
    v_mfma_f32_16x16x32_bf16 v[252:255], v[116:119], v[92:95], v[252:255]
    s_waitcnt lgkmcnt(0)
    s_barrier
    v_mfma_f32_16x16x32_bf16 v[160:163], v[136:139], v[120:123], v[160:163]
    ds_read_b128 v[80:83], v25 offset:0
    v_mfma_f32_16x16x32_bf16 v[184:187], v[136:139], v[124:127], v[184:187]
    ds_read_b64_tr_b16 v[96:97], v30 offset:0
    v_mfma_f32_16x16x32_bf16 v[208:211], v[136:139], v[128:131], v[208:211]
    ds_read_b64_tr_b16 v[98:99], v30 offset:1536
    v_mfma_f32_16x16x32_bf16 v[232:235], v[136:139], v[132:135], v[232:235]
    ds_read_b128 v[84:87], v25 offset:2048
    v_mfma_f32_16x16x32_bf16 v[164:167], v[140:143], v[120:123], v[164:167]
    ds_read_b128 v[88:91], v25 offset:4096
    v_mfma_f32_16x16x32_bf16 v[188:191], v[140:143], v[124:127], v[188:191]
    ds_read_b128 v[92:95], v25 offset:6144
    v_mfma_f32_16x16x32_bf16 v[212:215], v[140:143], v[128:131], v[212:215]
    ds_read_b64_tr_b16 v[100:101], v31 offset:0
    v_mfma_f32_16x16x32_bf16 v[236:239], v[140:143], v[132:135], v[236:239]
    ds_read_b64_tr_b16 v[102:103], v31 offset:1536
    v_mfma_f32_16x16x32_bf16 v[168:171], v[144:147], v[120:123], v[168:171]
    ds_read_b64_tr_b16 v[104:105], v32 offset:0
    v_mfma_f32_16x16x32_bf16 v[192:195], v[144:147], v[124:127], v[192:195]
    ds_read_b64_tr_b16 v[106:107], v32 offset:1536
    v_mfma_f32_16x16x32_bf16 v[216:219], v[144:147], v[128:131], v[216:219]
    ds_read_b64_tr_b16 v[108:109], v33 offset:0
    v_mfma_f32_16x16x32_bf16 v[240:243], v[144:147], v[132:135], v[240:243]
    ds_read_b64_tr_b16 v[110:111], v33 offset:1536
    v_mfma_f32_16x16x32_bf16 v[172:175], v[148:151], v[120:123], v[172:175]
    ds_read_b64_tr_b16 v[112:113], v30 offset:128
    v_mfma_f32_16x16x32_bf16 v[196:199], v[148:151], v[124:127], v[196:199]
    ds_read_b64_tr_b16 v[114:115], v30 offset:1664
    v_mfma_f32_16x16x32_bf16 v[220:223], v[148:151], v[128:131], v[220:223]
    ds_read_b64_tr_b16 v[116:117], v31 offset:128
    v_mfma_f32_16x16x32_bf16 v[244:247], v[148:151], v[132:135], v[244:247]
    ds_read_b64_tr_b16 v[118:119], v31 offset:1664
    v_mfma_f32_16x16x32_bf16 v[176:179], v[152:155], v[120:123], v[176:179]
    v_mfma_f32_16x16x32_bf16 v[200:203], v[152:155], v[124:127], v[200:203]
    v_mfma_f32_16x16x32_bf16 v[224:227], v[152:155], v[128:131], v[224:227]
    v_mfma_f32_16x16x32_bf16 v[248:251], v[152:155], v[132:135], v[248:251]
    v_mfma_f32_16x16x32_bf16 v[180:183], v[156:159], v[120:123], v[180:183]
    v_mfma_f32_16x16x32_bf16 v[204:207], v[156:159], v[124:127], v[204:207]
    v_mfma_f32_16x16x32_bf16 v[228:231], v[156:159], v[128:131], v[228:231]
    v_mfma_f32_16x16x32_bf16 v[252:255], v[156:159], v[132:135], v[252:255]
    s_waitcnt lgkmcnt(0)
    v_mfma_f32_16x16x32_bf16 v[160:163], v[96:99], v[80:83], v[160:163]
    ds_read_b128 v[120:123], v25 offset:1024
    v_mfma_f32_16x16x32_bf16 v[184:187], v[96:99], v[84:87], v[184:187]
    ds_read_b64_tr_b16 v[136:137], v30 offset:12288
    v_mfma_f32_16x16x32_bf16 v[208:211], v[96:99], v[88:91], v[208:211]
    ds_read_b64_tr_b16 v[138:139], v30 offset:13824
    v_mfma_f32_16x16x32_bf16 v[232:235], v[96:99], v[92:95], v[232:235]
    ds_read_b128 v[124:127], v25 offset:3072
    v_mfma_f32_16x16x32_bf16 v[164:167], v[100:103], v[80:83], v[164:167]
    ds_read_b128 v[128:131], v25 offset:5120
    v_mfma_f32_16x16x32_bf16 v[188:191], v[100:103], v[84:87], v[188:191]
    ds_read_b128 v[132:135], v25 offset:7168
    v_mfma_f32_16x16x32_bf16 v[212:215], v[100:103], v[88:91], v[212:215]
    ds_read_b64_tr_b16 v[140:141], v31 offset:12288
    v_mfma_f32_16x16x32_bf16 v[236:239], v[100:103], v[92:95], v[236:239]
    ds_read_b64_tr_b16 v[142:143], v31 offset:13824
    v_mfma_f32_16x16x32_bf16 v[168:171], v[104:107], v[80:83], v[168:171]
    ds_read_b64_tr_b16 v[144:145], v32 offset:12288
    v_mfma_f32_16x16x32_bf16 v[192:195], v[104:107], v[84:87], v[192:195]
    ds_read_b64_tr_b16 v[146:147], v32 offset:13824
    v_mfma_f32_16x16x32_bf16 v[216:219], v[104:107], v[88:91], v[216:219]
    ds_read_b64_tr_b16 v[148:149], v33 offset:12288
    v_mfma_f32_16x16x32_bf16 v[240:243], v[104:107], v[92:95], v[240:243]
    ds_read_b64_tr_b16 v[150:151], v33 offset:13824
    v_mfma_f32_16x16x32_bf16 v[172:175], v[108:111], v[80:83], v[172:175]
    ds_read_b64_tr_b16 v[152:153], v30 offset:12416
    v_mfma_f32_16x16x32_bf16 v[196:199], v[108:111], v[84:87], v[196:199]
    ds_read_b64_tr_b16 v[154:155], v30 offset:13952
    v_mfma_f32_16x16x32_bf16 v[220:223], v[108:111], v[88:91], v[220:223]
    ds_read_b64_tr_b16 v[156:157], v31 offset:12416
    v_mfma_f32_16x16x32_bf16 v[244:247], v[108:111], v[92:95], v[244:247]
    ds_read_b64_tr_b16 v[158:159], v31 offset:13952
    v_mfma_f32_16x16x32_bf16 v[176:179], v[112:115], v[80:83], v[176:179]
    v_mfma_f32_16x16x32_bf16 v[200:203], v[112:115], v[84:87], v[200:203]
    v_mfma_f32_16x16x32_bf16 v[224:227], v[112:115], v[88:91], v[224:227]
    v_mfma_f32_16x16x32_bf16 v[248:251], v[112:115], v[92:95], v[248:251]
    v_mfma_f32_16x16x32_bf16 v[180:183], v[116:119], v[80:83], v[180:183]
    v_mfma_f32_16x16x32_bf16 v[204:207], v[116:119], v[84:87], v[204:207]
    v_mfma_f32_16x16x32_bf16 v[228:231], v[116:119], v[88:91], v[228:231]
    v_mfma_f32_16x16x32_bf16 v[252:255], v[116:119], v[92:95], v[252:255]
    s_waitcnt lgkmcnt(0)
    s_barrier
    v_mfma_f32_16x16x32_bf16 v[160:163], v[136:139], v[120:123], v[160:163]
    ds_read_b128 v[80:83], v25 offset:40960
    v_mfma_f32_16x16x32_bf16 v[184:187], v[136:139], v[124:127], v[184:187]
    ds_read_b64_tr_b16 v[96:97], v30 offset:40960
    v_mfma_f32_16x16x32_bf16 v[208:211], v[136:139], v[128:131], v[208:211]
    ds_read_b64_tr_b16 v[98:99], v30 offset:42496
    v_mfma_f32_16x16x32_bf16 v[232:235], v[136:139], v[132:135], v[232:235]
    ds_read_b128 v[84:87], v25 offset:43008
    v_mfma_f32_16x16x32_bf16 v[164:167], v[140:143], v[120:123], v[164:167]
    ds_read_b128 v[88:91], v25 offset:45056
    v_mfma_f32_16x16x32_bf16 v[188:191], v[140:143], v[124:127], v[188:191]
    ds_read_b128 v[92:95], v25 offset:47104
    v_mfma_f32_16x16x32_bf16 v[212:215], v[140:143], v[128:131], v[212:215]
    ds_read_b64_tr_b16 v[100:101], v31 offset:40960
    v_mfma_f32_16x16x32_bf16 v[236:239], v[140:143], v[132:135], v[236:239]
    ds_read_b64_tr_b16 v[102:103], v31 offset:42496
    v_mfma_f32_16x16x32_bf16 v[168:171], v[144:147], v[120:123], v[168:171]
    ds_read_b64_tr_b16 v[104:105], v32 offset:40960
    v_mfma_f32_16x16x32_bf16 v[192:195], v[144:147], v[124:127], v[192:195]
    ds_read_b64_tr_b16 v[106:107], v32 offset:42496
    v_mfma_f32_16x16x32_bf16 v[216:219], v[144:147], v[128:131], v[216:219]
    ds_read_b64_tr_b16 v[108:109], v33 offset:40960
    v_mfma_f32_16x16x32_bf16 v[240:243], v[144:147], v[132:135], v[240:243]
    ds_read_b64_tr_b16 v[110:111], v33 offset:42496
    v_mfma_f32_16x16x32_bf16 v[172:175], v[148:151], v[120:123], v[172:175]
    ds_read_b64_tr_b16 v[112:113], v30 offset:41088
    v_mfma_f32_16x16x32_bf16 v[196:199], v[148:151], v[124:127], v[196:199]
    ds_read_b64_tr_b16 v[114:115], v30 offset:42624
    v_mfma_f32_16x16x32_bf16 v[220:223], v[148:151], v[128:131], v[220:223]
    ds_read_b64_tr_b16 v[116:117], v31 offset:41088
    v_mfma_f32_16x16x32_bf16 v[244:247], v[148:151], v[132:135], v[244:247]
    ds_read_b64_tr_b16 v[118:119], v31 offset:42624
    v_mfma_f32_16x16x32_bf16 v[176:179], v[152:155], v[120:123], v[176:179]
    v_mfma_f32_16x16x32_bf16 v[200:203], v[152:155], v[124:127], v[200:203]
    v_mfma_f32_16x16x32_bf16 v[224:227], v[152:155], v[128:131], v[224:227]
    v_mfma_f32_16x16x32_bf16 v[248:251], v[152:155], v[132:135], v[248:251]
    v_mfma_f32_16x16x32_bf16 v[180:183], v[156:159], v[120:123], v[180:183]
    v_mfma_f32_16x16x32_bf16 v[204:207], v[156:159], v[124:127], v[204:207]
    v_mfma_f32_16x16x32_bf16 v[228:231], v[156:159], v[128:131], v[228:231]
    v_mfma_f32_16x16x32_bf16 v[252:255], v[156:159], v[132:135], v[252:255]
    s_waitcnt lgkmcnt(0)
    v_mfma_f32_16x16x32_bf16 v[160:163], v[96:99], v[80:83], v[160:163]
    ds_read_b128 v[120:123], v25 offset:41984
    v_mfma_f32_16x16x32_bf16 v[184:187], v[96:99], v[84:87], v[184:187]
    ds_read_b64_tr_b16 v[136:137], v30 offset:53248
    v_mfma_f32_16x16x32_bf16 v[208:211], v[96:99], v[88:91], v[208:211]
    ds_read_b64_tr_b16 v[138:139], v30 offset:54784
    v_mfma_f32_16x16x32_bf16 v[232:235], v[96:99], v[92:95], v[232:235]
    ds_read_b128 v[124:127], v25 offset:44032
    v_mfma_f32_16x16x32_bf16 v[164:167], v[100:103], v[80:83], v[164:167]
    ds_read_b128 v[128:131], v25 offset:46080
    v_mfma_f32_16x16x32_bf16 v[188:191], v[100:103], v[84:87], v[188:191]
    ds_read_b128 v[132:135], v25 offset:48128
    v_mfma_f32_16x16x32_bf16 v[212:215], v[100:103], v[88:91], v[212:215]
    ds_read_b64_tr_b16 v[140:141], v31 offset:53248
    v_mfma_f32_16x16x32_bf16 v[236:239], v[100:103], v[92:95], v[236:239]
    ds_read_b64_tr_b16 v[142:143], v31 offset:54784
    v_mfma_f32_16x16x32_bf16 v[168:171], v[104:107], v[80:83], v[168:171]
    ds_read_b64_tr_b16 v[144:145], v32 offset:53248
    v_mfma_f32_16x16x32_bf16 v[192:195], v[104:107], v[84:87], v[192:195]
    ds_read_b64_tr_b16 v[146:147], v32 offset:54784
    v_mfma_f32_16x16x32_bf16 v[216:219], v[104:107], v[88:91], v[216:219]
    ds_read_b64_tr_b16 v[148:149], v33 offset:53248
    v_mfma_f32_16x16x32_bf16 v[240:243], v[104:107], v[92:95], v[240:243]
    ds_read_b64_tr_b16 v[150:151], v33 offset:54784
    v_mfma_f32_16x16x32_bf16 v[172:175], v[108:111], v[80:83], v[172:175]
    ds_read_b64_tr_b16 v[152:153], v30 offset:53376
    v_mfma_f32_16x16x32_bf16 v[196:199], v[108:111], v[84:87], v[196:199]
    ds_read_b64_tr_b16 v[154:155], v30 offset:54912
    v_mfma_f32_16x16x32_bf16 v[220:223], v[108:111], v[88:91], v[220:223]
    ds_read_b64_tr_b16 v[156:157], v31 offset:53376
    v_mfma_f32_16x16x32_bf16 v[244:247], v[108:111], v[92:95], v[244:247]
    ds_read_b64_tr_b16 v[158:159], v31 offset:54912
    v_mfma_f32_16x16x32_bf16 v[176:179], v[112:115], v[80:83], v[176:179]
    v_mfma_f32_16x16x32_bf16 v[200:203], v[112:115], v[84:87], v[200:203]
    v_mfma_f32_16x16x32_bf16 v[224:227], v[112:115], v[88:91], v[224:227]
    v_mfma_f32_16x16x32_bf16 v[248:251], v[112:115], v[92:95], v[248:251]
    v_mfma_f32_16x16x32_bf16 v[180:183], v[116:119], v[80:83], v[180:183]
    v_mfma_f32_16x16x32_bf16 v[204:207], v[116:119], v[84:87], v[204:207]
    v_mfma_f32_16x16x32_bf16 v[228:231], v[116:119], v[88:91], v[228:231]
    v_mfma_f32_16x16x32_bf16 v[252:255], v[116:119], v[92:95], v[252:255]
    s_waitcnt lgkmcnt(0)
    s_barrier
    v_mfma_f32_16x16x32_bf16 v[160:163], v[136:139], v[120:123], v[160:163]
    ds_read_b128 v[80:83], v24 offset:0
    v_mfma_f32_16x16x32_bf16 v[184:187], v[136:139], v[124:127], v[184:187]
    ds_read_b64_tr_b16 v[96:97], v26 offset:0
    v_mfma_f32_16x16x32_bf16 v[208:211], v[136:139], v[128:131], v[208:211]
    ds_read_b64_tr_b16 v[98:99], v26 offset:1536
    v_mfma_f32_16x16x32_bf16 v[232:235], v[136:139], v[132:135], v[232:235]
    ds_read_b128 v[84:87], v24 offset:2048
    v_mfma_f32_16x16x32_bf16 v[164:167], v[140:143], v[120:123], v[164:167]
    ds_read_b128 v[88:91], v24 offset:4096
    v_mfma_f32_16x16x32_bf16 v[188:191], v[140:143], v[124:127], v[188:191]
    ds_read_b128 v[92:95], v24 offset:6144
    v_mfma_f32_16x16x32_bf16 v[212:215], v[140:143], v[128:131], v[212:215]
    ds_read_b64_tr_b16 v[100:101], v27 offset:0
    v_mfma_f32_16x16x32_bf16 v[236:239], v[140:143], v[132:135], v[236:239]
    ds_read_b64_tr_b16 v[102:103], v27 offset:1536
    v_mfma_f32_16x16x32_bf16 v[168:171], v[144:147], v[120:123], v[168:171]
    ds_read_b64_tr_b16 v[104:105], v28 offset:0
    v_mfma_f32_16x16x32_bf16 v[192:195], v[144:147], v[124:127], v[192:195]
    ds_read_b64_tr_b16 v[106:107], v28 offset:1536
    v_mfma_f32_16x16x32_bf16 v[216:219], v[144:147], v[128:131], v[216:219]
    ds_read_b64_tr_b16 v[108:109], v29 offset:0
    v_mfma_f32_16x16x32_bf16 v[240:243], v[144:147], v[132:135], v[240:243]
    ds_read_b64_tr_b16 v[110:111], v29 offset:1536
    v_mfma_f32_16x16x32_bf16 v[172:175], v[148:151], v[120:123], v[172:175]
    ds_read_b64_tr_b16 v[112:113], v26 offset:128
    v_mfma_f32_16x16x32_bf16 v[196:199], v[148:151], v[124:127], v[196:199]
    ds_read_b64_tr_b16 v[114:115], v26 offset:1664
    v_mfma_f32_16x16x32_bf16 v[220:223], v[148:151], v[128:131], v[220:223]
    ds_read_b64_tr_b16 v[116:117], v27 offset:128
    v_mfma_f32_16x16x32_bf16 v[244:247], v[148:151], v[132:135], v[244:247]
    ds_read_b64_tr_b16 v[118:119], v27 offset:1664
    v_mfma_f32_16x16x32_bf16 v[176:179], v[152:155], v[120:123], v[176:179]
    v_mfma_f32_16x16x32_bf16 v[200:203], v[152:155], v[124:127], v[200:203]
    v_mfma_f32_16x16x32_bf16 v[224:227], v[152:155], v[128:131], v[224:227]
    v_mfma_f32_16x16x32_bf16 v[248:251], v[152:155], v[132:135], v[248:251]
    v_mfma_f32_16x16x32_bf16 v[180:183], v[156:159], v[120:123], v[180:183]
    v_mfma_f32_16x16x32_bf16 v[204:207], v[156:159], v[124:127], v[204:207]
    v_mfma_f32_16x16x32_bf16 v[228:231], v[156:159], v[128:131], v[228:231]
    v_mfma_f32_16x16x32_bf16 v[252:255], v[156:159], v[132:135], v[252:255]
    s_waitcnt lgkmcnt(0)
    v_mfma_f32_16x16x32_bf16 v[160:163], v[96:99], v[80:83], v[160:163]
    ds_read_b128 v[120:123], v24 offset:1024
    v_mfma_f32_16x16x32_bf16 v[184:187], v[96:99], v[84:87], v[184:187]
    ds_read_b64_tr_b16 v[136:137], v26 offset:12288
    v_mfma_f32_16x16x32_bf16 v[208:211], v[96:99], v[88:91], v[208:211]
    ds_read_b64_tr_b16 v[138:139], v26 offset:13824
    v_mfma_f32_16x16x32_bf16 v[232:235], v[96:99], v[92:95], v[232:235]
    ds_read_b128 v[124:127], v24 offset:3072
    v_mfma_f32_16x16x32_bf16 v[164:167], v[100:103], v[80:83], v[164:167]
    ds_read_b128 v[128:131], v24 offset:5120
    v_mfma_f32_16x16x32_bf16 v[188:191], v[100:103], v[84:87], v[188:191]
    ds_read_b128 v[132:135], v24 offset:7168
    v_mfma_f32_16x16x32_bf16 v[212:215], v[100:103], v[88:91], v[212:215]
    ds_read_b64_tr_b16 v[140:141], v27 offset:12288
    v_mfma_f32_16x16x32_bf16 v[236:239], v[100:103], v[92:95], v[236:239]
    ds_read_b64_tr_b16 v[142:143], v27 offset:13824
    v_mfma_f32_16x16x32_bf16 v[168:171], v[104:107], v[80:83], v[168:171]
    ds_read_b64_tr_b16 v[144:145], v28 offset:12288
    v_mfma_f32_16x16x32_bf16 v[192:195], v[104:107], v[84:87], v[192:195]
    ds_read_b64_tr_b16 v[146:147], v28 offset:13824
    v_mfma_f32_16x16x32_bf16 v[216:219], v[104:107], v[88:91], v[216:219]
    ds_read_b64_tr_b16 v[148:149], v29 offset:12288
    v_mfma_f32_16x16x32_bf16 v[240:243], v[104:107], v[92:95], v[240:243]
    ds_read_b64_tr_b16 v[150:151], v29 offset:13824
    v_mfma_f32_16x16x32_bf16 v[172:175], v[108:111], v[80:83], v[172:175]
    ds_read_b64_tr_b16 v[152:153], v26 offset:12416
    v_mfma_f32_16x16x32_bf16 v[196:199], v[108:111], v[84:87], v[196:199]
    ds_read_b64_tr_b16 v[154:155], v26 offset:13952
    v_mfma_f32_16x16x32_bf16 v[220:223], v[108:111], v[88:91], v[220:223]
    ds_read_b64_tr_b16 v[156:157], v27 offset:12416
    v_mfma_f32_16x16x32_bf16 v[244:247], v[108:111], v[92:95], v[244:247]
    ds_read_b64_tr_b16 v[158:159], v27 offset:13952
    v_mfma_f32_16x16x32_bf16 v[176:179], v[112:115], v[80:83], v[176:179]
    v_mfma_f32_16x16x32_bf16 v[200:203], v[112:115], v[84:87], v[200:203]
    v_mfma_f32_16x16x32_bf16 v[224:227], v[112:115], v[88:91], v[224:227]
    v_mfma_f32_16x16x32_bf16 v[248:251], v[112:115], v[92:95], v[248:251]
    v_mfma_f32_16x16x32_bf16 v[180:183], v[116:119], v[80:83], v[180:183]
    v_mfma_f32_16x16x32_bf16 v[204:207], v[116:119], v[84:87], v[204:207]
    v_mfma_f32_16x16x32_bf16 v[228:231], v[116:119], v[88:91], v[228:231]
    v_mfma_f32_16x16x32_bf16 v[252:255], v[116:119], v[92:95], v[252:255]
    s_waitcnt lgkmcnt(0)
    s_barrier
    v_mfma_f32_16x16x32_bf16 v[160:163], v[136:139], v[120:123], v[160:163]
    ds_read_b128 v[80:83], v24 offset:40960
    v_mfma_f32_16x16x32_bf16 v[184:187], v[136:139], v[124:127], v[184:187]
    ds_read_b64_tr_b16 v[96:97], v26 offset:40960
    v_mfma_f32_16x16x32_bf16 v[208:211], v[136:139], v[128:131], v[208:211]
    ds_read_b64_tr_b16 v[98:99], v26 offset:42496
    v_mfma_f32_16x16x32_bf16 v[232:235], v[136:139], v[132:135], v[232:235]
    ds_read_b128 v[84:87], v24 offset:43008
    v_mfma_f32_16x16x32_bf16 v[164:167], v[140:143], v[120:123], v[164:167]
    ds_read_b128 v[88:91], v24 offset:45056
    v_mfma_f32_16x16x32_bf16 v[188:191], v[140:143], v[124:127], v[188:191]
    ds_read_b128 v[92:95], v24 offset:47104
    v_mfma_f32_16x16x32_bf16 v[212:215], v[140:143], v[128:131], v[212:215]
    ds_read_b64_tr_b16 v[100:101], v27 offset:40960
    v_mfma_f32_16x16x32_bf16 v[236:239], v[140:143], v[132:135], v[236:239]
    ds_read_b64_tr_b16 v[102:103], v27 offset:42496
    v_mfma_f32_16x16x32_bf16 v[168:171], v[144:147], v[120:123], v[168:171]
    ds_read_b64_tr_b16 v[104:105], v28 offset:40960
    v_mfma_f32_16x16x32_bf16 v[192:195], v[144:147], v[124:127], v[192:195]
    ds_read_b64_tr_b16 v[106:107], v28 offset:42496
    v_mfma_f32_16x16x32_bf16 v[216:219], v[144:147], v[128:131], v[216:219]
    ds_read_b64_tr_b16 v[108:109], v29 offset:40960
    v_mfma_f32_16x16x32_bf16 v[240:243], v[144:147], v[132:135], v[240:243]
    ds_read_b64_tr_b16 v[110:111], v29 offset:42496
    v_mfma_f32_16x16x32_bf16 v[172:175], v[148:151], v[120:123], v[172:175]
    ds_read_b64_tr_b16 v[112:113], v26 offset:41088
    v_mfma_f32_16x16x32_bf16 v[196:199], v[148:151], v[124:127], v[196:199]
    ds_read_b64_tr_b16 v[114:115], v26 offset:42624
    v_mfma_f32_16x16x32_bf16 v[220:223], v[148:151], v[128:131], v[220:223]
    ds_read_b64_tr_b16 v[116:117], v27 offset:41088
    v_mfma_f32_16x16x32_bf16 v[244:247], v[148:151], v[132:135], v[244:247]
    ds_read_b64_tr_b16 v[118:119], v27 offset:42624
    v_mfma_f32_16x16x32_bf16 v[176:179], v[152:155], v[120:123], v[176:179]
    v_mfma_f32_16x16x32_bf16 v[200:203], v[152:155], v[124:127], v[200:203]
    v_mfma_f32_16x16x32_bf16 v[224:227], v[152:155], v[128:131], v[224:227]
    v_mfma_f32_16x16x32_bf16 v[248:251], v[152:155], v[132:135], v[248:251]
    v_mfma_f32_16x16x32_bf16 v[180:183], v[156:159], v[120:123], v[180:183]
    v_mfma_f32_16x16x32_bf16 v[204:207], v[156:159], v[124:127], v[204:207]
    v_mfma_f32_16x16x32_bf16 v[228:231], v[156:159], v[128:131], v[228:231]
    v_mfma_f32_16x16x32_bf16 v[252:255], v[156:159], v[132:135], v[252:255]
    s_waitcnt lgkmcnt(0)
    v_mfma_f32_16x16x32_bf16 v[160:163], v[96:99], v[80:83], v[160:163]
    ds_read_b128 v[120:123], v24 offset:41984
    v_mfma_f32_16x16x32_bf16 v[184:187], v[96:99], v[84:87], v[184:187]
    ds_read_b64_tr_b16 v[136:137], v26 offset:53248
    v_mfma_f32_16x16x32_bf16 v[208:211], v[96:99], v[88:91], v[208:211]
    ds_read_b64_tr_b16 v[138:139], v26 offset:54784
    v_mfma_f32_16x16x32_bf16 v[232:235], v[96:99], v[92:95], v[232:235]
    ds_read_b128 v[124:127], v24 offset:44032
    v_mfma_f32_16x16x32_bf16 v[164:167], v[100:103], v[80:83], v[164:167]
    ds_read_b128 v[128:131], v24 offset:46080
    v_mfma_f32_16x16x32_bf16 v[188:191], v[100:103], v[84:87], v[188:191]
    ds_read_b128 v[132:135], v24 offset:48128
    v_mfma_f32_16x16x32_bf16 v[212:215], v[100:103], v[88:91], v[212:215]
    ds_read_b64_tr_b16 v[140:141], v27 offset:53248
    v_mfma_f32_16x16x32_bf16 v[236:239], v[100:103], v[92:95], v[236:239]
    ds_read_b64_tr_b16 v[142:143], v27 offset:54784
    v_mfma_f32_16x16x32_bf16 v[168:171], v[104:107], v[80:83], v[168:171]
    ds_read_b64_tr_b16 v[144:145], v28 offset:53248
    v_mfma_f32_16x16x32_bf16 v[192:195], v[104:107], v[84:87], v[192:195]
    ds_read_b64_tr_b16 v[146:147], v28 offset:54784
    v_mfma_f32_16x16x32_bf16 v[216:219], v[104:107], v[88:91], v[216:219]
    ds_read_b64_tr_b16 v[148:149], v29 offset:53248
    v_mfma_f32_16x16x32_bf16 v[240:243], v[104:107], v[92:95], v[240:243]
    ds_read_b64_tr_b16 v[150:151], v29 offset:54784
    v_mfma_f32_16x16x32_bf16 v[172:175], v[108:111], v[80:83], v[172:175]
    ds_read_b64_tr_b16 v[152:153], v26 offset:53376
    v_mfma_f32_16x16x32_bf16 v[196:199], v[108:111], v[84:87], v[196:199]
    ds_read_b64_tr_b16 v[154:155], v26 offset:54912
    v_mfma_f32_16x16x32_bf16 v[220:223], v[108:111], v[88:91], v[220:223]
    ds_read_b64_tr_b16 v[156:157], v27 offset:53376
    v_mfma_f32_16x16x32_bf16 v[244:247], v[108:111], v[92:95], v[244:247]
    ds_read_b64_tr_b16 v[158:159], v27 offset:54912
    v_mfma_f32_16x16x32_bf16 v[176:179], v[112:115], v[80:83], v[176:179]
    v_mfma_f32_16x16x32_bf16 v[200:203], v[112:115], v[84:87], v[200:203]
    v_mfma_f32_16x16x32_bf16 v[224:227], v[112:115], v[88:91], v[224:227]
    v_mfma_f32_16x16x32_bf16 v[248:251], v[112:115], v[92:95], v[248:251]
    v_mfma_f32_16x16x32_bf16 v[180:183], v[116:119], v[80:83], v[180:183]
    v_mfma_f32_16x16x32_bf16 v[204:207], v[116:119], v[84:87], v[204:207]
    v_mfma_f32_16x16x32_bf16 v[228:231], v[116:119], v[88:91], v[228:231]
    v_mfma_f32_16x16x32_bf16 v[252:255], v[116:119], v[92:95], v[252:255]
    s_waitcnt lgkmcnt(0)
    s_barrier
    v_mfma_f32_16x16x32_bf16 v[160:163], v[136:139], v[120:123], v[160:163]
    ds_read_b128 v[80:83], v25 offset:0
    v_mfma_f32_16x16x32_bf16 v[184:187], v[136:139], v[124:127], v[184:187]
    ds_read_b64_tr_b16 v[96:97], v30 offset:0
    v_mfma_f32_16x16x32_bf16 v[208:211], v[136:139], v[128:131], v[208:211]
    ds_read_b64_tr_b16 v[98:99], v30 offset:1536
    v_mfma_f32_16x16x32_bf16 v[232:235], v[136:139], v[132:135], v[232:235]
    ds_read_b128 v[84:87], v25 offset:2048
    v_mfma_f32_16x16x32_bf16 v[164:167], v[140:143], v[120:123], v[164:167]
    ds_read_b128 v[88:91], v25 offset:4096
    v_mfma_f32_16x16x32_bf16 v[188:191], v[140:143], v[124:127], v[188:191]
    ds_read_b128 v[92:95], v25 offset:6144
    v_mfma_f32_16x16x32_bf16 v[212:215], v[140:143], v[128:131], v[212:215]
    ds_read_b64_tr_b16 v[100:101], v31 offset:0
    v_mfma_f32_16x16x32_bf16 v[236:239], v[140:143], v[132:135], v[236:239]
    ds_read_b64_tr_b16 v[102:103], v31 offset:1536
    v_mfma_f32_16x16x32_bf16 v[168:171], v[144:147], v[120:123], v[168:171]
    ds_read_b64_tr_b16 v[104:105], v32 offset:0
    v_mfma_f32_16x16x32_bf16 v[192:195], v[144:147], v[124:127], v[192:195]
    ds_read_b64_tr_b16 v[106:107], v32 offset:1536
    v_mfma_f32_16x16x32_bf16 v[216:219], v[144:147], v[128:131], v[216:219]
    ds_read_b64_tr_b16 v[108:109], v33 offset:0
    v_mfma_f32_16x16x32_bf16 v[240:243], v[144:147], v[132:135], v[240:243]
    ds_read_b64_tr_b16 v[110:111], v33 offset:1536
    v_mfma_f32_16x16x32_bf16 v[172:175], v[148:151], v[120:123], v[172:175]
    ds_read_b64_tr_b16 v[112:113], v30 offset:128
    v_mfma_f32_16x16x32_bf16 v[196:199], v[148:151], v[124:127], v[196:199]
    ds_read_b64_tr_b16 v[114:115], v30 offset:1664
    v_mfma_f32_16x16x32_bf16 v[220:223], v[148:151], v[128:131], v[220:223]
    ds_read_b64_tr_b16 v[116:117], v31 offset:128
    v_mfma_f32_16x16x32_bf16 v[244:247], v[148:151], v[132:135], v[244:247]
    ds_read_b64_tr_b16 v[118:119], v31 offset:1664
    v_mfma_f32_16x16x32_bf16 v[176:179], v[152:155], v[120:123], v[176:179]
    v_mfma_f32_16x16x32_bf16 v[200:203], v[152:155], v[124:127], v[200:203]
    v_mfma_f32_16x16x32_bf16 v[224:227], v[152:155], v[128:131], v[224:227]
    v_mfma_f32_16x16x32_bf16 v[248:251], v[152:155], v[132:135], v[248:251]
    v_mfma_f32_16x16x32_bf16 v[180:183], v[156:159], v[120:123], v[180:183]
    v_mfma_f32_16x16x32_bf16 v[204:207], v[156:159], v[124:127], v[204:207]
    v_mfma_f32_16x16x32_bf16 v[228:231], v[156:159], v[128:131], v[228:231]
    v_mfma_f32_16x16x32_bf16 v[252:255], v[156:159], v[132:135], v[252:255]
    s_waitcnt lgkmcnt(0)
    v_mfma_f32_16x16x32_bf16 v[160:163], v[96:99], v[80:83], v[160:163]
    ds_read_b128 v[120:123], v25 offset:1024
    v_mfma_f32_16x16x32_bf16 v[184:187], v[96:99], v[84:87], v[184:187]
    ds_read_b64_tr_b16 v[136:137], v30 offset:12288
    v_mfma_f32_16x16x32_bf16 v[208:211], v[96:99], v[88:91], v[208:211]
    ds_read_b64_tr_b16 v[138:139], v30 offset:13824
    v_mfma_f32_16x16x32_bf16 v[232:235], v[96:99], v[92:95], v[232:235]
    ds_read_b128 v[124:127], v25 offset:3072
    v_mfma_f32_16x16x32_bf16 v[164:167], v[100:103], v[80:83], v[164:167]
    ds_read_b128 v[128:131], v25 offset:5120
    v_mfma_f32_16x16x32_bf16 v[188:191], v[100:103], v[84:87], v[188:191]
    ds_read_b128 v[132:135], v25 offset:7168
    v_mfma_f32_16x16x32_bf16 v[212:215], v[100:103], v[88:91], v[212:215]
    ds_read_b64_tr_b16 v[140:141], v31 offset:12288
    v_mfma_f32_16x16x32_bf16 v[236:239], v[100:103], v[92:95], v[236:239]
    ds_read_b64_tr_b16 v[142:143], v31 offset:13824
    v_mfma_f32_16x16x32_bf16 v[168:171], v[104:107], v[80:83], v[168:171]
    ds_read_b64_tr_b16 v[144:145], v32 offset:12288
    v_mfma_f32_16x16x32_bf16 v[192:195], v[104:107], v[84:87], v[192:195]
    ds_read_b64_tr_b16 v[146:147], v32 offset:13824
    v_mfma_f32_16x16x32_bf16 v[216:219], v[104:107], v[88:91], v[216:219]
    ds_read_b64_tr_b16 v[148:149], v33 offset:12288
    v_mfma_f32_16x16x32_bf16 v[240:243], v[104:107], v[92:95], v[240:243]
    ds_read_b64_tr_b16 v[150:151], v33 offset:13824
    v_mfma_f32_16x16x32_bf16 v[172:175], v[108:111], v[80:83], v[172:175]
    ds_read_b64_tr_b16 v[152:153], v30 offset:12416
    v_mfma_f32_16x16x32_bf16 v[196:199], v[108:111], v[84:87], v[196:199]
    ds_read_b64_tr_b16 v[154:155], v30 offset:13952
    v_mfma_f32_16x16x32_bf16 v[220:223], v[108:111], v[88:91], v[220:223]
    ds_read_b64_tr_b16 v[156:157], v31 offset:12416
    v_mfma_f32_16x16x32_bf16 v[244:247], v[108:111], v[92:95], v[244:247]
    ds_read_b64_tr_b16 v[158:159], v31 offset:13952
    v_mfma_f32_16x16x32_bf16 v[176:179], v[112:115], v[80:83], v[176:179]
    v_mfma_f32_16x16x32_bf16 v[200:203], v[112:115], v[84:87], v[200:203]
    v_mfma_f32_16x16x32_bf16 v[224:227], v[112:115], v[88:91], v[224:227]
    v_mfma_f32_16x16x32_bf16 v[248:251], v[112:115], v[92:95], v[248:251]
    v_mfma_f32_16x16x32_bf16 v[180:183], v[116:119], v[80:83], v[180:183]
    v_mfma_f32_16x16x32_bf16 v[204:207], v[116:119], v[84:87], v[204:207]
    v_mfma_f32_16x16x32_bf16 v[228:231], v[116:119], v[88:91], v[228:231]
    v_mfma_f32_16x16x32_bf16 v[252:255], v[116:119], v[92:95], v[252:255]
    s_waitcnt lgkmcnt(0)
    s_barrier
    v_mfma_f32_16x16x32_bf16 v[160:163], v[136:139], v[120:123], v[160:163]
    ds_read_b128 v[80:83], v25 offset:40960
    v_mfma_f32_16x16x32_bf16 v[184:187], v[136:139], v[124:127], v[184:187]
    ds_read_b64_tr_b16 v[96:97], v30 offset:40960
    v_mfma_f32_16x16x32_bf16 v[208:211], v[136:139], v[128:131], v[208:211]
    ds_read_b64_tr_b16 v[98:99], v30 offset:42496
    v_mfma_f32_16x16x32_bf16 v[232:235], v[136:139], v[132:135], v[232:235]
    ds_read_b128 v[84:87], v25 offset:43008
    v_mfma_f32_16x16x32_bf16 v[164:167], v[140:143], v[120:123], v[164:167]
    ds_read_b128 v[88:91], v25 offset:45056
    v_mfma_f32_16x16x32_bf16 v[188:191], v[140:143], v[124:127], v[188:191]
    ds_read_b128 v[92:95], v25 offset:47104
    v_mfma_f32_16x16x32_bf16 v[212:215], v[140:143], v[128:131], v[212:215]
    ds_read_b64_tr_b16 v[100:101], v31 offset:40960
    v_mfma_f32_16x16x32_bf16 v[236:239], v[140:143], v[132:135], v[236:239]
    ds_read_b64_tr_b16 v[102:103], v31 offset:42496
    v_mfma_f32_16x16x32_bf16 v[168:171], v[144:147], v[120:123], v[168:171]
    ds_read_b64_tr_b16 v[104:105], v32 offset:40960
    v_mfma_f32_16x16x32_bf16 v[192:195], v[144:147], v[124:127], v[192:195]
    ds_read_b64_tr_b16 v[106:107], v32 offset:42496
    v_mfma_f32_16x16x32_bf16 v[216:219], v[144:147], v[128:131], v[216:219]
    ds_read_b64_tr_b16 v[108:109], v33 offset:40960
    v_mfma_f32_16x16x32_bf16 v[240:243], v[144:147], v[132:135], v[240:243]
    ds_read_b64_tr_b16 v[110:111], v33 offset:42496
    v_mfma_f32_16x16x32_bf16 v[172:175], v[148:151], v[120:123], v[172:175]
    ds_read_b64_tr_b16 v[112:113], v30 offset:41088
    v_mfma_f32_16x16x32_bf16 v[196:199], v[148:151], v[124:127], v[196:199]
    ds_read_b64_tr_b16 v[114:115], v30 offset:42624
    v_mfma_f32_16x16x32_bf16 v[220:223], v[148:151], v[128:131], v[220:223]
    ds_read_b64_tr_b16 v[116:117], v31 offset:41088
    v_mfma_f32_16x16x32_bf16 v[244:247], v[148:151], v[132:135], v[244:247]
    ds_read_b64_tr_b16 v[118:119], v31 offset:42624
    v_mfma_f32_16x16x32_bf16 v[176:179], v[152:155], v[120:123], v[176:179]
    v_mfma_f32_16x16x32_bf16 v[200:203], v[152:155], v[124:127], v[200:203]
    v_mfma_f32_16x16x32_bf16 v[224:227], v[152:155], v[128:131], v[224:227]
    v_mfma_f32_16x16x32_bf16 v[248:251], v[152:155], v[132:135], v[248:251]
    v_mfma_f32_16x16x32_bf16 v[180:183], v[156:159], v[120:123], v[180:183]
    v_mfma_f32_16x16x32_bf16 v[204:207], v[156:159], v[124:127], v[204:207]
    v_mfma_f32_16x16x32_bf16 v[228:231], v[156:159], v[128:131], v[228:231]
    v_mfma_f32_16x16x32_bf16 v[252:255], v[156:159], v[132:135], v[252:255]
    s_waitcnt lgkmcnt(0)
    v_mfma_f32_16x16x32_bf16 v[160:163], v[96:99], v[80:83], v[160:163]
    ds_read_b128 v[120:123], v25 offset:41984
    v_mfma_f32_16x16x32_bf16 v[184:187], v[96:99], v[84:87], v[184:187]
    ds_read_b64_tr_b16 v[136:137], v30 offset:53248
    v_mfma_f32_16x16x32_bf16 v[208:211], v[96:99], v[88:91], v[208:211]
    ds_read_b64_tr_b16 v[138:139], v30 offset:54784
    v_mfma_f32_16x16x32_bf16 v[232:235], v[96:99], v[92:95], v[232:235]
    ds_read_b128 v[124:127], v25 offset:44032
    v_mfma_f32_16x16x32_bf16 v[164:167], v[100:103], v[80:83], v[164:167]
    ds_read_b128 v[128:131], v25 offset:46080
    v_mfma_f32_16x16x32_bf16 v[188:191], v[100:103], v[84:87], v[188:191]
    ds_read_b128 v[132:135], v25 offset:48128
    v_mfma_f32_16x16x32_bf16 v[212:215], v[100:103], v[88:91], v[212:215]
    ds_read_b64_tr_b16 v[140:141], v31 offset:53248
    v_mfma_f32_16x16x32_bf16 v[236:239], v[100:103], v[92:95], v[236:239]
    ds_read_b64_tr_b16 v[142:143], v31 offset:54784
    v_mfma_f32_16x16x32_bf16 v[168:171], v[104:107], v[80:83], v[168:171]
    ds_read_b64_tr_b16 v[144:145], v32 offset:53248
    v_mfma_f32_16x16x32_bf16 v[192:195], v[104:107], v[84:87], v[192:195]
    ds_read_b64_tr_b16 v[146:147], v32 offset:54784
    v_mfma_f32_16x16x32_bf16 v[216:219], v[104:107], v[88:91], v[216:219]
    ds_read_b64_tr_b16 v[148:149], v33 offset:53248
    v_mfma_f32_16x16x32_bf16 v[240:243], v[104:107], v[92:95], v[240:243]
    ds_read_b64_tr_b16 v[150:151], v33 offset:54784
    v_mfma_f32_16x16x32_bf16 v[172:175], v[108:111], v[80:83], v[172:175]
    ds_read_b64_tr_b16 v[152:153], v30 offset:53376
    v_mfma_f32_16x16x32_bf16 v[196:199], v[108:111], v[84:87], v[196:199]
    ds_read_b64_tr_b16 v[154:155], v30 offset:54912
    v_mfma_f32_16x16x32_bf16 v[220:223], v[108:111], v[88:91], v[220:223]
    ds_read_b64_tr_b16 v[156:157], v31 offset:53376
    v_mfma_f32_16x16x32_bf16 v[244:247], v[108:111], v[92:95], v[244:247]
    ds_read_b64_tr_b16 v[158:159], v31 offset:54912
    v_mfma_f32_16x16x32_bf16 v[176:179], v[112:115], v[80:83], v[176:179]
    v_mfma_f32_16x16x32_bf16 v[200:203], v[112:115], v[84:87], v[200:203]
    v_mfma_f32_16x16x32_bf16 v[224:227], v[112:115], v[88:91], v[224:227]
    v_mfma_f32_16x16x32_bf16 v[248:251], v[112:115], v[92:95], v[248:251]
    v_mfma_f32_16x16x32_bf16 v[180:183], v[116:119], v[80:83], v[180:183]
    v_mfma_f32_16x16x32_bf16 v[204:207], v[116:119], v[84:87], v[204:207]
    v_mfma_f32_16x16x32_bf16 v[228:231], v[116:119], v[88:91], v[228:231]
    v_mfma_f32_16x16x32_bf16 v[252:255], v[116:119], v[92:95], v[252:255]
    s_waitcnt lgkmcnt(0)
    s_barrier
    v_mfma_f32_16x16x32_bf16 v[160:163], v[136:139], v[120:123], v[160:163]
    ds_read_b128 v[80:83], v24 offset:0
    v_mfma_f32_16x16x32_bf16 v[184:187], v[136:139], v[124:127], v[184:187]
    ds_read_b64_tr_b16 v[96:97], v26 offset:0
    v_mfma_f32_16x16x32_bf16 v[208:211], v[136:139], v[128:131], v[208:211]
    ds_read_b64_tr_b16 v[98:99], v26 offset:1536
    v_mfma_f32_16x16x32_bf16 v[232:235], v[136:139], v[132:135], v[232:235]
    ds_read_b128 v[84:87], v24 offset:2048
    v_mfma_f32_16x16x32_bf16 v[164:167], v[140:143], v[120:123], v[164:167]
    ds_read_b128 v[88:91], v24 offset:4096
    v_mfma_f32_16x16x32_bf16 v[188:191], v[140:143], v[124:127], v[188:191]
    ds_read_b128 v[92:95], v24 offset:6144
    v_mfma_f32_16x16x32_bf16 v[212:215], v[140:143], v[128:131], v[212:215]
    ds_read_b64_tr_b16 v[100:101], v27 offset:0
    v_mfma_f32_16x16x32_bf16 v[236:239], v[140:143], v[132:135], v[236:239]
    ds_read_b64_tr_b16 v[102:103], v27 offset:1536
    v_mfma_f32_16x16x32_bf16 v[168:171], v[144:147], v[120:123], v[168:171]
    ds_read_b64_tr_b16 v[104:105], v28 offset:0
    v_mfma_f32_16x16x32_bf16 v[192:195], v[144:147], v[124:127], v[192:195]
    ds_read_b64_tr_b16 v[106:107], v28 offset:1536
    v_mfma_f32_16x16x32_bf16 v[216:219], v[144:147], v[128:131], v[216:219]
    ds_read_b64_tr_b16 v[108:109], v29 offset:0
    v_mfma_f32_16x16x32_bf16 v[240:243], v[144:147], v[132:135], v[240:243]
    ds_read_b64_tr_b16 v[110:111], v29 offset:1536
    v_mfma_f32_16x16x32_bf16 v[172:175], v[148:151], v[120:123], v[172:175]
    ds_read_b64_tr_b16 v[112:113], v26 offset:128
    v_mfma_f32_16x16x32_bf16 v[196:199], v[148:151], v[124:127], v[196:199]
    ds_read_b64_tr_b16 v[114:115], v26 offset:1664
    v_mfma_f32_16x16x32_bf16 v[220:223], v[148:151], v[128:131], v[220:223]
    ds_read_b64_tr_b16 v[116:117], v27 offset:128
    v_mfma_f32_16x16x32_bf16 v[244:247], v[148:151], v[132:135], v[244:247]
    ds_read_b64_tr_b16 v[118:119], v27 offset:1664
    v_mfma_f32_16x16x32_bf16 v[176:179], v[152:155], v[120:123], v[176:179]
    v_mfma_f32_16x16x32_bf16 v[200:203], v[152:155], v[124:127], v[200:203]
    v_mfma_f32_16x16x32_bf16 v[224:227], v[152:155], v[128:131], v[224:227]
    v_mfma_f32_16x16x32_bf16 v[248:251], v[152:155], v[132:135], v[248:251]
    v_mfma_f32_16x16x32_bf16 v[180:183], v[156:159], v[120:123], v[180:183]
    v_mfma_f32_16x16x32_bf16 v[204:207], v[156:159], v[124:127], v[204:207]
    v_mfma_f32_16x16x32_bf16 v[228:231], v[156:159], v[128:131], v[228:231]
    v_mfma_f32_16x16x32_bf16 v[252:255], v[156:159], v[132:135], v[252:255]
    s_waitcnt lgkmcnt(0)
    v_mfma_f32_16x16x32_bf16 v[160:163], v[96:99], v[80:83], v[160:163]
    ds_read_b128 v[120:123], v24 offset:1024
    v_mfma_f32_16x16x32_bf16 v[184:187], v[96:99], v[84:87], v[184:187]
    ds_read_b64_tr_b16 v[136:137], v26 offset:12288
    v_mfma_f32_16x16x32_bf16 v[208:211], v[96:99], v[88:91], v[208:211]
    ds_read_b64_tr_b16 v[138:139], v26 offset:13824
    v_mfma_f32_16x16x32_bf16 v[232:235], v[96:99], v[92:95], v[232:235]
    ds_read_b128 v[124:127], v24 offset:3072
    v_mfma_f32_16x16x32_bf16 v[164:167], v[100:103], v[80:83], v[164:167]
    ds_read_b128 v[128:131], v24 offset:5120
    v_mfma_f32_16x16x32_bf16 v[188:191], v[100:103], v[84:87], v[188:191]
    ds_read_b128 v[132:135], v24 offset:7168
    v_mfma_f32_16x16x32_bf16 v[212:215], v[100:103], v[88:91], v[212:215]
    ds_read_b64_tr_b16 v[140:141], v27 offset:12288
    v_mfma_f32_16x16x32_bf16 v[236:239], v[100:103], v[92:95], v[236:239]
    ds_read_b64_tr_b16 v[142:143], v27 offset:13824
    v_mfma_f32_16x16x32_bf16 v[168:171], v[104:107], v[80:83], v[168:171]
    ds_read_b64_tr_b16 v[144:145], v28 offset:12288
    v_mfma_f32_16x16x32_bf16 v[192:195], v[104:107], v[84:87], v[192:195]
    ds_read_b64_tr_b16 v[146:147], v28 offset:13824
    v_mfma_f32_16x16x32_bf16 v[216:219], v[104:107], v[88:91], v[216:219]
    ds_read_b64_tr_b16 v[148:149], v29 offset:12288
    v_mfma_f32_16x16x32_bf16 v[240:243], v[104:107], v[92:95], v[240:243]
    ds_read_b64_tr_b16 v[150:151], v29 offset:13824
    v_mfma_f32_16x16x32_bf16 v[172:175], v[108:111], v[80:83], v[172:175]
    ds_read_b64_tr_b16 v[152:153], v26 offset:12416
    v_mfma_f32_16x16x32_bf16 v[196:199], v[108:111], v[84:87], v[196:199]
    ds_read_b64_tr_b16 v[154:155], v26 offset:13952
    v_mfma_f32_16x16x32_bf16 v[220:223], v[108:111], v[88:91], v[220:223]
    ds_read_b64_tr_b16 v[156:157], v27 offset:12416
    v_mfma_f32_16x16x32_bf16 v[244:247], v[108:111], v[92:95], v[244:247]
    ds_read_b64_tr_b16 v[158:159], v27 offset:13952
    v_mfma_f32_16x16x32_bf16 v[176:179], v[112:115], v[80:83], v[176:179]
    v_mfma_f32_16x16x32_bf16 v[200:203], v[112:115], v[84:87], v[200:203]
    v_mfma_f32_16x16x32_bf16 v[224:227], v[112:115], v[88:91], v[224:227]
    v_mfma_f32_16x16x32_bf16 v[248:251], v[112:115], v[92:95], v[248:251]
    v_mfma_f32_16x16x32_bf16 v[180:183], v[116:119], v[80:83], v[180:183]
    v_mfma_f32_16x16x32_bf16 v[204:207], v[116:119], v[84:87], v[204:207]
    v_mfma_f32_16x16x32_bf16 v[228:231], v[116:119], v[88:91], v[228:231]
    v_mfma_f32_16x16x32_bf16 v[252:255], v[116:119], v[92:95], v[252:255]
    s_waitcnt lgkmcnt(0)
    s_barrier
    v_mfma_f32_16x16x32_bf16 v[160:163], v[136:139], v[120:123], v[160:163]
    ds_read_b128 v[80:83], v24 offset:40960
    v_mfma_f32_16x16x32_bf16 v[184:187], v[136:139], v[124:127], v[184:187]
    ds_read_b64_tr_b16 v[96:97], v26 offset:40960
    v_mfma_f32_16x16x32_bf16 v[208:211], v[136:139], v[128:131], v[208:211]
    ds_read_b64_tr_b16 v[98:99], v26 offset:42496
    v_mfma_f32_16x16x32_bf16 v[232:235], v[136:139], v[132:135], v[232:235]
    ds_read_b128 v[84:87], v24 offset:43008
    v_mfma_f32_16x16x32_bf16 v[164:167], v[140:143], v[120:123], v[164:167]
    ds_read_b128 v[88:91], v24 offset:45056
    v_mfma_f32_16x16x32_bf16 v[188:191], v[140:143], v[124:127], v[188:191]
    ds_read_b128 v[92:95], v24 offset:47104
    v_mfma_f32_16x16x32_bf16 v[212:215], v[140:143], v[128:131], v[212:215]
    ds_read_b64_tr_b16 v[100:101], v27 offset:40960
    v_mfma_f32_16x16x32_bf16 v[236:239], v[140:143], v[132:135], v[236:239]
    ds_read_b64_tr_b16 v[102:103], v27 offset:42496
    v_mfma_f32_16x16x32_bf16 v[168:171], v[144:147], v[120:123], v[168:171]
    ds_read_b64_tr_b16 v[104:105], v28 offset:40960
    v_mfma_f32_16x16x32_bf16 v[192:195], v[144:147], v[124:127], v[192:195]
    ds_read_b64_tr_b16 v[106:107], v28 offset:42496
    v_mfma_f32_16x16x32_bf16 v[216:219], v[144:147], v[128:131], v[216:219]
    ds_read_b64_tr_b16 v[108:109], v29 offset:40960
    v_mfma_f32_16x16x32_bf16 v[240:243], v[144:147], v[132:135], v[240:243]
    ds_read_b64_tr_b16 v[110:111], v29 offset:42496
    v_mfma_f32_16x16x32_bf16 v[172:175], v[148:151], v[120:123], v[172:175]
    ds_read_b64_tr_b16 v[112:113], v26 offset:41088
    v_mfma_f32_16x16x32_bf16 v[196:199], v[148:151], v[124:127], v[196:199]
    ds_read_b64_tr_b16 v[114:115], v26 offset:42624
    v_mfma_f32_16x16x32_bf16 v[220:223], v[148:151], v[128:131], v[220:223]
    ds_read_b64_tr_b16 v[116:117], v27 offset:41088
    v_mfma_f32_16x16x32_bf16 v[244:247], v[148:151], v[132:135], v[244:247]
    ds_read_b64_tr_b16 v[118:119], v27 offset:42624
    v_mfma_f32_16x16x32_bf16 v[176:179], v[152:155], v[120:123], v[176:179]
    v_mfma_f32_16x16x32_bf16 v[200:203], v[152:155], v[124:127], v[200:203]
    v_mfma_f32_16x16x32_bf16 v[224:227], v[152:155], v[128:131], v[224:227]
    v_mfma_f32_16x16x32_bf16 v[248:251], v[152:155], v[132:135], v[248:251]
    v_mfma_f32_16x16x32_bf16 v[180:183], v[156:159], v[120:123], v[180:183]
    v_mfma_f32_16x16x32_bf16 v[204:207], v[156:159], v[124:127], v[204:207]
    v_mfma_f32_16x16x32_bf16 v[228:231], v[156:159], v[128:131], v[228:231]
    v_mfma_f32_16x16x32_bf16 v[252:255], v[156:159], v[132:135], v[252:255]
    s_waitcnt lgkmcnt(0)
    v_mfma_f32_16x16x32_bf16 v[160:163], v[96:99], v[80:83], v[160:163]
    ds_read_b128 v[120:123], v24 offset:41984
    v_mfma_f32_16x16x32_bf16 v[184:187], v[96:99], v[84:87], v[184:187]
    ds_read_b64_tr_b16 v[136:137], v26 offset:53248
    v_mfma_f32_16x16x32_bf16 v[208:211], v[96:99], v[88:91], v[208:211]
    ds_read_b64_tr_b16 v[138:139], v26 offset:54784
    v_mfma_f32_16x16x32_bf16 v[232:235], v[96:99], v[92:95], v[232:235]
    ds_read_b128 v[124:127], v24 offset:44032
    v_mfma_f32_16x16x32_bf16 v[164:167], v[100:103], v[80:83], v[164:167]
    ds_read_b128 v[128:131], v24 offset:46080
    v_mfma_f32_16x16x32_bf16 v[188:191], v[100:103], v[84:87], v[188:191]
    ds_read_b128 v[132:135], v24 offset:48128
    v_mfma_f32_16x16x32_bf16 v[212:215], v[100:103], v[88:91], v[212:215]
    ds_read_b64_tr_b16 v[140:141], v27 offset:53248
    v_mfma_f32_16x16x32_bf16 v[236:239], v[100:103], v[92:95], v[236:239]
    ds_read_b64_tr_b16 v[142:143], v27 offset:54784
    v_mfma_f32_16x16x32_bf16 v[168:171], v[104:107], v[80:83], v[168:171]
    ds_read_b64_tr_b16 v[144:145], v28 offset:53248
    v_mfma_f32_16x16x32_bf16 v[192:195], v[104:107], v[84:87], v[192:195]
    ds_read_b64_tr_b16 v[146:147], v28 offset:54784
    v_mfma_f32_16x16x32_bf16 v[216:219], v[104:107], v[88:91], v[216:219]
    ds_read_b64_tr_b16 v[148:149], v29 offset:53248
    v_mfma_f32_16x16x32_bf16 v[240:243], v[104:107], v[92:95], v[240:243]
    ds_read_b64_tr_b16 v[150:151], v29 offset:54784
    v_mfma_f32_16x16x32_bf16 v[172:175], v[108:111], v[80:83], v[172:175]
    ds_read_b64_tr_b16 v[152:153], v26 offset:53376
    v_mfma_f32_16x16x32_bf16 v[196:199], v[108:111], v[84:87], v[196:199]
    ds_read_b64_tr_b16 v[154:155], v26 offset:54912
    v_mfma_f32_16x16x32_bf16 v[220:223], v[108:111], v[88:91], v[220:223]
    ds_read_b64_tr_b16 v[156:157], v27 offset:53376
    v_mfma_f32_16x16x32_bf16 v[244:247], v[108:111], v[92:95], v[244:247]
    ds_read_b64_tr_b16 v[158:159], v27 offset:54912
    v_mfma_f32_16x16x32_bf16 v[176:179], v[112:115], v[80:83], v[176:179]
    v_mfma_f32_16x16x32_bf16 v[200:203], v[112:115], v[84:87], v[200:203]
    v_mfma_f32_16x16x32_bf16 v[224:227], v[112:115], v[88:91], v[224:227]
    v_mfma_f32_16x16x32_bf16 v[248:251], v[112:115], v[92:95], v[248:251]
    v_mfma_f32_16x16x32_bf16 v[180:183], v[116:119], v[80:83], v[180:183]
    v_mfma_f32_16x16x32_bf16 v[204:207], v[116:119], v[84:87], v[204:207]
    v_mfma_f32_16x16x32_bf16 v[228:231], v[116:119], v[88:91], v[228:231]
    v_mfma_f32_16x16x32_bf16 v[252:255], v[116:119], v[92:95], v[252:255]
    s_waitcnt lgkmcnt(0)
    s_barrier
    v_mfma_f32_16x16x32_bf16 v[160:163], v[136:139], v[120:123], v[160:163]
    ds_read_b128 v[80:83], v25 offset:0
    v_mfma_f32_16x16x32_bf16 v[184:187], v[136:139], v[124:127], v[184:187]
    ds_read_b64_tr_b16 v[96:97], v30 offset:0
    v_mfma_f32_16x16x32_bf16 v[208:211], v[136:139], v[128:131], v[208:211]
    ds_read_b64_tr_b16 v[98:99], v30 offset:1536
    v_mfma_f32_16x16x32_bf16 v[232:235], v[136:139], v[132:135], v[232:235]
    ds_read_b128 v[84:87], v25 offset:2048
    v_mfma_f32_16x16x32_bf16 v[164:167], v[140:143], v[120:123], v[164:167]
    ds_read_b128 v[88:91], v25 offset:4096
    v_mfma_f32_16x16x32_bf16 v[188:191], v[140:143], v[124:127], v[188:191]
    ds_read_b128 v[92:95], v25 offset:6144
    v_mfma_f32_16x16x32_bf16 v[212:215], v[140:143], v[128:131], v[212:215]
    ds_read_b64_tr_b16 v[100:101], v31 offset:0
    v_mfma_f32_16x16x32_bf16 v[236:239], v[140:143], v[132:135], v[236:239]
    ds_read_b64_tr_b16 v[102:103], v31 offset:1536
    v_mfma_f32_16x16x32_bf16 v[168:171], v[144:147], v[120:123], v[168:171]
    ds_read_b64_tr_b16 v[104:105], v32 offset:0
    v_mfma_f32_16x16x32_bf16 v[192:195], v[144:147], v[124:127], v[192:195]
    ds_read_b64_tr_b16 v[106:107], v32 offset:1536
    v_mfma_f32_16x16x32_bf16 v[216:219], v[144:147], v[128:131], v[216:219]
    ds_read_b64_tr_b16 v[108:109], v33 offset:0
    v_mfma_f32_16x16x32_bf16 v[240:243], v[144:147], v[132:135], v[240:243]
    ds_read_b64_tr_b16 v[110:111], v33 offset:1536
    v_mfma_f32_16x16x32_bf16 v[172:175], v[148:151], v[120:123], v[172:175]
    ds_read_b64_tr_b16 v[112:113], v30 offset:128
    v_mfma_f32_16x16x32_bf16 v[196:199], v[148:151], v[124:127], v[196:199]
    ds_read_b64_tr_b16 v[114:115], v30 offset:1664
    v_mfma_f32_16x16x32_bf16 v[220:223], v[148:151], v[128:131], v[220:223]
    ds_read_b64_tr_b16 v[116:117], v31 offset:128
    v_mfma_f32_16x16x32_bf16 v[244:247], v[148:151], v[132:135], v[244:247]
    ds_read_b64_tr_b16 v[118:119], v31 offset:1664
    v_mfma_f32_16x16x32_bf16 v[176:179], v[152:155], v[120:123], v[176:179]
    v_mfma_f32_16x16x32_bf16 v[200:203], v[152:155], v[124:127], v[200:203]
    v_mfma_f32_16x16x32_bf16 v[224:227], v[152:155], v[128:131], v[224:227]
    v_mfma_f32_16x16x32_bf16 v[248:251], v[152:155], v[132:135], v[248:251]
    v_mfma_f32_16x16x32_bf16 v[180:183], v[156:159], v[120:123], v[180:183]
    v_mfma_f32_16x16x32_bf16 v[204:207], v[156:159], v[124:127], v[204:207]
    v_mfma_f32_16x16x32_bf16 v[228:231], v[156:159], v[128:131], v[228:231]
    v_mfma_f32_16x16x32_bf16 v[252:255], v[156:159], v[132:135], v[252:255]
    s_waitcnt lgkmcnt(0)
    v_mfma_f32_16x16x32_bf16 v[160:163], v[96:99], v[80:83], v[160:163]
    ds_read_b128 v[120:123], v25 offset:1024
    v_mfma_f32_16x16x32_bf16 v[184:187], v[96:99], v[84:87], v[184:187]
    ds_read_b64_tr_b16 v[136:137], v30 offset:12288
    v_mfma_f32_16x16x32_bf16 v[208:211], v[96:99], v[88:91], v[208:211]
    ds_read_b64_tr_b16 v[138:139], v30 offset:13824
    v_mfma_f32_16x16x32_bf16 v[232:235], v[96:99], v[92:95], v[232:235]
    ds_read_b128 v[124:127], v25 offset:3072
    v_mfma_f32_16x16x32_bf16 v[164:167], v[100:103], v[80:83], v[164:167]
    ds_read_b128 v[128:131], v25 offset:5120
    v_mfma_f32_16x16x32_bf16 v[188:191], v[100:103], v[84:87], v[188:191]
    ds_read_b128 v[132:135], v25 offset:7168
    v_mfma_f32_16x16x32_bf16 v[212:215], v[100:103], v[88:91], v[212:215]
    ds_read_b64_tr_b16 v[140:141], v31 offset:12288
    v_mfma_f32_16x16x32_bf16 v[236:239], v[100:103], v[92:95], v[236:239]
    ds_read_b64_tr_b16 v[142:143], v31 offset:13824
    v_mfma_f32_16x16x32_bf16 v[168:171], v[104:107], v[80:83], v[168:171]
    ds_read_b64_tr_b16 v[144:145], v32 offset:12288
    v_mfma_f32_16x16x32_bf16 v[192:195], v[104:107], v[84:87], v[192:195]
    ds_read_b64_tr_b16 v[146:147], v32 offset:13824
    v_mfma_f32_16x16x32_bf16 v[216:219], v[104:107], v[88:91], v[216:219]
    ds_read_b64_tr_b16 v[148:149], v33 offset:12288
    v_mfma_f32_16x16x32_bf16 v[240:243], v[104:107], v[92:95], v[240:243]
    ds_read_b64_tr_b16 v[150:151], v33 offset:13824
    v_mfma_f32_16x16x32_bf16 v[172:175], v[108:111], v[80:83], v[172:175]
    ds_read_b64_tr_b16 v[152:153], v30 offset:12416
    v_mfma_f32_16x16x32_bf16 v[196:199], v[108:111], v[84:87], v[196:199]
    ds_read_b64_tr_b16 v[154:155], v30 offset:13952
    v_mfma_f32_16x16x32_bf16 v[220:223], v[108:111], v[88:91], v[220:223]
    ds_read_b64_tr_b16 v[156:157], v31 offset:12416
    v_mfma_f32_16x16x32_bf16 v[244:247], v[108:111], v[92:95], v[244:247]
    ds_read_b64_tr_b16 v[158:159], v31 offset:13952
    v_mfma_f32_16x16x32_bf16 v[176:179], v[112:115], v[80:83], v[176:179]
    v_mfma_f32_16x16x32_bf16 v[200:203], v[112:115], v[84:87], v[200:203]
    v_mfma_f32_16x16x32_bf16 v[224:227], v[112:115], v[88:91], v[224:227]
    v_mfma_f32_16x16x32_bf16 v[248:251], v[112:115], v[92:95], v[248:251]
    v_mfma_f32_16x16x32_bf16 v[180:183], v[116:119], v[80:83], v[180:183]
    v_mfma_f32_16x16x32_bf16 v[204:207], v[116:119], v[84:87], v[204:207]
    v_mfma_f32_16x16x32_bf16 v[228:231], v[116:119], v[88:91], v[228:231]
    v_mfma_f32_16x16x32_bf16 v[252:255], v[116:119], v[92:95], v[252:255]
    s_waitcnt lgkmcnt(0)
    s_barrier
    v_mfma_f32_16x16x32_bf16 v[160:163], v[136:139], v[120:123], v[160:163]
    ds_read_b128 v[80:83], v25 offset:40960
    v_mfma_f32_16x16x32_bf16 v[184:187], v[136:139], v[124:127], v[184:187]
    ds_read_b64_tr_b16 v[96:97], v30 offset:40960
    v_mfma_f32_16x16x32_bf16 v[208:211], v[136:139], v[128:131], v[208:211]
    ds_read_b64_tr_b16 v[98:99], v30 offset:42496
    v_mfma_f32_16x16x32_bf16 v[232:235], v[136:139], v[132:135], v[232:235]
    ds_read_b128 v[84:87], v25 offset:43008
    v_mfma_f32_16x16x32_bf16 v[164:167], v[140:143], v[120:123], v[164:167]
    ds_read_b128 v[88:91], v25 offset:45056
    v_mfma_f32_16x16x32_bf16 v[188:191], v[140:143], v[124:127], v[188:191]
    ds_read_b128 v[92:95], v25 offset:47104
    v_mfma_f32_16x16x32_bf16 v[212:215], v[140:143], v[128:131], v[212:215]
    ds_read_b64_tr_b16 v[100:101], v31 offset:40960
    v_mfma_f32_16x16x32_bf16 v[236:239], v[140:143], v[132:135], v[236:239]
    ds_read_b64_tr_b16 v[102:103], v31 offset:42496
    v_mfma_f32_16x16x32_bf16 v[168:171], v[144:147], v[120:123], v[168:171]
    ds_read_b64_tr_b16 v[104:105], v32 offset:40960
    v_mfma_f32_16x16x32_bf16 v[192:195], v[144:147], v[124:127], v[192:195]
    ds_read_b64_tr_b16 v[106:107], v32 offset:42496
    v_mfma_f32_16x16x32_bf16 v[216:219], v[144:147], v[128:131], v[216:219]
    ds_read_b64_tr_b16 v[108:109], v33 offset:40960
    v_mfma_f32_16x16x32_bf16 v[240:243], v[144:147], v[132:135], v[240:243]
    ds_read_b64_tr_b16 v[110:111], v33 offset:42496
    v_mfma_f32_16x16x32_bf16 v[172:175], v[148:151], v[120:123], v[172:175]
    ds_read_b64_tr_b16 v[112:113], v30 offset:41088
    v_mfma_f32_16x16x32_bf16 v[196:199], v[148:151], v[124:127], v[196:199]
    ds_read_b64_tr_b16 v[114:115], v30 offset:42624
    v_mfma_f32_16x16x32_bf16 v[220:223], v[148:151], v[128:131], v[220:223]
    ds_read_b64_tr_b16 v[116:117], v31 offset:41088
    v_mfma_f32_16x16x32_bf16 v[244:247], v[148:151], v[132:135], v[244:247]
    ds_read_b64_tr_b16 v[118:119], v31 offset:42624
    v_mfma_f32_16x16x32_bf16 v[176:179], v[152:155], v[120:123], v[176:179]
    v_mfma_f32_16x16x32_bf16 v[200:203], v[152:155], v[124:127], v[200:203]
    v_mfma_f32_16x16x32_bf16 v[224:227], v[152:155], v[128:131], v[224:227]
    v_mfma_f32_16x16x32_bf16 v[248:251], v[152:155], v[132:135], v[248:251]
    v_mfma_f32_16x16x32_bf16 v[180:183], v[156:159], v[120:123], v[180:183]
    v_mfma_f32_16x16x32_bf16 v[204:207], v[156:159], v[124:127], v[204:207]
    v_mfma_f32_16x16x32_bf16 v[228:231], v[156:159], v[128:131], v[228:231]
    v_mfma_f32_16x16x32_bf16 v[252:255], v[156:159], v[132:135], v[252:255]
    s_waitcnt lgkmcnt(0)
    v_mfma_f32_16x16x32_bf16 v[160:163], v[96:99], v[80:83], v[160:163]
    ds_read_b128 v[120:123], v25 offset:41984
    v_mfma_f32_16x16x32_bf16 v[184:187], v[96:99], v[84:87], v[184:187]
    ds_read_b64_tr_b16 v[136:137], v30 offset:53248
    v_mfma_f32_16x16x32_bf16 v[208:211], v[96:99], v[88:91], v[208:211]
    ds_read_b64_tr_b16 v[138:139], v30 offset:54784
    v_mfma_f32_16x16x32_bf16 v[232:235], v[96:99], v[92:95], v[232:235]
    ds_read_b128 v[124:127], v25 offset:44032
    v_mfma_f32_16x16x32_bf16 v[164:167], v[100:103], v[80:83], v[164:167]
    ds_read_b128 v[128:131], v25 offset:46080
    v_mfma_f32_16x16x32_bf16 v[188:191], v[100:103], v[84:87], v[188:191]
    ds_read_b128 v[132:135], v25 offset:48128
    v_mfma_f32_16x16x32_bf16 v[212:215], v[100:103], v[88:91], v[212:215]
    ds_read_b64_tr_b16 v[140:141], v31 offset:53248
    v_mfma_f32_16x16x32_bf16 v[236:239], v[100:103], v[92:95], v[236:239]
    ds_read_b64_tr_b16 v[142:143], v31 offset:54784
    v_mfma_f32_16x16x32_bf16 v[168:171], v[104:107], v[80:83], v[168:171]
    ds_read_b64_tr_b16 v[144:145], v32 offset:53248
    v_mfma_f32_16x16x32_bf16 v[192:195], v[104:107], v[84:87], v[192:195]
    ds_read_b64_tr_b16 v[146:147], v32 offset:54784
    v_mfma_f32_16x16x32_bf16 v[216:219], v[104:107], v[88:91], v[216:219]
    ds_read_b64_tr_b16 v[148:149], v33 offset:53248
    v_mfma_f32_16x16x32_bf16 v[240:243], v[104:107], v[92:95], v[240:243]
    ds_read_b64_tr_b16 v[150:151], v33 offset:54784
    v_mfma_f32_16x16x32_bf16 v[172:175], v[108:111], v[80:83], v[172:175]
    ds_read_b64_tr_b16 v[152:153], v30 offset:53376
    v_mfma_f32_16x16x32_bf16 v[196:199], v[108:111], v[84:87], v[196:199]
    ds_read_b64_tr_b16 v[154:155], v30 offset:54912
    v_mfma_f32_16x16x32_bf16 v[220:223], v[108:111], v[88:91], v[220:223]
    ds_read_b64_tr_b16 v[156:157], v31 offset:53376
    v_mfma_f32_16x16x32_bf16 v[244:247], v[108:111], v[92:95], v[244:247]
    ds_read_b64_tr_b16 v[158:159], v31 offset:54912
    v_mfma_f32_16x16x32_bf16 v[176:179], v[112:115], v[80:83], v[176:179]
    v_mfma_f32_16x16x32_bf16 v[200:203], v[112:115], v[84:87], v[200:203]
    v_mfma_f32_16x16x32_bf16 v[224:227], v[112:115], v[88:91], v[224:227]
    v_mfma_f32_16x16x32_bf16 v[248:251], v[112:115], v[92:95], v[248:251]
    v_mfma_f32_16x16x32_bf16 v[180:183], v[116:119], v[80:83], v[180:183]
    v_mfma_f32_16x16x32_bf16 v[204:207], v[116:119], v[84:87], v[204:207]
    v_mfma_f32_16x16x32_bf16 v[228:231], v[116:119], v[88:91], v[228:231]
    v_mfma_f32_16x16x32_bf16 v[252:255], v[116:119], v[92:95], v[252:255]
    s_waitcnt lgkmcnt(0)
    s_barrier
    v_mfma_f32_16x16x32_bf16 v[160:163], v[136:139], v[120:123], v[160:163]
    ds_read_b128 v[80:83], v24 offset:0
    v_mfma_f32_16x16x32_bf16 v[184:187], v[136:139], v[124:127], v[184:187]
    ds_read_b64_tr_b16 v[96:97], v26 offset:0
    v_mfma_f32_16x16x32_bf16 v[208:211], v[136:139], v[128:131], v[208:211]
    ds_read_b64_tr_b16 v[98:99], v26 offset:1536
    v_mfma_f32_16x16x32_bf16 v[232:235], v[136:139], v[132:135], v[232:235]
    ds_read_b128 v[84:87], v24 offset:2048
    v_mfma_f32_16x16x32_bf16 v[164:167], v[140:143], v[120:123], v[164:167]
    ds_read_b128 v[88:91], v24 offset:4096
    v_mfma_f32_16x16x32_bf16 v[188:191], v[140:143], v[124:127], v[188:191]
    ds_read_b128 v[92:95], v24 offset:6144
    v_mfma_f32_16x16x32_bf16 v[212:215], v[140:143], v[128:131], v[212:215]
    ds_read_b64_tr_b16 v[100:101], v27 offset:0
    v_mfma_f32_16x16x32_bf16 v[236:239], v[140:143], v[132:135], v[236:239]
    ds_read_b64_tr_b16 v[102:103], v27 offset:1536
    v_mfma_f32_16x16x32_bf16 v[168:171], v[144:147], v[120:123], v[168:171]
    ds_read_b64_tr_b16 v[104:105], v28 offset:0
    v_mfma_f32_16x16x32_bf16 v[192:195], v[144:147], v[124:127], v[192:195]
    ds_read_b64_tr_b16 v[106:107], v28 offset:1536
    v_mfma_f32_16x16x32_bf16 v[216:219], v[144:147], v[128:131], v[216:219]
    ds_read_b64_tr_b16 v[108:109], v29 offset:0
    v_mfma_f32_16x16x32_bf16 v[240:243], v[144:147], v[132:135], v[240:243]
    ds_read_b64_tr_b16 v[110:111], v29 offset:1536
    v_mfma_f32_16x16x32_bf16 v[172:175], v[148:151], v[120:123], v[172:175]
    ds_read_b64_tr_b16 v[112:113], v26 offset:128
    v_mfma_f32_16x16x32_bf16 v[196:199], v[148:151], v[124:127], v[196:199]
    ds_read_b64_tr_b16 v[114:115], v26 offset:1664
    v_mfma_f32_16x16x32_bf16 v[220:223], v[148:151], v[128:131], v[220:223]
    ds_read_b64_tr_b16 v[116:117], v27 offset:128
    v_mfma_f32_16x16x32_bf16 v[244:247], v[148:151], v[132:135], v[244:247]
    ds_read_b64_tr_b16 v[118:119], v27 offset:1664
    v_mfma_f32_16x16x32_bf16 v[176:179], v[152:155], v[120:123], v[176:179]
    v_mfma_f32_16x16x32_bf16 v[200:203], v[152:155], v[124:127], v[200:203]
    v_mfma_f32_16x16x32_bf16 v[224:227], v[152:155], v[128:131], v[224:227]
    v_mfma_f32_16x16x32_bf16 v[248:251], v[152:155], v[132:135], v[248:251]
    v_mfma_f32_16x16x32_bf16 v[180:183], v[156:159], v[120:123], v[180:183]
    v_mfma_f32_16x16x32_bf16 v[204:207], v[156:159], v[124:127], v[204:207]
    v_mfma_f32_16x16x32_bf16 v[228:231], v[156:159], v[128:131], v[228:231]
    v_mfma_f32_16x16x32_bf16 v[252:255], v[156:159], v[132:135], v[252:255]
    s_waitcnt lgkmcnt(0)
    v_mfma_f32_16x16x32_bf16 v[160:163], v[96:99], v[80:83], v[160:163]
    ds_read_b128 v[120:123], v24 offset:1024
    v_mfma_f32_16x16x32_bf16 v[184:187], v[96:99], v[84:87], v[184:187]
    ds_read_b64_tr_b16 v[136:137], v26 offset:12288
    v_mfma_f32_16x16x32_bf16 v[208:211], v[96:99], v[88:91], v[208:211]
    ds_read_b64_tr_b16 v[138:139], v26 offset:13824
    v_mfma_f32_16x16x32_bf16 v[232:235], v[96:99], v[92:95], v[232:235]
    ds_read_b128 v[124:127], v24 offset:3072
    v_mfma_f32_16x16x32_bf16 v[164:167], v[100:103], v[80:83], v[164:167]
    ds_read_b128 v[128:131], v24 offset:5120
    v_mfma_f32_16x16x32_bf16 v[188:191], v[100:103], v[84:87], v[188:191]
    ds_read_b128 v[132:135], v24 offset:7168
    v_mfma_f32_16x16x32_bf16 v[212:215], v[100:103], v[88:91], v[212:215]
    ds_read_b64_tr_b16 v[140:141], v27 offset:12288
    v_mfma_f32_16x16x32_bf16 v[236:239], v[100:103], v[92:95], v[236:239]
    ds_read_b64_tr_b16 v[142:143], v27 offset:13824
    v_mfma_f32_16x16x32_bf16 v[168:171], v[104:107], v[80:83], v[168:171]
    ds_read_b64_tr_b16 v[144:145], v28 offset:12288
    v_mfma_f32_16x16x32_bf16 v[192:195], v[104:107], v[84:87], v[192:195]
    ds_read_b64_tr_b16 v[146:147], v28 offset:13824
    v_mfma_f32_16x16x32_bf16 v[216:219], v[104:107], v[88:91], v[216:219]
    ds_read_b64_tr_b16 v[148:149], v29 offset:12288
    v_mfma_f32_16x16x32_bf16 v[240:243], v[104:107], v[92:95], v[240:243]
    ds_read_b64_tr_b16 v[150:151], v29 offset:13824
    v_mfma_f32_16x16x32_bf16 v[172:175], v[108:111], v[80:83], v[172:175]
    ds_read_b64_tr_b16 v[152:153], v26 offset:12416
    v_mfma_f32_16x16x32_bf16 v[196:199], v[108:111], v[84:87], v[196:199]
    ds_read_b64_tr_b16 v[154:155], v26 offset:13952
    v_mfma_f32_16x16x32_bf16 v[220:223], v[108:111], v[88:91], v[220:223]
    ds_read_b64_tr_b16 v[156:157], v27 offset:12416
    v_mfma_f32_16x16x32_bf16 v[244:247], v[108:111], v[92:95], v[244:247]
    ds_read_b64_tr_b16 v[158:159], v27 offset:13952
    v_mfma_f32_16x16x32_bf16 v[176:179], v[112:115], v[80:83], v[176:179]
    v_mfma_f32_16x16x32_bf16 v[200:203], v[112:115], v[84:87], v[200:203]
    v_mfma_f32_16x16x32_bf16 v[224:227], v[112:115], v[88:91], v[224:227]
    v_mfma_f32_16x16x32_bf16 v[248:251], v[112:115], v[92:95], v[248:251]
    v_mfma_f32_16x16x32_bf16 v[180:183], v[116:119], v[80:83], v[180:183]
    v_mfma_f32_16x16x32_bf16 v[204:207], v[116:119], v[84:87], v[204:207]
    v_mfma_f32_16x16x32_bf16 v[228:231], v[116:119], v[88:91], v[228:231]
    v_mfma_f32_16x16x32_bf16 v[252:255], v[116:119], v[92:95], v[252:255]
    s_waitcnt lgkmcnt(0)
    s_barrier
    v_mfma_f32_16x16x32_bf16 v[160:163], v[136:139], v[120:123], v[160:163]
    ds_read_b128 v[80:83], v24 offset:40960
    v_mfma_f32_16x16x32_bf16 v[184:187], v[136:139], v[124:127], v[184:187]
    ds_read_b64_tr_b16 v[96:97], v26 offset:40960
    v_mfma_f32_16x16x32_bf16 v[208:211], v[136:139], v[128:131], v[208:211]
    ds_read_b64_tr_b16 v[98:99], v26 offset:42496
    v_mfma_f32_16x16x32_bf16 v[232:235], v[136:139], v[132:135], v[232:235]
    ds_read_b128 v[84:87], v24 offset:43008
    v_mfma_f32_16x16x32_bf16 v[164:167], v[140:143], v[120:123], v[164:167]
    ds_read_b128 v[88:91], v24 offset:45056
    v_mfma_f32_16x16x32_bf16 v[188:191], v[140:143], v[124:127], v[188:191]
    ds_read_b128 v[92:95], v24 offset:47104
    v_mfma_f32_16x16x32_bf16 v[212:215], v[140:143], v[128:131], v[212:215]
    ds_read_b64_tr_b16 v[100:101], v27 offset:40960
    v_mfma_f32_16x16x32_bf16 v[236:239], v[140:143], v[132:135], v[236:239]
    ds_read_b64_tr_b16 v[102:103], v27 offset:42496
    v_mfma_f32_16x16x32_bf16 v[168:171], v[144:147], v[120:123], v[168:171]
    ds_read_b64_tr_b16 v[104:105], v28 offset:40960
    v_mfma_f32_16x16x32_bf16 v[192:195], v[144:147], v[124:127], v[192:195]
    ds_read_b64_tr_b16 v[106:107], v28 offset:42496
    v_mfma_f32_16x16x32_bf16 v[216:219], v[144:147], v[128:131], v[216:219]
    ds_read_b64_tr_b16 v[108:109], v29 offset:40960
    v_mfma_f32_16x16x32_bf16 v[240:243], v[144:147], v[132:135], v[240:243]
    ds_read_b64_tr_b16 v[110:111], v29 offset:42496
    v_mfma_f32_16x16x32_bf16 v[172:175], v[148:151], v[120:123], v[172:175]
    ds_read_b64_tr_b16 v[112:113], v26 offset:41088
    v_mfma_f32_16x16x32_bf16 v[196:199], v[148:151], v[124:127], v[196:199]
    ds_read_b64_tr_b16 v[114:115], v26 offset:42624
    v_mfma_f32_16x16x32_bf16 v[220:223], v[148:151], v[128:131], v[220:223]
    ds_read_b64_tr_b16 v[116:117], v27 offset:41088
    v_mfma_f32_16x16x32_bf16 v[244:247], v[148:151], v[132:135], v[244:247]
    ds_read_b64_tr_b16 v[118:119], v27 offset:42624
    v_mfma_f32_16x16x32_bf16 v[176:179], v[152:155], v[120:123], v[176:179]
    v_mfma_f32_16x16x32_bf16 v[200:203], v[152:155], v[124:127], v[200:203]
    v_mfma_f32_16x16x32_bf16 v[224:227], v[152:155], v[128:131], v[224:227]
    v_mfma_f32_16x16x32_bf16 v[248:251], v[152:155], v[132:135], v[248:251]
    v_mfma_f32_16x16x32_bf16 v[180:183], v[156:159], v[120:123], v[180:183]
    v_mfma_f32_16x16x32_bf16 v[204:207], v[156:159], v[124:127], v[204:207]
    v_mfma_f32_16x16x32_bf16 v[228:231], v[156:159], v[128:131], v[228:231]
    v_mfma_f32_16x16x32_bf16 v[252:255], v[156:159], v[132:135], v[252:255]
    s_waitcnt lgkmcnt(0)
    v_mfma_f32_16x16x32_bf16 v[184:187], v[96:99], v[84:87], v[184:187]
    ds_read_b128 v[120:123], v24 offset:41984
    ds_read_b64_tr_b16 v[136:137], v26 offset:53248
    v_mfma_f32_16x16x32_bf16 v[188:191], v[100:103], v[84:87], v[188:191]
    ds_read_b64_tr_b16 v[138:139], v26 offset:54784
    ds_read_b128 v[124:127], v24 offset:44032
    v_mfma_f32_16x16x32_bf16 v[192:195], v[104:107], v[84:87], v[192:195]
    ds_read_b128 v[128:131], v24 offset:46080
    ds_read_b128 v[132:135], v24 offset:48128
    v_mfma_f32_16x16x32_bf16 v[196:199], v[108:111], v[84:87], v[196:199]
    ds_read_b64_tr_b16 v[140:141], v27 offset:53248
    ds_read_b64_tr_b16 v[142:143], v27 offset:54784
    v_mfma_f32_16x16x32_bf16 v[200:203], v[112:115], v[84:87], v[200:203]
    ds_read_b64_tr_b16 v[144:145], v28 offset:53248
    ds_read_b64_tr_b16 v[146:147], v28 offset:54784
    v_mfma_f32_16x16x32_bf16 v[204:207], v[116:119], v[84:87], v[204:207]
    ds_read_b64_tr_b16 v[148:149], v29 offset:53248
    ds_read_b64_tr_b16 v[150:151], v29 offset:54784
    v_mfma_f32_16x16x32_bf16 v[208:211], v[96:99], v[88:91], v[208:211]
    ds_read_b64_tr_b16 v[152:153], v26 offset:53376
    ds_read_b64_tr_b16 v[154:155], v26 offset:54912
    v_mfma_f32_16x16x32_bf16 v[212:215], v[100:103], v[88:91], v[212:215]
    ds_read_b64_tr_b16 v[156:157], v27 offset:53376
    ds_read_b64_tr_b16 v[158:159], v27 offset:54912
    v_mfma_f32_16x16x32_bf16 v[216:219], v[104:107], v[88:91], v[216:219]
    v_mfma_f32_16x16x32_bf16 v[220:223], v[108:111], v[88:91], v[220:223]
    v_mfma_f32_16x16x32_bf16 v[224:227], v[112:115], v[88:91], v[224:227]
    v_mfma_f32_16x16x32_bf16 v[228:231], v[116:119], v[88:91], v[228:231]
    s_waitcnt lgkmcnt(0)
    v_mfma_f32_16x16x32_bf16 v[184:187], v[136:139], v[124:127], v[184:187]
    v_mfma_f32_16x16x32_bf16 v[188:191], v[140:143], v[124:127], v[188:191]
    v_mfma_f32_16x16x32_bf16 v[192:195], v[144:147], v[124:127], v[192:195]
    v_mfma_f32_16x16x32_bf16 v[196:199], v[148:151], v[124:127], v[196:199]
    v_mfma_f32_16x16x32_bf16 v[200:203], v[152:155], v[124:127], v[200:203]
    v_cvt_pk_bf16_f32 v40, v184, v185
    v_cvt_pk_bf16_f32 v41, v186, v187
    v_mfma_f32_16x16x32_bf16 v[204:207], v[156:159], v[124:127], v[204:207]
    v_cvt_pk_bf16_f32 v42, v188, v189
    v_cvt_pk_bf16_f32 v43, v190, v191
    v_mfma_f32_16x16x32_bf16 v[208:211], v[136:139], v[128:131], v[208:211]
    v_min_u32 v40, -2, v40
    v_min_u32 v41, -2, v41
    v_mfma_f32_16x16x32_bf16 v[212:215], v[140:143], v[128:131], v[212:215]
    v_min_u32 v42, -2, v42
    v_min_u32 v43, -2, v43
    buffer_store_dwordx4 v[40:43], v5, s[56:59], s44 offen offset:0 sc0 sc1
    v_mfma_f32_16x16x32_bf16 v[216:219], v[144:147], v[128:131], v[216:219]
    v_cvt_pk_bf16_f32 v44, v192, v193
    v_cvt_pk_bf16_f32 v45, v194, v195
    v_mfma_f32_16x16x32_bf16 v[220:223], v[148:151], v[128:131], v[220:223]
    v_cvt_pk_bf16_f32 v46, v196, v197
    v_cvt_pk_bf16_f32 v47, v198, v199
    v_mfma_f32_16x16x32_bf16 v[224:227], v[152:155], v[128:131], v[224:227]
    v_min_u32 v44, -2, v44
    v_min_u32 v45, -2, v45
    v_mfma_f32_16x16x32_bf16 v[228:231], v[156:159], v[128:131], v[228:231]
    v_min_u32 v46, -2, v46
    v_min_u32 v47, -2, v47
    buffer_store_dwordx4 v[44:47], v5, s[56:59], s44 offen offset:1024 sc0 sc1
    v_mfma_f32_16x16x32_bf16 v[232:235], v[96:99], v[92:95], v[232:235]
    v_cvt_pk_bf16_f32 v48, v200, v201
    v_cvt_pk_bf16_f32 v49, v202, v203
    v_mfma_f32_16x16x32_bf16 v[236:239], v[100:103], v[92:95], v[236:239]
    v_cvt_pk_bf16_f32 v50, v204, v205
    v_cvt_pk_bf16_f32 v51, v206, v207
    v_mfma_f32_16x16x32_bf16 v[240:243], v[104:107], v[92:95], v[240:243]
    v_min_u32 v48, -2, v48
    v_min_u32 v49, -2, v49
    v_mfma_f32_16x16x32_bf16 v[244:247], v[108:111], v[92:95], v[244:247]
    v_min_u32 v50, -2, v50
    v_min_u32 v51, -2, v51
    buffer_store_dwordx4 v[48:51], v5, s[56:59], s44 offen offset:2048 sc0 sc1
    s_add_u32 s44, s44, 3072
    v_mfma_f32_16x16x32_bf16 v[248:251], v[112:115], v[92:95], v[248:251]
    v_cvt_pk_bf16_f32 v52, v208, v209
    v_cvt_pk_bf16_f32 v53, v210, v211
    v_mfma_f32_16x16x32_bf16 v[252:255], v[116:119], v[92:95], v[252:255]
    v_cvt_pk_bf16_f32 v54, v212, v213
    v_cvt_pk_bf16_f32 v55, v214, v215
    v_mfma_f32_16x16x32_bf16 v[232:235], v[136:139], v[132:135], v[232:235]
    v_min_u32 v52, -2, v52
    v_min_u32 v53, -2, v53
    v_mfma_f32_16x16x32_bf16 v[236:239], v[140:143], v[132:135], v[236:239]
    v_min_u32 v54, -2, v54
    v_min_u32 v55, -2, v55
    buffer_store_dwordx4 v[52:55], v5, s[56:59], s44 offen offset:0 sc0 sc1
    v_mfma_f32_16x16x32_bf16 v[240:243], v[144:147], v[132:135], v[240:243]
    v_cvt_pk_bf16_f32 v56, v216, v217
    v_cvt_pk_bf16_f32 v57, v218, v219
    v_mfma_f32_16x16x32_bf16 v[244:247], v[148:151], v[132:135], v[244:247]
    v_cvt_pk_bf16_f32 v58, v220, v221
    v_cvt_pk_bf16_f32 v59, v222, v223
    v_mfma_f32_16x16x32_bf16 v[248:251], v[152:155], v[132:135], v[248:251]
    v_min_u32 v56, -2, v56
    v_min_u32 v57, -2, v57
    v_mfma_f32_16x16x32_bf16 v[252:255], v[156:159], v[132:135], v[252:255]
    v_min_u32 v58, -2, v58
    v_min_u32 v59, -2, v59
    buffer_store_dwordx4 v[56:59], v5, s[56:59], s44 offen offset:1024 sc0 sc1
    v_mfma_f32_16x16x32_bf16 v[160:163], v[96:99], v[80:83], v[160:163]
    v_cvt_pk_bf16_f32 v60, v224, v225
    v_cvt_pk_bf16_f32 v61, v226, v227
    v_mfma_f32_16x16x32_bf16 v[164:167], v[100:103], v[80:83], v[164:167]
    v_cvt_pk_bf16_f32 v62, v228, v229
    v_cvt_pk_bf16_f32 v63, v230, v231
    v_mfma_f32_16x16x32_bf16 v[168:171], v[104:107], v[80:83], v[168:171]
    v_min_u32 v60, -2, v60
    v_min_u32 v61, -2, v61
    v_mfma_f32_16x16x32_bf16 v[172:175], v[108:111], v[80:83], v[172:175]
    v_min_u32 v62, -2, v62
    v_min_u32 v63, -2, v63
    buffer_store_dwordx4 v[60:63], v5, s[56:59], s44 offen offset:2048 sc0 sc1
    s_add_u32 s44, s44, 3072
    v_mfma_f32_16x16x32_bf16 v[176:179], v[112:115], v[80:83], v[176:179]
    v_cvt_pk_bf16_f32 v40, v232, v233
    v_cvt_pk_bf16_f32 v41, v234, v235
    v_mfma_f32_16x16x32_bf16 v[180:183], v[116:119], v[80:83], v[180:183]
    v_cvt_pk_bf16_f32 v42, v236, v237
    v_cvt_pk_bf16_f32 v43, v238, v239
    v_mfma_f32_16x16x32_bf16 v[160:163], v[136:139], v[120:123], v[160:163]
    v_min_u32 v40, -2, v40
    v_min_u32 v41, -2, v41
    v_mfma_f32_16x16x32_bf16 v[164:167], v[140:143], v[120:123], v[164:167]
    v_min_u32 v42, -2, v42
    v_min_u32 v43, -2, v43
    buffer_store_dwordx4 v[40:43], v5, s[56:59], s44 offen offset:0 sc0 sc1
    v_mfma_f32_16x16x32_bf16 v[168:171], v[144:147], v[120:123], v[168:171]
    v_cvt_pk_bf16_f32 v44, v240, v241
    v_cvt_pk_bf16_f32 v45, v242, v243
    v_mfma_f32_16x16x32_bf16 v[172:175], v[148:151], v[120:123], v[172:175]
    v_cvt_pk_bf16_f32 v46, v244, v245
    v_cvt_pk_bf16_f32 v47, v246, v247
    v_mfma_f32_16x16x32_bf16 v[176:179], v[152:155], v[120:123], v[176:179]
    v_min_u32 v44, -2, v44
    v_min_u32 v45, -2, v45
    v_mfma_f32_16x16x32_bf16 v[180:183], v[156:159], v[120:123], v[180:183]
    v_min_u32 v46, -2, v46
    v_min_u32 v47, -2, v47
    buffer_store_dwordx4 v[44:47], v5, s[56:59], s44 offen offset:1024 sc0 sc1
    v_cvt_pk_bf16_f32 v48, v248, v249
    v_cvt_pk_bf16_f32 v49, v250, v251
    v_cvt_pk_bf16_f32 v50, v252, v253
    v_cvt_pk_bf16_f32 v51, v254, v255
    v_min_u32 v48, -2, v48
    v_min_u32 v49, -2, v49
    v_min_u32 v50, -2, v50
    v_min_u32 v51, -2, v51
    buffer_store_dwordx4 v[48:51], v5, s[56:59], s44 offen offset:2048 sc0 sc1
    ds_write_b128 v6, v[160:163] offset:0
    ds_write_b128 v6, v[164:167] offset:1024
    ds_write_b128 v6, v[168:171] offset:2048
    ds_write_b128 v6, v[172:175] offset:3072
    ds_write_b128 v6, v[176:179] offset:4096
    ds_write_b128 v6, v[180:183] offset:5120
    s_waitcnt lgkmcnt(0)
    s_barrier
    s_endpgm
fused_kernel_ylate:
    s_bitcmp1_b32 s66, 1
    s_cbranch_scc1 fused_kernel_yl_s1_ok
    s_movk_i32 s98, 0x4000
fused_kernel_yl_s1_l:
    s_andn2_b32 exec_lo, 0x30003, s76
    s_mov_b32 exec_hi, 0
    buffer_load_dword v9, v22, s[92:95], 0 offen sc0 sc1
    s_mov_b64 exec, -1
    s_waitcnt vmcnt(0)
    v_bfe_u32 v24, v22, 2, 3
    v_bfe_u32 v24, v9, v24, 1
    v_cmp_ne_u32 vcc, 0, v24
    s_nop 1
    s_mov_b32 s76, vcc_lo
    s_lshr_b32 s66, vcc_lo, 16
    s_and_b32 s66, s66, vcc_lo
    s_bitcmp1_b32 s66, 1
    s_cbranch_scc1 fused_kernel_yl_s1_ok
    s_sleep 2
    s_sub_u32 s98, s98, 1
    s_cbranch_scc0 fused_kernel_yl_s1_l
fused_kernel_yl_s1_ok:
    s_bfe_u32 s3, s54, 0x40004
    s_lshl_b32 s3, s3, 1
    s_lshl_b32 s21, s3, 18
    s_add_u32 s20, s21, s60
    s_add_u32 s21, s21, s61
    s_add_u32 s21, s21, 2048
    s_cmp_eq_u32 s33, 0
    s_cselect_b32 s20, s20, s21
    s_lshl_b32 s21, s33, 11
    s_add_u32 s21, s21, s40
    s_add_u32 m0, s21, 81920
    s_nop 0
    buffer_load_dwordx4 v3, s[16:19], s20 offen sc0 sc1 lds
    buffer_load_dwordx4 v3, s[16:19], s20 offen offset:1024 sc0 sc1 lds
    s_waitcnt vmcnt(0)
fused_kernel_prod:
    s_bfe_u32 s3, s54, 0x40004
    s_lshl_b32 s3, s3, 1
    s_add_u32 s3, s3, 1
    s_lshl_b32 s21, s3, 18
    s_add_u32 s20, s21, s60
    s_add_u32 s21, s21, s61
    s_mul_i32 s3, s3, 73728
    s_add_u32 s3, s3, s62
    s_add_u32 m0, s41, 122880
    s_nop 0
    buffer_load_dwordx4 v1, s[12:15], s3 offen lds
    buffer_load_dwordx4 v2, s[12:15], s3 offen offset:1024 lds
    v_mul_f32 v10, s46, v64
    v_mul_f32 v11, s46, v65
    v_mul_f32 v12, s46, v66
    v_mul_f32 v13, s46, v67
    v_exp_f32 v10, v10
    buffer_load_dwordx4 v6, s[12:15], s3 offen offset:2048 lds
    v_exp_f32 v11, v11
    v_exp_f32 v12, v12
    v_exp_f32 v13, v13
    v_mul_f32 v14, v64, v68
    v_mul_f32 v15, v65, v69
    s_add_u32 m0, s40, 122880
    s_nop 0
    buffer_load_dwordx4 v3, s[16:19], s20 offen  lds
    v_mul_f32 v16, v66, v70
    v_mul_f32 v17, v67, v71
    v_add_f32 v10, 1.0, v10
    v_add_f32 v11, 1.0, v11
    v_add_f32 v12, 1.0, v12
    buffer_load_dwordx4 v3, s[16:19], s20 offen offset:1024  lds
    v_add_f32 v13, 1.0, v13
    v_rcp_f32 v10, v10
    v_rcp_f32 v11, v11
    v_rcp_f32 v12, v12
    v_rcp_f32 v13, v13
    buffer_load_dwordx4 v3, s[16:19], s21 offen offset:2048  lds
    v_mul_f32 v14, v14, v10
    v_mul_f32 v15, v15, v11
    v_mul_f32 v16, v16, v12
    v_mul_f32 v17, v17, v13
    v_cvt_pk_bf16_f32 v20, v14, v15
    buffer_load_dwordx4 v3, s[16:19], s21 offen offset:3072  lds
    v_cvt_pk_bf16_f32 v21, v16, v17
    s_nop 0
    v_permlane16_swap_b32 v18, v20
    v_permlane16_swap_b32 v19, v21
    s_add_u32 m0, s41, 129024
    s_add_u32 s3, s3, 18432
    buffer_load_dwordx4 v1, s[12:15], s3 offen lds
    buffer_load_dwordx4 v2, s[12:15], s3 offen offset:1024 lds
    buffer_load_dwordx4 v6, s[12:15], s3 offen offset:2048 lds
    s_bfe_u32 s3, s54, 0x40008
    s_lshl_b32 s3, s3, 1
    s_lshl_b32 s21, s3, 18
    s_add_u32 s20, s21, s60
    s_add_u32 s21, s21, s61
    s_mul_i32 s3, s3, 73728
    s_add_u32 s3, s3, s62
    s_add_u32 m0, s41, 0
    s_nop 0
    buffer_load_dwordx4 v1, s[12:15], s3 offen lds
    buffer_load_dwordx4 v2, s[12:15], s3 offen offset:1024 lds
    buffer_load_dwordx4 v6, s[12:15], s3 offen offset:2048 lds
    s_waitcnt vmcnt(18)
    v_bfe_u32 v24, v22, 2, 3
    v_bfe_u32 v24, v9, v24, 1
    v_cmp_ne_u32 vcc, 0, v24
    s_nop 1
    s_mov_b32 s76, vcc_lo
    s_lshr_b32 s66, vcc_lo, 16
    s_and_b32 s66, s66, vcc_lo
    s_bitcmp1_b32 s66, 2
    s_cbranch_scc1 fused_kernel_ps4_ok
    s_movk_i32 s98, 0x4000
fused_kernel_ps4_l:
    s_andn2_b32 exec_lo, 0x70007, s76
    s_mov_b32 exec_hi, 0
    buffer_load_dword v9, v22, s[92:95], 0 offen sc0 sc1
    s_mov_b64 exec, -1
    s_waitcnt vmcnt(0)
    v_bfe_u32 v24, v22, 2, 3
    v_bfe_u32 v24, v9, v24, 1
    v_cmp_ne_u32 vcc, 0, v24
    s_nop 1
    s_mov_b32 s76, vcc_lo
    s_lshr_b32 s66, vcc_lo, 16
    s_and_b32 s66, s66, vcc_lo
    s_bitcmp1_b32 s66, 2
    s_cbranch_scc1 fused_kernel_ps4_ok
    s_sleep 2
    s_sub_u32 s98, s98, 1
    s_cbranch_scc0 fused_kernel_ps4_l
fused_kernel_ps4_ok:
    s_andn2_b32 exec_lo, 0x1f001f, s76
    s_mov_b32 exec_hi, 0
    buffer_load_dword v9, v22, s[92:95], 0 offen sc0 sc1
    s_mov_b64 exec, -1
    s_add_u32 m0, s40, 0
    s_nop 0
    buffer_load_dwordx4 v3, s[16:19], s20 offen  lds
    s_nop 0
    buffer_store_dwordx4 v[18:21], v23, s[16:19], s47 offen sc0 sc1
    s_add_u32 s47, s47, 4096
    s_waitcnt vmcnt(16)
    s_barrier
    buffer_load_dwordx4 v3, s[16:19], s20 offen offset:1024  lds
    buffer_load_dwordx4 v3, s[16:19], s21 offen offset:2048  lds
    buffer_load_dwordx4 v3, s[16:19], s21 offen offset:3072  lds
    s_add_u32 m0, s41, 6144
    s_add_u32 s3, s3, 18432
    buffer_load_dwordx4 v1, s[12:15], s3 offen lds
    buffer_load_dwordx4 v2, s[12:15], s3 offen offset:1024 lds
    buffer_load_dwordx4 v6, s[12:15], s3 offen offset:2048 lds
    s_bfe_u32 s3, s54, 0x40008
    s_lshl_b32 s3, s3, 1
    s_add_u32 s3, s3, 1
    s_lshl_b32 s21, s3, 18
    s_add_u32 s20, s21, s60
    s_add_u32 s21, s21, s61
    s_mul_i32 s3, s3, 73728
    s_add_u32 s3, s3, s62
    s_add_u32 m0, s41, 40960
    s_nop 0
    buffer_load_dwordx4 v1, s[12:15], s3 offen lds
    buffer_load_dwordx4 v2, s[12:15], s3 offen offset:1024 lds
    buffer_load_dwordx4 v6, s[12:15], s3 offen offset:2048 lds
    s_add_u32 m0, s40, 40960
    s_nop 0
    buffer_load_dwordx4 v3, s[16:19], s20 offen  lds
    buffer_load_dwordx4 v3, s[16:19], s20 offen offset:1024  lds
    s_waitcnt vmcnt(17)
    s_barrier
    buffer_load_dwordx4 v3, s[16:19], s21 offen offset:2048  lds
    buffer_load_dwordx4 v3, s[16:19], s21 offen offset:3072  lds
    s_add_u32 m0, s41, 47104
    s_add_u32 s3, s3, 18432
    buffer_load_dwordx4 v1, s[12:15], s3 offen lds
    buffer_load_dwordx4 v2, s[12:15], s3 offen offset:1024 lds
    buffer_load_dwordx4 v6, s[12:15], s3 offen offset:2048 lds
    s_bfe_u32 s3, s54, 0x4000c
    s_lshl_b32 s3, s3, 1
    s_lshl_b32 s21, s3, 18
    s_add_u32 s20, s21, s60
    s_add_u32 s21, s21, s61
    s_mul_i32 s3, s3, 73728
    s_add_u32 s3, s3, s62
    s_add_u32 m0, s41, 81920
    s_nop 0
    buffer_load_dwordx4 v1, s[12:15], s3 offen lds
    buffer_load_dwordx4 v2, s[12:15], s3 offen offset:1024 lds
    buffer_load_dwordx4 v6, s[12:15], s3 offen offset:2048 lds
    s_waitcnt vmcnt(21)
    v_bfe_u32 v24, v22, 2, 3
    v_bfe_u32 v24, v9, v24, 1
    v_cmp_ne_u32 vcc, 0, v24
    s_nop 1
    s_mov_b32 s76, vcc_lo
    s_lshr_b32 s66, vcc_lo, 16
    s_and_b32 s66, s66, vcc_lo
    s_bitcmp1_b32 s66, 3
    s_cbranch_scc1 fused_kernel_ps6_ok
    s_movk_i32 s98, 0x4000
fused_kernel_ps6_l:
    s_andn2_b32 exec_lo, 0xf000f, s76
    s_mov_b32 exec_hi, 0
    buffer_load_dword v9, v22, s[92:95], 0 offen sc0 sc1
    s_mov_b64 exec, -1
    s_waitcnt vmcnt(0)
    v_bfe_u32 v24, v22, 2, 3
    v_bfe_u32 v24, v9, v24, 1
    v_cmp_ne_u32 vcc, 0, v24
    s_nop 1
    s_mov_b32 s76, vcc_lo
    s_lshr_b32 s66, vcc_lo, 16
    s_and_b32 s66, s66, vcc_lo
    s_bitcmp1_b32 s66, 3
    s_cbranch_scc1 fused_kernel_ps6_ok
    s_sleep 2
    s_sub_u32 s98, s98, 1
    s_cbranch_scc0 fused_kernel_ps6_l
fused_kernel_ps6_ok:
    s_andn2_b32 exec_lo, 0x3f003f, s76
    s_mov_b32 exec_hi, 0
    buffer_load_dword v9, v22, s[92:95], 0 offen sc0 sc1
    s_mov_b64 exec, -1
    s_add_u32 m0, s40, 81920
    s_nop 0
    buffer_load_dwordx4 v3, s[16:19], s20 offen  lds
    buffer_load_dwordx4 v3, s[16:19], s20 offen offset:1024  lds
    buffer_load_dwordx4 v3, s[16:19], s21 offen offset:2048  lds
    s_waitcnt vmcnt(17)
    s_barrier
    buffer_load_dwordx4 v3, s[16:19], s21 offen offset:3072  lds
    s_cmp_eq_u32 s84, 0
    s_cselect_b32 s100, -1, 0
    s_mov_b32 s101, 0
    v_mov_b32 v24, 63
    v_lshlrev_b32 v25, 2, v0
    v_and_b32 v25, 127, v25
    s_mov_b64 exec, s[100:101]
    buffer_store_dword v24, v25, s[92:95], s2 offen sc0 sc1
    s_mov_b64 exec, -1
    s_add_u32 m0, s41, 88064
    s_add_u32 s3, s3, 18432
    buffer_load_dwordx4 v1, s[12:15], s3 offen lds
    buffer_load_dwordx4 v2, s[12:15], s3 offen offset:1024 lds
    buffer_load_dwordx4 v6, s[12:15], s3 offen offset:2048 lds
    s_bfe_u32 s3, s54, 0x4000c
    s_lshl_b32 s3, s3, 1
    s_add_u32 s3, s3, 1
    s_lshl_b32 s21, s3, 18
    s_add_u32 s20, s21, s60
    s_add_u32 s21, s21, s61
    s_mul_i32 s3, s3, 73728
    s_add_u32 s3, s3, s62
    s_add_u32 m0, s41, 122880
    s_nop 0
    buffer_load_dwordx4 v1, s[12:15], s3 offen lds
    buffer_load_dwordx4 v2, s[12:15], s3 offen offset:1024 lds
    buffer_load_dwordx4 v6, s[12:15], s3 offen offset:2048 lds
    s_add_u32 m0, s40, 122880
    s_nop 0
    buffer_load_dwordx4 v3, s[16:19], s20 offen  lds
    buffer_load_dwordx4 v3, s[16:19], s20 offen offset:1024  lds
    buffer_load_dwordx4 v3, s[16:19], s21 offen offset:2048  lds
    buffer_load_dwordx4 v3, s[16:19], s21 offen offset:3072  lds
    s_add_u32 m0, s41, 129024
    s_add_u32 s3, s3, 18432
    s_waitcnt vmcnt(19)
    s_barrier
    buffer_load_dwordx4 v1, s[12:15], s3 offen lds
    buffer_load_dwordx4 v2, s[12:15], s3 offen offset:1024 lds
    buffer_load_dwordx4 v6, s[12:15], s3 offen offset:2048 lds
    s_bfe_u32 s3, s54, 0x40010
    s_lshl_b32 s3, s3, 1
    s_lshl_b32 s21, s3, 18
    s_add_u32 s20, s21, s60
    s_add_u32 s21, s21, s61
    s_mul_i32 s3, s3, 73728
    s_add_u32 s3, s3, s62
    s_add_u32 m0, s41, 0
    s_nop 0
    buffer_load_dwordx4 v1, s[12:15], s3 offen lds
    buffer_load_dwordx4 v2, s[12:15], s3 offen offset:1024 lds
    buffer_load_dwordx4 v6, s[12:15], s3 offen offset:2048 lds
    s_waitcnt vmcnt(21)
    v_bfe_u32 v24, v22, 2, 3
    v_bfe_u32 v24, v9, v24, 1
    v_cmp_ne_u32 vcc, 0, v24
    s_nop 1
    s_mov_b32 s76, vcc_lo
    s_lshr_b32 s66, vcc_lo, 16
    s_and_b32 s66, s66, vcc_lo
    s_bitcmp1_b32 s66, 4
    s_cbranch_scc1 fused_kernel_ps8_ok
    s_movk_i32 s98, 0x4000
fused_kernel_ps8_l:
    s_andn2_b32 exec_lo, 0x1f001f, s76
    s_mov_b32 exec_hi, 0
    buffer_load_dword v9, v22, s[92:95], 0 offen sc0 sc1
    s_mov_b64 exec, -1
    s_waitcnt vmcnt(0)
    v_bfe_u32 v24, v22, 2, 3
    v_bfe_u32 v24, v9, v24, 1
    v_cmp_ne_u32 vcc, 0, v24
    s_nop 1
    s_mov_b32 s76, vcc_lo
    s_lshr_b32 s66, vcc_lo, 16
    s_and_b32 s66, s66, vcc_lo
    s_bitcmp1_b32 s66, 4
    s_cbranch_scc1 fused_kernel_ps8_ok
    s_sleep 2
    s_sub_u32 s98, s98, 1
    s_cbranch_scc0 fused_kernel_ps8_l
fused_kernel_ps8_ok:
    s_andn2_b32 exec_lo, 0x7f007f, s76
    s_mov_b32 exec_hi, 0
    buffer_load_dword v9, v22, s[92:95], 0 offen sc0 sc1
    s_mov_b64 exec, -1
    s_add_u32 m0, s40, 0
    s_nop 0
    buffer_load_dwordx4 v3, s[16:19], s20 offen  lds
    buffer_load_dwordx4 v3, s[16:19], s20 offen offset:1024  lds
    buffer_load_dwordx4 v3, s[16:19], s21 offen offset:2048  lds
    buffer_load_dwordx4 v3, s[16:19], s21 offen offset:3072  lds
    s_add_u32 m0, s41, 6144
    s_add_u32 s3, s3, 18432
    buffer_load_dwordx4 v1, s[12:15], s3 offen lds
    s_waitcnt vmcnt(19)
    s_barrier
    buffer_load_dwordx4 v2, s[12:15], s3 offen offset:1024 lds
    buffer_load_dwordx4 v6, s[12:15], s3 offen offset:2048 lds
    s_bfe_u32 s3, s54, 0x40010
    s_lshl_b32 s3, s3, 1
    s_add_u32 s3, s3, 1
    s_lshl_b32 s21, s3, 18
    s_add_u32 s20, s21, s60
    s_add_u32 s21, s21, s61
    s_mul_i32 s3, s3, 73728
    s_add_u32 s3, s3, s62
    s_add_u32 m0, s41, 40960
    s_nop 0
    buffer_load_dwordx4 v1, s[12:15], s3 offen lds
    buffer_load_dwordx4 v2, s[12:15], s3 offen offset:1024 lds
    buffer_load_dwordx4 v6, s[12:15], s3 offen offset:2048 lds
    s_add_u32 m0, s40, 40960
    s_nop 0
    buffer_load_dwordx4 v3, s[16:19], s20 offen  lds
    buffer_load_dwordx4 v3, s[16:19], s20 offen offset:1024  lds
    buffer_load_dwordx4 v3, s[16:19], s21 offen offset:2048  lds
    buffer_load_dwordx4 v3, s[16:19], s21 offen offset:3072  lds
    s_add_u32 m0, s41, 47104
    s_add_u32 s3, s3, 18432
    buffer_load_dwordx4 v1, s[12:15], s3 offen lds
    buffer_load_dwordx4 v2, s[12:15], s3 offen offset:1024 lds
    s_waitcnt vmcnt(20)
    s_barrier
    buffer_load_dwordx4 v6, s[12:15], s3 offen offset:2048 lds
    s_bfe_u32 s3, s54, 0x40014
    s_lshl_b32 s3, s3, 1
    s_lshl_b32 s21, s3, 18
    s_add_u32 s20, s21, s60
    s_add_u32 s21, s21, s61
    s_mul_i32 s3, s3, 73728
    s_add_u32 s3, s3, s62
    s_add_u32 m0, s41, 81920
    s_nop 0
    buffer_load_dwordx4 v1, s[12:15], s3 offen lds
    buffer_load_dwordx4 v2, s[12:15], s3 offen offset:1024 lds
    buffer_load_dwordx4 v6, s[12:15], s3 offen offset:2048 lds
    s_waitcnt vmcnt(20)
    v_bfe_u32 v24, v22, 2, 3
    v_bfe_u32 v24, v9, v24, 1
    v_cmp_ne_u32 vcc, 0, v24
    s_nop 1
    s_mov_b32 s76, vcc_lo
    s_lshr_b32 s66, vcc_lo, 16
    s_and_b32 s66, s66, vcc_lo
    s_bitcmp1_b32 s66, 5
    s_cbranch_scc1 fused_kernel_ps10_ok
    s_movk_i32 s98, 0x4000
fused_kernel_ps10_l:
    s_andn2_b32 exec_lo, 0x3f003f, s76
    s_mov_b32 exec_hi, 0
    buffer_load_dword v9, v22, s[92:95], 0 offen sc0 sc1
    s_mov_b64 exec, -1
    s_waitcnt vmcnt(0)
    v_bfe_u32 v24, v22, 2, 3
    v_bfe_u32 v24, v9, v24, 1
    v_cmp_ne_u32 vcc, 0, v24
    s_nop 1
    s_mov_b32 s76, vcc_lo
    s_lshr_b32 s66, vcc_lo, 16
    s_and_b32 s66, s66, vcc_lo
    s_bitcmp1_b32 s66, 5
    s_cbranch_scc1 fused_kernel_ps10_ok
    s_sleep 2
    s_sub_u32 s98, s98, 1
    s_cbranch_scc0 fused_kernel_ps10_l
fused_kernel_ps10_ok:
    s_andn2_b32 exec_lo, 0xff00ff, s76
    s_mov_b32 exec_hi, 0
    buffer_load_dword v9, v22, s[92:95], 0 offen sc0 sc1
    s_mov_b64 exec, -1
    s_add_u32 m0, s40, 81920
    s_nop 0
    buffer_load_dwordx4 v3, s[16:19], s20 offen  lds
    buffer_load_dwordx4 v3, s[16:19], s20 offen offset:1024  lds
    buffer_load_dwordx4 v3, s[16:19], s21 offen offset:2048  lds
    buffer_load_dwordx4 v3, s[16:19], s21 offen offset:3072  lds
    s_add_u32 m0, s41, 88064
    s_add_u32 s3, s3, 18432
    buffer_load_dwordx4 v1, s[12:15], s3 offen lds
    buffer_load_dwordx4 v2, s[12:15], s3 offen offset:1024 lds
    buffer_load_dwordx4 v6, s[12:15], s3 offen offset:2048 lds
    s_bfe_u32 s3, s54, 0x40014
    s_lshl_b32 s3, s3, 1
    s_add_u32 s3, s3, 1
    s_lshl_b32 s21, s3, 18
    s_add_u32 s20, s21, s60
    s_add_u32 s21, s21, s61
    s_mul_i32 s3, s3, 73728
    s_add_u32 s3, s3, s62
    s_add_u32 m0, s41, 122880
    s_waitcnt vmcnt(21)
    s_barrier
    buffer_load_dwordx4 v1, s[12:15], s3 offen lds
    s_and_b32 s23, s96, 7
    s_xor_b32 s34, s23, 2
    s_mul_i32 s34, s34, 24
    s_add_u32 s50, s34, s78
    s_xor_b32 s34, s23, 4
    buffer_load_dwordx4 v2, s[12:15], s3 offen offset:1024 lds
    s_mul_i32 s34, s34, 24
    s_add_u32 s51, s34, s78
    s_xor_b32 s34, s23, 6
    s_mul_i32 s34, s34, 24
    s_add_u32 s52, s34, s78
    buffer_load_dwordx4 v6, s[12:15], s3 offen offset:2048 lds
    v_and_b32 v10, 63, v0
    v_lshlrev_b32 v10, 7, v10
    v_add_u32 v10, 57344, v10
    v_mov_b32 v11, s50
    v_writelane_b32 v11, s51, 1
    s_add_u32 m0, s40, 122880
    s_nop 0
    buffer_load_dwordx4 v3, s[16:19], s20 offen  lds
    v_writelane_b32 v11, s52, 2
    v_lshlrev_b32 v11, 7, v11
    v_add_u32 v11, 32768, v11
    v_mov_b32 v12, 1
    v_mov_b32 v13, 1
    buffer_load_dwordx4 v3, s[16:19], s20 offen offset:1024  lds
    s_cmp_eq_u32 s86, 0
    s_mov_b32 s36, 0xff008000
    s_cselect_b32 s36, 0x80ffffff, s36
    s_mov_b32 s37, 0x8000ffff
    s_cselect_b32 s37, 0x80008000, s37
    buffer_load_dwordx4 v3, s[16:19], s21 offen offset:2048  lds
    s_cmp_eq_u32 s86, 2
    s_cselect_b64 s[36:37], -1, s[36:37]
    s_lshl_b32 s34, 0x11111111, s84
    s_and_b32 s36, s36, s34
    s_and_b32 s37, s37, s34
    buffer_load_dwordx4 v3, s[16:19], s21 offen offset:3072  lds
    s_and_b32 s38, s34, 7
    s_mov_b32 s39, 0
    s_mov_b64 exec, s[36:37]
    buffer_load_dword v12, v10, s[92:95], 0 offen sc0 sc1
    s_mov_b64 exec, s[38:39]
    buffer_load_dword v13, v11, s[92:95], 0 offen sc0 sc1
    s_mov_b64 exec, -1
    s_add_u32 m0, s41, 129024
    s_add_u32 s3, s3, 18432
    buffer_load_dwordx4 v1, s[12:15], s3 offen lds
    buffer_load_dwordx4 v2, s[12:15], s3 offen offset:1024 lds
    buffer_load_dwordx4 v6, s[12:15], s3 offen offset:2048 lds
    s_bfe_u32 s3, s54, 0x40018
    s_lshl_b32 s3, s3, 1
    s_lshl_b32 s21, s3, 18
    s_add_u32 s20, s21, s60
    s_add_u32 s21, s21, s61
    s_mul_i32 s3, s3, 73728
    s_add_u32 s3, s3, s62
    s_add_u32 m0, s41, 0
    s_waitcnt vmcnt(23)
    s_barrier
    buffer_load_dwordx4 v1, s[12:15], s3 offen lds
    buffer_load_dwordx4 v2, s[12:15], s3 offen offset:1024 lds
    buffer_load_dwordx4 v6, s[12:15], s3 offen offset:2048 lds
    s_waitcnt vmcnt(22)
    v_bfe_u32 v24, v22, 2, 3
    v_bfe_u32 v24, v9, v24, 1
    v_cmp_ne_u32 vcc, 0, v24
    s_nop 1
    s_mov_b32 s76, vcc_lo
    s_lshr_b32 s66, vcc_lo, 16
    s_and_b32 s66, s66, vcc_lo
    s_bitcmp1_b32 s66, 6
    s_cbranch_scc1 fused_kernel_ps12_ok
    s_movk_i32 s98, 0x4000
fused_kernel_ps12_l:
    s_andn2_b32 exec_lo, 0x7f007f, s76
    s_mov_b32 exec_hi, 0
    buffer_load_dword v9, v22, s[92:95], 0 offen sc0 sc1
    s_mov_b64 exec, -1
    s_waitcnt vmcnt(0)
    v_bfe_u32 v24, v22, 2, 3
    v_bfe_u32 v24, v9, v24, 1
    v_cmp_ne_u32 vcc, 0, v24
    s_nop 1
    s_mov_b32 s76, vcc_lo
    s_lshr_b32 s66, vcc_lo, 16
    s_and_b32 s66, s66, vcc_lo
    s_bitcmp1_b32 s66, 6
    s_cbranch_scc1 fused_kernel_ps12_ok
    s_sleep 2
    s_sub_u32 s98, s98, 1
    s_cbranch_scc0 fused_kernel_ps12_l
fused_kernel_ps12_ok:
    s_andn2_b32 exec_lo, 0x1ff01ff, s76
    s_mov_b32 exec_hi, 0
    buffer_load_dword v9, v22, s[92:95], 0 offen sc0 sc1
    s_mov_b64 exec, -1
    s_add_u32 m0, s40, 0
    s_nop 0
    buffer_load_dwordx4 v3, s[16:19], s20 offen  lds
    buffer_load_dwordx4 v3, s[16:19], s20 offen offset:1024  lds
    buffer_load_dwordx4 v3, s[16:19], s21 offen offset:2048  lds
    buffer_load_dwordx4 v3, s[16:19], s21 offen offset:3072  lds
    s_add_u32 m0, s41, 6144
    s_add_u32 s3, s3, 18432
    buffer_load_dwordx4 v1, s[12:15], s3 offen lds
    buffer_load_dwordx4 v2, s[12:15], s3 offen offset:1024 lds
    buffer_load_dwordx4 v6, s[12:15], s3 offen offset:2048 lds
    s_bfe_u32 s3, s54, 0x40018
    s_lshl_b32 s3, s3, 1
    s_add_u32 s3, s3, 1
    s_lshl_b32 s21, s3, 18
    s_add_u32 s20, s21, s60
    s_add_u32 s21, s21, s61
    s_mul_i32 s3, s3, 73728
    s_add_u32 s3, s3, s62
    s_add_u32 m0, s41, 40960
    s_waitcnt vmcnt(23)
    s_barrier
    buffer_load_dwordx4 v1, s[12:15], s3 offen lds
    s_load_dwordx2 s[44:45], s[0:1], 88
    s_add_u32 s56, s6, 20971520
    s_addc_u32 s57, s7, 0
    s_and_b32 s57, s57, 0xffff
    s_mov_b32 s58, 10493952
    buffer_load_dwordx4 v2, s[12:15], s3 offen offset:1024 lds
    s_mov_b32 s59, 0x00020000
    s_and_b32 s42, s22, 1
    s_lshr_b32 s43, s84, 1
    s_lshl_b32 s42, s42, 1
    s_lshr_b32 s34, s79, 1
    buffer_load_dwordx4 v6, s[12:15], s3 offen offset:2048 lds
    s_add_u32 s42, s42, s34
    s_and_b32 s34, s85, 3
    s_lshl_b32 s34, s34, 1
    s_lshr_b32 s35, s42, 1
    s_add_u32 s87, s34, s35
    s_add_u32 m0, s40, 40960
    s_nop 0
    buffer_load_dwordx4 v3, s[16:19], s20 offen  lds
    s_lshr_b32 s34, s85, 2
    s_lshl_b32 s34, s34, 1
    s_and_b32 s35, s42, 1
    s_add_u32 s34, s34, s35
    s_lshl_b32 s35, s32, 2
    buffer_load_dwordx4 v3, s[16:19], s20 offen offset:1024  lds
    s_add_u32 s35, s35, s34
    s_add_u32 s34, s35, s32
    s_cmp_eq_u32 s87, 7
    s_cselect_b32 s89, 1, 0
    s_cselect_b32 s87, s35, s87
    s_cselect_b32 s34, 4, s34
    buffer_load_dwordx4 v3, s[16:19], s21 offen offset:2048  lds
    s_mul_i32 s29, s87, 9
    s_add_u32 s29, s29, s34
    s_cmp_eq_u32 s87, 6
    s_addc_u32 s29, s29, 0
    s_mov_b32 s88, s87
    buffer_load_dwordx4 v3, s[16:19], s21 offen offset:3072  lds
    s_cmp_eq_u32 s87, 7
    s_cselect_b32 s29, 54, s29
    s_cselect_b32 s87, 5, s87
    s_cselect_b32 s88, 6, s88
    s_lshl_b32 s29, s29, 1
    s_add_u32 m0, s41, 47104
    s_add_u32 s3, s3, 18432
    buffer_load_dwordx4 v1, s[12:15], s3 offen lds
    s_and_b32 s34, s79, 1
    s_add_u32 s29, s29, s34
    s_mul_i32 s30, s29, 18432
    s_mul_i32 s34, s86, 384
    s_add_u32 s30, s30, s34
    buffer_load_dwordx4 v2, s[12:15], s3 offen offset:1024 lds
    s_mul_i32 s34, s43, 192
    s_add_u32 s30, s30, s34
    v_bfe_u32 v7, v0, 4, 2
    v_and_b32 v4, 15, v0
    v_mul_u32_u24 v26, 1152, v4
    buffer_load_dwordx4 v6, s[12:15], s3 offen offset:2048 lds
    v_lshl_add_u32 v26, v7, 4, v26
    v_lshrrev_b32 v5, 1, v7
    v_lshl_add_u32 v8, v5, 3, v26
    v_xor_b32 v27, 8, v8
    s_bfe_u32 s3, s54, 0x4001c
    s_lshl_b32 s3, s3, 1
    s_lshl_b32 s21, s3, 18
    s_add_u32 s20, s21, s60
    s_add_u32 s21, s21, s61
    s_mul_i32 s3, s3, 73728
    s_add_u32 s3, s3, s62
    s_add_u32 m0, s41, 81920
    s_waitcnt vmcnt(21)
    s_barrier
    buffer_load_dwordx4 v1, s[12:15], s3 offen lds
    buffer_load_dwordx4 v2, s[12:15], s3 offen offset:1024 lds
    buffer_load_dwordx4 v6, s[12:15], s3 offen offset:2048 lds
    s_waitcnt vmcnt(20)
    v_bfe_u32 v24, v22, 2, 3
    v_bfe_u32 v24, v9, v24, 1
    v_cmp_ne_u32 vcc, 0, v24
    s_nop 1
    s_mov_b32 s76, vcc_lo
    s_lshr_b32 s66, vcc_lo, 16
    s_and_b32 s66, s66, vcc_lo
    s_bitcmp1_b32 s66, 7
    s_cbranch_scc1 fused_kernel_ps14_ok
    s_movk_i32 s98, 0x4000
fused_kernel_ps14_l:
    s_andn2_b32 exec_lo, 0xff00ff, s76
    s_mov_b32 exec_hi, 0
    buffer_load_dword v9, v22, s[92:95], 0 offen sc0 sc1
    s_mov_b64 exec, -1
    s_waitcnt vmcnt(0)
    v_bfe_u32 v24, v22, 2, 3
    v_bfe_u32 v24, v9, v24, 1
    v_cmp_ne_u32 vcc, 0, v24
    s_nop 1
    s_mov_b32 s76, vcc_lo
    s_lshr_b32 s66, vcc_lo, 16
    s_and_b32 s66, s66, vcc_lo
    s_bitcmp1_b32 s66, 7
    s_cbranch_scc1 fused_kernel_ps14_ok
    s_sleep 2
    s_sub_u32 s98, s98, 1
    s_cbranch_scc0 fused_kernel_ps14_l
fused_kernel_ps14_ok:
    s_andn2_b32 exec_lo, 0x1ff01ff, s76
    s_mov_b32 exec_hi, 0
    buffer_load_dword v9, v22, s[92:95], 0 offen sc0 sc1
    s_mov_b64 exec, -1
    s_add_u32 m0, s40, 81920
    s_nop 0
    buffer_load_dwordx4 v3, s[16:19], s20 offen  lds
    buffer_load_dwordx4 v3, s[16:19], s20 offen offset:1024  lds
    buffer_load_dwordx4 v3, s[16:19], s21 offen offset:2048  lds
    buffer_load_dwordx4 v3, s[16:19], s21 offen offset:3072  lds
    s_add_u32 m0, s41, 88064
    s_add_u32 s3, s3, 18432
    buffer_load_dwordx4 v1, s[12:15], s3 offen lds
    buffer_load_dwordx4 v2, s[12:15], s3 offen offset:1024 lds
    buffer_load_dwordx4 v6, s[12:15], s3 offen offset:2048 lds
    s_bfe_u32 s3, s54, 0x4001c
    s_lshl_b32 s3, s3, 1
    s_add_u32 s3, s3, 1
    s_lshl_b32 s21, s3, 18
    s_add_u32 s20, s21, s60
    s_add_u32 s21, s21, s61
    s_mul_i32 s3, s3, 73728
    s_add_u32 s3, s3, s62
    s_add_u32 m0, s41, 122880
    s_waitcnt vmcnt(21)
    s_barrier
    buffer_load_dwordx4 v1, s[12:15], s3 offen lds
    v_and_b32 v28, 63, v0
    v_lshlrev_b32 v28, 4, v28
    s_mul_i32 s34, s84, 6144
    s_add_u32 s34, s34, 81920
    v_add_u32 v25, s34, v28
    buffer_load_dwordx4 v2, s[12:15], s3 offen offset:1024 lds
    v_mul_u32_u24 v29, 40960, v7
    v_lshl_add_u32 v29, v4, 4, v29
    v_lshl_add_u32 v15, v7, 1, v5
    v_mul_u32_u24 v30, 163840, v15
    v_lshl_add_u32 v30, v4, 3, v30
    buffer_load_dwordx4 v6, s[12:15], s3 offen offset:2048 lds
    v_xor_b32 v15, 1, v15
    v_mul_u32_u24 v31, 163840, v15
    v_lshl_add_u32 v31, v4, 3, v31
    s_mul_i32 s63, s86, 24
    s_mul_i32 s34, s43, 12
    s_add_u32 m0, s40, 122880
    s_nop 0
    buffer_load_dwordx4 v3, s[16:19], s20 offen  lds
    s_add_u32 s63, s63, s34
    s_add_u32 s34, s63, 192
    s_mul_i32 s64, s34, 40960
    s_lshr_b32 s34, s29, 4
    s_lshl_b32 s35, s34, 12
    buffer_load_dwordx4 v3, s[16:19], s20 offen offset:1024  lds
    s_add_u32 s64, s64, s35
    s_lshl_b32 s65, s34, 9
    s_and_b32 s34, s29, 3
    s_lshl_b32 s35, s34, 10
    s_add_u32 s64, s64, s35
    buffer_load_dwordx4 v3, s[16:19], s21 offen offset:2048  lds
    s_lshr_b32 s34, s34, 1
    s_lshl_b32 s34, s34, 2
    s_add_u32 s65, s65, s34
    s_bfe_u32 s34, s29, 0x20002
    s_lshl_b32 s35, s34, 8
    buffer_load_dwordx4 v3, s[16:19], s21 offen offset:3072  lds
    s_add_u32 s64, s64, s35
    s_lshl_b32 s34, s34, 7
    s_add_u32 s65, s65, s34
    s_add_u32 s65, s65, 7897088
    s_bitcmp1_b32 s29, 0
    s_mov_b32 s31, 0x05040100
    s_cselect_b32 s31, 0x07060302, s31
    s_add_u32 m0, s41, 129024
    s_add_u32 s3, s3, 18432
    buffer_load_dwordx4 v1, s[12:15], s3 offen lds
    s_waitcnt lgkmcnt(0)
    s_and_b32 s45, s45, 0xffff
    s_mov_b32 s46, 2359296
    s_mov_b32 s47, 0x00020000
    buffer_load_dwordx4 v2, s[12:15], s3 offen offset:1024 lds
    buffer_load_dwordx4 v6, s[12:15], s3 offen offset:2048 lds
    s_bfe_u32 s3, s55, 0x40000
    s_lshl_b32 s3, s3, 1
    s_lshl_b32 s21, s3, 18
    s_add_u32 s20, s21, s60
    s_add_u32 s21, s21, s61
    s_mul_i32 s3, s3, 73728
    s_add_u32 s3, s3, s62
    s_add_u32 m0, s41, 0
    s_waitcnt vmcnt(21)
    s_barrier
    buffer_load_dwordx4 v1, s[12:15], s3 offen lds
    buffer_load_dwordx4 v2, s[12:15], s3 offen offset:1024 lds
    buffer_load_dwordx4 v6, s[12:15], s3 offen offset:2048 lds
    s_waitcnt vmcnt(20)
    v_bfe_u32 v24, v22, 2, 3
    v_bfe_u32 v24, v9, v24, 1
    v_cmp_ne_u32 vcc, 0, v24
    s_nop 1
    s_mov_b32 s76, vcc_lo
    s_lshr_b32 s66, vcc_lo, 16
    s_and_b32 s66, s66, vcc_lo
    s_bitcmp1_b32 s66, 8
    s_cbranch_scc1 fused_kernel_ps16_ok
    s_movk_i32 s98, 0x4000
fused_kernel_ps16_l:
    s_andn2_b32 exec_lo, 0x1ff01ff, s76
    s_mov_b32 exec_hi, 0
    buffer_load_dword v9, v22, s[92:95], 0 offen sc0 sc1
    s_mov_b64 exec, -1
    s_waitcnt vmcnt(0)
    v_bfe_u32 v24, v22, 2, 3
    v_bfe_u32 v24, v9, v24, 1
    v_cmp_ne_u32 vcc, 0, v24
    s_nop 1
    s_mov_b32 s76, vcc_lo
    s_lshr_b32 s66, vcc_lo, 16
    s_and_b32 s66, s66, vcc_lo
    s_bitcmp1_b32 s66, 8
    s_cbranch_scc1 fused_kernel_ps16_ok
    s_sleep 2
    s_sub_u32 s98, s98, 1
    s_cbranch_scc0 fused_kernel_ps16_l
fused_kernel_ps16_ok:
    s_add_u32 m0, s40, 0
    s_nop 0
    buffer_load_dwordx4 v3, s[16:19], s20 offen  lds
    buffer_load_dwordx4 v3, s[16:19], s20 offen offset:1024  lds
    buffer_load_dwordx4 v3, s[16:19], s21 offen offset:2048  lds
    buffer_load_dwordx4 v3, s[16:19], s21 offen offset:3072  lds
    s_add_u32 m0, s41, 6144
    s_add_u32 s3, s3, 18432
    buffer_load_dwordx4 v1, s[12:15], s3 offen lds
    buffer_load_dwordx4 v2, s[12:15], s3 offen offset:1024 lds
    buffer_load_dwordx4 v6, s[12:15], s3 offen offset:2048 lds
    s_bfe_u32 s3, s55, 0x40000
    s_lshl_b32 s3, s3, 1
    s_add_u32 s3, s3, 1
    s_lshl_b32 s21, s3, 18
    s_add_u32 s20, s21, s60
    s_add_u32 s21, s21, s61
    s_mul_i32 s3, s3, 73728
    s_add_u32 s3, s3, s62
    s_add_u32 m0, s41, 40960
    s_waitcnt vmcnt(20)
    s_barrier
    buffer_load_dwordx4 v1, s[12:15], s3 offen lds
    s_movk_i32 s98, 0x4000
fused_kernel_tf_l:
    v_and_b32 v14, v12, v13
    v_and_b32 v14, 1, v14
    v_cmp_eq_u32 vcc, 1, v14
    s_nop 1
    s_cmp_eq_u64 vcc, -1
    s_cbranch_scc1 fused_kernel_tf_ok
    s_sleep 4
    s_mov_b64 exec, s[36:37]
    buffer_load_dword v12, v10, s[92:95], 0 offen sc0 sc1
    s_mov_b64 exec, s[38:39]
    buffer_load_dword v13, v11, s[92:95], 0 offen sc0 sc1
    s_mov_b64 exec, -1
    s_waitcnt vmcnt(0)
    s_sub_u32 s98, s98, 1
    s_cbranch_scc0 fused_kernel_tf_l
fused_kernel_tf_ok:
    buffer_load_dwordx4 v2, s[12:15], s3 offen offset:1024 lds
    buffer_load_dwordx4 v6, s[12:15], s3 offen offset:2048 lds
    s_add_u32 m0, s40, 40960
    s_nop 0
    buffer_load_dwordx4 v3, s[16:19], s20 offen  lds
    buffer_load_dwordx4 v3, s[16:19], s20 offen offset:1024  lds
    buffer_load_dwordx4 v3, s[16:19], s21 offen offset:2048  lds
    buffer_load_dwordx4 v3, s[16:19], s21 offen offset:3072  lds
    s_add_u32 m0, s41, 47104
    s_add_u32 s3, s3, 18432
    buffer_load_dwordx4 v1, s[12:15], s3 offen lds
    buffer_load_dwordx4 v2, s[12:15], s3 offen offset:1024 lds
    buffer_load_dwordx4 v6, s[12:15], s3 offen offset:2048 lds
    s_waitcnt vmcnt(20)
    s_barrier
    buffer_load_dwordx2 v[32:33], v8, s[8:11], s30 offen offset:0
    buffer_load_dwordx2 v[34:35], v27, s[8:11], s30 offen offset:0
    buffer_load_dwordx2 v[36:37], v8, s[8:11], s30 offen offset:64
    buffer_load_dwordx2 v[38:39], v27, s[8:11], s30 offen offset:64
    buffer_load_dwordx2 v[40:41], v8, s[8:11], s30 offen offset:128
    buffer_load_dwordx2 v[42:43], v27, s[8:11], s30 offen offset:128
    v_lshlrev_b32 v15, 2, v4
    s_lshl_b32 s34, s29, 6
    s_add_u32 s34, s34, 10485760
    buffer_load_dword v44, v15, s[56:59], s34 offen sc0 sc1
    s_mul_i32 s60, s50, 40960
    s_mul_i32 s34, s84, 9216
    s_add_u32 s60, s60, s34
    s_add_u32 s60, s60, 0
    s_mul_i32 s61, s51, 40960
    s_mul_i32 s34, s84, 9216
    s_add_u32 s61, s61, s34
    s_add_u32 s61, s61, 3072
    s_mul_i32 s62, s52, 40960
    s_mul_i32 s34, s84, 9216
    s_add_u32 s62, s62, s34
    s_add_u32 s62, s62, 6144
    s_waitcnt vmcnt(17)
    s_barrier
    s_waitcnt vmcnt(7)
    s_barrier
    s_waitcnt vmcnt(0)
    s_cmp_eq_u32 s63, 60
    s_cbranch_scc1 fused_kernel_fpool
    v_sub_f32 v47, 1.0, v44
    v_cvt_pk_bf16_f32 v45, v47, v47
    v_and_b32 v46, 0xffff0000, v45
    v_lshrrev_b32 v45, 16, v45
    v_lshlrev_b32 v48, 16, v32
    v_and_b32 v49, 0xffff0000, v32
    v_lshlrev_b32 v50, 16, v33
    v_and_b32 v51, 0xffff0000, v33
    v_lshlrev_b32 v52, 16, v34
    v_and_b32 v53, 0xffff0000, v34
    v_lshlrev_b32 v54, 16, v35
    v_and_b32 v55, 0xffff0000, v35
    v_lshlrev_b32 v56, 16, v36
    v_and_b32 v57, 0xffff0000, v36
    v_lshlrev_b32 v58, 16, v37
    v_and_b32 v59, 0xffff0000, v37
    v_lshlrev_b32 v60, 16, v38
    v_and_b32 v61, 0xffff0000, v38
    v_lshlrev_b32 v62, 16, v39
    v_and_b32 v63, 0xffff0000, v39
    v_lshlrev_b32 v64, 16, v40
    v_and_b32 v65, 0xffff0000, v40
    v_lshlrev_b32 v66, 16, v41
    v_and_b32 v67, 0xffff0000, v41
    v_lshlrev_b32 v68, 16, v42
    v_and_b32 v69, 0xffff0000, v42
    v_lshlrev_b32 v70, 16, v43
    v_and_b32 v71, 0xffff0000, v43
    v_mul_f32 v48, v48, v44
    v_mul_f32 v49, v49, v44
    v_mul_f32 v50, v50, v44
    v_mul_f32 v51, v51, v44
    v_mul_f32 v52, v52, v44
    v_mul_f32 v53, v53, v44
    v_mul_f32 v54, v54, v44
    v_mul_f32 v55, v55, v44
    v_mul_f32 v56, v56, v44
    v_mul_f32 v57, v57, v44
    v_mul_f32 v58, v58, v44
    v_mul_f32 v59, v59, v44
    v_mul_f32 v60, v60, v44
    v_mul_f32 v61, v61, v44
    v_mul_f32 v62, v62, v44
    v_mul_f32 v63, v63, v44
    v_mul_f32 v64, v64, v44
    v_mul_f32 v65, v65, v44
    v_mul_f32 v66, v66, v44
    v_mul_f32 v67, v67, v44
    v_mul_f32 v68, v68, v44
    v_mul_f32 v69, v69, v44
    v_mul_f32 v70, v70, v44
    v_mul_f32 v71, v71, v44
    v_cmp_lt_u32 s[52:53], 1, v7
    s_mov_b32 s67, 15
    s_barrier
    buffer_load_dwordx4 v[144:147], v29, s[56:59], s64 offen sc0 sc1
    s_add_u32 s34, s64, 163840
    buffer_load_dwordx4 v[148:151], v29, s[56:59], s34 offen sc0 sc1
    s_add_u32 s34, s64, 327680
    buffer_load_dwordx4 v[152:155], v29, s[56:59], s34 offen sc0 sc1
fused_kernel_fn_p_sk3:
    buffer_load_dwordx4 v[96:99], v28, s[56:59], s60 offen offset:0 sc0 sc1
    buffer_load_dwordx4 v[100:103], v28, s[56:59], s60 offen offset:1024 sc0 sc1
    buffer_load_dwordx4 v[104:107], v28, s[56:59], s60 offen offset:2048 sc0 sc1
fused_kernel_fn_p_sk0:
    buffer_load_dwordx4 v[112:115], v28, s[56:59], s61 offen offset:0 sc0 sc1
    buffer_load_dwordx4 v[116:119], v28, s[56:59], s61 offen offset:1024 sc0 sc1
    buffer_load_dwordx4 v[120:123], v28, s[56:59], s61 offen offset:2048 sc0 sc1
fused_kernel_fn_p_sk1:
    buffer_load_dwordx4 v[128:131], v28, s[56:59], s62 offen offset:0 sc0 sc1
    buffer_load_dwordx4 v[132:135], v28, s[56:59], s62 offen offset:1024 sc0 sc1
    buffer_load_dwordx4 v[136:139], v28, s[56:59], s62 offen offset:2048 sc0 sc1
fused_kernel_fn_p_sk2:
    s_mov_b64 exec, -1
    ds_read_b128 v[72:75], v25 offset:0
    ds_read_b128 v[76:79], v25 offset:1024
    ds_read_b128 v[80:83], v25 offset:2048
    ds_read_b128 v[84:87], v25 offset:3072
    ds_read_b128 v[88:91], v25 offset:4096
    ds_read_b128 v[92:95], v25 offset:5120
    s_movk_i32 s98, 0x4000
    s_waitcnt lgkmcnt(0)
    v_mul_f32 v72, v46, v72
    v_mul_f32 v73, v46, v73
    v_mul_f32 v74, v46, v74
    v_mul_f32 v75, v46, v75
    v_mul_f32 v76, v46, v76
    v_mul_f32 v77, v46, v77
    v_mul_f32 v78, v46, v78
    v_mul_f32 v79, v46, v79
    v_mul_f32 v80, v46, v80
    v_mul_f32 v81, v46, v81
    v_mul_f32 v82, v46, v82
    v_mul_f32 v83, v46, v83
    v_mul_f32 v84, v46, v84
    v_mul_f32 v85, v46, v85
    v_mul_f32 v86, v46, v86
    v_mul_f32 v87, v46, v87
    v_mul_f32 v88, v46, v88
    v_mul_f32 v89, v46, v89
    v_mul_f32 v90, v46, v90
    v_mul_f32 v91, v46, v91
    v_mul_f32 v92, v46, v92
    v_mul_f32 v93, v46, v93
    v_mul_f32 v94, v46, v94
    v_mul_f32 v95, v46, v95
fused_kernel_fn_round:
    s_mov_b64 s[54:55], 0
    s_bitcmp1_b32 s67, 3
    s_waitcnt vmcnt(9)
    s_cbranch_scc0 fused_kernel_fn_ld3
    v_max3_u32 v19, v144, v145, v146
    v_max3_u32 v19, v19, v147, v148
    v_max3_u32 v19, v19, v149, v150
    v_max3_u32 v19, v19, v151, v152
    v_max3_u32 v19, v19, v153, v154
    v_max_u32 v19, v19, v155
    v_cmp_eq_u32 s[54:55], -1, v19
    s_nop 1
    s_cmp_eq_u64 s[54:55], 0
    s_cbranch_scc0 fused_kernel_fn_ld3
    s_bitset0_b32 s67, 3
    v_lshlrev_b32 v168, 16, v144
    v_and_b32 v169, 0xffff0000, v144
    v_lshlrev_b32 v170, 16, v145
    v_and_b32 v171, 0xffff0000, v145
    v_lshlrev_b32 v172, 16, v146
    v_and_b32 v173, 0xffff0000, v146
    v_lshlrev_b32 v174, 16, v147
    v_and_b32 v175, 0xffff0000, v147
    v_lshlrev_b32 v176, 16, v148
    v_and_b32 v177, 0xffff0000, v148
    v_lshlrev_b32 v178, 16, v149
    v_and_b32 v179, 0xffff0000, v149
    v_lshlrev_b32 v180, 16, v150
    v_and_b32 v181, 0xffff0000, v150
    v_lshlrev_b32 v182, 16, v151
    v_and_b32 v183, 0xffff0000, v151
    v_lshlrev_b32 v184, 16, v152
    v_and_b32 v185, 0xffff0000, v152
    v_lshlrev_b32 v186, 16, v153
    v_and_b32 v187, 0xffff0000, v153
    v_lshlrev_b32 v188, 16, v154
    v_and_b32 v189, 0xffff0000, v154
    v_lshlrev_b32 v190, 16, v155
    v_and_b32 v191, 0xffff0000, v155
    v_fmac_f32 v72, v48, v168
    v_fmac_f32 v73, v49, v169
    v_fmac_f32 v74, v50, v170
    v_fmac_f32 v75, v51, v171
    v_fmac_f32 v76, v52, v172
    v_fmac_f32 v77, v53, v173
    v_fmac_f32 v78, v54, v174
    v_fmac_f32 v79, v55, v175
    v_fmac_f32 v80, v56, v176
    v_fmac_f32 v81, v57, v177
    v_fmac_f32 v82, v58, v178
    v_fmac_f32 v83, v59, v179
    v_fmac_f32 v84, v60, v180
    v_fmac_f32 v85, v61, v181
    v_fmac_f32 v86, v62, v182
    v_fmac_f32 v87, v63, v183
    v_fmac_f32 v88, v64, v184
    v_fmac_f32 v89, v65, v185
    v_fmac_f32 v90, v66, v186
    v_fmac_f32 v91, v67, v187
    v_fmac_f32 v92, v68, v188
    v_fmac_f32 v93, v69, v189
    v_fmac_f32 v94, v70, v190
    v_fmac_f32 v95, v71, v191
    s_cmp_eq_u32 s67, 0
    s_cbranch_scc1 fused_kernel_fn_fin
fused_kernel_fn_ld3:
    s_or_b64 exec, s[54:55], 1
    buffer_load_dwordx4 v[144:147], v29, s[56:59], s64 offen sc0 sc1
    s_add_u32 s34, s64, 163840
    buffer_load_dwordx4 v[148:151], v29, s[56:59], s34 offen sc0 sc1
    s_add_u32 s34, s64, 327680
    buffer_load_dwordx4 v[152:155], v29, s[56:59], s34 offen sc0 sc1
    s_mov_b64 exec, -1
    s_mov_b64 s[36:37], 0
    s_bitcmp1_b32 s67, 0
    s_waitcnt vmcnt(9)
    s_cbranch_scc0 fused_kernel_fn_ld0
    v_max3_u32 v16, v96, v97, v98
    v_max3_u32 v16, v16, v99, v100
    v_max3_u32 v16, v16, v101, v102
    v_max3_u32 v16, v16, v103, v104
    v_max3_u32 v16, v16, v105, v106
    v_max_u32 v16, v16, v107
    v_cmp_eq_u32 s[36:37], -1, v16
    s_nop 1
    s_cmp_eq_u64 s[36:37], 0
    s_cbranch_scc0 fused_kernel_fn_ld0
    s_bitset0_b32 s67, 0
    v_dot2_f32_bf16 v72, v96, v45, v72
    v_dot2_f32_bf16 v73, v96, v46, v73
    v_dot2_f32_bf16 v74, v97, v45, v74
    v_dot2_f32_bf16 v75, v97, v46, v75
    v_dot2_f32_bf16 v76, v98, v45, v76
    v_dot2_f32_bf16 v77, v98, v46, v77
    v_dot2_f32_bf16 v78, v99, v45, v78
    v_dot2_f32_bf16 v79, v99, v46, v79
    v_dot2_f32_bf16 v80, v100, v45, v80
    v_dot2_f32_bf16 v81, v100, v46, v81
    v_dot2_f32_bf16 v82, v101, v45, v82
    v_dot2_f32_bf16 v83, v101, v46, v83
    v_dot2_f32_bf16 v84, v102, v45, v84
    v_dot2_f32_bf16 v85, v102, v46, v85
    v_dot2_f32_bf16 v86, v103, v45, v86
    v_dot2_f32_bf16 v87, v103, v46, v87
    v_dot2_f32_bf16 v88, v104, v45, v88
    v_dot2_f32_bf16 v89, v104, v46, v89
    v_dot2_f32_bf16 v90, v105, v45, v90
    v_dot2_f32_bf16 v91, v105, v46, v91
    v_dot2_f32_bf16 v92, v106, v45, v92
    v_dot2_f32_bf16 v93, v106, v46, v93
    v_dot2_f32_bf16 v94, v107, v45, v94
    v_dot2_f32_bf16 v95, v107, v46, v95
    s_cmp_eq_u32 s67, 0
    s_cbranch_scc1 fused_kernel_fn_fin
fused_kernel_fn_ld0:
    s_or_b64 exec, s[36:37], 1
    buffer_load_dwordx4 v[96:99], v28, s[56:59], s60 offen offset:0 sc0 sc1
    buffer_load_dwordx4 v[100:103], v28, s[56:59], s60 offen offset:1024 sc0 sc1
    buffer_load_dwordx4 v[104:107], v28, s[56:59], s60 offen offset:2048 sc0 sc1
    s_mov_b64 exec, -1
    s_mov_b64 s[38:39], 0
    s_bitcmp1_b32 s67, 1
    s_waitcnt vmcnt(9)
    s_cbranch_scc0 fused_kernel_fn_ld1
    v_max3_u32 v17, v112, v113, v114
    v_max3_u32 v17, v17, v115, v116
    v_max3_u32 v17, v17, v117, v118
    v_max3_u32 v17, v17, v119, v120
    v_max3_u32 v17, v17, v121, v122
    v_max_u32 v17, v17, v123
    v_cmp_eq_u32 s[38:39], -1, v17
    s_nop 1
    s_cmp_eq_u64 s[38:39], 0
    s_cbranch_scc0 fused_kernel_fn_ld1
    s_bitset0_b32 s67, 1
    v_dot2_f32_bf16 v72, v112, v45, v72
    v_dot2_f32_bf16 v73, v112, v46, v73
    v_dot2_f32_bf16 v74, v113, v45, v74
    v_dot2_f32_bf16 v75, v113, v46, v75
    v_dot2_f32_bf16 v76, v114, v45, v76
    v_dot2_f32_bf16 v77, v114, v46, v77
    v_dot2_f32_bf16 v78, v115, v45, v78
    v_dot2_f32_bf16 v79, v115, v46, v79
    v_dot2_f32_bf16 v80, v116, v45, v80
    v_dot2_f32_bf16 v81, v116, v46, v81
    v_dot2_f32_bf16 v82, v117, v45, v82
    v_dot2_f32_bf16 v83, v117, v46, v83
    v_dot2_f32_bf16 v84, v118, v45, v84
    v_dot2_f32_bf16 v85, v118, v46, v85
    v_dot2_f32_bf16 v86, v119, v45, v86
    v_dot2_f32_bf16 v87, v119, v46, v87
    v_dot2_f32_bf16 v88, v120, v45, v88
    v_dot2_f32_bf16 v89, v120, v46, v89
    v_dot2_f32_bf16 v90, v121, v45, v90
    v_dot2_f32_bf16 v91, v121, v46, v91
    v_dot2_f32_bf16 v92, v122, v45, v92
    v_dot2_f32_bf16 v93, v122, v46, v93
    v_dot2_f32_bf16 v94, v123, v45, v94
    v_dot2_f32_bf16 v95, v123, v46, v95
    s_cmp_eq_u32 s67, 0
    s_cbranch_scc1 fused_kernel_fn_fin
fused_kernel_fn_ld1:
    s_or_b64 exec, s[38:39], 1
    buffer_load_dwordx4 v[112:115], v28, s[56:59], s61 offen offset:0 sc0 sc1
    buffer_load_dwordx4 v[116:119], v28, s[56:59], s61 offen offset:1024 sc0 sc1
    buffer_load_dwordx4 v[120:123], v28, s[56:59], s61 offen offset:2048 sc0 sc1
    s_mov_b64 exec, -1
    s_mov_b64 s[40:41], 0
    s_bitcmp1_b32 s67, 2
    s_waitcnt vmcnt(9)
    s_cbranch_scc0 fused_kernel_fn_ld2
    v_max3_u32 v18, v128, v129, v130
    v_max3_u32 v18, v18, v131, v132
    v_max3_u32 v18, v18, v133, v134
    v_max3_u32 v18, v18, v135, v136
    v_max3_u32 v18, v18, v137, v138
    v_max_u32 v18, v18, v139
    v_cmp_eq_u32 s[40:41], -1, v18
    s_nop 1
    s_cmp_eq_u64 s[40:41], 0
    s_cbranch_scc0 fused_kernel_fn_ld2
    s_bitset0_b32 s67, 2
    v_dot2_f32_bf16 v72, v128, v45, v72
    v_dot2_f32_bf16 v73, v128, v46, v73
    v_dot2_f32_bf16 v74, v129, v45, v74
    v_dot2_f32_bf16 v75, v129, v46, v75
    v_dot2_f32_bf16 v76, v130, v45, v76
    v_dot2_f32_bf16 v77, v130, v46, v77
    v_dot2_f32_bf16 v78, v131, v45, v78
    v_dot2_f32_bf16 v79, v131, v46, v79
    v_dot2_f32_bf16 v80, v132, v45, v80
    v_dot2_f32_bf16 v81, v132, v46, v81
    v_dot2_f32_bf16 v82, v133, v45, v82
    v_dot2_f32_bf16 v83, v133, v46, v83
    v_dot2_f32_bf16 v84, v134, v45, v84
    v_dot2_f32_bf16 v85, v134, v46, v85
    v_dot2_f32_bf16 v86, v135, v45, v86
    v_dot2_f32_bf16 v87, v135, v46, v87
    v_dot2_f32_bf16 v88, v136, v45, v88
    v_dot2_f32_bf16 v89, v136, v46, v89
    v_dot2_f32_bf16 v90, v137, v45, v90
    v_dot2_f32_bf16 v91, v137, v46, v91
    v_dot2_f32_bf16 v92, v138, v45, v92
    v_dot2_f32_bf16 v93, v138, v46, v93
    v_dot2_f32_bf16 v94, v139, v45, v94
    v_dot2_f32_bf16 v95, v139, v46, v95
    s_cmp_eq_u32 s67, 0
    s_cbranch_scc1 fused_kernel_fn_fin
fused_kernel_fn_ld2:
    s_or_b64 exec, s[40:41], 1
    buffer_load_dwordx4 v[128:131], v28, s[56:59], s62 offen offset:0 sc0 sc1
    buffer_load_dwordx4 v[132:135], v28, s[56:59], s62 offen offset:1024 sc0 sc1
    buffer_load_dwordx4 v[136:139], v28, s[56:59], s62 offen offset:2048 sc0 sc1
    s_mov_b64 exec, -1
    s_sub_u32 s98, s98, 1
    s_cbranch_scc0 fused_kernel_fn_round
fused_kernel_fn_fin:
    s_nop 2
    v_cvt_pk_bf16_f32 v32, v72, v73
    v_cvt_pk_bf16_f32 v33, v74, v75
    v_cvt_pk_bf16_f32 v34, v76, v77
    v_cvt_pk_bf16_f32 v35, v78, v79
    v_cndmask_b32 v168, v32, v34, s[52:53]
    v_cndmask_b32 v169, v33, v35, s[52:53]
    v_cndmask_b32 v170, v34, v32, s[52:53]
    v_cndmask_b32 v171, v35, v33, s[52:53]
    buffer_store_dwordx4 v[168:171], v26, s[44:47], s30 offen offset:0
    v_cvt_pk_bf16_f32 v36, v80, v81
    v_cvt_pk_bf16_f32 v37, v82, v83
    v_cvt_pk_bf16_f32 v38, v84, v85
    v_cvt_pk_bf16_f32 v39, v86, v87
    v_cndmask_b32 v172, v36, v38, s[52:53]
    v_cndmask_b32 v173, v37, v39, s[52:53]
    v_cndmask_b32 v174, v38, v36, s[52:53]
    v_cndmask_b32 v175, v39, v37, s[52:53]
    buffer_store_dwordx4 v[172:175], v26, s[44:47], s30 offen offset:64
    v_cvt_pk_bf16_f32 v40, v88, v89
    v_cvt_pk_bf16_f32 v41, v90, v91
    v_cvt_pk_bf16_f32 v42, v92, v93
    v_cvt_pk_bf16_f32 v43, v94, v95
    v_cndmask_b32 v176, v40, v42, s[52:53]
    v_cndmask_b32 v177, v41, v43, s[52:53]
    v_cndmask_b32 v178, v42, v40, s[52:53]
    v_cndmask_b32 v179, v43, v41, s[52:53]
    buffer_store_dwordx4 v[176:179], v26, s[44:47], s30 offen offset:128
    s_waitcnt vmcnt(3)
    s_endpgm
fused_kernel_fpool:
    v_sub_f32 v47, 1.0, v44
    v_cvt_pk_bf16_f32 v45, v47, v47
    v_and_b32 v46, 0xffff0000, v45
    v_lshrrev_b32 v45, 16, v45
    v_lshlrev_b32 v48, 16, v32
    v_and_b32 v49, 0xffff0000, v32
    v_lshlrev_b32 v50, 16, v33
    v_and_b32 v51, 0xffff0000, v33
    v_lshlrev_b32 v52, 16, v34
    v_and_b32 v53, 0xffff0000, v34
    v_lshlrev_b32 v54, 16, v35
    v_and_b32 v55, 0xffff0000, v35
    v_lshlrev_b32 v56, 16, v36
    v_and_b32 v57, 0xffff0000, v36
    v_lshlrev_b32 v58, 16, v37
    v_and_b32 v59, 0xffff0000, v37
    v_lshlrev_b32 v60, 16, v38
    v_and_b32 v61, 0xffff0000, v38
    v_lshlrev_b32 v62, 16, v39
    v_and_b32 v63, 0xffff0000, v39
    v_lshlrev_b32 v64, 16, v40
    v_and_b32 v65, 0xffff0000, v40
    v_lshlrev_b32 v66, 16, v41
    v_and_b32 v67, 0xffff0000, v41
    v_lshlrev_b32 v68, 16, v42
    v_and_b32 v69, 0xffff0000, v42
    v_lshlrev_b32 v70, 16, v43
    v_and_b32 v71, 0xffff0000, v43
    v_mul_f32 v48, v48, v44
    v_mul_f32 v49, v49, v44
    v_mul_f32 v50, v50, v44
    v_mul_f32 v51, v51, v44
    v_mul_f32 v52, v52, v44
    v_mul_f32 v53, v53, v44
    v_mul_f32 v54, v54, v44
    v_mul_f32 v55, v55, v44
    v_mul_f32 v56, v56, v44
    v_mul_f32 v57, v57, v44
    v_mul_f32 v58, v58, v44
    v_mul_f32 v59, v59, v44
    v_mul_f32 v60, v60, v44
    v_mul_f32 v61, v61, v44
    v_mul_f32 v62, v62, v44
    v_mul_f32 v63, v63, v44
    v_mul_f32 v64, v64, v44
    v_mul_f32 v65, v65, v44
    v_mul_f32 v66, v66, v44
    v_mul_f32 v67, v67, v44
    v_mul_f32 v68, v68, v44
    v_mul_f32 v69, v69, v44
    v_mul_f32 v70, v70, v44
    v_mul_f32 v71, v71, v44
    v_cmp_lt_u32 s[52:53], 1, v7
    s_mov_b32 s67, 15
    s_barrier
    buffer_load_dwordx4 v[96:99], v28, s[56:59], s60 offen offset:0 sc0 sc1
    buffer_load_dwordx4 v[100:103], v28, s[56:59], s60 offen offset:1024 sc0 sc1
    buffer_load_dwordx4 v[104:107], v28, s[56:59], s60 offen offset:2048 sc0 sc1
fused_kernel_fp_p_sk0:
    buffer_load_dwordx4 v[112:115], v28, s[56:59], s61 offen offset:0 sc0 sc1
    buffer_load_dwordx4 v[116:119], v28, s[56:59], s61 offen offset:1024 sc0 sc1
    buffer_load_dwordx4 v[120:123], v28, s[56:59], s61 offen offset:2048 sc0 sc1
fused_kernel_fp_p_sk1:
    buffer_load_dwordx4 v[128:131], v28, s[56:59], s62 offen offset:0 sc0 sc1
    buffer_load_dwordx4 v[132:135], v28, s[56:59], s62 offen offset:1024 sc0 sc1
    buffer_load_dwordx4 v[136:139], v28, s[56:59], s62 offen offset:2048 sc0 sc1
fused_kernel_fp_p_sk2:
    buffer_load_dwordx4 v[144:147], v29, s[56:59], s64 offen sc0 sc1
    s_add_u32 s34, s65, 0
    buffer_load_dword v148, v30, s[56:59], s34 offen sc0 sc1
    buffer_load_dword v152, v31, s[56:59], s34 offen sc0 sc1
    s_add_u32 s34, s65, 40960
    buffer_load_dword v149, v30, s[56:59], s34 offen sc0 sc1
    buffer_load_dword v153, v31, s[56:59], s34 offen sc0 sc1
    s_add_u32 s34, s65, 81920
    buffer_load_dword v150, v30, s[56:59], s34 offen sc0 sc1
    buffer_load_dword v154, v31, s[56:59], s34 offen sc0 sc1
    s_add_u32 s34, s65, 122880
    buffer_load_dword v151, v30, s[56:59], s34 offen sc0 sc1
    buffer_load_dword v155, v31, s[56:59], s34 offen sc0 sc1
    s_add_u32 s34, s65, 1310720
    buffer_load_dword v156, v30, s[56:59], s34 offen sc0 sc1
    buffer_load_dword v160, v31, s[56:59], s34 offen sc0 sc1
    s_add_u32 s34, s65, 1351680
    buffer_load_dword v157, v30, s[56:59], s34 offen sc0 sc1
    buffer_load_dword v161, v31, s[56:59], s34 offen sc0 sc1
    s_add_u32 s34, s65, 1392640
    buffer_load_dword v158, v30, s[56:59], s34 offen sc0 sc1
    buffer_load_dword v162, v31, s[56:59], s34 offen sc0 sc1
    s_add_u32 s34, s65, 1433600
    buffer_load_dword v159, v30, s[56:59], s34 offen sc0 sc1
    buffer_load_dword v163, v31, s[56:59], s34 offen sc0 sc1
fused_kernel_fp_p_sk3:
    s_mov_b64 exec, -1
    ds_read_b128 v[72:75], v25 offset:0
    ds_read_b128 v[76:79], v25 offset:1024
    ds_read_b128 v[80:83], v25 offset:2048
    ds_read_b128 v[84:87], v25 offset:3072
    ds_read_b128 v[88:91], v25 offset:4096
    ds_read_b128 v[92:95], v25 offset:5120
    s_movk_i32 s98, 0x4000
    s_waitcnt lgkmcnt(0)
    v_mul_f32 v72, v46, v72
    v_mul_f32 v73, v46, v73
    v_mul_f32 v74, v46, v74
    v_mul_f32 v75, v46, v75
    v_mul_f32 v76, v46, v76
    v_mul_f32 v77, v46, v77
    v_mul_f32 v78, v46, v78
    v_mul_f32 v79, v46, v79
    v_mul_f32 v80, v46, v80
    v_mul_f32 v81, v46, v81
    v_mul_f32 v82, v46, v82
    v_mul_f32 v83, v46, v83
    v_mul_f32 v84, v46, v84
    v_mul_f32 v85, v46, v85
    v_mul_f32 v86, v46, v86
    v_mul_f32 v87, v46, v87
    v_mul_f32 v88, v46, v88
    v_mul_f32 v89, v46, v89
    v_mul_f32 v90, v46, v90
    v_mul_f32 v91, v46, v91
    v_mul_f32 v92, v46, v92
    v_mul_f32 v93, v46, v93
    v_mul_f32 v94, v46, v94
    v_mul_f32 v95, v46, v95
fused_kernel_fp_round:
    s_mov_b64 s[36:37], 0
    s_bitcmp1_b32 s67, 0
    s_waitcnt vmcnt(23)
    s_cbranch_scc0 fused_kernel_fp_ld0
    v_max3_u32 v16, v96, v97, v98
    v_max3_u32 v16, v16, v99, v100
    v_max3_u32 v16, v16, v101, v102
    v_max3_u32 v16, v16, v103, v104
    v_max3_u32 v16, v16, v105, v106
    v_max_u32 v16, v16, v107
    v_cmp_eq_u32 s[36:37], -1, v16
    s_nop 1
    s_cmp_eq_u64 s[36:37], 0
    s_cbranch_scc0 fused_kernel_fp_ld0
    s_bitset0_b32 s67, 0
    v_dot2_f32_bf16 v72, v96, v45, v72
    v_dot2_f32_bf16 v73, v96, v46, v73
    v_dot2_f32_bf16 v74, v97, v45, v74
    v_dot2_f32_bf16 v75, v97, v46, v75
    v_dot2_f32_bf16 v76, v98, v45, v76
    v_dot2_f32_bf16 v77, v98, v46, v77
    v_dot2_f32_bf16 v78, v99, v45, v78
    v_dot2_f32_bf16 v79, v99, v46, v79
    v_dot2_f32_bf16 v80, v100, v45, v80
    v_dot2_f32_bf16 v81, v100, v46, v81
    v_dot2_f32_bf16 v82, v101, v45, v82
    v_dot2_f32_bf16 v83, v101, v46, v83
    v_dot2_f32_bf16 v84, v102, v45, v84
    v_dot2_f32_bf16 v85, v102, v46, v85
    v_dot2_f32_bf16 v86, v103, v45, v86
    v_dot2_f32_bf16 v87, v103, v46, v87
    v_dot2_f32_bf16 v88, v104, v45, v88
    v_dot2_f32_bf16 v89, v104, v46, v89
    v_dot2_f32_bf16 v90, v105, v45, v90
    v_dot2_f32_bf16 v91, v105, v46, v91
    v_dot2_f32_bf16 v92, v106, v45, v92
    v_dot2_f32_bf16 v93, v106, v46, v93
    v_dot2_f32_bf16 v94, v107, v45, v94
    v_dot2_f32_bf16 v95, v107, v46, v95
    s_cmp_eq_u32 s67, 0
    s_cbranch_scc1 fused_kernel_fp_fin
fused_kernel_fp_ld0:
    s_or_b64 exec, s[36:37], 1
    buffer_load_dwordx4 v[96:99], v28, s[56:59], s60 offen offset:0 sc0 sc1
    buffer_load_dwordx4 v[100:103], v28, s[56:59], s60 offen offset:1024 sc0 sc1
    buffer_load_dwordx4 v[104:107], v28, s[56:59], s60 offen offset:2048 sc0 sc1
    s_mov_b64 exec, -1
    s_mov_b64 s[38:39], 0
    s_bitcmp1_b32 s67, 1
    s_waitcnt vmcnt(23)
    s_cbranch_scc0 fused_kernel_fp_ld1
    v_max3_u32 v17, v112, v113, v114
    v_max3_u32 v17, v17, v115, v116
    v_max3_u32 v17, v17, v117, v118
    v_max3_u32 v17, v17, v119, v120
    v_max3_u32 v17, v17, v121, v122
    v_max_u32 v17, v17, v123
    v_cmp_eq_u32 s[38:39], -1, v17
    s_nop 1
    s_cmp_eq_u64 s[38:39], 0
    s_cbranch_scc0 fused_kernel_fp_ld1
    s_bitset0_b32 s67, 1
    v_dot2_f32_bf16 v72, v112, v45, v72
    v_dot2_f32_bf16 v73, v112, v46, v73
    v_dot2_f32_bf16 v74, v113, v45, v74
    v_dot2_f32_bf16 v75, v113, v46, v75
    v_dot2_f32_bf16 v76, v114, v45, v76
    v_dot2_f32_bf16 v77, v114, v46, v77
    v_dot2_f32_bf16 v78, v115, v45, v78
    v_dot2_f32_bf16 v79, v115, v46, v79
    v_dot2_f32_bf16 v80, v116, v45, v80
    v_dot2_f32_bf16 v81, v116, v46, v81
    v_dot2_f32_bf16 v82, v117, v45, v82
    v_dot2_f32_bf16 v83, v117, v46, v83
    v_dot2_f32_bf16 v84, v118, v45, v84
    v_dot2_f32_bf16 v85, v118, v46, v85
    v_dot2_f32_bf16 v86, v119, v45, v86
    v_dot2_f32_bf16 v87, v119, v46, v87
    v_dot2_f32_bf16 v88, v120, v45, v88
    v_dot2_f32_bf16 v89, v120, v46, v89
    v_dot2_f32_bf16 v90, v121, v45, v90
    v_dot2_f32_bf16 v91, v121, v46, v91
    v_dot2_f32_bf16 v92, v122, v45, v92
    v_dot2_f32_bf16 v93, v122, v46, v93
    v_dot2_f32_bf16 v94, v123, v45, v94
    v_dot2_f32_bf16 v95, v123, v46, v95
    s_cmp_eq_u32 s67, 0
    s_cbranch_scc1 fused_kernel_fp_fin
fused_kernel_fp_ld1:
    s_or_b64 exec, s[38:39], 1
    buffer_load_dwordx4 v[112:115], v28, s[56:59], s61 offen offset:0 sc0 sc1
    buffer_load_dwordx4 v[116:119], v28, s[56:59], s61 offen offset:1024 sc0 sc1
    buffer_load_dwordx4 v[120:123], v28, s[56:59], s61 offen offset:2048 sc0 sc1
    s_mov_b64 exec, -1
    s_mov_b64 s[40:41], 0
    s_bitcmp1_b32 s67, 2
    s_waitcnt vmcnt(23)
    s_cbranch_scc0 fused_kernel_fp_ld2
    v_max3_u32 v18, v128, v129, v130
    v_max3_u32 v18, v18, v131, v132
    v_max3_u32 v18, v18, v133, v134
    v_max3_u32 v18, v18, v135, v136
    v_max3_u32 v18, v18, v137, v138
    v_max_u32 v18, v18, v139
    v_cmp_eq_u32 s[40:41], -1, v18
    s_nop 1
    s_cmp_eq_u64 s[40:41], 0
    s_cbranch_scc0 fused_kernel_fp_ld2
    s_bitset0_b32 s67, 2
    v_dot2_f32_bf16 v72, v128, v45, v72
    v_dot2_f32_bf16 v73, v128, v46, v73
    v_dot2_f32_bf16 v74, v129, v45, v74
    v_dot2_f32_bf16 v75, v129, v46, v75
    v_dot2_f32_bf16 v76, v130, v45, v76
    v_dot2_f32_bf16 v77, v130, v46, v77
    v_dot2_f32_bf16 v78, v131, v45, v78
    v_dot2_f32_bf16 v79, v131, v46, v79
    v_dot2_f32_bf16 v80, v132, v45, v80
    v_dot2_f32_bf16 v81, v132, v46, v81
    v_dot2_f32_bf16 v82, v133, v45, v82
    v_dot2_f32_bf16 v83, v133, v46, v83
    v_dot2_f32_bf16 v84, v134, v45, v84
    v_dot2_f32_bf16 v85, v134, v46, v85
    v_dot2_f32_bf16 v86, v135, v45, v86
    v_dot2_f32_bf16 v87, v135, v46, v87
    v_dot2_f32_bf16 v88, v136, v45, v88
    v_dot2_f32_bf16 v89, v136, v46, v89
    v_dot2_f32_bf16 v90, v137, v45, v90
    v_dot2_f32_bf16 v91, v137, v46, v91
    v_dot2_f32_bf16 v92, v138, v45, v92
    v_dot2_f32_bf16 v93, v138, v46, v93
    v_dot2_f32_bf16 v94, v139, v45, v94
    v_dot2_f32_bf16 v95, v139, v46, v95
    s_cmp_eq_u32 s67, 0
    s_cbranch_scc1 fused_kernel_fp_fin
fused_kernel_fp_ld2:
    s_or_b64 exec, s[40:41], 1
    buffer_load_dwordx4 v[128:131], v28, s[56:59], s62 offen offset:0 sc0 sc1
    buffer_load_dwordx4 v[132:135], v28, s[56:59], s62 offen offset:1024 sc0 sc1
    buffer_load_dwordx4 v[136:139], v28, s[56:59], s62 offen offset:2048 sc0 sc1
    s_mov_b64 exec, -1
    s_mov_b64 s[54:55], 0
    s_bitcmp1_b32 s67, 3
    s_waitcnt vmcnt(9)
    s_cbranch_scc0 fused_kernel_fp_ld3
    v_max3_u32 v19, v144, v145, v146
    v_max3_u32 v19, v19, v147, v148
    v_max3_u32 v19, v19, v149, v150
    v_max3_u32 v19, v19, v151, v152
    v_max3_u32 v19, v19, v153, v154
    v_max3_u32 v19, v19, v155, v156
    v_max3_u32 v19, v19, v157, v158
    v_max3_u32 v19, v19, v159, v160
    v_max3_u32 v19, v19, v161, v162
    v_max_u32 v19, v19, v163
    v_cmp_eq_u32 s[54:55], -1, v19
    s_nop 1
    s_cmp_eq_u64 s[54:55], 0
    s_cbranch_scc0 fused_kernel_fp_ld3
    s_bitset0_b32 s67, 3
    v_perm_b32 v192, v149, v148, s31
    v_perm_b32 v193, v151, v150, s31
    v_perm_b32 v194, v153, v152, s31
    v_perm_b32 v195, v155, v154, s31
    v_perm_b32 v196, v157, v156, s31
    v_perm_b32 v197, v159, v158, s31
    v_perm_b32 v198, v161, v160, s31
    v_perm_b32 v199, v163, v162, s31
    v_lshlrev_b32 v168, 16, v144
    v_and_b32 v169, 0xffff0000, v144
    v_lshlrev_b32 v170, 16, v145
    v_and_b32 v171, 0xffff0000, v145
    v_lshlrev_b32 v172, 16, v146
    v_and_b32 v173, 0xffff0000, v146
    v_lshlrev_b32 v174, 16, v147
    v_and_b32 v175, 0xffff0000, v147
    v_lshlrev_b32 v176, 16, v192
    v_and_b32 v177, 0xffff0000, v192
    v_lshlrev_b32 v178, 16, v193
    v_and_b32 v179, 0xffff0000, v193
    v_lshlrev_b32 v180, 16, v194
    v_and_b32 v181, 0xffff0000, v194
    v_lshlrev_b32 v182, 16, v195
    v_and_b32 v183, 0xffff0000, v195
    v_lshlrev_b32 v184, 16, v196
    v_and_b32 v185, 0xffff0000, v196
    v_lshlrev_b32 v186, 16, v197
    v_and_b32 v187, 0xffff0000, v197
    v_lshlrev_b32 v188, 16, v198
    v_and_b32 v189, 0xffff0000, v198
    v_lshlrev_b32 v190, 16, v199
    v_and_b32 v191, 0xffff0000, v199
    v_fmac_f32 v72, v48, v168
    v_fmac_f32 v73, v49, v169
    v_fmac_f32 v74, v50, v170
    v_fmac_f32 v75, v51, v171
    v_fmac_f32 v76, v52, v172
    v_fmac_f32 v77, v53, v173
    v_fmac_f32 v78, v54, v174
    v_fmac_f32 v79, v55, v175
    v_fmac_f32 v80, v56, v176
    v_fmac_f32 v81, v57, v177
    v_fmac_f32 v82, v58, v178
    v_fmac_f32 v83, v59, v179
    v_fmac_f32 v84, v60, v180
    v_fmac_f32 v85, v61, v181
    v_fmac_f32 v86, v62, v182
    v_fmac_f32 v87, v63, v183
    v_fmac_f32 v88, v64, v184
    v_fmac_f32 v89, v65, v185
    v_fmac_f32 v90, v66, v186
    v_fmac_f32 v91, v67, v187
    v_fmac_f32 v92, v68, v188
    v_fmac_f32 v93, v69, v189
    v_fmac_f32 v94, v70, v190
    v_fmac_f32 v95, v71, v191
    s_cmp_eq_u32 s67, 0
    s_cbranch_scc1 fused_kernel_fp_fin
fused_kernel_fp_ld3:
    s_or_b64 exec, s[54:55], 1
    buffer_load_dwordx4 v[144:147], v29, s[56:59], s64 offen sc0 sc1
    s_add_u32 s34, s65, 0
    buffer_load_dword v148, v30, s[56:59], s34 offen sc0 sc1
    buffer_load_dword v152, v31, s[56:59], s34 offen sc0 sc1
    s_add_u32 s34, s65, 40960
    buffer_load_dword v149, v30, s[56:59], s34 offen sc0 sc1
    buffer_load_dword v153, v31, s[56:59], s34 offen sc0 sc1
    s_add_u32 s34, s65, 81920
    buffer_load_dword v150, v30, s[56:59], s34 offen sc0 sc1
    buffer_load_dword v154, v31, s[56:59], s34 offen sc0 sc1
    s_add_u32 s34, s65, 122880
    buffer_load_dword v151, v30, s[56:59], s34 offen sc0 sc1
    buffer_load_dword v155, v31, s[56:59], s34 offen sc0 sc1
    s_add_u32 s34, s65, 1310720
    buffer_load_dword v156, v30, s[56:59], s34 offen sc0 sc1
    buffer_load_dword v160, v31, s[56:59], s34 offen sc0 sc1
    s_add_u32 s34, s65, 1351680
    buffer_load_dword v157, v30, s[56:59], s34 offen sc0 sc1
    buffer_load_dword v161, v31, s[56:59], s34 offen sc0 sc1
    s_add_u32 s34, s65, 1392640
    buffer_load_dword v158, v30, s[56:59], s34 offen sc0 sc1
    buffer_load_dword v162, v31, s[56:59], s34 offen sc0 sc1
    s_add_u32 s34, s65, 1433600
    buffer_load_dword v159, v30, s[56:59], s34 offen sc0 sc1
    buffer_load_dword v163, v31, s[56:59], s34 offen sc0 sc1
    s_mov_b64 exec, -1
    s_sub_u32 s98, s98, 1
    s_cbranch_scc0 fused_kernel_fp_round
fused_kernel_fp_fin:
    s_nop 2
    v_cvt_pk_bf16_f32 v32, v72, v73
    v_cvt_pk_bf16_f32 v33, v74, v75
    v_cvt_pk_bf16_f32 v34, v76, v77
    v_cvt_pk_bf16_f32 v35, v78, v79
    v_cndmask_b32 v168, v32, v34, s[52:53]
    v_cndmask_b32 v169, v33, v35, s[52:53]
    v_cndmask_b32 v170, v34, v32, s[52:53]
    v_cndmask_b32 v171, v35, v33, s[52:53]
    buffer_store_dwordx4 v[168:171], v26, s[44:47], s30 offen offset:0
    v_cvt_pk_bf16_f32 v36, v80, v81
    v_cvt_pk_bf16_f32 v37, v82, v83
    v_cvt_pk_bf16_f32 v38, v84, v85
    v_cvt_pk_bf16_f32 v39, v86, v87
    v_cndmask_b32 v172, v36, v38, s[52:53]
    v_cndmask_b32 v173, v37, v39, s[52:53]
    v_cndmask_b32 v174, v38, v36, s[52:53]
    v_cndmask_b32 v175, v39, v37, s[52:53]
    buffer_store_dwordx4 v[172:175], v26, s[44:47], s30 offen offset:64
    v_cvt_pk_bf16_f32 v40, v88, v89
    v_cvt_pk_bf16_f32 v41, v90, v91
    v_cvt_pk_bf16_f32 v42, v92, v93
    v_cvt_pk_bf16_f32 v43, v94, v95
    v_cndmask_b32 v176, v40, v42, s[52:53]
    v_cndmask_b32 v177, v41, v43, s[52:53]
    v_cndmask_b32 v178, v42, v40, s[52:53]
    v_cndmask_b32 v179, v43, v41, s[52:53]
    buffer_store_dwordx4 v[176:179], v26, s[44:47], s30 offen offset:128
    s_waitcnt vmcnt(3)
    s_endpgm
fused_kernel_conv:
    s_setprio 2
    v_bfe_u32 v3, v0, 4, 2
    v_and_b32 v4, 15, v0
    v_lshlrev_b32 v6, 1, v4
    v_sub_u32 v6, v3, v6
    s_mov_b32 s35, 74368
    s_mul_i32 s32, s22, 4128
    s_add_u32 s32, s32, 0
    v_add_u32 v8, 34, v6
    v_lshrrev_b32 v7, 1, v8
    v_xor_b32 v7, s22, v7
    v_and_b32 v7, 7, v7
    v_lshl_add_u32 v8, v8, 7, s35
    v_lshl_add_u32 v25, v7, 4, v8
    ds_read_b128 v[132:135], v25 offset:0
    ds_read_b128 v[128:131], v25 offset:4096
    ds_read_b128 v[124:127], v25 offset:8192
    ds_read_b128 v[120:123], v25 offset:12288
    ds_read_b128 v[116:119], v25 offset:16384
    ds_read_b128 v[112:115], v25 offset:20480
    ds_read_b128 v[108:111], v25 offset:24576
    ds_read_b128 v[104:107], v25 offset:28672
    v_bfe_u32 v212, v0, 0, 1
    v_xor_b32 v212, 1, v212
    v_mul_u32_u24 v222, 37186, v212
    v_lshl_add_u32 v222, v4, 1, v222
    v_lshl_add_u32 v222, v3, 4, v222
    s_add_u32 s34, s32, 2
    v_add_u32 v204, s34, v222
    ds_read2_b32 v[72:73], v204 offset0:16 offset1:17
    ds_read2_b32 v[74:75], v204 offset0:18 offset1:19
    ds_read2_b32 v[76:77], v204 offset0:144 offset1:145
    ds_read2_b32 v[78:79], v204 offset0:146 offset1:147
    v_add_u32 v205, 1024, v204
    ds_read2_b32 v[80:81], v205 offset0:16 offset1:17
    ds_read2_b32 v[82:83], v205 offset0:18 offset1:19
    ds_read2_b32 v[84:85], v205 offset0:144 offset1:145
    ds_read2_b32 v[86:87], v205 offset0:146 offset1:147
    v_add_u32 v206, 2048, v204
    ds_read2_b32 v[88:89], v206 offset0:16 offset1:17
    ds_read2_b32 v[90:91], v206 offset0:18 offset1:19
    ds_read2_b32 v[92:93], v206 offset0:144 offset1:145
    ds_read2_b32 v[94:95], v206 offset0:146 offset1:147
    v_add_u32 v207, 3072, v204
    ds_read2_b32 v[96:97], v207 offset0:16 offset1:17
    ds_read2_b32 v[98:99], v207 offset0:18 offset1:19
    ds_read2_b32 v[100:101], v207 offset0:144 offset1:145
    ds_read2_b32 v[102:103], v207 offset0:146 offset1:147
    v_add_u32 v8, 38, v6
    v_lshrrev_b32 v7, 1, v8
    v_xor_b32 v7, s22, v7
    v_and_b32 v7, 7, v7
    v_lshl_add_u32 v8, v8, 7, s35
    v_lshl_add_u32 v26, v7, 4, v8
    s_setprio 0
    s_waitcnt lgkmcnt(15)
    s_waitcnt lgkmcnt(14)
    v_mfma_f32_16x16x32_bf16 v[60:63], v[132:135], v[72:75], 0
    ds_read_b128 v[132:135], v26 offset:0
    v_mul_f32 v10, s46, v64
    v_mfma_f32_16x16x32_bf16 v[56:59], v[128:131], v[72:75], 0
    v_mul_f32 v11, s46, v65
    v_mfma_f32_16x16x32_bf16 v[52:55], v[124:127], v[72:75], 0
    v_mul_f32 v12, s46, v66
    v_mfma_f32_16x16x32_bf16 v[48:51], v[120:123], v[72:75], 0
    v_mul_f32 v13, s46, v67
    v_mfma_f32_16x16x32_bf16 v[44:47], v[116:119], v[72:75], 0
    v_exp_f32 v10, v10
    v_mfma_f32_16x16x32_bf16 v[40:43], v[112:115], v[72:75], 0
    v_exp_f32 v11, v11
    v_mfma_f32_16x16x32_bf16 v[36:39], v[108:111], v[72:75], 0
    v_exp_f32 v12, v12
    v_mfma_f32_16x16x32_bf16 v[32:35], v[104:107], v[72:75], 0
    ds_read2_b32 v[72:73], v204 offset0:32 offset1:33
    ds_read2_b32 v[74:75], v204 offset0:34 offset1:35
    v_exp_f32 v13, v13
    s_waitcnt lgkmcnt(15)
    v_mfma_f32_16x16x32_bf16 v[60:63], v[128:131], v[76:79], v[60:63]
    ds_read_b128 v[128:131], v26 offset:4096
    v_mul_f32 v14, v64, v68
    v_mfma_f32_16x16x32_bf16 v[56:59], v[124:127], v[76:79], v[56:59]
    v_mul_f32 v15, v65, v69
    v_mfma_f32_16x16x32_bf16 v[52:55], v[120:123], v[76:79], v[52:55]
    v_mul_f32 v16, v66, v70
    v_mfma_f32_16x16x32_bf16 v[48:51], v[116:119], v[76:79], v[48:51]
    v_mul_f32 v17, v67, v71
    v_mfma_f32_16x16x32_bf16 v[44:47], v[112:115], v[76:79], v[44:47]
    v_add_f32 v10, 1.0, v10
    v_mfma_f32_16x16x32_bf16 v[40:43], v[108:111], v[76:79], v[40:43]
    v_add_f32 v11, 1.0, v11
    v_mfma_f32_16x16x32_bf16 v[36:39], v[104:107], v[76:79], v[36:39]
    ds_read2_b32 v[76:77], v204 offset0:160 offset1:161
    ds_read2_b32 v[78:79], v204 offset0:162 offset1:163
    v_add_f32 v12, 1.0, v12
    s_waitcnt lgkmcnt(15)
    v_mfma_f32_16x16x32_bf16 v[60:63], v[124:127], v[80:83], v[60:63]
    ds_read_b128 v[124:127], v26 offset:8192
    v_add_f32 v13, 1.0, v13
    v_mfma_f32_16x16x32_bf16 v[56:59], v[120:123], v[80:83], v[56:59]
    v_rcp_f32 v10, v10
    v_mfma_f32_16x16x32_bf16 v[52:55], v[116:119], v[80:83], v[52:55]
    v_rcp_f32 v11, v11
    v_mfma_f32_16x16x32_bf16 v[48:51], v[112:115], v[80:83], v[48:51]
    v_rcp_f32 v12, v12
    v_mfma_f32_16x16x32_bf16 v[44:47], v[108:111], v[80:83], v[44:47]
    v_rcp_f32 v13, v13
    v_mfma_f32_16x16x32_bf16 v[40:43], v[104:107], v[80:83], v[40:43]
    ds_read2_b32 v[80:81], v205 offset0:32 offset1:33
    ds_read2_b32 v[82:83], v205 offset0:34 offset1:35
    v_mul_f32 v14, v14, v10
    s_waitcnt lgkmcnt(15)
    v_mfma_f32_16x16x32_bf16 v[60:63], v[120:123], v[84:87], v[60:63]
    ds_read_b128 v[120:123], v26 offset:12288
    v_mul_f32 v15, v15, v11
    v_mfma_f32_16x16x32_bf16 v[56:59], v[116:119], v[84:87], v[56:59]
    v_mul_f32 v16, v16, v12
    v_mfma_f32_16x16x32_bf16 v[52:55], v[112:115], v[84:87], v[52:55]
    v_mul_f32 v17, v17, v13
    v_mfma_f32_16x16x32_bf16 v[48:51], v[108:111], v[84:87], v[48:51]
    v_cvt_pk_bf16_f32 v20, v14, v15
    v_mfma_f32_16x16x32_bf16 v[44:47], v[104:107], v[84:87], v[44:47]
    ds_read2_b32 v[84:85], v205 offset0:160 offset1:161
    ds_read2_b32 v[86:87], v205 offset0:162 offset1:163
    v_cvt_pk_bf16_f32 v21, v16, v17
    v_mfma_f32_16x16x32_bf16 v[60:63], v[116:119], v[88:91], v[60:63]
    ds_read_b128 v[116:119], v26 offset:16384
    s_nop 0
    v_permlane16_swap_b32 v18, v20
    v_permlane16_swap_b32 v19, v21
    v_mfma_f32_16x16x32_bf16 v[56:59], v[112:115], v[88:91], v[56:59]
    s_nop 0
    buffer_store_dwordx4 v[18:21], v23, s[16:19], s47 offen sc0 sc1
    s_add_u32 s47, s47, 4096
    v_mfma_f32_16x16x32_bf16 v[52:55], v[108:111], v[88:91], v[52:55]
    v_add_u32 v8, 42, v6
    v_mfma_f32_16x16x32_bf16 v[48:51], v[104:107], v[88:91], v[48:51]
    ds_read2_b32 v[88:89], v206 offset0:32 offset1:33
    ds_read2_b32 v[90:91], v206 offset0:34 offset1:35
    v_lshrrev_b32 v7, 1, v8
    s_waitcnt lgkmcnt(15)
    v_mfma_f32_16x16x32_bf16 v[60:63], v[112:115], v[92:95], v[60:63]
    ds_read_b128 v[112:115], v26 offset:20480
    v_xor_b32 v7, s22, v7
    v_mfma_f32_16x16x32_bf16 v[56:59], v[108:111], v[92:95], v[56:59]
    v_and_b32 v7, 7, v7
    v_mfma_f32_16x16x32_bf16 v[52:55], v[104:107], v[92:95], v[52:55]
    ds_read2_b32 v[92:93], v206 offset0:160 offset1:161
    ds_read2_b32 v[94:95], v206 offset0:162 offset1:163
    v_lshl_add_u32 v8, v8, 7, s35
    v_mfma_f32_16x16x32_bf16 v[60:63], v[108:111], v[96:99], v[60:63]
    ds_read_b128 v[108:111], v26 offset:24576
    v_lshl_add_u32 v27, v7, 4, v8
    v_mfma_f32_16x16x32_bf16 v[56:59], v[104:107], v[96:99], v[56:59]
    ds_read2_b32 v[96:97], v207 offset0:32 offset1:33
    ds_read2_b32 v[98:99], v207 offset0:34 offset1:35
    v_mfma_f32_16x16x32_bf16 v[60:63], v[104:107], v[100:103], v[60:63]
    ds_read_b128 v[104:107], v26 offset:28672
    ds_read2_b32 v[100:101], v207 offset0:160 offset1:161
    ds_read2_b32 v[102:103], v207 offset0:162 offset1:163
    s_waitcnt lgkmcnt(15)
    v_mfma_f32_16x16x32_bf16 v[60:63], v[132:135], v[72:75], v[60:63]
    ds_read_b128 v[132:135], v27 offset:0
    v_add_u32 v8, 30, v6
    v_mfma_f32_16x16x32_bf16 v[56:59], v[128:131], v[72:75], v[56:59]
    v_lshrrev_b32 v7, 1, v8
    v_mfma_f32_16x16x32_bf16 v[52:55], v[124:127], v[72:75], v[52:55]
    v_xor_b32 v7, s22, v7
    s_waitcnt lgkmcnt(15)
    v_mfma_f32_16x16x32_bf16 v[48:51], v[120:123], v[72:75], v[48:51]
    v_and_b32 v7, 7, v7
    s_waitcnt lgkmcnt(12)
    v_mfma_f32_16x16x32_bf16 v[44:47], v[116:119], v[72:75], v[44:47]
    v_lshl_add_u32 v8, v8, 7, s35
    s_waitcnt lgkmcnt(9)
    v_mfma_f32_16x16x32_bf16 v[40:43], v[112:115], v[72:75], v[40:43]
    v_lshl_add_u32 v24, v7, 4, v8
    s_waitcnt lgkmcnt(6)
    v_mfma_f32_16x16x32_bf16 v[36:39], v[108:111], v[72:75], v[36:39]
    v_mov_b32 v9, s32
    s_waitcnt lgkmcnt(3)
    v_mfma_f32_16x16x32_bf16 v[32:35], v[104:107], v[72:75], v[32:35]
    ds_read2_b32 v[72:73], v204 offset0:48 offset1:49
    ds_read2_b32 v[74:75], v204 offset0:50 offset1:51
    ds_read_b128 v[192:195], v9 offset:32
    v_mfma_f32_16x16x32_bf16 v[60:63], v[128:131], v[76:79], v[60:63]
    ds_read_b128 v[128:131], v27 offset:4096
    v_mov_b32 v200, 0
    v_mfma_f32_16x16x32_bf16 v[56:59], v[124:127], v[76:79], v[56:59]
    v_mov_b32 v201, 0
    v_mfma_f32_16x16x32_bf16 v[52:55], v[120:123], v[76:79], v[52:55]
    v_mov_b32 v202, 0
    v_mfma_f32_16x16x32_bf16 v[48:51], v[116:119], v[76:79], v[48:51]
    v_mov_b32 v203, 0
    v_mfma_f32_16x16x32_bf16 v[44:47], v[112:115], v[76:79], v[44:47]
    v_bfe_u32 v7, v0, 1, 1
    v_mfma_f32_16x16x32_bf16 v[40:43], v[108:111], v[76:79], v[40:43]
    v_mul_u32_u24 v7, 37184, v7
    v_mfma_f32_16x16x32_bf16 v[36:39], v[104:107], v[76:79], v[36:39]
    ds_read2_b32 v[76:77], v204 offset0:176 offset1:177
    ds_read2_b32 v[78:79], v204 offset0:178 offset1:179
    v_and_b32 v8, 1, v0
    v_mfma_f32_16x16x32_bf16 v[60:63], v[124:127], v[80:83], v[60:63]
    ds_read_b128 v[124:127], v27 offset:8192
    v_lshl_add_u32 v7, v8, 4, v7
    v_mfma_f32_16x16x32_bf16 v[56:59], v[120:123], v[80:83], v[56:59]
    v_add_u32 v8, s32, v7
    v_mfma_f32_16x16x32_bf16 v[52:55], v[116:119], v[80:83], v[52:55]
    v_add_u32 v7, 33024, v7
    v_mfma_f32_16x16x32_bf16 v[48:51], v[112:115], v[80:83], v[48:51]
    v_mov_b32 v212, 70240
    v_mfma_f32_16x16x32_bf16 v[44:47], v[108:111], v[80:83], v[44:47]
    v_and_b32 v2, 63, v0
    v_mfma_f32_16x16x32_bf16 v[40:43], v[104:107], v[80:83], v[40:43]
    ds_read2_b32 v[80:81], v205 offset0:48 offset1:49
    ds_read2_b32 v[82:83], v205 offset0:50 offset1:51
    v_lshlrev_b32 v5, 4, v2
    v_mfma_f32_16x16x32_bf16 v[60:63], v[120:123], v[84:87], v[60:63]
    ds_read_b128 v[120:123], v27 offset:12288
    s_waitcnt lgkmcnt(7)
    v_lshlrev_b32 v196, 16, v192
    v_mfma_f32_16x16x32_bf16 v[56:59], v[116:119], v[84:87], v[56:59]
    v_alignbit_b32 v197, v193, v192, 16
    v_mfma_f32_16x16x32_bf16 v[52:55], v[112:115], v[84:87], v[52:55]
    v_alignbit_b32 v198, v194, v193, 16
    v_mfma_f32_16x16x32_bf16 v[48:51], v[108:111], v[84:87], v[48:51]
    v_alignbit_b32 v199, v195, v194, 16
    v_mfma_f32_16x16x32_bf16 v[44:47], v[104:107], v[84:87], v[44:47]
    ds_read2_b32 v[84:85], v205 offset0:176 offset1:177
    ds_read2_b32 v[86:87], v205 offset0:178 offset1:179
    s_mov_b64 exec, 15
    ds_write_b128 v8, v[200:203]
    ds_write_b128 v7, v[200:203]
    s_mov_b64 exec, -1
    v_mfma_f32_16x16x32_bf16 v[60:63], v[116:119], v[88:91], v[60:63]
    ds_read_b128 v[116:119], v27 offset:16384
    s_mov_b64 exec, 1
    ds_write_b128 v9, v[196:199] offset:37216
    s_cmp_eq_u32 s22, 0
    s_cselect_b64 exec, 1, 0
    ds_write_b16 v212, v200
    s_mov_b64 exec, -1
    v_mfma_f32_16x16x32_bf16 v[56:59], v[112:115], v[88:91], v[56:59]
    v_mfma_f32_16x16x32_bf16 v[52:55], v[108:111], v[88:91], v[52:55]
    v_mfma_f32_16x16x32_bf16 v[48:51], v[104:107], v[88:91], v[48:51]
    ds_read2_b32 v[88:89], v206 offset0:48 offset1:49
    ds_read2_b32 v[90:91], v206 offset0:50 offset1:51
    v_mfma_f32_16x16x32_bf16 v[60:63], v[112:115], v[92:95], v[60:63]
    ds_read_b128 v[112:115], v27 offset:20480
    v_mfma_f32_16x16x32_bf16 v[56:59], v[108:111], v[92:95], v[56:59]
    v_mfma_f32_16x16x32_bf16 v[52:55], v[104:107], v[92:95], v[52:55]
    ds_read2_b32 v[92:93], v206 offset0:176 offset1:177
    ds_read2_b32 v[94:95], v206 offset0:178 offset1:179
    v_mfma_f32_16x16x32_bf16 v[60:63], v[108:111], v[96:99], v[60:63]
    ds_read_b128 v[108:111], v27 offset:24576
    v_mfma_f32_16x16x32_bf16 v[56:59], v[104:107], v[96:99], v[56:59]
    ds_read2_b32 v[96:97], v207 offset0:48 offset1:49
    ds_read2_b32 v[98:99], v207 offset0:50 offset1:51
    v_mfma_f32_16x16x32_bf16 v[60:63], v[104:107], v[100:103], v[60:63]
    ds_read_b128 v[104:107], v27 offset:28672
    ds_read2_b32 v[100:101], v207 offset0:176 offset1:177
    ds_read2_b32 v[102:103], v207 offset0:178 offset1:179
    v_mfma_f32_16x16x32_bf16 v[60:63], v[132:135], v[72:75], v[60:63]
    ds_read_b128 v[132:135], v24 offset:2048
    s_waitcnt lgkmcnt(15)
    v_mfma_f32_16x16x32_bf16 v[56:59], v[128:131], v[72:75], v[56:59]
    v_mfma_f32_16x16x32_bf16 v[52:55], v[124:127], v[72:75], v[52:55]
    v_mfma_f32_16x16x32_bf16 v[48:51], v[120:123], v[72:75], v[48:51]
    s_waitcnt lgkmcnt(14)
    v_mfma_f32_16x16x32_bf16 v[44:47], v[116:119], v[72:75], v[44:47]
    s_waitcnt lgkmcnt(9)
    v_mfma_f32_16x16x32_bf16 v[40:43], v[112:115], v[72:75], v[40:43]
    s_waitcnt lgkmcnt(6)
    v_mfma_f32_16x16x32_bf16 v[36:39], v[108:111], v[72:75], v[36:39]
    s_waitcnt lgkmcnt(3)
    v_mfma_f32_16x16x32_bf16 v[32:35], v[104:107], v[72:75], v[32:35]
    ds_read2_b32 v[72:73], v204 offset0:64 offset1:65
    ds_read2_b32 v[74:75], v204 offset0:66 offset1:67
    v_mfma_f32_16x16x32_bf16 v[60:63], v[128:131], v[76:79], v[60:63]
    ds_read_b128 v[128:131], v24 offset:6144
    v_mfma_f32_16x16x32_bf16 v[56:59], v[124:127], v[76:79], v[56:59]
    v_mfma_f32_16x16x32_bf16 v[52:55], v[120:123], v[76:79], v[52:55]
    v_mfma_f32_16x16x32_bf16 v[48:51], v[116:119], v[76:79], v[48:51]
    v_mfma_f32_16x16x32_bf16 v[44:47], v[112:115], v[76:79], v[44:47]
    v_mfma_f32_16x16x32_bf16 v[40:43], v[108:111], v[76:79], v[40:43]
    v_mfma_f32_16x16x32_bf16 v[36:39], v[104:107], v[76:79], v[36:39]
    ds_read2_b32 v[76:77], v204 offset0:192 offset1:193
    ds_read2_b32 v[78:79], v204 offset0:194 offset1:195
    v_mfma_f32_16x16x32_bf16 v[60:63], v[124:127], v[80:83], v[60:63]
    ds_read_b128 v[124:127], v24 offset:10240
    v_mfma_f32_16x16x32_bf16 v[56:59], v[120:123], v[80:83], v[56:59]
    v_mfma_f32_16x16x32_bf16 v[52:55], v[116:119], v[80:83], v[52:55]
    v_mfma_f32_16x16x32_bf16 v[48:51], v[112:115], v[80:83], v[48:51]
    v_mfma_f32_16x16x32_bf16 v[44:47], v[108:111], v[80:83], v[44:47]
    v_mfma_f32_16x16x32_bf16 v[40:43], v[104:107], v[80:83], v[40:43]
    ds_read2_b32 v[80:81], v205 offset0:64 offset1:65
    ds_read2_b32 v[82:83], v205 offset0:66 offset1:67
    v_mfma_f32_16x16x32_bf16 v[60:63], v[120:123], v[84:87], v[60:63]
    ds_read_b128 v[120:123], v24 offset:14336
    v_mfma_f32_16x16x32_bf16 v[56:59], v[116:119], v[84:87], v[56:59]
    v_mfma_f32_16x16x32_bf16 v[52:55], v[112:115], v[84:87], v[52:55]
    v_mfma_f32_16x16x32_bf16 v[48:51], v[108:111], v[84:87], v[48:51]
    v_mfma_f32_16x16x32_bf16 v[44:47], v[104:107], v[84:87], v[44:47]
    ds_read2_b32 v[84:85], v205 offset0:192 offset1:193
    ds_read2_b32 v[86:87], v205 offset0:194 offset1:195
    v_mfma_f32_16x16x32_bf16 v[60:63], v[116:119], v[88:91], v[60:63]
    ds_read_b128 v[116:119], v24 offset:18432
    v_mfma_f32_16x16x32_bf16 v[56:59], v[112:115], v[88:91], v[56:59]
    v_mfma_f32_16x16x32_bf16 v[52:55], v[108:111], v[88:91], v[52:55]
    v_mfma_f32_16x16x32_bf16 v[48:51], v[104:107], v[88:91], v[48:51]
    ds_read2_b32 v[88:89], v206 offset0:64 offset1:65
    ds_read2_b32 v[90:91], v206 offset0:66 offset1:67
    v_mfma_f32_16x16x32_bf16 v[60:63], v[112:115], v[92:95], v[60:63]
    ds_read_b128 v[112:115], v24 offset:22528
    v_mfma_f32_16x16x32_bf16 v[56:59], v[108:111], v[92:95], v[56:59]
    v_mfma_f32_16x16x32_bf16 v[52:55], v[104:107], v[92:95], v[52:55]
    ds_read2_b32 v[92:93], v206 offset0:192 offset1:193
    ds_read2_b32 v[94:95], v206 offset0:194 offset1:195
    v_mfma_f32_16x16x32_bf16 v[60:63], v[108:111], v[96:99], v[60:63]
    ds_read_b128 v[108:111], v24 offset:26624
    v_mfma_f32_16x16x32_bf16 v[56:59], v[104:107], v[96:99], v[56:59]
    ds_read2_b32 v[96:97], v207 offset0:64 offset1:65
    ds_read2_b32 v[98:99], v207 offset0:66 offset1:67
    s_waitcnt lgkmcnt(15)
    v_mfma_f32_16x16x32_bf16 v[60:63], v[104:107], v[100:103], v[60:63]
    ds_read_b128 v[104:107], v24 offset:30720
    ds_read2_b32 v[100:101], v207 offset0:192 offset1:193
    ds_read2_b32 v[102:103], v207 offset0:194 offset1:195
    s_waitcnt vmcnt(0)
    s_barrier
    v_mov_b32 v28, 63
    v_lshlrev_b32 v29, 2, v0
    v_and_b32 v29, 127, v29
    s_mov_b64 exec, s[100:101]
    buffer_store_dword v28, v29, s[92:95], s2 offen sc0 sc1
    s_mov_b64 exec, -1
    v_mfma_f32_16x16x32_bf16 v[60:63], v[132:135], v[72:75], v[60:63]
    ds_read_b128 v[132:135], v25 offset:2048
    s_lshl_b32 s34, s22, 6
    v_mfma_f32_16x16x32_bf16 v[56:59], v[128:131], v[72:75], v[56:59]
    s_add_u32 s35, s34, 33026
    s_waitcnt lgkmcnt(15)
    v_mfma_f32_16x16x32_bf16 v[52:55], v[124:127], v[72:75], v[52:55]
    v_add_u32 v208, s35, v222
    v_mfma_f32_16x16x32_bf16 v[48:51], v[120:123], v[72:75], v[48:51]
    v_add_u32 v209, 1024, v208
    s_waitcnt lgkmcnt(12)
    v_mfma_f32_16x16x32_bf16 v[44:47], v[116:119], v[72:75], v[44:47]
    v_add_u32 v210, 2048, v208
    s_waitcnt lgkmcnt(9)
    v_mfma_f32_16x16x32_bf16 v[40:43], v[112:115], v[72:75], v[40:43]
    v_add_u32 v211, 3072, v208
    s_waitcnt lgkmcnt(6)
    v_mfma_f32_16x16x32_bf16 v[36:39], v[108:111], v[72:75], v[36:39]
    v_lshlrev_b32 v213, 5, v4
    s_waitcnt lgkmcnt(3)
    v_mfma_f32_16x16x32_bf16 v[32:35], v[104:107], v[72:75], v[32:35]
    ds_read2_b32 v[72:73], v204 offset0:80 offset1:81
    ds_read2_b32 v[74:75], v204 offset0:82 offset1:83
    v_lshlrev_b32 v214, 4, v3
    v_mfma_f32_16x16x32_bf16 v[60:63], v[128:131], v[76:79], v[60:63]
    ds_read_b128 v[128:131], v25 offset:6144
    v_sub_u32 v214, v214, v213
    v_mfma_f32_16x16x32_bf16 v[56:59], v[124:127], v[76:79], v[56:59]
    s_add_u32 s34, s34, 111456
    v_mfma_f32_16x16x32_bf16 v[52:55], v[120:123], v[76:79], v[52:55]
    v_add_u32 v220, s34, v214
    v_mfma_f32_16x16x32_bf16 v[48:51], v[116:119], v[76:79], v[48:51]
    v_lshl_add_u32 v221, v2, 3, s32
    v_mfma_f32_16x16x32_bf16 v[44:47], v[112:115], v[76:79], v[44:47]
    v_lshl_add_u32 v213, v3, 3, v4
    v_mfma_f32_16x16x32_bf16 v[40:43], v[108:111], v[76:79], v[40:43]
    v_sub_u32 v213, 15, v213
    v_mfma_f32_16x16x32_bf16 v[36:39], v[104:107], v[76:79], v[36:39]
    ds_read2_b32 v[76:77], v204 offset0:208 offset1:209
    ds_read2_b32 v[78:79], v204 offset0:210 offset1:211
    v_and_b32 v214, 1, v213
    v_mfma_f32_16x16x32_bf16 v[60:63], v[124:127], v[80:83], v[60:63]
    ds_read_b128 v[124:127], v25 offset:10240
    v_lshlrev_b32 v214, 4, v214
    v_mfma_f32_16x16x32_bf16 v[56:59], v[120:123], v[80:83], v[56:59]
    v_lshrrev_b32 v213, 1, v213
    v_mfma_f32_16x16x32_bf16 v[52:55], v[116:119], v[80:83], v[52:55]
    s_and_b32 s34, s22, 1
    v_mfma_f32_16x16x32_bf16 v[48:51], v[112:115], v[80:83], v[48:51]
    s_lshl_b32 s34, s34, 4
    v_mfma_f32_16x16x32_bf16 v[44:47], v[108:111], v[80:83], v[44:47]
    s_lshr_b32 s60, s60, s34
    v_mfma_f32_16x16x32_bf16 v[40:43], v[104:107], v[80:83], v[40:43]
    ds_read2_b32 v[80:81], v205 offset0:80 offset1:81
    ds_read2_b32 v[82:83], v205 offset0:82 offset1:83
    s_and_b32 s60, s60, 0xffff
    v_mfma_f32_16x16x32_bf16 v[60:63], v[120:123], v[84:87], v[60:63]
    ds_read_b128 v[120:123], v25 offset:14336
    s_and_b32 s34, s78, 1
    v_mfma_f32_16x16x32_bf16 v[56:59], v[116:119], v[84:87], v[56:59]
    s_lshl_b32 s34, s34, 4
    v_mfma_f32_16x16x32_bf16 v[52:55], v[112:115], v[84:87], v[52:55]
    s_lshr_b32 s61, s61, s34
    v_mfma_f32_16x16x32_bf16 v[48:51], v[108:111], v[84:87], v[48:51]
    s_and_b32 s61, s61, 0xffff
    v_mfma_f32_16x16x32_bf16 v[44:47], v[104:107], v[84:87], v[44:47]
    ds_read2_b32 v[84:85], v205 offset0:208 offset1:209
    ds_read2_b32 v[86:87], v205 offset0:210 offset1:211
    s_cmp_eq_u32 s22, 0
    v_mfma_f32_16x16x32_bf16 v[60:63], v[116:119], v[88:91], v[60:63]
    ds_read_b128 v[116:119], v25 offset:18432
    s_cselect_b32 s61, s61, 0
    v_mfma_f32_16x16x32_bf16 v[56:59], v[112:115], v[88:91], v[56:59]
    v_lshlrev_b32 v215, v214, s60
    v_mfma_f32_16x16x32_bf16 v[52:55], v[108:111], v[88:91], v[52:55]
    v_lshlrev_b32 v214, v214, s61
    v_mfma_f32_16x16x32_bf16 v[48:51], v[104:107], v[88:91], v[48:51]
    ds_read2_b32 v[88:89], v206 offset0:80 offset1:81
    ds_read2_b32 v[90:91], v206 offset0:82 offset1:83
    v_mfma_f32_16x16x32_bf16 v[60:63], v[112:115], v[92:95], v[60:63]
    ds_read_b128 v[112:115], v25 offset:22528
    v_mfma_f32_16x16x32_bf16 v[56:59], v[108:111], v[92:95], v[56:59]
    v_mfma_f32_16x16x32_bf16 v[52:55], v[104:107], v[92:95], v[52:55]
    ds_read2_b32 v[92:93], v206 offset0:208 offset1:209
    ds_read2_b32 v[94:95], v206 offset0:210 offset1:211
    v_mfma_f32_16x16x32_bf16 v[60:63], v[108:111], v[96:99], v[60:63]
    ds_read_b128 v[108:111], v25 offset:26624
    v_mfma_f32_16x16x32_bf16 v[56:59], v[104:107], v[96:99], v[56:59]
    ds_read2_b32 v[96:97], v207 offset0:80 offset1:81
    ds_read2_b32 v[98:99], v207 offset0:82 offset1:83
    s_waitcnt lgkmcnt(15)
    v_mfma_f32_16x16x32_bf16 v[60:63], v[104:107], v[100:103], v[60:63]
    ds_read_b128 v[104:107], v25 offset:30720
    ds_read2_b32 v[100:101], v207 offset0:208 offset1:209
    ds_read2_b32 v[102:103], v207 offset0:210 offset1:211
    v_mfma_f32_16x16x32_bf16 v[60:63], v[132:135], v[72:75], v[60:63]
    ds_read_b128 v[132:135], v26 offset:2048
    v_cmp_eq_u32 vcc, 0, v213
    v_mfma_f32_16x16x32_bf16 v[56:59], v[128:131], v[72:75], v[56:59]
    s_waitcnt lgkmcnt(15)
    v_mfma_f32_16x16x32_bf16 v[52:55], v[124:127], v[72:75], v[52:55]
    v_cndmask_b32 v168, 0, v215, vcc
    v_mfma_f32_16x16x32_bf16 v[48:51], v[120:123], v[72:75], v[48:51]
    v_cndmask_b32 v172, 0, v214, vcc
    s_waitcnt lgkmcnt(12)
    v_mfma_f32_16x16x32_bf16 v[44:47], v[116:119], v[72:75], v[44:47]
    v_cmp_eq_u32 vcc, 1, v213
    s_waitcnt lgkmcnt(9)
    v_mfma_f32_16x16x32_bf16 v[40:43], v[112:115], v[72:75], v[40:43]
    s_waitcnt lgkmcnt(6)
    v_mfma_f32_16x16x32_bf16 v[36:39], v[108:111], v[72:75], v[36:39]
    v_cndmask_b32 v169, 0, v215, vcc
    s_waitcnt lgkmcnt(3)
    v_mfma_f32_16x16x32_bf16 v[32:35], v[104:107], v[72:75], v[32:35]
    ds_read2_b32 v[72:73], v204 offset0:96 offset1:97
    ds_read2_b32 v[74:75], v204 offset0:98 offset1:99
    v_cndmask_b32 v173, 0, v214, vcc
    v_mfma_f32_16x16x32_bf16 v[60:63], v[128:131], v[76:79], v[60:63]
    ds_read_b128 v[128:131], v26 offset:6144
    v_cmp_eq_u32 vcc, 2, v213
    v_mfma_f32_16x16x32_bf16 v[56:59], v[124:127], v[76:79], v[56:59]
    v_mfma_f32_16x16x32_bf16 v[52:55], v[120:123], v[76:79], v[52:55]
    v_cndmask_b32 v170, 0, v215, vcc
    v_mfma_f32_16x16x32_bf16 v[48:51], v[116:119], v[76:79], v[48:51]
    v_cndmask_b32 v174, 0, v214, vcc
    v_mfma_f32_16x16x32_bf16 v[44:47], v[112:115], v[76:79], v[44:47]
    v_cmp_eq_u32 vcc, 3, v213
    v_mfma_f32_16x16x32_bf16 v[40:43], v[108:111], v[76:79], v[40:43]
    v_mfma_f32_16x16x32_bf16 v[36:39], v[104:107], v[76:79], v[36:39]
    ds_read2_b32 v[76:77], v204 offset0:224 offset1:225
    ds_read2_b32 v[78:79], v204 offset0:226 offset1:227
    v_cndmask_b32 v171, 0, v215, vcc
    v_mfma_f32_16x16x32_bf16 v[60:63], v[124:127], v[80:83], v[60:63]
    ds_read_b128 v[124:127], v26 offset:10240
    v_cndmask_b32 v175, 0, v214, vcc
    v_mfma_f32_16x16x32_bf16 v[56:59], v[120:123], v[80:83], v[56:59]
    s_add_u32 s16, s6, 20971520
    v_mfma_f32_16x16x32_bf16 v[52:55], v[116:119], v[80:83], v[52:55]
    s_addc_u32 s17, s7, 0
    v_mfma_f32_16x16x32_bf16 v[48:51], v[112:115], v[80:83], v[48:51]
    s_and_b32 s17, s17, 0xffff
    v_mfma_f32_16x16x32_bf16 v[44:47], v[108:111], v[80:83], v[44:47]
    s_mov_b32 s18, 10493952
    v_mfma_f32_16x16x32_bf16 v[40:43], v[104:107], v[80:83], v[40:43]
    ds_read2_b32 v[80:81], v205 offset0:96 offset1:97
    ds_read2_b32 v[82:83], v205 offset0:98 offset1:99
    s_mov_b32 s19, 0x00020000
    v_mfma_f32_16x16x32_bf16 v[60:63], v[120:123], v[84:87], v[60:63]
    ds_read_b128 v[120:123], v26 offset:14336
    v_mfma_f32_16x16x32_bf16 v[56:59], v[116:119], v[84:87], v[56:59]
    v_mfma_f32_16x16x32_bf16 v[52:55], v[112:115], v[84:87], v[52:55]
    v_mfma_f32_16x16x32_bf16 v[48:51], v[108:111], v[84:87], v[48:51]
    v_mfma_f32_16x16x32_bf16 v[44:47], v[104:107], v[84:87], v[44:47]
    ds_read2_b32 v[84:85], v205 offset0:224 offset1:225
    ds_read2_b32 v[86:87], v205 offset0:226 offset1:227
    v_mfma_f32_16x16x32_bf16 v[60:63], v[116:119], v[88:91], v[60:63]
    ds_read_b128 v[116:119], v26 offset:18432
    v_mfma_f32_16x16x32_bf16 v[56:59], v[112:115], v[88:91], v[56:59]
    v_mfma_f32_16x16x32_bf16 v[52:55], v[108:111], v[88:91], v[52:55]
    v_mfma_f32_16x16x32_bf16 v[48:51], v[104:107], v[88:91], v[48:51]
    ds_read2_b32 v[88:89], v206 offset0:96 offset1:97
    ds_read2_b32 v[90:91], v206 offset0:98 offset1:99
    v_mfma_f32_16x16x32_bf16 v[60:63], v[112:115], v[92:95], v[60:63]
    ds_read_b128 v[112:115], v26 offset:22528
    v_mfma_f32_16x16x32_bf16 v[56:59], v[108:111], v[92:95], v[56:59]
    v_mfma_f32_16x16x32_bf16 v[52:55], v[104:107], v[92:95], v[52:55]
    ds_read2_b32 v[92:93], v206 offset0:224 offset1:225
    ds_read2_b32 v[94:95], v206 offset0:226 offset1:227
    v_mfma_f32_16x16x32_bf16 v[60:63], v[108:111], v[96:99], v[60:63]
    ds_read_b128 v[108:111], v26 offset:26624
    v_mfma_f32_16x16x32_bf16 v[56:59], v[104:107], v[96:99], v[56:59]
    ds_read2_b32 v[96:97], v207 offset0:96 offset1:97
    ds_read2_b32 v[98:99], v207 offset0:98 offset1:99
    s_waitcnt lgkmcnt(15)
    v_mfma_f32_16x16x32_bf16 v[60:63], v[104:107], v[100:103], v[60:63]
    ds_read_b128 v[104:107], v26 offset:30720
    ds_read2_b32 v[100:101], v207 offset0:224 offset1:225
    ds_read2_b32 v[102:103], v207 offset0:226 offset1:227
    v_mfma_f32_16x16x32_bf16 v[60:63], v[132:135], v[72:75], v[60:63]
    ds_read_b128 v[132:135], v27 offset:2048
    v_mfma_f32_16x16x32_bf16 v[56:59], v[128:131], v[72:75], v[56:59]
    s_waitcnt lgkmcnt(15)
    v_mfma_f32_16x16x32_bf16 v[52:55], v[124:127], v[72:75], v[52:55]
    v_mfma_f32_16x16x32_bf16 v[48:51], v[120:123], v[72:75], v[48:51]
    s_waitcnt lgkmcnt(12)
    v_mfma_f32_16x16x32_bf16 v[44:47], v[116:119], v[72:75], v[44:47]
    s_waitcnt lgkmcnt(9)
    v_mfma_f32_16x16x32_bf16 v[40:43], v[112:115], v[72:75], v[40:43]
    s_waitcnt lgkmcnt(6)
    v_mfma_f32_16x16x32_bf16 v[36:39], v[108:111], v[72:75], v[36:39]
    s_waitcnt lgkmcnt(3)
    v_mfma_f32_16x16x32_bf16 v[32:35], v[104:107], v[72:75], v[32:35]
    ds_read2_b32 v[72:73], v204 offset0:112 offset1:113
    ds_read2_b32 v[74:75], v204 offset0:114 offset1:115
    v_mfma_f32_16x16x32_bf16 v[60:63], v[128:131], v[76:79], v[60:63]
    ds_read_b128 v[128:131], v27 offset:6144
    v_mfma_f32_16x16x32_bf16 v[56:59], v[124:127], v[76:79], v[56:59]
    v_mfma_f32_16x16x32_bf16 v[52:55], v[120:123], v[76:79], v[52:55]
    v_mfma_f32_16x16x32_bf16 v[48:51], v[116:119], v[76:79], v[48:51]
    v_mfma_f32_16x16x32_bf16 v[44:47], v[112:115], v[76:79], v[44:47]
    v_mfma_f32_16x16x32_bf16 v[40:43], v[108:111], v[76:79], v[40:43]
    v_mfma_f32_16x16x32_bf16 v[36:39], v[104:107], v[76:79], v[36:39]
    ds_read2_b32 v[76:77], v204 offset0:240 offset1:241
    ds_read2_b32 v[78:79], v204 offset0:242 offset1:243
    v_mfma_f32_16x16x32_bf16 v[60:63], v[124:127], v[80:83], v[60:63]
    ds_read_b128 v[124:127], v27 offset:10240
    v_mfma_f32_16x16x32_bf16 v[56:59], v[120:123], v[80:83], v[56:59]
    v_mfma_f32_16x16x32_bf16 v[52:55], v[116:119], v[80:83], v[52:55]
    v_mfma_f32_16x16x32_bf16 v[48:51], v[112:115], v[80:83], v[48:51]
    v_mfma_f32_16x16x32_bf16 v[44:47], v[108:111], v[80:83], v[44:47]
    v_mfma_f32_16x16x32_bf16 v[40:43], v[104:107], v[80:83], v[40:43]
    ds_read2_b32 v[80:81], v205 offset0:112 offset1:113
    ds_read2_b32 v[82:83], v205 offset0:114 offset1:115
    v_mfma_f32_16x16x32_bf16 v[60:63], v[120:123], v[84:87], v[60:63]
    ds_read_b128 v[120:123], v27 offset:14336
    v_mfma_f32_16x16x32_bf16 v[56:59], v[116:119], v[84:87], v[56:59]
    v_mfma_f32_16x16x32_bf16 v[52:55], v[112:115], v[84:87], v[52:55]
    v_mfma_f32_16x16x32_bf16 v[48:51], v[108:111], v[84:87], v[48:51]
    v_mfma_f32_16x16x32_bf16 v[44:47], v[104:107], v[84:87], v[44:47]
    ds_read2_b32 v[84:85], v205 offset0:240 offset1:241
    ds_read2_b32 v[86:87], v205 offset0:242 offset1:243
    v_mfma_f32_16x16x32_bf16 v[60:63], v[116:119], v[88:91], v[60:63]
    ds_read_b128 v[116:119], v27 offset:18432
    v_mfma_f32_16x16x32_bf16 v[56:59], v[112:115], v[88:91], v[56:59]
    v_mfma_f32_16x16x32_bf16 v[52:55], v[108:111], v[88:91], v[52:55]
    v_mfma_f32_16x16x32_bf16 v[48:51], v[104:107], v[88:91], v[48:51]
    ds_read2_b32 v[88:89], v206 offset0:112 offset1:113
    ds_read2_b32 v[90:91], v206 offset0:114 offset1:115
    v_mfma_f32_16x16x32_bf16 v[60:63], v[112:115], v[92:95], v[60:63]
    ds_read_b128 v[112:115], v27 offset:22528
    v_mfma_f32_16x16x32_bf16 v[56:59], v[108:111], v[92:95], v[56:59]
    v_mfma_f32_16x16x32_bf16 v[52:55], v[104:107], v[92:95], v[52:55]
    ds_read2_b32 v[92:93], v206 offset0:240 offset1:241
    ds_read2_b32 v[94:95], v206 offset0:242 offset1:243
    v_mfma_f32_16x16x32_bf16 v[60:63], v[108:111], v[96:99], v[60:63]
    ds_read_b128 v[108:111], v27 offset:26624
    v_mfma_f32_16x16x32_bf16 v[56:59], v[104:107], v[96:99], v[56:59]
    ds_read2_b32 v[96:97], v207 offset0:112 offset1:113
    ds_read2_b32 v[98:99], v207 offset0:114 offset1:115
    s_waitcnt lgkmcnt(15)
    v_mfma_f32_16x16x32_bf16 v[60:63], v[104:107], v[100:103], v[60:63]
    ds_read_b128 v[104:107], v27 offset:30720
    ds_read2_b32 v[100:101], v207 offset0:240 offset1:241
    ds_read2_b32 v[102:103], v207 offset0:242 offset1:243
    v_mfma_f32_16x16x32_bf16 v[60:63], v[132:135], v[72:75], v[60:63]
    ds_read_b128 v[132:135], v24 offset:0
    s_bitcmp1_b32 s78, 1
    s_cselect_b32 s42, 16512, 0
    s_cselect_b32 s43, 0, 16512
    v_mfma_f32_16x16x32_bf16 v[56:59], v[128:131], v[72:75], v[56:59]
    s_add_u32 s42, s42, 0
    s_waitcnt lgkmcnt(15)
    v_mfma_f32_16x16x32_bf16 v[52:55], v[124:127], v[72:75], v[52:55]
    s_add_u32 s43, s43, 0
    v_mfma_f32_16x16x32_bf16 v[48:51], v[120:123], v[72:75], v[48:51]
    v_lshl_add_u32 v212, v0, 3, s42
    s_waitcnt lgkmcnt(12)
    v_mfma_f32_16x16x32_bf16 v[44:47], v[116:119], v[72:75], v[44:47]
    v_lshl_add_u32 v213, v0, 3, s43
    s_waitcnt lgkmcnt(9)
    v_mfma_f32_16x16x32_bf16 v[40:43], v[112:115], v[72:75], v[40:43]
    s_mov_b32 s56, 0x05040100
    s_waitcnt lgkmcnt(6)
    v_mfma_f32_16x16x32_bf16 v[36:39], v[108:111], v[72:75], v[36:39]
    s_mov_b32 s57, 0x07060302
    s_waitcnt lgkmcnt(3)
    v_mfma_f32_16x16x32_bf16 v[32:35], v[104:107], v[72:75], v[32:35]
    ds_read2_b32 v[72:73], v204 offset0:0 offset1:1
    ds_read2_b32 v[74:75], v204 offset0:2 offset1:3
    s_mul_i32 s58, s77, 40960
    v_mfma_f32_16x16x32_bf16 v[60:63], v[128:131], v[76:79], v[60:63]
    ds_read_b128 v[128:131], v24 offset:4096
    s_lshl_b32 s59, s22, 9
    v_mfma_f32_16x16x32_bf16 v[56:59], v[124:127], v[76:79], v[56:59]
    s_add_u32 s59, s59, s58
    v_mfma_f32_16x16x32_bf16 v[52:55], v[120:123], v[76:79], v[52:55]
    s_add_u32 s59, s59, 32768
    v_mfma_f32_16x16x32_bf16 v[48:51], v[116:119], v[76:79], v[48:51]
    s_lshl_b32 s60, s22, 12
    v_mfma_f32_16x16x32_bf16 v[44:47], v[112:115], v[76:79], v[44:47]
    s_add_u32 s58, s58, s60
    v_mfma_f32_16x16x32_bf16 v[40:43], v[108:111], v[76:79], v[40:43]
    v_lshlrev_b32 v21, 3, v2
    v_mfma_f32_16x16x32_bf16 v[36:39], v[104:107], v[76:79], v[36:39]
    ds_read2_b32 v[76:77], v204 offset0:128 offset1:129
    ds_read2_b32 v[78:79], v204 offset0:130 offset1:131
    s_add_u32 s34, s32, 37184
    v_mfma_f32_16x16x32_bf16 v[60:63], v[124:127], v[80:83], v[60:63]
    ds_read_b128 v[124:127], v24 offset:8192
    v_add_u32 v17, s34, v5
    v_mfma_f32_16x16x32_bf16 v[56:59], v[120:123], v[80:83], v[56:59]
    v_add_u32 v18, 78400, v17
    v_mfma_f32_16x16x32_bf16 v[52:55], v[116:119], v[80:83], v[52:55]
    v_mfma_f32_16x16x32_bf16 v[48:51], v[112:115], v[80:83], v[48:51]
    v_mfma_f32_16x16x32_bf16 v[44:47], v[108:111], v[80:83], v[44:47]
    v_mfma_f32_16x16x32_bf16 v[40:43], v[104:107], v[80:83], v[40:43]
    ds_read2_b32 v[80:81], v205 offset0:0 offset1:1
    ds_read2_b32 v[82:83], v205 offset0:2 offset1:3
    v_mfma_f32_16x16x32_bf16 v[60:63], v[120:123], v[84:87], v[60:63]
    ds_read_b128 v[120:123], v24 offset:12288
    v_mfma_f32_16x16x32_bf16 v[56:59], v[116:119], v[84:87], v[56:59]
    v_mfma_f32_16x16x32_bf16 v[52:55], v[112:115], v[84:87], v[52:55]
    v_mfma_f32_16x16x32_bf16 v[48:51], v[108:111], v[84:87], v[48:51]
    v_mfma_f32_16x16x32_bf16 v[44:47], v[104:107], v[84:87], v[44:47]
    ds_read2_b32 v[84:85], v205 offset0:128 offset1:129
    ds_read2_b32 v[86:87], v205 offset0:130 offset1:131
    v_mfma_f32_16x16x32_bf16 v[60:63], v[116:119], v[88:91], v[60:63]
    ds_read_b128 v[116:119], v24 offset:16384
    v_mfma_f32_16x16x32_bf16 v[56:59], v[112:115], v[88:91], v[56:59]
    v_mfma_f32_16x16x32_bf16 v[52:55], v[108:111], v[88:91], v[52:55]
    v_mfma_f32_16x16x32_bf16 v[48:51], v[104:107], v[88:91], v[48:51]
    ds_read2_b32 v[88:89], v206 offset0:0 offset1:1
    ds_read2_b32 v[90:91], v206 offset0:2 offset1:3
    v_mfma_f32_16x16x32_bf16 v[60:63], v[112:115], v[92:95], v[60:63]
    ds_read_b128 v[112:115], v24 offset:20480
    v_mfma_f32_16x16x32_bf16 v[56:59], v[108:111], v[92:95], v[56:59]
    v_mfma_f32_16x16x32_bf16 v[52:55], v[104:107], v[92:95], v[52:55]
    ds_read2_b32 v[92:93], v206 offset0:128 offset1:129
    ds_read2_b32 v[94:95], v206 offset0:130 offset1:131
    v_mfma_f32_16x16x32_bf16 v[60:63], v[108:111], v[96:99], v[60:63]
    ds_read_b128 v[108:111], v24 offset:24576
    v_mfma_f32_16x16x32_bf16 v[56:59], v[104:107], v[96:99], v[56:59]
    ds_read2_b32 v[96:97], v207 offset0:0 offset1:1
    ds_read2_b32 v[98:99], v207 offset0:2 offset1:3
    s_waitcnt lgkmcnt(15)
    v_mfma_f32_16x16x32_bf16 v[60:63], v[104:107], v[100:103], v[60:63]
    ds_read_b128 v[104:107], v24 offset:28672
    ds_read2_b32 v[100:101], v207 offset0:128 offset1:129
    ds_read2_b32 v[102:103], v207 offset0:130 offset1:131
    v_mfma_f32_16x16x32_bf16 v[60:63], v[132:135], v[168:171], v[60:63]
    v_mfma_f32_16x16x32_bf16 v[56:59], v[128:131], v[168:171], v[56:59]
    s_waitcnt lgkmcnt(15)
    v_mfma_f32_16x16x32_bf16 v[52:55], v[124:127], v[168:171], v[52:55]
    s_waitcnt lgkmcnt(14)
    v_mfma_f32_16x16x32_bf16 v[48:51], v[120:123], v[168:171], v[48:51]
    s_waitcnt lgkmcnt(11)
    v_mfma_f32_16x16x32_bf16 v[44:47], v[116:119], v[168:171], v[44:47]
    s_waitcnt lgkmcnt(8)
    v_mfma_f32_16x16x32_bf16 v[40:43], v[112:115], v[168:171], v[40:43]
    s_waitcnt lgkmcnt(5)
    v_mfma_f32_16x16x32_bf16 v[36:39], v[108:111], v[168:171], v[36:39]
    s_waitcnt lgkmcnt(2)
    v_mfma_f32_16x16x32_bf16 v[32:35], v[104:107], v[168:171], v[32:35]
    v_mfma_f32_16x16x32_bf16 v[60:63], v[132:135], v[72:75], v[60:63]
    ds_read_b128 v[132:135], v220 offset:0
    v_mfma_f32_16x16x32_bf16 v[56:59], v[128:131], v[72:75], v[56:59]
    v_mfma_f32_16x16x32_bf16 v[52:55], v[124:127], v[72:75], v[52:55]
    v_mfma_f32_16x16x32_bf16 v[48:51], v[120:123], v[72:75], v[48:51]
    v_mfma_f32_16x16x32_bf16 v[44:47], v[116:119], v[72:75], v[44:47]
    v_mfma_f32_16x16x32_bf16 v[40:43], v[112:115], v[72:75], v[40:43]
    v_mfma_f32_16x16x32_bf16 v[36:39], v[108:111], v[72:75], v[36:39]
    v_mfma_f32_16x16x32_bf16 v[32:35], v[104:107], v[72:75], v[32:35]
    ds_read2_b32 v[72:73], v208 offset0:0 offset1:1
    ds_read2_b32 v[74:75], v208 offset0:2 offset1:3
    v_mfma_f32_16x16x32_bf16 v[60:63], v[128:131], v[76:79], v[60:63]
    ds_read_b128 v[128:131], v220 offset:512
    v_mfma_f32_16x16x32_bf16 v[56:59], v[124:127], v[76:79], v[56:59]
    v_mfma_f32_16x16x32_bf16 v[52:55], v[120:123], v[76:79], v[52:55]
    v_cvt_pk_bf16_f32 v176, v32, v33
    v_mfma_f32_16x16x32_bf16 v[48:51], v[116:119], v[76:79], v[48:51]
    v_cvt_pk_bf16_f32 v177, v34, v35
    v_mfma_f32_16x16x32_bf16 v[44:47], v[112:115], v[76:79], v[44:47]
    ds_write_b64 v221, v[176:177] offset:0
    v_mfma_f32_16x16x32_bf16 v[40:43], v[108:111], v[76:79], v[40:43]
    v_mfma_f32_16x16x32_bf16 v[36:39], v[104:107], v[76:79], v[36:39]
    ds_read2_b32 v[76:77], v208 offset0:128 offset1:129
    ds_read2_b32 v[78:79], v208 offset0:130 offset1:131
    v_mfma_f32_16x16x32_bf16 v[60:63], v[124:127], v[80:83], v[60:63]
    ds_read_b128 v[124:127], v220 offset:1024
    v_mfma_f32_16x16x32_bf16 v[56:59], v[120:123], v[80:83], v[56:59]
    v_mfma_f32_16x16x32_bf16 v[52:55], v[116:119], v[80:83], v[52:55]
    v_cvt_pk_bf16_f32 v178, v36, v37
    v_mfma_f32_16x16x32_bf16 v[48:51], v[112:115], v[80:83], v[48:51]
    v_cvt_pk_bf16_f32 v179, v38, v39
    v_mfma_f32_16x16x32_bf16 v[44:47], v[108:111], v[80:83], v[44:47]
    ds_write_b64 v221, v[178:179] offset:512
    v_mfma_f32_16x16x32_bf16 v[40:43], v[104:107], v[80:83], v[40:43]
    ds_read2_b32 v[80:81], v209 offset0:0 offset1:1
    ds_read2_b32 v[82:83], v209 offset0:2 offset1:3
    v_mfma_f32_16x16x32_bf16 v[60:63], v[120:123], v[84:87], v[60:63]
    ds_read_b128 v[120:123], v220 offset:1536
    v_mfma_f32_16x16x32_bf16 v[56:59], v[116:119], v[84:87], v[56:59]
    v_mfma_f32_16x16x32_bf16 v[52:55], v[112:115], v[84:87], v[52:55]
    v_cvt_pk_bf16_f32 v180, v40, v41
    v_mfma_f32_16x16x32_bf16 v[48:51], v[108:111], v[84:87], v[48:51]
    v_cvt_pk_bf16_f32 v181, v42, v43
    v_mfma_f32_16x16x32_bf16 v[44:47], v[104:107], v[84:87], v[44:47]
    ds_read2_b32 v[84:85], v209 offset0:128 offset1:129
    ds_read2_b32 v[86:87], v209 offset0:130 offset1:131
    ds_write_b64 v221, v[180:181] offset:1024
    v_mfma_f32_16x16x32_bf16 v[60:63], v[116:119], v[88:91], v[60:63]
    ds_read_b128 v[116:119], v220 offset:2048
    v_mfma_f32_16x16x32_bf16 v[56:59], v[112:115], v[88:91], v[56:59]
    v_mfma_f32_16x16x32_bf16 v[52:55], v[108:111], v[88:91], v[52:55]
    v_cvt_pk_bf16_f32 v182, v44, v45
    v_mfma_f32_16x16x32_bf16 v[48:51], v[104:107], v[88:91], v[48:51]
    ds_read2_b32 v[88:89], v210 offset0:0 offset1:1
    ds_read2_b32 v[90:91], v210 offset0:2 offset1:3
    v_cvt_pk_bf16_f32 v183, v46, v47
    v_mfma_f32_16x16x32_bf16 v[60:63], v[112:115], v[92:95], v[60:63]
    ds_read_b128 v[112:115], v220 offset:2560
    ds_write_b64 v221, v[182:183] offset:1536
    v_mfma_f32_16x16x32_bf16 v[56:59], v[108:111], v[92:95], v[56:59]
    v_mfma_f32_16x16x32_bf16 v[52:55], v[104:107], v[92:95], v[52:55]
    ds_read2_b32 v[92:93], v210 offset0:128 offset1:129
    ds_read2_b32 v[94:95], v210 offset0:130 offset1:131
    v_cvt_pk_bf16_f32 v184, v48, v49
    v_mfma_f32_16x16x32_bf16 v[60:63], v[108:111], v[96:99], v[60:63]
    ds_read_b128 v[108:111], v220 offset:3072
    v_cvt_pk_bf16_f32 v185, v50, v51
    v_mfma_f32_16x16x32_bf16 v[56:59], v[104:107], v[96:99], v[56:59]
    ds_read2_b32 v[96:97], v211 offset0:0 offset1:1
    ds_read2_b32 v[98:99], v211 offset0:2 offset1:3
    ds_write_b64 v221, v[184:185] offset:2048
    s_waitcnt lgkmcnt(15)
    v_mfma_f32_16x16x32_bf16 v[60:63], v[104:107], v[100:103], v[60:63]
    ds_read_b128 v[104:107], v220 offset:3584
    ds_read2_b32 v[100:101], v211 offset0:128 offset1:129
    ds_read2_b32 v[102:103], v211 offset0:130 offset1:131
    v_cvt_pk_bf16_f32 v186, v52, v53
    v_cvt_pk_bf16_f32 v187, v54, v55
    ds_write_b64 v221, v[186:187] offset:2560
    v_mfma_f32_16x16x32_bf16 v[164:167], v[132:135], v[172:175], 0
    v_mfma_f32_16x16x32_bf16 v[160:163], v[128:131], v[172:175], 0
    v_cvt_pk_bf16_f32 v188, v56, v57
    v_cvt_pk_bf16_f32 v189, v58, v59
    ds_write_b64 v221, v[188:189] offset:3072
    v_mfma_f32_16x16x32_bf16 v[156:159], v[124:127], v[172:175], 0
    v_cvt_pk_bf16_f32 v190, v60, v61
    v_cvt_pk_bf16_f32 v191, v62, v63
    ds_write_b64 v221, v[190:191] offset:3584
    s_waitcnt lgkmcnt(15)
    v_mfma_f32_16x16x32_bf16 v[152:155], v[120:123], v[172:175], 0
    v_mfma_f32_16x16x32_bf16 v[148:151], v[116:119], v[172:175], 0
    s_waitcnt lgkmcnt(0)
    s_barrier
    ds_read_b64 v[176:177], v212 offset:0
    ds_read_b64 v[178:179], v212 offset:4128
    ds_read_b64 v[180:181], v212 offset:8256
    ds_read_b64 v[182:183], v212 offset:12384
    v_mfma_f32_16x16x32_bf16 v[144:147], v[112:115], v[172:175], 0
    ds_read_b64 v[184:185], v213 offset:0
    ds_read_b64 v[186:187], v213 offset:4128
    ds_read_b64 v[188:189], v213 offset:8256
    ds_read_b64 v[190:191], v213 offset:12384
    v_mfma_f32_16x16x32_bf16 v[140:143], v[108:111], v[172:175], 0
    v_mfma_f32_16x16x32_bf16 v[136:139], v[104:107], v[172:175], 0
    v_mfma_f32_16x16x32_bf16 v[164:167], v[132:135], v[72:75], v[164:167]
    s_waitcnt lgkmcnt(0)
    v_perm_b32 v32, v178, v176, s56
    v_perm_b32 v33, v182, v180, s56
    v_mfma_f32_16x16x32_bf16 v[160:163], v[128:131], v[72:75], v[160:163]
    v_perm_b32 v34, v186, v184, s56
    v_perm_b32 v35, v190, v188, s56
    v_mfma_f32_16x16x32_bf16 v[156:159], v[124:127], v[72:75], v[156:159]
    v_min_u32 v32, -2, v32
    v_min_u32 v33, -2, v33
    v_mfma_f32_16x16x32_bf16 v[152:155], v[120:123], v[72:75], v[152:155]
    v_min_u32 v34, -2, v34
    v_min_u32 v35, -2, v35
    buffer_store_dwordx4 v[32:35], v5, s[16:19], s58 offen offset:0 sc0 sc1
    v_mfma_f32_16x16x32_bf16 v[148:151], v[116:119], v[72:75], v[148:151]
    v_perm_b32 v36, v178, v176, s57
    v_perm_b32 v37, v182, v180, s57
    v_mfma_f32_16x16x32_bf16 v[144:147], v[112:115], v[72:75], v[144:147]
    v_perm_b32 v38, v186, v184, s57
    v_perm_b32 v39, v190, v188, s57
    v_mfma_f32_16x16x32_bf16 v[140:143], v[108:111], v[72:75], v[140:143]
    v_min_u32 v36, -2, v36
    v_min_u32 v37, -2, v37
    v_mfma_f32_16x16x32_bf16 v[136:139], v[104:107], v[72:75], v[136:139]
    v_min_u32 v38, -2, v38
    v_min_u32 v39, -2, v39
    buffer_store_dwordx4 v[36:39], v5, s[16:19], s58 offen offset:1024 sc0 sc1
    v_mfma_f32_16x16x32_bf16 v[164:167], v[128:131], v[76:79], v[164:167]
    v_perm_b32 v40, v179, v177, s56
    v_perm_b32 v41, v183, v181, s56
    v_mfma_f32_16x16x32_bf16 v[160:163], v[124:127], v[76:79], v[160:163]
    v_perm_b32 v42, v187, v185, s56
    v_perm_b32 v43, v191, v189, s56
    v_mfma_f32_16x16x32_bf16 v[156:159], v[120:123], v[76:79], v[156:159]
    v_min_u32 v40, -2, v40
    v_min_u32 v41, -2, v41
    v_mfma_f32_16x16x32_bf16 v[152:155], v[116:119], v[76:79], v[152:155]
    v_min_u32 v42, -2, v42
    v_min_u32 v43, -2, v43
    buffer_store_dwordx4 v[40:43], v5, s[16:19], s58 offen offset:2048 sc0 sc1
    v_mfma_f32_16x16x32_bf16 v[148:151], v[112:115], v[76:79], v[148:151]
    v_perm_b32 v44, v179, v177, s57
    v_perm_b32 v45, v183, v181, s57
    v_mfma_f32_16x16x32_bf16 v[144:147], v[108:111], v[76:79], v[144:147]
    v_perm_b32 v46, v187, v185, s57
    v_perm_b32 v47, v191, v189, s57
    v_mfma_f32_16x16x32_bf16 v[140:143], v[104:107], v[76:79], v[140:143]
    v_min_u32 v44, -2, v44
    v_min_u32 v45, -2, v45
    v_mfma_f32_16x16x32_bf16 v[164:167], v[124:127], v[80:83], v[164:167]
    v_min_u32 v46, -2, v46
    v_min_u32 v47, -2, v47
    buffer_store_dwordx4 v[44:47], v5, s[16:19], s58 offen offset:3072 sc0 sc1
    v_mfma_f32_16x16x32_bf16 v[160:163], v[120:123], v[80:83], v[160:163]
    v_mfma_f32_16x16x32_bf16 v[156:159], v[116:119], v[80:83], v[156:159]
    v_mfma_f32_16x16x32_bf16 v[152:155], v[112:115], v[80:83], v[152:155]
    v_mfma_f32_16x16x32_bf16 v[148:151], v[108:111], v[80:83], v[148:151]
    v_mfma_f32_16x16x32_bf16 v[144:147], v[104:107], v[80:83], v[144:147]
    v_mfma_f32_16x16x32_bf16 v[164:167], v[120:123], v[84:87], v[164:167]
    v_mfma_f32_16x16x32_bf16 v[160:163], v[116:119], v[84:87], v[160:163]
    v_mfma_f32_16x16x32_bf16 v[156:159], v[112:115], v[84:87], v[156:159]
    v_mfma_f32_16x16x32_bf16 v[152:155], v[108:111], v[84:87], v[152:155]
    v_mfma_f32_16x16x32_bf16 v[148:151], v[104:107], v[84:87], v[148:151]
    v_mfma_f32_16x16x32_bf16 v[164:167], v[116:119], v[88:91], v[164:167]
    v_mfma_f32_16x16x32_bf16 v[160:163], v[112:115], v[88:91], v[160:163]
    v_mfma_f32_16x16x32_bf16 v[156:159], v[108:111], v[88:91], v[156:159]
    v_mfma_f32_16x16x32_bf16 v[152:155], v[104:107], v[88:91], v[152:155]
    v_mfma_f32_16x16x32_bf16 v[164:167], v[112:115], v[92:95], v[164:167]
    v_mfma_f32_16x16x32_bf16 v[160:163], v[108:111], v[92:95], v[160:163]
    v_mfma_f32_16x16x32_bf16 v[156:159], v[104:107], v[92:95], v[156:159]
    v_mfma_f32_16x16x32_bf16 v[164:167], v[108:111], v[96:99], v[164:167]
    v_mfma_f32_16x16x32_bf16 v[160:163], v[104:107], v[96:99], v[160:163]
    v_mfma_f32_16x16x32_bf16 v[164:167], v[104:107], v[100:103], v[164:167]
    s_nop 7
    s_nop 3
    ds_write_b128 v17, v[136:139] offset:0
    ds_write_b128 v17, v[140:143] offset:1024
    ds_write_b128 v17, v[144:147] offset:2048
    ds_write_b128 v17, v[148:151] offset:3072
    ds_write_b128 v18, v[152:155] offset:0
    ds_write_b128 v18, v[156:159] offset:1024
    ds_write_b128 v18, v[160:163] offset:2048
    ds_write_b128 v18, v[164:167] offset:3072
    s_waitcnt lgkmcnt(0)
    s_barrier
    s_and_b32 s42, s22, 3
    s_lshl_b32 s42, s42, 10
    s_mul_i32 s43, s33, 78400
    s_add_u32 s42, s42, s43
    s_add_u32 s42, s42, 37184
    v_add_u32 v19, s42, v5
    ds_read_b128 v[104:107], v19 offset:0
    ds_read_b128 v[108:111], v19 offset:4128
    ds_read_b128 v[112:115], v19 offset:8256
    ds_read_b128 v[116:119], v19 offset:12384
    ds_read_b128 v[120:123], v19 offset:16512
    ds_read_b128 v[124:127], v19 offset:20640
    ds_read_b128 v[128:131], v19 offset:24768
    ds_read_b128 v[132:135], v19 offset:28896
    s_waitcnt lgkmcnt(0)
    v_pk_add_f32 v[104:105], v[104:105], v[108:109]
    v_pk_add_f32 v[106:107], v[106:107], v[110:111]
    v_pk_add_f32 v[104:105], v[104:105], v[112:113]
    v_pk_add_f32 v[106:107], v[106:107], v[114:115]
    v_pk_add_f32 v[104:105], v[104:105], v[116:117]
    v_pk_add_f32 v[106:107], v[106:107], v[118:119]
    v_pk_add_f32 v[104:105], v[104:105], v[120:121]
    v_pk_add_f32 v[106:107], v[106:107], v[122:123]
    v_pk_add_f32 v[104:105], v[104:105], v[124:125]
    v_pk_add_f32 v[106:107], v[106:107], v[126:127]
    v_pk_add_f32 v[104:105], v[104:105], v[128:129]
    v_pk_add_f32 v[106:107], v[106:107], v[130:131]
    v_pk_add_f32 v[104:105], v[104:105], v[132:133]
    v_pk_add_f32 v[106:107], v[106:107], v[134:135]
    v_cvt_pk_bf16_f32 v52, v104, v105
    v_cvt_pk_bf16_f32 v53, v106, v107
    v_min_u32 v52, -2, v52
    v_min_u32 v53, -2, v53
    buffer_store_dwordx2 v[52:53], v21, s[16:19], s59 offen sc0 sc1
    s_endpgm
.section .rodata,"a"
.p2align 6
.amdhsa_kernel fused_kernel
  .amdhsa_next_free_vgpr 256
  .amdhsa_next_free_sgpr 102
  .amdhsa_accum_offset 256
  .amdhsa_group_segment_fixed_size 0
  .amdhsa_kernarg_size 112
  .amdhsa_user_sgpr_count 2
  .amdhsa_user_sgpr_kernarg_segment_ptr 1
  .amdhsa_system_sgpr_workgroup_id_x 1
  .amdhsa_float_denorm_mode_32 3
  .amdhsa_float_denorm_mode_16_64 3
.end_amdhsa_kernel
```
